```python
import torch

def _softmax(x, axis=-1):
    return torch.softmax(x, dim=axis)

def _gelu(x):
    return torch.nn.functional.gelu(x, approximate='tanh')

def _silu(x):
    return torch.nn.functional.silu(x)

def _sigmoid(x):
    return torch.sigmoid(x)

def _layernorm(x, axis=-1, eps=1e-05):
    m = x.mean(dim=axis, keepdim=True)
    v = x.var(dim=axis, keepdim=True, unbiased=False)
    return (x - m) / torch.sqrt(v + eps)

def _scatter_add(tgt, idx, src, axis=0):
    return tgt.clone().index_add_(axis, idx, src)

def _segment_sum(src, seg, n):
    out = torch.zeros((n,) + src.shape[1:], dtype=src.dtype)
    return out.index_add_(0, seg, src)

def _pad(x, pw):
    flat = tuple((v for pair in reversed(pw) for v in pair))
    return torch.nn.functional.pad(x, flat)
kernel_name = 'adaLN_cond__mha_block_cached__geglu_ffn__prompt'

def setup_inputs():

    _w = lambda a: (lambda t: t.to(torch.bfloat16) if t.is_floating_point() else t)(torch.as_tensor(a))

    def _A_setup():
        B, Sq, D = (1, 2048, 512)
        H, Sk, Dh = (32, 2048, 128)
        return {'x': _w((lambda *s: torch.randn(*s, dtype=torch.bfloat16) * 0.1)(B, Sq, D)), 'k_cache': _w((lambda *s: torch.randn(*s, dtype=torch.bfloat16) * 0.8)(B, H, Sk, Dh)), 'v_cache': _w((lambda *s: torch.randn(*s, dtype=torch.bfloat16) * 1.6)(B, H, Sk, Dh)), 'wq': _w((lambda *s: torch.randn(*s, dtype=torch.bfloat16) * 0.8)(D, H * Dh) * D ** (-0.5)), 'wo': _w((lambda *s: torch.randn(*s, dtype=torch.bfloat16) * 1.6)(H * Dh, D) * (H * Dh) ** (-0.5))}
    _A_in = _A_setup()

    def _B_setup():
        B, S, D, F = (1, 2048, 512, 1792)
        return {'x': _w((lambda *s: torch.randn(*s, dtype=torch.bfloat16) * 0.1)(B, S, D)), 'w_gate': _w((lambda *s: torch.randn(*s, dtype=torch.bfloat16) * 0.1)(D, F)), 'w_up': _w((lambda *s: torch.randn(*s, dtype=torch.bfloat16) * 0.1)(D, F)), 'w_down': _w((lambda *s: torch.randn(*s, dtype=torch.bfloat16) * 0.1)(F, D))}
    _B_in = _B_setup()
    return {'A_x': _A_in['x'], 'A_k_cache': _A_in['k_cache'], 'A_v_cache': _A_in['v_cache'], 'A_wq': _A_in['wq'], 'A_wo': _A_in['wo'], 'B_x': _B_in['x'], 'B_w_gate': _B_in['w_gate'], 'B_w_up': _B_in['w_up'], 'B_w_down': _B_in['w_down'], 'c': _w((lambda *s: torch.randn(*s, dtype=torch.bfloat16) * 0.8)(1, 512) * 8.0), 'w_mod': _w((lambda *s: torch.randn(*s, dtype=torch.bfloat16) * 0.8)(512, 6 * 512) * 512 ** (-0.5) * 8.0)}

def reference(A_x, A_k_cache, A_v_cache, A_wq, A_wo, B_x, B_w_gate, B_w_up, B_w_down, c, w_mod):

    def _A_ref(x, k_cache, v_cache, wq, wo):
        B, Sq, D = x.shape
        H, Dh = (32, 128)
        q = (lambda x, *d: x.permute(*d))((x @ wq).reshape(B, Sq, H, Dh), 0, 2, 1, 3)
        scores = torch.einsum('bhqd,bhkd->bhqk', q, k_cache) * Dh ** (-0.5)
        p = _softmax(scores, axis=-1)
        o = torch.einsum('bhqk,bhkd->bhqd', p, v_cache)
        return (lambda x, *d: x.permute(*d))(o, 0, 2, 1, 3).reshape(B, Sq, H * Dh) @ wo

    def _B_ref(x, w_gate, w_up, w_down):
        return _gelu(x @ w_gate) * (x @ w_up) @ w_down
    x = A_x
    mod = (_silu(c) @ w_mod).reshape(c.shape[0], 6, 1, -1)
    sa, ca, ga, sb, cb, gb = (mod[:, 0].clone(), mod[:, 1].clone(), mod[:, 2].clone(), mod[:, 3].clone(), mod[:, 4].clone(), mod[:, 5].clone())
    h = _layernorm(x, axis=-1) * (1 + ca) + sa
    x = x + ga * _A_ref(h, A_k_cache, A_v_cache, A_wq, A_wo)
    h = _layernorm(x, axis=-1) * (1 + cb) + sb
    x = x + gb * _B_ref(h, B_w_gate, B_w_up, B_w_down)
    return x
```

```asm
; @launch kernel=k0_kernel grid=(353,1,1) block=(256,1,1) lds=9216
; @launch kernel=attn_kernel grid=(256,1,1) block=(256,1,1) lds=163840
.amdgcn_target "amdgcn-amd-amdhsa--gfx950"
.text
.globl k0_kernel
.p2align 8
.type k0_kernel,@function
k0_kernel:
    s_cmp_ge_u32 s2, 353
    s_cbranch_scc1 k0_end
    s_cmp_ge_u32 s2, 352
    s_cbranch_scc1 k0_pf
    s_load_dwordx2 s[8:9], s[0:1], 104
    s_load_dwordx2 s[10:11], s[0:1], 96
    s_cmp_ge_u32 s2, 96
    s_cbranch_scc1 k0_ln
    s_load_dwordx2 s[4:5], s[0:1], 72
    s_load_dwordx2 s[6:7], s[0:1], 80
    v_and_b32 v1, 3, v0
    v_lshrrev_b32 v2, 2, v0
    v_lshlrev_b32 v3, 1, v2
    v_mul_u32_u24 v4, 6144, v2
    v_lshl_add_u32 v4, v1, 4, v4
    s_lshl_b32 s3, s2, 6
    s_waitcnt lgkmcnt(0)
    s_mov_b32 s12, s4
    s_mov_b32 s13, s5
    s_mov_b32 s14, 0x400
    s_mov_b32 s15, 0x00020000
    s_mov_b32 s16, s6
    s_mov_b32 s17, s7
    s_mov_b32 s18, 0x300000
    s_mov_b32 s19, 0x00020000
    s_mov_b32 s20, s8
    s_mov_b32 s21, s9
    s_mov_b32 s22, 0x3000
    s_mov_b32 s23, 0x00020000
    s_mov_b32 s28, s10
    s_mov_b32 s29, s11
    s_mov_b32 s30, 0x100
    s_mov_b32 s31, 0x00020000
    buffer_load_ushort v8, v3, s[12:15], 0 offen offset:0
    buffer_load_ushort v9, v3, s[12:15], 0 offen offset:128
    buffer_load_ushort v10, v3, s[12:15], 0 offen offset:256
    buffer_load_ushort v11, v3, s[12:15], 0 offen offset:384
    buffer_load_ushort v12, v3, s[12:15], 0 offen offset:512
    buffer_load_ushort v13, v3, s[12:15], 0 offen offset:640
    buffer_load_ushort v14, v3, s[12:15], 0 offen offset:768
    buffer_load_ushort v15, v3, s[12:15], 0 offen offset:896
    s_add_u32 s24, s3, 0
    buffer_load_dwordx4 v[16:19], v4, s[16:19], s24 offen
    s_add_u32 s24, s3, 393216
    buffer_load_dwordx4 v[20:23], v4, s[16:19], s24 offen
    s_add_u32 s24, s3, 786432
    buffer_load_dwordx4 v[24:27], v4, s[16:19], s24 offen
    s_add_u32 s24, s3, 1179648
    buffer_load_dwordx4 v[28:31], v4, s[16:19], s24 offen
    s_add_u32 s24, s3, 1572864
    buffer_load_dwordx4 v[32:35], v4, s[16:19], s24 offen
    s_add_u32 s24, s3, 1966080
    buffer_load_dwordx4 v[36:39], v4, s[16:19], s24 offen
    s_add_u32 s24, s3, 2359296
    buffer_load_dwordx4 v[40:43], v4, s[16:19], s24 offen
    s_add_u32 s24, s3, 2752512
    buffer_load_dwordx4 v[44:47], v4, s[16:19], s24 offen
    v_mov_b32 v48, 0
    v_mov_b32 v49, 0
    v_mov_b32 v50, 0
    v_mov_b32 v51, 0
    v_mov_b32 v52, 0
    v_mov_b32 v53, 0
    v_mov_b32 v54, 0
    v_mov_b32 v55, 0
    s_waitcnt vmcnt(15)
    v_lshlrev_b32 v8, 16, v8
    v_mul_f32 v5, 0xbfb8aa3b, v8
    v_exp_f32 v5, v5
    s_nop 0
    v_add_f32 v5, 1.0, v5
    v_rcp_f32 v5, v5
    s_nop 0
    v_mul_f32 v8, v8, v5
    v_cvt_pk_bf16_f32 v8, v8, v8
    v_lshlrev_b32 v8, 16, v8
    s_waitcnt vmcnt(14)
    v_lshlrev_b32 v9, 16, v9
    v_mul_f32 v5, 0xbfb8aa3b, v9
    v_exp_f32 v5, v5
    s_nop 0
    v_add_f32 v5, 1.0, v5
    v_rcp_f32 v5, v5
    s_nop 0
    v_mul_f32 v9, v9, v5
    v_cvt_pk_bf16_f32 v9, v9, v9
    v_lshlrev_b32 v9, 16, v9
    s_waitcnt vmcnt(13)
    v_lshlrev_b32 v10, 16, v10
    v_mul_f32 v5, 0xbfb8aa3b, v10
    v_exp_f32 v5, v5
    s_nop 0
    v_add_f32 v5, 1.0, v5
    v_rcp_f32 v5, v5
    s_nop 0
    v_mul_f32 v10, v10, v5
    v_cvt_pk_bf16_f32 v10, v10, v10
    v_lshlrev_b32 v10, 16, v10
    s_waitcnt vmcnt(12)
    v_lshlrev_b32 v11, 16, v11
    v_mul_f32 v5, 0xbfb8aa3b, v11
    v_exp_f32 v5, v5
    s_nop 0
    v_add_f32 v5, 1.0, v5
    v_rcp_f32 v5, v5
    s_nop 0
    v_mul_f32 v11, v11, v5
    v_cvt_pk_bf16_f32 v11, v11, v11
    v_lshlrev_b32 v11, 16, v11
    s_waitcnt vmcnt(11)
    v_lshlrev_b32 v12, 16, v12
    v_mul_f32 v5, 0xbfb8aa3b, v12
    v_exp_f32 v5, v5
    s_nop 0
    v_add_f32 v5, 1.0, v5
    v_rcp_f32 v5, v5
    s_nop 0
    v_mul_f32 v12, v12, v5
    v_cvt_pk_bf16_f32 v12, v12, v12
    v_lshlrev_b32 v12, 16, v12
    s_waitcnt vmcnt(10)
    v_lshlrev_b32 v13, 16, v13
    v_mul_f32 v5, 0xbfb8aa3b, v13
    v_exp_f32 v5, v5
    s_nop 0
    v_add_f32 v5, 1.0, v5
    v_rcp_f32 v5, v5
    s_nop 0
    v_mul_f32 v13, v13, v5
    v_cvt_pk_bf16_f32 v13, v13, v13
    v_lshlrev_b32 v13, 16, v13
    s_waitcnt vmcnt(9)
    v_lshlrev_b32 v14, 16, v14
    v_mul_f32 v5, 0xbfb8aa3b, v14
    v_exp_f32 v5, v5
    s_nop 0
    v_add_f32 v5, 1.0, v5
    v_rcp_f32 v5, v5
    s_nop 0
    v_mul_f32 v14, v14, v5
    v_cvt_pk_bf16_f32 v14, v14, v14
    v_lshlrev_b32 v14, 16, v14
    s_waitcnt vmcnt(8)
    v_lshlrev_b32 v15, 16, v15
    v_mul_f32 v5, 0xbfb8aa3b, v15
    v_exp_f32 v5, v5
    s_nop 0
    v_add_f32 v5, 1.0, v5
    v_rcp_f32 v5, v5
    s_nop 0
    v_mul_f32 v15, v15, v5
    v_cvt_pk_bf16_f32 v15, v15, v15
    v_lshlrev_b32 v15, 16, v15
    s_waitcnt vmcnt(7)
    v_lshlrev_b32 v5, 16, v16
    v_and_b32 v6, 0xffff0000, v16
    v_fmac_f32 v48, v8, v5
    v_fmac_f32 v49, v8, v6
    v_lshlrev_b32 v5, 16, v17
    v_and_b32 v6, 0xffff0000, v17
    v_fmac_f32 v50, v8, v5
    v_fmac_f32 v51, v8, v6
    v_lshlrev_b32 v5, 16, v18
    v_and_b32 v6, 0xffff0000, v18
    v_fmac_f32 v52, v8, v5
    v_fmac_f32 v53, v8, v6
    v_lshlrev_b32 v5, 16, v19
    v_and_b32 v6, 0xffff0000, v19
    v_fmac_f32 v54, v8, v5
    v_fmac_f32 v55, v8, v6
    s_waitcnt vmcnt(6)
    v_lshlrev_b32 v5, 16, v20
    v_and_b32 v6, 0xffff0000, v20
    v_fmac_f32 v48, v9, v5
    v_fmac_f32 v49, v9, v6
    v_lshlrev_b32 v5, 16, v21
    v_and_b32 v6, 0xffff0000, v21
    v_fmac_f32 v50, v9, v5
    v_fmac_f32 v51, v9, v6
    v_lshlrev_b32 v5, 16, v22
    v_and_b32 v6, 0xffff0000, v22
    v_fmac_f32 v52, v9, v5
    v_fmac_f32 v53, v9, v6
    v_lshlrev_b32 v5, 16, v23
    v_and_b32 v6, 0xffff0000, v23
    v_fmac_f32 v54, v9, v5
    v_fmac_f32 v55, v9, v6
    s_waitcnt vmcnt(5)
    v_lshlrev_b32 v5, 16, v24
    v_and_b32 v6, 0xffff0000, v24
    v_fmac_f32 v48, v10, v5
    v_fmac_f32 v49, v10, v6
    v_lshlrev_b32 v5, 16, v25
    v_and_b32 v6, 0xffff0000, v25
    v_fmac_f32 v50, v10, v5
    v_fmac_f32 v51, v10, v6
    v_lshlrev_b32 v5, 16, v26
    v_and_b32 v6, 0xffff0000, v26
    v_fmac_f32 v52, v10, v5
    v_fmac_f32 v53, v10, v6
    v_lshlrev_b32 v5, 16, v27
    v_and_b32 v6, 0xffff0000, v27
    v_fmac_f32 v54, v10, v5
    v_fmac_f32 v55, v10, v6
    s_waitcnt vmcnt(4)
    v_lshlrev_b32 v5, 16, v28
    v_and_b32 v6, 0xffff0000, v28
    v_fmac_f32 v48, v11, v5
    v_fmac_f32 v49, v11, v6
    v_lshlrev_b32 v5, 16, v29
    v_and_b32 v6, 0xffff0000, v29
    v_fmac_f32 v50, v11, v5
    v_fmac_f32 v51, v11, v6
    v_lshlrev_b32 v5, 16, v30
    v_and_b32 v6, 0xffff0000, v30
    v_fmac_f32 v52, v11, v5
    v_fmac_f32 v53, v11, v6
    v_lshlrev_b32 v5, 16, v31
    v_and_b32 v6, 0xffff0000, v31
    v_fmac_f32 v54, v11, v5
    v_fmac_f32 v55, v11, v6
    s_waitcnt vmcnt(3)
    v_lshlrev_b32 v5, 16, v32
    v_and_b32 v6, 0xffff0000, v32
    v_fmac_f32 v48, v12, v5
    v_fmac_f32 v49, v12, v6
    v_lshlrev_b32 v5, 16, v33
    v_and_b32 v6, 0xffff0000, v33
    v_fmac_f32 v50, v12, v5
    v_fmac_f32 v51, v12, v6
    v_lshlrev_b32 v5, 16, v34
    v_and_b32 v6, 0xffff0000, v34
    v_fmac_f32 v52, v12, v5
    v_fmac_f32 v53, v12, v6
    v_lshlrev_b32 v5, 16, v35
    v_and_b32 v6, 0xffff0000, v35
    v_fmac_f32 v54, v12, v5
    v_fmac_f32 v55, v12, v6
    s_waitcnt vmcnt(2)
    v_lshlrev_b32 v5, 16, v36
    v_and_b32 v6, 0xffff0000, v36
    v_fmac_f32 v48, v13, v5
    v_fmac_f32 v49, v13, v6
    v_lshlrev_b32 v5, 16, v37
    v_and_b32 v6, 0xffff0000, v37
    v_fmac_f32 v50, v13, v5
    v_fmac_f32 v51, v13, v6
    v_lshlrev_b32 v5, 16, v38
    v_and_b32 v6, 0xffff0000, v38
    v_fmac_f32 v52, v13, v5
    v_fmac_f32 v53, v13, v6
    v_lshlrev_b32 v5, 16, v39
    v_and_b32 v6, 0xffff0000, v39
    v_fmac_f32 v54, v13, v5
    v_fmac_f32 v55, v13, v6
    s_waitcnt vmcnt(1)
    v_lshlrev_b32 v5, 16, v40
    v_and_b32 v6, 0xffff0000, v40
    v_fmac_f32 v48, v14, v5
    v_fmac_f32 v49, v14, v6
    v_lshlrev_b32 v5, 16, v41
    v_and_b32 v6, 0xffff0000, v41
    v_fmac_f32 v50, v14, v5
    v_fmac_f32 v51, v14, v6
    v_lshlrev_b32 v5, 16, v42
    v_and_b32 v6, 0xffff0000, v42
    v_fmac_f32 v52, v14, v5
    v_fmac_f32 v53, v14, v6
    v_lshlrev_b32 v5, 16, v43
    v_and_b32 v6, 0xffff0000, v43
    v_fmac_f32 v54, v14, v5
    v_fmac_f32 v55, v14, v6
    s_waitcnt vmcnt(0)
    v_lshlrev_b32 v5, 16, v44
    v_and_b32 v6, 0xffff0000, v44
    v_fmac_f32 v48, v15, v5
    v_fmac_f32 v49, v15, v6
    v_lshlrev_b32 v5, 16, v45
    v_and_b32 v6, 0xffff0000, v45
    v_fmac_f32 v50, v15, v5
    v_fmac_f32 v51, v15, v6
    v_lshlrev_b32 v5, 16, v46
    v_and_b32 v6, 0xffff0000, v46
    v_fmac_f32 v52, v15, v5
    v_fmac_f32 v53, v15, v6
    v_lshlrev_b32 v5, 16, v47
    v_and_b32 v6, 0xffff0000, v47
    v_fmac_f32 v54, v15, v5
    v_fmac_f32 v55, v15, v6
    v_lshlrev_b32 v5, 7, v2
    v_lshl_add_u32 v5, v1, 5, v5
    ds_write_b128 v5, v[48:51]
    ds_write_b128 v5, v[52:55] offset:16
    s_waitcnt lgkmcnt(0)
    s_barrier
    v_and_b32 v6, 31, v0
    v_lshrrev_b32 v7, 5, v0
    v_lshlrev_b32 v5, 10, v7
    v_lshl_add_u32 v5, v6, 2, v5
    ds_read_b32 v8, v5 offset:0
    ds_read_b32 v9, v5 offset:128
    ds_read_b32 v10, v5 offset:256
    ds_read_b32 v11, v5 offset:384
    ds_read_b32 v12, v5 offset:512
    ds_read_b32 v13, v5 offset:640
    ds_read_b32 v14, v5 offset:768
    ds_read_b32 v15, v5 offset:896
    s_waitcnt lgkmcnt(6)
    v_add_f32 v8, v8, v9
    s_waitcnt lgkmcnt(5)
    v_add_f32 v8, v8, v10
    s_waitcnt lgkmcnt(4)
    v_add_f32 v8, v8, v11
    s_waitcnt lgkmcnt(3)
    v_add_f32 v8, v8, v12
    s_waitcnt lgkmcnt(2)
    v_add_f32 v8, v8, v13
    s_waitcnt lgkmcnt(1)
    v_add_f32 v8, v8, v14
    s_waitcnt lgkmcnt(0)
    v_add_f32 v8, v8, v15
    v_lshlrev_b32 v5, 2, v0
    ds_write_b32 v5, v8 offset:8192
    s_waitcnt lgkmcnt(0)
    s_barrier
    v_readfirstlane_b32 s26, v7
    s_nop 0
    s_cmp_lg_u32 s26, 0
    s_cbranch_scc1 k0_end
    v_lshlrev_b32 v5, 2, v6
    ds_read_b32 v8, v5 offset:8192
    ds_read_b32 v9, v5 offset:8320
    ds_read_b32 v10, v5 offset:8448
    ds_read_b32 v11, v5 offset:8576
    ds_read_b32 v12, v5 offset:8704
    ds_read_b32 v13, v5 offset:8832
    ds_read_b32 v14, v5 offset:8960
    ds_read_b32 v15, v5 offset:9088
    s_waitcnt lgkmcnt(6)
    v_add_f32 v8, v8, v9
    s_waitcnt lgkmcnt(5)
    v_add_f32 v8, v8, v10
    s_waitcnt lgkmcnt(4)
    v_add_f32 v8, v8, v11
    s_waitcnt lgkmcnt(3)
    v_add_f32 v8, v8, v12
    s_waitcnt lgkmcnt(2)
    v_add_f32 v8, v8, v13
    s_waitcnt lgkmcnt(1)
    v_add_f32 v8, v8, v14
    s_waitcnt lgkmcnt(0)
    v_add_f32 v8, v8, v15
    v_cvt_pk_bf16_f32 v8, v8, v8
    v_lshlrev_b32 v8, 16, v8
    s_lshl_b32 s3, s2, 7
    buffer_store_dword v8, v5, s[20:23], s3 offen
    s_endpgm
k0_ln:
    s_load_dwordx2 s[4:5], s[0:1], 0
    s_sub_u32 s3, s2, 96
    v_lshrrev_b32 v2, 6, v0
    v_and_b32 v1, 63, v0
    v_readfirstlane_b32 s25, v2
    s_lshl_b32 s3, s3, 3
    s_lshl_b32 s26, s25, 1
    s_add_u32 s3, s3, s26
    v_lshlrev_b32 v3, 4, v1
    v_lshlrev_b32 v2, 5, v1
    s_waitcnt lgkmcnt(0)
    s_mov_b32 s12, s4
    s_mov_b32 s13, s5
    s_mov_b32 s14, 0x200000
    s_mov_b32 s15, 0x00020000
    s_mov_b32 s16, s8
    s_mov_b32 s17, s9
    s_mov_b32 s18, 0x3000
    s_mov_b32 s19, 0x00020000
    s_add_u32 s20, s8, 0x100000
    s_addc_u32 s21, s9, 0
    s_mov_b32 s22, 0x200000
    s_mov_b32 s23, 0x00020000
    s_mov_b32 s28, s10
    s_mov_b32 s29, s11
    s_mov_b32 s30, 0x100
    s_mov_b32 s31, 0x00020000
    s_lshl_b32 s26, s3, 10
    buffer_load_dwordx4 v[4:7], v3, s[12:15], s26 offen
    buffer_load_dwordx4 v[40:43], v3, s[12:15], s26 offen offset:1024
    s_waitcnt vmcnt(1)
    v_lshlrev_b32 v8, 16, v4
    v_and_b32 v9, 0xffff0000, v4
    v_lshlrev_b32 v10, 16, v5
    v_and_b32 v11, 0xffff0000, v5
    v_lshlrev_b32 v12, 16, v6
    v_and_b32 v13, 0xffff0000, v6
    v_lshlrev_b32 v14, 16, v7
    v_and_b32 v15, 0xffff0000, v7
    v_add_f32 v16, v8, v9
    v_add_f32 v16, v16, v10
    v_add_f32 v16, v16, v11
    v_add_f32 v16, v16, v12
    v_add_f32 v16, v16, v13
    v_add_f32 v16, v16, v14
    v_add_f32 v16, v16, v15
    s_nop 1
    v_add_f32_dpp v16, v16, v16 quad_perm:[1,0,3,2] row_mask:0xf bank_mask:0xf
    s_nop 1
    v_add_f32_dpp v16, v16, v16 quad_perm:[2,3,0,1] row_mask:0xf bank_mask:0xf
    s_nop 1
    v_add_f32_dpp v16, v16, v16 row_half_mirror row_mask:0xf bank_mask:0xf
    s_nop 1
    v_add_f32_dpp v16, v16, v16 row_mirror row_mask:0xf bank_mask:0xf
    v_mov_b32 v18, v16
    s_nop 1
    v_permlane16_swap_b32 v16, v18
    v_add_f32 v16, v16, v18
    v_mov_b32 v18, v16
    s_nop 1
    v_permlane32_swap_b32 v16, v18
    v_add_f32 v16, v16, v18
    v_mul_f32 v16, 0x3b000000, v16
    v_sub_f32 v18, v8, v16
    v_mul_f32 v17, v18, v18
    v_sub_f32 v18, v9, v16
    v_fmac_f32 v17, v18, v18
    v_sub_f32 v18, v10, v16
    v_fmac_f32 v17, v18, v18
    v_sub_f32 v18, v11, v16
    v_fmac_f32 v17, v18, v18
    v_sub_f32 v18, v12, v16
    v_fmac_f32 v17, v18, v18
    v_sub_f32 v18, v13, v16
    v_fmac_f32 v17, v18, v18
    v_sub_f32 v18, v14, v16
    v_fmac_f32 v17, v18, v18
    v_sub_f32 v18, v15, v16
    v_fmac_f32 v17, v18, v18
    s_nop 1
    v_add_f32_dpp v17, v17, v17 quad_perm:[1,0,3,2] row_mask:0xf bank_mask:0xf
    s_nop 1
    v_add_f32_dpp v17, v17, v17 quad_perm:[2,3,0,1] row_mask:0xf bank_mask:0xf
    s_nop 1
    v_add_f32_dpp v17, v17, v17 row_half_mirror row_mask:0xf bank_mask:0xf
    s_nop 1
    v_add_f32_dpp v17, v17, v17 row_mirror row_mask:0xf bank_mask:0xf
    v_mov_b32 v18, v17
    s_nop 1
    v_permlane16_swap_b32 v17, v18
    v_add_f32 v17, v17, v18
    v_mov_b32 v18, v17
    s_nop 1
    v_permlane32_swap_b32 v17, v18
    v_add_f32 v17, v17, v18
    v_mul_f32 v17, 0x3b000000, v17
    v_cvt_pk_bf16_f32 v16, v16, v16
    v_lshlrev_b32 v16, 16, v16
    v_cvt_pk_bf16_f32 v17, v17, v17
    v_lshlrev_b32 v17, 16, v17
    v_add_f32 v17, 0x3727c5ac, v17
    v_cvt_pk_bf16_f32 v17, v17, v17
    v_lshlrev_b32 v17, 16, v17
    v_sqrt_f32 v17, v17
    s_nop 0
    v_cvt_pk_bf16_f32 v17, v17, v17
    v_lshlrev_b32 v17, 16, v17
    v_rcp_f32 v18, v17
    v_sub_f32 v8, v8, v16
    v_sub_f32 v9, v9, v16
    v_cvt_pk_bf16_f32 v19, v8, v9
    v_lshlrev_b32 v8, 16, v19
    v_and_b32 v9, 0xffff0000, v19
    v_mul_f32 v20, v8, v18
    v_fma_f32 v21, -v20, v17, v8
    v_fma_f32 v8, v21, v18, v20
    v_mul_f32 v20, v9, v18
    v_fma_f32 v21, -v20, v17, v9
    v_fma_f32 v9, v21, v18, v20
    v_cvt_pk_bf16_f32 v19, v8, v9
    v_lshlrev_b32 v8, 16, v19
    v_and_b32 v9, 0xffff0000, v19
    v_sub_f32 v10, v10, v16
    v_sub_f32 v11, v11, v16
    v_cvt_pk_bf16_f32 v19, v10, v11
    v_lshlrev_b32 v10, 16, v19
    v_and_b32 v11, 0xffff0000, v19
    v_mul_f32 v20, v10, v18
    v_fma_f32 v21, -v20, v17, v10
    v_fma_f32 v10, v21, v18, v20
    v_mul_f32 v20, v11, v18
    v_fma_f32 v21, -v20, v17, v11
    v_fma_f32 v11, v21, v18, v20
    v_cvt_pk_bf16_f32 v19, v10, v11
    v_lshlrev_b32 v10, 16, v19
    v_and_b32 v11, 0xffff0000, v19
    v_sub_f32 v12, v12, v16
    v_sub_f32 v13, v13, v16
    v_cvt_pk_bf16_f32 v19, v12, v13
    v_lshlrev_b32 v12, 16, v19
    v_and_b32 v13, 0xffff0000, v19
    v_mul_f32 v20, v12, v18
    v_fma_f32 v21, -v20, v17, v12
    v_fma_f32 v12, v21, v18, v20
    v_mul_f32 v20, v13, v18
    v_fma_f32 v21, -v20, v17, v13
    v_fma_f32 v13, v21, v18, v20
    v_cvt_pk_bf16_f32 v19, v12, v13
    v_lshlrev_b32 v12, 16, v19
    v_and_b32 v13, 0xffff0000, v19
    v_sub_f32 v14, v14, v16
    v_sub_f32 v15, v15, v16
    v_cvt_pk_bf16_f32 v19, v14, v15
    v_lshlrev_b32 v14, 16, v19
    v_and_b32 v15, 0xffff0000, v19
    v_mul_f32 v20, v14, v18
    v_fma_f32 v21, -v20, v17, v14
    v_fma_f32 v14, v21, v18, v20
    v_mul_f32 v20, v15, v18
    v_fma_f32 v21, -v20, v17, v15
    v_fma_f32 v15, v21, v18, v20
    v_cvt_pk_bf16_f32 v19, v14, v15
    v_lshlrev_b32 v14, 16, v19
    v_and_b32 v15, 0xffff0000, v19
    s_waitcnt vmcnt(0)
    v_lshlrev_b32 v44, 16, v40
    v_and_b32 v45, 0xffff0000, v40
    v_lshlrev_b32 v46, 16, v41
    v_and_b32 v47, 0xffff0000, v41
    v_lshlrev_b32 v48, 16, v42
    v_and_b32 v49, 0xffff0000, v42
    v_lshlrev_b32 v50, 16, v43
    v_and_b32 v51, 0xffff0000, v43
    v_add_f32 v16, v44, v45
    v_add_f32 v16, v16, v46
    v_add_f32 v16, v16, v47
    v_add_f32 v16, v16, v48
    v_add_f32 v16, v16, v49
    v_add_f32 v16, v16, v50
    v_add_f32 v16, v16, v51
    s_nop 1
    v_add_f32_dpp v16, v16, v16 quad_perm:[1,0,3,2] row_mask:0xf bank_mask:0xf
    s_nop 1
    v_add_f32_dpp v16, v16, v16 quad_perm:[2,3,0,1] row_mask:0xf bank_mask:0xf
    s_nop 1
    v_add_f32_dpp v16, v16, v16 row_half_mirror row_mask:0xf bank_mask:0xf
    s_nop 1
    v_add_f32_dpp v16, v16, v16 row_mirror row_mask:0xf bank_mask:0xf
    v_mov_b32 v18, v16
    s_nop 1
    v_permlane16_swap_b32 v16, v18
    v_add_f32 v16, v16, v18
    v_mov_b32 v18, v16
    s_nop 1
    v_permlane32_swap_b32 v16, v18
    v_add_f32 v16, v16, v18
    v_mul_f32 v16, 0x3b000000, v16
    v_sub_f32 v18, v44, v16
    v_mul_f32 v17, v18, v18
    v_sub_f32 v18, v45, v16
    v_fmac_f32 v17, v18, v18
    v_sub_f32 v18, v46, v16
    v_fmac_f32 v17, v18, v18
    v_sub_f32 v18, v47, v16
    v_fmac_f32 v17, v18, v18
    v_sub_f32 v18, v48, v16
    v_fmac_f32 v17, v18, v18
    v_sub_f32 v18, v49, v16
    v_fmac_f32 v17, v18, v18
    v_sub_f32 v18, v50, v16
    v_fmac_f32 v17, v18, v18
    v_sub_f32 v18, v51, v16
    v_fmac_f32 v17, v18, v18
    s_nop 1
    v_add_f32_dpp v17, v17, v17 quad_perm:[1,0,3,2] row_mask:0xf bank_mask:0xf
    s_nop 1
    v_add_f32_dpp v17, v17, v17 quad_perm:[2,3,0,1] row_mask:0xf bank_mask:0xf
    s_nop 1
    v_add_f32_dpp v17, v17, v17 row_half_mirror row_mask:0xf bank_mask:0xf
    s_nop 1
    v_add_f32_dpp v17, v17, v17 row_mirror row_mask:0xf bank_mask:0xf
    v_mov_b32 v18, v17
    s_nop 1
    v_permlane16_swap_b32 v17, v18
    v_add_f32 v17, v17, v18
    v_mov_b32 v18, v17
    s_nop 1
    v_permlane32_swap_b32 v17, v18
    v_add_f32 v17, v17, v18
    v_mul_f32 v17, 0x3b000000, v17
    v_cvt_pk_bf16_f32 v16, v16, v16
    v_lshlrev_b32 v16, 16, v16
    v_cvt_pk_bf16_f32 v17, v17, v17
    v_lshlrev_b32 v17, 16, v17
    v_add_f32 v17, 0x3727c5ac, v17
    v_cvt_pk_bf16_f32 v17, v17, v17
    v_lshlrev_b32 v17, 16, v17
    v_sqrt_f32 v17, v17
    s_nop 0
    v_cvt_pk_bf16_f32 v17, v17, v17
    v_lshlrev_b32 v17, 16, v17
    v_rcp_f32 v18, v17
    v_sub_f32 v44, v44, v16
    v_sub_f32 v45, v45, v16
    v_cvt_pk_bf16_f32 v19, v44, v45
    v_lshlrev_b32 v44, 16, v19
    v_and_b32 v45, 0xffff0000, v19
    v_mul_f32 v20, v44, v18
    v_fma_f32 v21, -v20, v17, v44
    v_fma_f32 v44, v21, v18, v20
    v_mul_f32 v20, v45, v18
    v_fma_f32 v21, -v20, v17, v45
    v_fma_f32 v45, v21, v18, v20
    v_cvt_pk_bf16_f32 v19, v44, v45
    v_lshlrev_b32 v44, 16, v19
    v_and_b32 v45, 0xffff0000, v19
    v_sub_f32 v46, v46, v16
    v_sub_f32 v47, v47, v16
    v_cvt_pk_bf16_f32 v19, v46, v47
    v_lshlrev_b32 v46, 16, v19
    v_and_b32 v47, 0xffff0000, v19
    v_mul_f32 v20, v46, v18
    v_fma_f32 v21, -v20, v17, v46
    v_fma_f32 v46, v21, v18, v20
    v_mul_f32 v20, v47, v18
    v_fma_f32 v21, -v20, v17, v47
    v_fma_f32 v47, v21, v18, v20
    v_cvt_pk_bf16_f32 v19, v46, v47
    v_lshlrev_b32 v46, 16, v19
    v_and_b32 v47, 0xffff0000, v19
    v_sub_f32 v48, v48, v16
    v_sub_f32 v49, v49, v16
    v_cvt_pk_bf16_f32 v19, v48, v49
    v_lshlrev_b32 v48, 16, v19
    v_and_b32 v49, 0xffff0000, v19
    v_mul_f32 v20, v48, v18
    v_fma_f32 v21, -v20, v17, v48
    v_fma_f32 v48, v21, v18, v20
    v_mul_f32 v20, v49, v18
    v_fma_f32 v21, -v20, v17, v49
    v_fma_f32 v49, v21, v18, v20
    v_cvt_pk_bf16_f32 v19, v48, v49
    v_lshlrev_b32 v48, 16, v19
    v_and_b32 v49, 0xffff0000, v19
    v_sub_f32 v50, v50, v16
    v_sub_f32 v51, v51, v16
    v_cvt_pk_bf16_f32 v19, v50, v51
    v_lshlrev_b32 v50, 16, v19
    v_and_b32 v51, 0xffff0000, v19
    v_mul_f32 v20, v50, v18
    v_fma_f32 v21, -v20, v17, v50
    v_fma_f32 v50, v21, v18, v20
    v_mul_f32 v20, v51, v18
    v_fma_f32 v21, -v20, v17, v51
    v_fma_f32 v51, v21, v18, v20
    v_cvt_pk_bf16_f32 v19, v50, v51
    v_lshlrev_b32 v50, 16, v19
    v_and_b32 v51, 0xffff0000, v19
    v_lshrrev_b32 v22, 1, v1
    v_lshlrev_b32 v22, 10, v22
    v_and_b32 v23, 1, v1
    v_lshl_add_u32 v22, v23, 9, v22
    s_lshr_b32 s26, s3, 5
    s_lshl_b32 s26, s26, 15
    s_and_b32 s27, s3, 31
    s_lshl_b32 s27, s27, 4
    s_add_u32 s26, s26, s27
    v_cvt_pk_bf16_f32 v4, v8, v9
    v_cvt_pk_bf16_f32 v5, v10, v11
    v_cvt_pk_bf16_f32 v6, v12, v13
    v_cvt_pk_bf16_f32 v7, v14, v15
    v_cvt_pk_bf16_f32 v40, v44, v45
    v_cvt_pk_bf16_f32 v41, v46, v47
    v_cvt_pk_bf16_f32 v42, v48, v49
    v_cvt_pk_bf16_f32 v43, v50, v51
    buffer_store_dwordx4 v[4:7], v22, s[20:23], s26 offen
    buffer_store_dwordx4 v[40:43], v22, s[20:23], s26 offen offset:16
k0_end:
    s_endpgm
k0_pf:
    s_load_dwordx4 s[4:7], s[0:1], 24
    s_load_dwordx4 s[8:11], s[0:1], 48
    s_load_dwordx2 s[12:13], s[0:1], 64
    s_load_dwordx2 s[14:15], s[0:1], 104
    s_sub_u32 s3, s2, 352
    v_lshlrev_b32 v1, 4, v0
    s_waitcnt lgkmcnt(0)
    s_cmp_lg_u32 s3, 0
    s_cbranch_scc1 k0_pf2
    s_add_u32 s16, s14, 0x80000
    s_addc_u32 s17, s15, 0
    s_mov_b32 s18, 0x4000
    s_mov_b32 s19, 0x00020000
    v_mov_b32 v4, 0
    v_mov_b32 v5, 0
    v_mov_b32 v6, 0
    v_mov_b32 v7, 0
    s_mov_b32 s20, 0
    buffer_store_dwordx4 v[4:7], v1, s[16:19], s20 offen
    s_mov_b32 s20, 4096
    buffer_store_dwordx4 v[4:7], v1, s[16:19], s20 offen
    s_mov_b32 s20, 8192
    buffer_store_dwordx4 v[4:7], v1, s[16:19], s20 offen
    s_mov_b32 s20, 12288
    buffer_store_dwordx4 v[4:7], v1, s[16:19], s20 offen
    s_waitcnt vmcnt(0)
k0_pf2:
    s_endpgm
.globl attn_kernel
.p2align 8
.type attn_kernel,@function
attn_kernel:
    s_cmp_ge_u32 s2, 256
    s_cbranch_scc1 attn_end
    s_load_dwordx4 s[28:31], s[0:1], 8
    s_load_dwordx2 s[32:33], s[0:1], 24
    s_load_dwordx2 s[34:35], s[0:1], 104
    v_lshrrev_b32 v236, 6, v0
    v_and_b32 v222, 63, v0
    v_readfirstlane_b32 s3, v236
    s_and_b32 s4, s2, 7
    s_lshr_b32 s5, s2, 6
    s_lshl_b32 s4, s4, 2
    s_add_u32 s4, s4, s5
    s_lshr_b32 s5, s2, 3
    s_and_b32 s5, s5, 7
    v_and_b32 v232, 15, v222
    v_lshrrev_b32 v233, 4, v222
    v_bfe_u32 v234, v222, 2, 2
    v_and_b32 v235, 3, v222
    s_waitcnt lgkmcnt(0)
    s_lshl_b32 s6, s4, 19
    s_add_u32 s8, s28, s6
    s_addc_u32 s9, s29, 0
    s_mov_b32 s10, 0x80000
    s_mov_b32 s11, 0x00020000
    s_add_u32 s12, s30, s6
    s_addc_u32 s13, s31, 0
    s_mov_b32 s14, 0x80000
    s_mov_b32 s15, 0x00020000
    s_lshl_b32 s6, s4, 8
    s_sub_u32 s7, 0x400000, s6
    s_add_u32 s16, s32, s6
    s_addc_u32 s17, s33, 0
    s_mov_b32 s18, s7
    s_mov_b32 s19, 0x00020000
    s_lshl_b32 s7, s5, 18
    s_add_u32 s7, s7, 0x100000
    s_add_u32 s20, s34, s7
    s_addc_u32 s21, s35, 0
    s_mov_b32 s22, 0x40000
    s_mov_b32 s23, 0x00020000
    s_lshl_b32 s7, s5, 21
    s_lshl_b32 s6, s4, 15
    s_add_u32 s7, s7, s6
    s_add_u32 s7, s7, 0x400000
    s_sub_u32 s36, 0x200000, s6
    s_add_u32 s24, s34, s7
    s_addc_u32 s25, s35, 0
    s_mov_b32 s26, s36
    s_mov_b32 s27, 0x00020000
    s_mov_b32 s52, s34
    s_mov_b32 s53, s35
    s_mov_b32 s54, 0x1000
    s_mov_b32 s55, 0x00020000
    v_lshlrev_b32 v237, 2, v233
    v_xor_b32 v223, v232, v237
    v_lshlrev_b32 v223, 4, v223
    v_lshl_add_u32 v223, v233, 13, v223
    v_add_u32 v237, 0, v233
    v_xor_b32 v240, v232, v237
    v_lshlrev_b32 v240, 4, v240
    v_lshl_add_u32 v240, v233, 8, v240
    v_lshlrev_b32 v237, 1, v237
    v_xor_b32 v244, v232, v237
    v_lshlrev_b32 v244, 4, v244
    v_lshl_add_u32 v244, v233, 8, v244
    v_add_u32 v237, 4, v233
    v_xor_b32 v241, v232, v237
    v_lshlrev_b32 v241, 4, v241
    v_lshl_add_u32 v241, v233, 8, v241
    v_lshlrev_b32 v237, 1, v237
    v_xor_b32 v245, v232, v237
    v_lshlrev_b32 v245, 4, v245
    v_lshl_add_u32 v245, v233, 8, v245
    v_add_u32 v237, 8, v233
    v_xor_b32 v242, v232, v237
    v_lshlrev_b32 v242, 4, v242
    v_lshl_add_u32 v242, v233, 8, v242
    v_add_u32 v237, 12, v233
    v_xor_b32 v243, v232, v237
    v_lshlrev_b32 v243, 4, v243
    v_lshl_add_u32 v243, v233, 8, v243
    s_lshl_b32 s49, s3, 12
    s_lshl_b32 s42, s3, 10
    s_lshl_b32 s38, s3, 15
    s_lshl_b32 s39, s3, 16
    s_mov_b32 s43, s49
    s_mov_b32 s44, s49
    v_lshlrev_b32 v224, 4, v222
    v_lshlrev_b32 v225, 4, v0
    buffer_load_dwordx4 v[176:179], v225, s[52:55], 0 offen
    s_add_u32 m0, s42, 32768
    s_add_u32 s45, s38, 0
    buffer_load_dwordx4 v223, s[16:19], s45 offen lds
    s_add_u32 m0, s42, 36864
    s_add_u32 s45, s38, 131072
    buffer_load_dwordx4 v223, s[16:19], s45 offen lds
    s_add_u32 m0, s42, 40960
    s_add_u32 s45, s38, 262144
    buffer_load_dwordx4 v223, s[16:19], s45 offen lds
    s_add_u32 m0, s42, 45056
    s_add_u32 s45, s38, 393216
    buffer_load_dwordx4 v223, s[16:19], s45 offen lds
    s_add_u32 s38, s38, 524288
    s_add_u32 s47, s39, 0
    buffer_load_dwordx4 v[64:67], v224, s[20:23], s47 offen offset:0
    s_add_u32 s47, s39, 32768
    buffer_load_dwordx4 v[68:71], v224, s[20:23], s47 offen offset:0
    s_add_u32 s47, s39, 0
    buffer_load_dwordx4 v[72:75], v224, s[20:23], s47 offen offset:1024
    s_add_u32 s47, s39, 32768
    buffer_load_dwordx4 v[76:79], v224, s[20:23], s47 offen offset:1024
    s_add_u32 s47, s39, 2048
    buffer_load_dwordx4 v[80:83], v224, s[20:23], s47 offen offset:0
    s_add_u32 s47, s39, 34816
    buffer_load_dwordx4 v[84:87], v224, s[20:23], s47 offen offset:0
    s_add_u32 s47, s39, 2048
    buffer_load_dwordx4 v[88:91], v224, s[20:23], s47 offen offset:1024
    s_add_u32 s47, s39, 34816
    buffer_load_dwordx4 v[92:95], v224, s[20:23], s47 offen offset:1024
    s_add_u32 m0, s42, 49152
    s_add_u32 s45, s38, 0
    buffer_load_dwordx4 v223, s[16:19], s45 offen lds
    s_add_u32 m0, s42, 53248
    s_add_u32 s45, s38, 131072
    buffer_load_dwordx4 v223, s[16:19], s45 offen lds
    s_add_u32 m0, s42, 57344
    s_add_u32 s45, s38, 262144
    buffer_load_dwordx4 v223, s[16:19], s45 offen lds
    s_add_u32 m0, s42, 61440
    s_add_u32 s45, s38, 393216
    buffer_load_dwordx4 v223, s[16:19], s45 offen lds
    s_add_u32 s38, s38, 524288
    s_add_u32 s47, s39, 4096
    buffer_load_dwordx4 v[96:99], v224, s[20:23], s47 offen offset:0
    s_add_u32 s47, s39, 36864
    buffer_load_dwordx4 v[100:103], v224, s[20:23], s47 offen offset:0
    s_add_u32 s47, s39, 4096
    buffer_load_dwordx4 v[104:107], v224, s[20:23], s47 offen offset:1024
    s_add_u32 s47, s39, 36864
    buffer_load_dwordx4 v[108:111], v224, s[20:23], s47 offen offset:1024
    s_add_u32 m0, s42, 65536
    s_add_u32 s45, s38, 0
    buffer_load_dwordx4 v223, s[16:19], s45 offen lds
    s_add_u32 m0, s42, 69632
    s_add_u32 s45, s38, 131072
    buffer_load_dwordx4 v223, s[16:19], s45 offen lds
    s_add_u32 m0, s42, 73728
    s_add_u32 s45, s38, 262144
    buffer_load_dwordx4 v223, s[16:19], s45 offen lds
    s_add_u32 m0, s42, 77824
    s_add_u32 s45, s38, 393216
    buffer_load_dwordx4 v223, s[16:19], s45 offen lds
    s_add_u32 s38, s38, 524288
    v_accvgpr_write_b32 a0, 0
    v_accvgpr_write_b32 a1, 0
    v_accvgpr_write_b32 a2, 0
    v_accvgpr_write_b32 a3, 0
    v_accvgpr_write_b32 a4, 0
    v_accvgpr_write_b32 a5, 0
    v_accvgpr_write_b32 a6, 0
    v_accvgpr_write_b32 a7, 0
    v_accvgpr_write_b32 a8, 0
    v_accvgpr_write_b32 a9, 0
    v_accvgpr_write_b32 a10, 0
    v_accvgpr_write_b32 a11, 0
    v_accvgpr_write_b32 a12, 0
    v_accvgpr_write_b32 a13, 0
    v_accvgpr_write_b32 a14, 0
    v_accvgpr_write_b32 a15, 0
    v_accvgpr_write_b32 a16, 0
    v_accvgpr_write_b32 a17, 0
    v_accvgpr_write_b32 a18, 0
    v_accvgpr_write_b32 a19, 0
    v_accvgpr_write_b32 a20, 0
    v_accvgpr_write_b32 a21, 0
    v_accvgpr_write_b32 a22, 0
    v_accvgpr_write_b32 a23, 0
    v_accvgpr_write_b32 a24, 0
    v_accvgpr_write_b32 a25, 0
    v_accvgpr_write_b32 a26, 0
    v_accvgpr_write_b32 a27, 0
    v_accvgpr_write_b32 a28, 0
    v_accvgpr_write_b32 a29, 0
    v_accvgpr_write_b32 a30, 0
    v_accvgpr_write_b32 a31, 0
    v_accvgpr_write_b32 a32, 0
    v_accvgpr_write_b32 a33, 0
    v_accvgpr_write_b32 a34, 0
    v_accvgpr_write_b32 a35, 0
    v_accvgpr_write_b32 a36, 0
    v_accvgpr_write_b32 a37, 0
    v_accvgpr_write_b32 a38, 0
    v_accvgpr_write_b32 a39, 0
    v_accvgpr_write_b32 a40, 0
    v_accvgpr_write_b32 a41, 0
    v_accvgpr_write_b32 a42, 0
    v_accvgpr_write_b32 a43, 0
    v_accvgpr_write_b32 a44, 0
    v_accvgpr_write_b32 a45, 0
    v_accvgpr_write_b32 a46, 0
    v_accvgpr_write_b32 a47, 0
    v_accvgpr_write_b32 a48, 0
    v_accvgpr_write_b32 a49, 0
    v_accvgpr_write_b32 a50, 0
    v_accvgpr_write_b32 a51, 0
    v_accvgpr_write_b32 a52, 0
    v_accvgpr_write_b32 a53, 0
    v_accvgpr_write_b32 a54, 0
    v_accvgpr_write_b32 a55, 0
    v_accvgpr_write_b32 a56, 0
    v_accvgpr_write_b32 a57, 0
    v_accvgpr_write_b32 a58, 0
    v_accvgpr_write_b32 a59, 0
    v_accvgpr_write_b32 a60, 0
    v_accvgpr_write_b32 a61, 0
    v_accvgpr_write_b32 a62, 0
    v_accvgpr_write_b32 a63, 0
    v_accvgpr_write_b32 a64, 0
    v_accvgpr_write_b32 a65, 0
    v_accvgpr_write_b32 a66, 0
    v_accvgpr_write_b32 a67, 0
    v_accvgpr_write_b32 a68, 0
    v_accvgpr_write_b32 a69, 0
    v_accvgpr_write_b32 a70, 0
    v_accvgpr_write_b32 a71, 0
    v_accvgpr_write_b32 a72, 0
    v_accvgpr_write_b32 a73, 0
    v_accvgpr_write_b32 a74, 0
    v_accvgpr_write_b32 a75, 0
    v_accvgpr_write_b32 a76, 0
    v_accvgpr_write_b32 a77, 0
    v_accvgpr_write_b32 a78, 0
    v_accvgpr_write_b32 a79, 0
    v_accvgpr_write_b32 a80, 0
    v_accvgpr_write_b32 a81, 0
    v_accvgpr_write_b32 a82, 0
    v_accvgpr_write_b32 a83, 0
    v_accvgpr_write_b32 a84, 0
    v_accvgpr_write_b32 a85, 0
    v_accvgpr_write_b32 a86, 0
    v_accvgpr_write_b32 a87, 0
    v_accvgpr_write_b32 a88, 0
    v_accvgpr_write_b32 a89, 0
    v_accvgpr_write_b32 a90, 0
    v_accvgpr_write_b32 a91, 0
    v_accvgpr_write_b32 a92, 0
    v_accvgpr_write_b32 a93, 0
    v_accvgpr_write_b32 a94, 0
    v_accvgpr_write_b32 a95, 0
    v_accvgpr_write_b32 a96, 0
    v_accvgpr_write_b32 a97, 0
    v_accvgpr_write_b32 a98, 0
    v_accvgpr_write_b32 a99, 0
    v_accvgpr_write_b32 a100, 0
    v_accvgpr_write_b32 a101, 0
    v_accvgpr_write_b32 a102, 0
    v_accvgpr_write_b32 a103, 0
    v_accvgpr_write_b32 a104, 0
    v_accvgpr_write_b32 a105, 0
    v_accvgpr_write_b32 a106, 0
    v_accvgpr_write_b32 a107, 0
    v_accvgpr_write_b32 a108, 0
    v_accvgpr_write_b32 a109, 0
    v_accvgpr_write_b32 a110, 0
    v_accvgpr_write_b32 a111, 0
    v_accvgpr_write_b32 a112, 0
    v_accvgpr_write_b32 a113, 0
    v_accvgpr_write_b32 a114, 0
    v_accvgpr_write_b32 a115, 0
    v_accvgpr_write_b32 a116, 0
    v_accvgpr_write_b32 a117, 0
    v_accvgpr_write_b32 a118, 0
    v_accvgpr_write_b32 a119, 0
    v_accvgpr_write_b32 a120, 0
    v_accvgpr_write_b32 a121, 0
    v_accvgpr_write_b32 a122, 0
    v_accvgpr_write_b32 a123, 0
    v_accvgpr_write_b32 a124, 0
    v_accvgpr_write_b32 a125, 0
    v_accvgpr_write_b32 a126, 0
    v_accvgpr_write_b32 a127, 0
    v_cmp_le_u32 vcc, 2048, v225
    s_nop 1
    v_cndmask_b32 v236, 0, 1.0, vcc
    s_mov_b32 s40, 0x3e0293ee
    s_waitcnt vmcnt(24)
    v_add_f32 v176, v176, v236
    v_mul_f32 v176, s40, v176
    v_add_f32 v177, v177, v236
    v_mul_f32 v177, s40, v177
    v_add_f32 v178, v178, v236
    v_mul_f32 v178, s40, v178
    v_add_f32 v179, v179, v236
    v_mul_f32 v179, s40, v179
    v_add_u32 v225, 147456, v225
    ds_write_b128 v225, v[176:179]
    v_lshrrev_b32 v225, 5, v222
    v_lshlrev_b32 v225, 5, v225
    v_add_u32 v225, 147456, v225
    v_lshrrev_b32 v236, 5, v222
    v_lshl_add_u32 v236, v236, 3, v234
    v_lshlrev_b32 v236, 8, v236
    v_and_b32 v237, 1, v235
    v_lshl_add_u32 v236, v237, 5, v236
    v_and_b32 v237, 1, v233
    v_lshl_add_u32 v236, v237, 4, v236
    v_lshrrev_b32 v237, 1, v235
    v_lshl_add_u32 v236, v237, 3, v236
    v_add_u32 v236, 0x8000, v236
    v_xor_b32 v237, 0, v234
    v_lshl_add_u32 v228, v237, 6, v236
    v_xor_b32 v237, 1, v234
    v_lshl_add_u32 v229, v237, 6, v236
    v_xor_b32 v237, 2, v234
    v_lshl_add_u32 v230, v237, 6, v236
    v_xor_b32 v237, 3, v234
    v_lshl_add_u32 v231, v237, 6, v236
    v_xor_b32 v236, v232, v233
    v_lshlrev_b32 v236, 4, v236
    v_lshl_add_u32 v236, v232, 8, v236
    v_xor_b32 v200, 0, v236
    v_xor_b32 v201, 64, v236
    v_xor_b32 v202, 128, v236
    v_xor_b32 v203, 192, v236
    v_lshl_add_u32 v236, v233, 2, v234
    v_and_b32 v237, 7, v236
    v_lshlrev_b32 v236, 8, v236
    v_lshl_add_u32 v236, v237, 5, v236
    v_lshl_add_u32 v236, v235, 3, v236
    v_add_u32 v236, 0x10000, v236
    v_xor_b32 v204, 0, v236
    v_xor_b32 v205, 32, v236
    v_xor_b32 v206, 64, v236
    v_xor_b32 v207, 96, v236
    v_xor_b32 v208, 128, v236
    v_xor_b32 v209, 160, v236
    v_xor_b32 v210, 192, v236
    v_xor_b32 v211, 224, v236
    s_waitcnt vmcnt(8) lgkmcnt(0)
    s_barrier
    ds_read_b128 v[0:3], v225 offset:2048
    ds_read_b128 v[4:7], v225 offset:2064
    ds_read_b128 v[8:11], v225 offset:0
    ds_read_b128 v[12:15], v225 offset:16
    ds_read_b128 v[16:19], v225 offset:2112
    ds_read_b128 v[20:23], v225 offset:2128
    ds_read_b128 v[24:27], v225 offset:64
    ds_read_b128 v[28:31], v225 offset:80
    ds_read_b64_tr_b16 v[128:129], v228 offset:0
    ds_read_b64_tr_b16 v[130:131], v228 offset:1024
    ds_read_b64_tr_b16 v[132:133], v229 offset:0
    ds_read_b64_tr_b16 v[134:135], v229 offset:1024
    ds_read_b64_tr_b16 v[136:137], v230 offset:0
    ds_read_b64_tr_b16 v[138:139], v230 offset:1024
    ds_read_b64_tr_b16 v[140:141], v231 offset:0
    ds_read_b64_tr_b16 v[142:143], v231 offset:1024
    v_lshlrev_b32 v176, 16, v64
    v_and_b32 v177, 0xffff0000, v64
    s_waitcnt lgkmcnt(13)
    v_fma_f32 v176, v176, v0, v8
    v_fma_f32 v177, v177, v1, v9
    v_cvt_pk_bf16_f32 v64, v176, v177
    v_lshlrev_b32 v178, 16, v65
    v_and_b32 v179, 0xffff0000, v65
    v_fma_f32 v178, v178, v2, v10
    v_fma_f32 v179, v179, v3, v11
    v_cvt_pk_bf16_f32 v65, v178, v179
    v_lshlrev_b32 v180, 16, v66
    v_and_b32 v181, 0xffff0000, v66
    s_waitcnt lgkmcnt(12)
    v_fma_f32 v180, v180, v4, v12
    v_fma_f32 v181, v181, v5, v13
    v_cvt_pk_bf16_f32 v66, v180, v181
    v_lshlrev_b32 v182, 16, v67
    v_and_b32 v183, 0xffff0000, v67
    v_fma_f32 v182, v182, v6, v14
    v_fma_f32 v183, v183, v7, v15
    v_cvt_pk_bf16_f32 v67, v182, v183
    v_lshlrev_b32 v176, 16, v68
    v_and_b32 v177, 0xffff0000, v68
    v_fma_f32 v176, v176, v0, v8
    v_fma_f32 v177, v177, v1, v9
    v_cvt_pk_bf16_f32 v68, v176, v177
    v_lshlrev_b32 v178, 16, v69
    v_and_b32 v179, 0xffff0000, v69
    v_fma_f32 v178, v178, v2, v10
    v_fma_f32 v179, v179, v3, v11
    v_cvt_pk_bf16_f32 v69, v178, v179
    v_lshlrev_b32 v180, 16, v70
    v_and_b32 v181, 0xffff0000, v70
    v_fma_f32 v180, v180, v4, v12
    v_fma_f32 v181, v181, v5, v13
    v_cvt_pk_bf16_f32 v70, v180, v181
    v_lshlrev_b32 v182, 16, v71
    v_and_b32 v183, 0xffff0000, v71
    v_fma_f32 v182, v182, v6, v14
    v_fma_f32 v183, v183, v7, v15
    v_cvt_pk_bf16_f32 v71, v182, v183
    v_lshlrev_b32 v176, 16, v72
    v_and_b32 v177, 0xffff0000, v72
    s_waitcnt lgkmcnt(9)
    v_fma_f32 v176, v176, v16, v24
    v_fma_f32 v177, v177, v17, v25
    v_cvt_pk_bf16_f32 v72, v176, v177
    v_lshlrev_b32 v178, 16, v73
    v_and_b32 v179, 0xffff0000, v73
    v_fma_f32 v178, v178, v18, v26
    v_fma_f32 v179, v179, v19, v27
    v_cvt_pk_bf16_f32 v73, v178, v179
    v_lshlrev_b32 v180, 16, v74
    v_and_b32 v181, 0xffff0000, v74
    s_waitcnt lgkmcnt(8)
    v_fma_f32 v180, v180, v20, v28
    v_fma_f32 v181, v181, v21, v29
    v_cvt_pk_bf16_f32 v74, v180, v181
    v_lshlrev_b32 v182, 16, v75
    v_and_b32 v183, 0xffff0000, v75
    v_fma_f32 v182, v182, v22, v30
    v_fma_f32 v183, v183, v23, v31
    v_cvt_pk_bf16_f32 v75, v182, v183
    v_lshlrev_b32 v176, 16, v76
    v_and_b32 v177, 0xffff0000, v76
    v_fma_f32 v176, v176, v16, v24
    v_fma_f32 v177, v177, v17, v25
    v_cvt_pk_bf16_f32 v76, v176, v177
    v_lshlrev_b32 v178, 16, v77
    v_and_b32 v179, 0xffff0000, v77
    v_fma_f32 v178, v178, v18, v26
    v_fma_f32 v179, v179, v19, v27
    v_cvt_pk_bf16_f32 v77, v178, v179
    v_lshlrev_b32 v180, 16, v78
    v_and_b32 v181, 0xffff0000, v78
    v_fma_f32 v180, v180, v20, v28
    v_fma_f32 v181, v181, v21, v29
    v_cvt_pk_bf16_f32 v78, v180, v181
    v_lshlrev_b32 v182, 16, v79
    v_and_b32 v183, 0xffff0000, v79
    v_fma_f32 v182, v182, v22, v30
    v_fma_f32 v183, v183, v23, v31
    v_cvt_pk_bf16_f32 v79, v182, v183
    s_waitcnt lgkmcnt(6)
    v_mfma_f32_32x32x16_bf16 a[128:143], v[128:131], v[64:67], 0
    ds_read_b128 v[0:3], v225 offset:2176
    ds_read_b128 v[4:7], v225 offset:2192
    ds_read_b128 v[8:11], v225 offset:128
    ds_read_b128 v[12:15], v225 offset:144
    ds_read_b128 v[16:19], v225 offset:2240
    ds_read_b128 v[20:23], v225 offset:2256
    ds_read_b128 v[24:27], v225 offset:192
    ds_read_b128 v[28:31], v225 offset:208
    s_add_u32 s47, s39, 6144
    buffer_load_dwordx4 v[112:115], v224, s[20:23], s47 offen offset:0
    v_mfma_f32_32x32x16_bf16 a[192:207], v[128:131], v[68:71], 0
    ds_read_b64_tr_b16 v[144:145], v228 offset:4096
    ds_read_b64_tr_b16 v[146:147], v228 offset:5120
    s_waitcnt lgkmcnt(14)
    v_mfma_f32_32x32x16_bf16 a[144:159], v[132:135], v[64:67], 0
    s_add_u32 s47, s39, 38912
    buffer_load_dwordx4 v[116:119], v224, s[20:23], s47 offen offset:0
    v_mfma_f32_32x32x16_bf16 a[208:223], v[132:135], v[68:71], 0
    ds_read_b64_tr_b16 v[148:149], v229 offset:4096
    ds_read_b64_tr_b16 v[150:151], v229 offset:5120
    s_waitcnt lgkmcnt(14)
    v_mfma_f32_32x32x16_bf16 a[160:175], v[136:139], v[64:67], 0
    s_add_u32 s47, s39, 6144
    buffer_load_dwordx4 v[120:123], v224, s[20:23], s47 offen offset:1024
    v_lshlrev_b32 v176, 16, v80
    v_and_b32 v177, 0xffff0000, v80
    s_waitcnt lgkmcnt(9)
    v_fma_f32 v176, v176, v0, v8
    v_fma_f32 v177, v177, v1, v9
    v_cvt_pk_bf16_f32 v80, v176, v177
    v_lshlrev_b32 v178, 16, v81
    v_and_b32 v179, 0xffff0000, v81
    v_mfma_f32_32x32x16_bf16 a[224:239], v[136:139], v[68:71], 0
    ds_read_b64_tr_b16 v[152:153], v230 offset:4096
    ds_read_b64_tr_b16 v[154:155], v230 offset:5120
    v_fma_f32 v178, v178, v2, v10
    v_fma_f32 v179, v179, v3, v11
    v_cvt_pk_bf16_f32 v81, v178, v179
    v_lshlrev_b32 v180, 16, v82
    v_and_b32 v181, 0xffff0000, v82
    s_waitcnt lgkmcnt(10)
    v_fma_f32 v180, v180, v4, v12
    v_fma_f32 v181, v181, v5, v13
    v_mfma_f32_32x32x16_bf16 a[176:191], v[140:143], v[64:67], 0
    s_add_u32 s47, s39, 38912
    buffer_load_dwordx4 v[124:127], v224, s[20:23], s47 offen offset:1024
    v_cvt_pk_bf16_f32 v82, v180, v181
    v_lshlrev_b32 v182, 16, v83
    v_and_b32 v183, 0xffff0000, v83
    v_fma_f32 v182, v182, v6, v14
    v_fma_f32 v183, v183, v7, v15
    v_cvt_pk_bf16_f32 v83, v182, v183
    v_mfma_f32_32x32x16_bf16 a[240:255], v[140:143], v[68:71], 0
    ds_read_b64_tr_b16 v[156:157], v231 offset:4096
    ds_read_b64_tr_b16 v[158:159], v231 offset:5120
    v_lshlrev_b32 v176, 16, v84
    v_and_b32 v177, 0xffff0000, v84
    v_fma_f32 v176, v176, v0, v8
    v_fma_f32 v177, v177, v1, v9
    v_cvt_pk_bf16_f32 v84, v176, v177
    v_lshlrev_b32 v178, 16, v85
    v_and_b32 v179, 0xffff0000, v85
    s_waitcnt lgkmcnt(6)
    v_mfma_f32_32x32x16_bf16 a[128:143], v[144:147], v[72:75], a[128:143]
    s_add_u32 m0, s42, 81920
    s_add_u32 s45, s38, 0
    buffer_load_dwordx4 v223, s[16:19], s45 offen lds
    v_fma_f32 v178, v178, v2, v10
    v_fma_f32 v179, v179, v3, v11
    v_cvt_pk_bf16_f32 v85, v178, v179
    v_lshlrev_b32 v180, 16, v86
    v_and_b32 v181, 0xffff0000, v86
    v_fma_f32 v180, v180, v4, v12
    v_fma_f32 v181, v181, v5, v13
    v_mfma_f32_32x32x16_bf16 a[192:207], v[144:147], v[76:79], a[192:207]
    ds_read_b64_tr_b16 v[128:129], v228 offset:8192
    ds_read_b64_tr_b16 v[130:131], v228 offset:9216
    v_cvt_pk_bf16_f32 v86, v180, v181
    v_lshlrev_b32 v182, 16, v87
    v_and_b32 v183, 0xffff0000, v87
    v_fma_f32 v182, v182, v6, v14
    v_fma_f32 v183, v183, v7, v15
    v_cvt_pk_bf16_f32 v87, v182, v183
    s_waitcnt lgkmcnt(6)
    v_mfma_f32_32x32x16_bf16 a[144:159], v[148:151], v[72:75], a[144:159]
    s_add_u32 m0, s42, 86016
    s_add_u32 s45, s38, 131072
    buffer_load_dwordx4 v223, s[16:19], s45 offen lds
    v_lshlrev_b32 v176, 16, v88
    v_and_b32 v177, 0xffff0000, v88
    v_fma_f32 v176, v176, v16, v24
    v_fma_f32 v177, v177, v17, v25
    v_cvt_pk_bf16_f32 v88, v176, v177
    v_lshlrev_b32 v178, 16, v89
    v_and_b32 v179, 0xffff0000, v89
    v_mfma_f32_32x32x16_bf16 a[208:223], v[148:151], v[76:79], a[208:223]
    ds_read_b64_tr_b16 v[132:133], v229 offset:8192
    ds_read_b64_tr_b16 v[134:135], v229 offset:9216
    v_fma_f32 v178, v178, v18, v26
    v_fma_f32 v179, v179, v19, v27
    v_cvt_pk_bf16_f32 v89, v178, v179
    v_lshlrev_b32 v180, 16, v90
    v_and_b32 v181, 0xffff0000, v90
    v_fma_f32 v180, v180, v20, v28
    v_fma_f32 v181, v181, v21, v29
    s_waitcnt lgkmcnt(6)
    v_mfma_f32_32x32x16_bf16 a[160:175], v[152:155], v[72:75], a[160:175]
    s_add_u32 m0, s42, 90112
    s_add_u32 s45, s38, 262144
    buffer_load_dwordx4 v223, s[16:19], s45 offen lds
    v_cvt_pk_bf16_f32 v90, v180, v181
    v_lshlrev_b32 v182, 16, v91
    v_and_b32 v183, 0xffff0000, v91
    v_fma_f32 v182, v182, v22, v30
    v_fma_f32 v183, v183, v23, v31
    v_cvt_pk_bf16_f32 v91, v182, v183
    v_mfma_f32_32x32x16_bf16 a[224:239], v[152:155], v[76:79], a[224:239]
    ds_read_b64_tr_b16 v[136:137], v230 offset:8192
    ds_read_b64_tr_b16 v[138:139], v230 offset:9216
    v_lshlrev_b32 v176, 16, v92
    v_and_b32 v177, 0xffff0000, v92
    v_fma_f32 v176, v176, v16, v24
    v_fma_f32 v177, v177, v17, v25
    v_cvt_pk_bf16_f32 v92, v176, v177
    v_lshlrev_b32 v178, 16, v93
    v_and_b32 v179, 0xffff0000, v93
    s_waitcnt lgkmcnt(6)
    v_mfma_f32_32x32x16_bf16 a[176:191], v[156:159], v[72:75], a[176:191]
    s_add_u32 m0, s42, 94208
    s_add_u32 s45, s38, 393216
    buffer_load_dwordx4 v223, s[16:19], s45 offen lds
    s_add_u32 s38, s38, 524288
    v_fma_f32 v178, v178, v18, v26
    v_fma_f32 v179, v179, v19, v27
    v_cvt_pk_bf16_f32 v93, v178, v179
    v_lshlrev_b32 v180, 16, v94
    v_and_b32 v181, 0xffff0000, v94
    v_fma_f32 v180, v180, v20, v28
    v_fma_f32 v181, v181, v21, v29
    v_mfma_f32_32x32x16_bf16 a[240:255], v[156:159], v[76:79], a[240:255]
    ds_read_b64_tr_b16 v[140:141], v231 offset:8192
    ds_read_b64_tr_b16 v[142:143], v231 offset:9216
    v_cvt_pk_bf16_f32 v94, v180, v181
    v_lshlrev_b32 v182, 16, v95
    v_and_b32 v183, 0xffff0000, v95
    v_fma_f32 v182, v182, v22, v30
    v_fma_f32 v183, v183, v23, v31
    v_cvt_pk_bf16_f32 v95, v182, v183
    s_waitcnt lgkmcnt(6)
    v_mfma_f32_32x32x16_bf16 a[128:143], v[128:131], v[80:83], a[128:143]
    ds_read_b128 v[0:3], v225 offset:2304
    ds_read_b128 v[4:7], v225 offset:2320
    ds_read_b128 v[8:11], v225 offset:256
    ds_read_b128 v[12:15], v225 offset:272
    ds_read_b128 v[16:19], v225 offset:2368
    ds_read_b128 v[20:23], v225 offset:2384
    ds_read_b128 v[24:27], v225 offset:320
    ds_read_b128 v[28:31], v225 offset:336
    s_add_u32 s47, s39, 8192
    buffer_load_dwordx4 v[64:67], v224, s[20:23], s47 offen offset:0
    v_mfma_f32_32x32x16_bf16 a[192:207], v[128:131], v[84:87], a[192:207]
    ds_read_b64_tr_b16 v[144:145], v228 offset:12288
    ds_read_b64_tr_b16 v[146:147], v228 offset:13312
    s_waitcnt lgkmcnt(14)
    v_mfma_f32_32x32x16_bf16 a[144:159], v[132:135], v[80:83], a[144:159]
    s_add_u32 s47, s39, 40960
    buffer_load_dwordx4 v[68:71], v224, s[20:23], s47 offen offset:0
    v_mfma_f32_32x32x16_bf16 a[208:223], v[132:135], v[84:87], a[208:223]
    ds_read_b64_tr_b16 v[148:149], v229 offset:12288
    ds_read_b64_tr_b16 v[150:151], v229 offset:13312
    s_waitcnt lgkmcnt(14)
    v_mfma_f32_32x32x16_bf16 a[160:175], v[136:139], v[80:83], a[160:175]
    s_add_u32 s47, s39, 8192
    buffer_load_dwordx4 v[72:75], v224, s[20:23], s47 offen offset:1024
    s_waitcnt vmcnt(18)
    v_lshlrev_b32 v176, 16, v96
    v_and_b32 v177, 0xffff0000, v96
    s_waitcnt lgkmcnt(9)
    v_fma_f32 v176, v176, v0, v8
    v_fma_f32 v177, v177, v1, v9
    v_cvt_pk_bf16_f32 v96, v176, v177
    v_lshlrev_b32 v178, 16, v97
    v_and_b32 v179, 0xffff0000, v97
    v_mfma_f32_32x32x16_bf16 a[224:239], v[136:139], v[84:87], a[224:239]
    ds_read_b64_tr_b16 v[152:153], v230 offset:12288
    ds_read_b64_tr_b16 v[154:155], v230 offset:13312
    v_fma_f32 v178, v178, v2, v10
    v_fma_f32 v179, v179, v3, v11
    v_cvt_pk_bf16_f32 v97, v178, v179
    v_lshlrev_b32 v180, 16, v98
    v_and_b32 v181, 0xffff0000, v98
    s_waitcnt lgkmcnt(10)
    v_fma_f32 v180, v180, v4, v12
    v_fma_f32 v181, v181, v5, v13
    v_mfma_f32_32x32x16_bf16 a[176:191], v[140:143], v[80:83], a[176:191]
    s_add_u32 s47, s39, 40960
    buffer_load_dwordx4 v[76:79], v224, s[20:23], s47 offen offset:1024
    v_cvt_pk_bf16_f32 v98, v180, v181
    v_lshlrev_b32 v182, 16, v99
    v_and_b32 v183, 0xffff0000, v99
    v_fma_f32 v182, v182, v6, v14
    v_fma_f32 v183, v183, v7, v15
    v_cvt_pk_bf16_f32 v99, v182, v183
    v_mfma_f32_32x32x16_bf16 a[240:255], v[140:143], v[84:87], a[240:255]
    ds_read_b64_tr_b16 v[156:157], v231 offset:12288
    ds_read_b64_tr_b16 v[158:159], v231 offset:13312
    s_waitcnt vmcnt(18)
    v_lshlrev_b32 v176, 16, v100
    v_and_b32 v177, 0xffff0000, v100
    v_fma_f32 v176, v176, v0, v8
    v_fma_f32 v177, v177, v1, v9
    v_cvt_pk_bf16_f32 v100, v176, v177
    v_lshlrev_b32 v178, 16, v101
    v_and_b32 v179, 0xffff0000, v101
    s_waitcnt lgkmcnt(6)
    v_mfma_f32_32x32x16_bf16 a[128:143], v[144:147], v[88:91], a[128:143]
    v_fma_f32 v178, v178, v2, v10
    v_fma_f32 v179, v179, v3, v11
    v_cvt_pk_bf16_f32 v101, v178, v179
    v_lshlrev_b32 v180, 16, v102
    v_and_b32 v181, 0xffff0000, v102
    v_fma_f32 v180, v180, v4, v12
    v_fma_f32 v181, v181, v5, v13
    v_mfma_f32_32x32x16_bf16 a[192:207], v[144:147], v[92:95], a[192:207]
    ds_read_b64_tr_b16 v[128:129], v228 offset:16384
    ds_read_b64_tr_b16 v[130:131], v228 offset:17408
    v_cvt_pk_bf16_f32 v102, v180, v181
    v_lshlrev_b32 v182, 16, v103
    v_and_b32 v183, 0xffff0000, v103
    v_fma_f32 v182, v182, v6, v14
    v_fma_f32 v183, v183, v7, v15
    v_cvt_pk_bf16_f32 v103, v182, v183
    s_waitcnt lgkmcnt(6)
    v_mfma_f32_32x32x16_bf16 a[144:159], v[148:151], v[88:91], a[144:159]
    s_waitcnt vmcnt(17)
    v_lshlrev_b32 v176, 16, v104
    v_and_b32 v177, 0xffff0000, v104
    v_fma_f32 v176, v176, v16, v24
    v_fma_f32 v177, v177, v17, v25
    v_cvt_pk_bf16_f32 v104, v176, v177
    v_lshlrev_b32 v178, 16, v105
    v_and_b32 v179, 0xffff0000, v105
    v_mfma_f32_32x32x16_bf16 a[208:223], v[148:151], v[92:95], a[208:223]
    ds_read_b64_tr_b16 v[132:133], v229 offset:16384
    ds_read_b64_tr_b16 v[134:135], v229 offset:17408
    v_fma_f32 v178, v178, v18, v26
    v_fma_f32 v179, v179, v19, v27
    v_cvt_pk_bf16_f32 v105, v178, v179
    v_lshlrev_b32 v180, 16, v106
    v_and_b32 v181, 0xffff0000, v106
    v_fma_f32 v180, v180, v20, v28
    v_fma_f32 v181, v181, v21, v29
    s_waitcnt lgkmcnt(6)
    v_mfma_f32_32x32x16_bf16 a[160:175], v[152:155], v[88:91], a[160:175]
    v_cvt_pk_bf16_f32 v106, v180, v181
    v_lshlrev_b32 v182, 16, v107
    v_and_b32 v183, 0xffff0000, v107
    v_fma_f32 v182, v182, v22, v30
    v_fma_f32 v183, v183, v23, v31
    v_cvt_pk_bf16_f32 v107, v182, v183
    v_mfma_f32_32x32x16_bf16 a[224:239], v[152:155], v[92:95], a[224:239]
    ds_read_b64_tr_b16 v[136:137], v230 offset:16384
    ds_read_b64_tr_b16 v[138:139], v230 offset:17408
    s_waitcnt vmcnt(16)
    v_lshlrev_b32 v176, 16, v108
    v_and_b32 v177, 0xffff0000, v108
    v_fma_f32 v176, v176, v16, v24
    v_fma_f32 v177, v177, v17, v25
    v_cvt_pk_bf16_f32 v108, v176, v177
    v_lshlrev_b32 v178, 16, v109
    v_and_b32 v179, 0xffff0000, v109
    s_waitcnt lgkmcnt(6)
    v_mfma_f32_32x32x16_bf16 a[176:191], v[156:159], v[88:91], a[176:191]
    v_fma_f32 v178, v178, v18, v26
    v_fma_f32 v179, v179, v19, v27
    v_cvt_pk_bf16_f32 v109, v178, v179
    v_lshlrev_b32 v180, 16, v110
    v_and_b32 v181, 0xffff0000, v110
    v_fma_f32 v180, v180, v20, v28
    v_fma_f32 v181, v181, v21, v29
    v_mfma_f32_32x32x16_bf16 a[240:255], v[156:159], v[92:95], a[240:255]
    ds_read_b64_tr_b16 v[140:141], v231 offset:16384
    ds_read_b64_tr_b16 v[142:143], v231 offset:17408
    v_cvt_pk_bf16_f32 v110, v180, v181
    v_lshlrev_b32 v182, 16, v111
    v_and_b32 v183, 0xffff0000, v111
    v_fma_f32 v182, v182, v22, v30
    v_fma_f32 v183, v183, v23, v31
    v_cvt_pk_bf16_f32 v111, v182, v183
    s_waitcnt vmcnt(12) lgkmcnt(0)
    s_barrier
    v_mfma_f32_32x32x16_bf16 a[128:143], v[128:131], v[96:99], a[128:143]
    ds_read_b128 v[0:3], v225 offset:2432
    ds_read_b128 v[4:7], v225 offset:2448
    ds_read_b128 v[8:11], v225 offset:384
    ds_read_b128 v[12:15], v225 offset:400
    ds_read_b128 v[16:19], v225 offset:2496
    ds_read_b128 v[20:23], v225 offset:2512
    ds_read_b128 v[24:27], v225 offset:448
    ds_read_b128 v[28:31], v225 offset:464
    s_add_u32 s47, s39, 10240
    buffer_load_dwordx4 v[80:83], v224, s[20:23], s47 offen offset:0
    v_mfma_f32_32x32x16_bf16 a[192:207], v[128:131], v[100:103], a[192:207]
    ds_read_b64_tr_b16 v[144:145], v228 offset:20480
    ds_read_b64_tr_b16 v[146:147], v228 offset:21504
    v_mfma_f32_32x32x16_bf16 a[144:159], v[132:135], v[96:99], a[144:159]
    s_add_u32 s47, s39, 43008
    buffer_load_dwordx4 v[84:87], v224, s[20:23], s47 offen offset:0
    v_mfma_f32_32x32x16_bf16 a[208:223], v[132:135], v[100:103], a[208:223]
    ds_read_b64_tr_b16 v[148:149], v229 offset:20480
    ds_read_b64_tr_b16 v[150:151], v229 offset:21504
    v_mfma_f32_32x32x16_bf16 a[160:175], v[136:139], v[96:99], a[160:175]
    s_add_u32 s47, s39, 10240
    buffer_load_dwordx4 v[88:91], v224, s[20:23], s47 offen offset:1024
    s_waitcnt vmcnt(14)
    v_lshlrev_b32 v176, 16, v112
    v_and_b32 v177, 0xffff0000, v112
    s_waitcnt lgkmcnt(9)
    v_fma_f32 v176, v176, v0, v8
    v_fma_f32 v177, v177, v1, v9
    v_cvt_pk_bf16_f32 v112, v176, v177
    v_lshlrev_b32 v178, 16, v113
    v_and_b32 v179, 0xffff0000, v113
    v_mfma_f32_32x32x16_bf16 a[224:239], v[136:139], v[100:103], a[224:239]
    ds_read_b64_tr_b16 v[152:153], v230 offset:20480
    ds_read_b64_tr_b16 v[154:155], v230 offset:21504
    v_fma_f32 v178, v178, v2, v10
    v_fma_f32 v179, v179, v3, v11
    v_cvt_pk_bf16_f32 v113, v178, v179
    v_lshlrev_b32 v180, 16, v114
    v_and_b32 v181, 0xffff0000, v114
    s_waitcnt lgkmcnt(10)
    v_fma_f32 v180, v180, v4, v12
    v_fma_f32 v181, v181, v5, v13
    v_mfma_f32_32x32x16_bf16 a[176:191], v[140:143], v[96:99], a[176:191]
    s_add_u32 s47, s39, 43008
    buffer_load_dwordx4 v[92:95], v224, s[20:23], s47 offen offset:1024
    v_cvt_pk_bf16_f32 v114, v180, v181
    v_lshlrev_b32 v182, 16, v115
    v_and_b32 v183, 0xffff0000, v115
    v_fma_f32 v182, v182, v6, v14
    v_fma_f32 v183, v183, v7, v15
    v_cvt_pk_bf16_f32 v115, v182, v183
    v_mfma_f32_32x32x16_bf16 a[240:255], v[140:143], v[100:103], a[240:255]
    ds_read_b64_tr_b16 v[156:157], v231 offset:20480
    ds_read_b64_tr_b16 v[158:159], v231 offset:21504
    s_waitcnt vmcnt(14)
    v_lshlrev_b32 v176, 16, v116
    v_and_b32 v177, 0xffff0000, v116
    v_fma_f32 v176, v176, v0, v8
    v_fma_f32 v177, v177, v1, v9
    v_cvt_pk_bf16_f32 v116, v176, v177
    v_lshlrev_b32 v178, 16, v117
    v_and_b32 v179, 0xffff0000, v117
    s_waitcnt lgkmcnt(6)
    v_mfma_f32_32x32x16_bf16 a[128:143], v[144:147], v[104:107], a[128:143]
    s_add_u32 m0, s42, 98304
    s_add_u32 s45, s38, 0
    buffer_load_dwordx4 v223, s[16:19], s45 offen lds
    v_fma_f32 v178, v178, v2, v10
    v_fma_f32 v179, v179, v3, v11
    v_cvt_pk_bf16_f32 v117, v178, v179
    v_lshlrev_b32 v180, 16, v118
    v_and_b32 v181, 0xffff0000, v118
    v_fma_f32 v180, v180, v4, v12
    v_fma_f32 v181, v181, v5, v13
    v_mfma_f32_32x32x16_bf16 a[192:207], v[144:147], v[108:111], a[192:207]
    ds_read_b64_tr_b16 v[128:129], v228 offset:24576
    ds_read_b64_tr_b16 v[130:131], v228 offset:25600
    v_cvt_pk_bf16_f32 v118, v180, v181
    v_lshlrev_b32 v182, 16, v119
    v_and_b32 v183, 0xffff0000, v119
    v_fma_f32 v182, v182, v6, v14
    v_fma_f32 v183, v183, v7, v15
    v_cvt_pk_bf16_f32 v119, v182, v183
    s_waitcnt lgkmcnt(6)
    v_mfma_f32_32x32x16_bf16 a[144:159], v[148:151], v[104:107], a[144:159]
    s_add_u32 m0, s42, 102400
    s_add_u32 s45, s38, 131072
    buffer_load_dwordx4 v223, s[16:19], s45 offen lds
    s_waitcnt vmcnt(15)
    v_lshlrev_b32 v176, 16, v120
    v_and_b32 v177, 0xffff0000, v120
    v_fma_f32 v176, v176, v16, v24
    v_fma_f32 v177, v177, v17, v25
    v_cvt_pk_bf16_f32 v120, v176, v177
    v_lshlrev_b32 v178, 16, v121
    v_and_b32 v179, 0xffff0000, v121
    v_mfma_f32_32x32x16_bf16 a[208:223], v[148:151], v[108:111], a[208:223]
    ds_read_b64_tr_b16 v[132:133], v229 offset:24576
    ds_read_b64_tr_b16 v[134:135], v229 offset:25600
    v_fma_f32 v178, v178, v18, v26
    v_fma_f32 v179, v179, v19, v27
    v_cvt_pk_bf16_f32 v121, v178, v179
    v_lshlrev_b32 v180, 16, v122
    v_and_b32 v181, 0xffff0000, v122
    v_fma_f32 v180, v180, v20, v28
    v_fma_f32 v181, v181, v21, v29
    s_waitcnt lgkmcnt(6)
    v_mfma_f32_32x32x16_bf16 a[160:175], v[152:155], v[104:107], a[160:175]
    s_add_u32 m0, s42, 106496
    s_add_u32 s45, s38, 262144
    buffer_load_dwordx4 v223, s[16:19], s45 offen lds
    v_cvt_pk_bf16_f32 v122, v180, v181
    v_lshlrev_b32 v182, 16, v123
    v_and_b32 v183, 0xffff0000, v123
    v_fma_f32 v182, v182, v22, v30
    v_fma_f32 v183, v183, v23, v31
    v_cvt_pk_bf16_f32 v123, v182, v183
    v_mfma_f32_32x32x16_bf16 a[224:239], v[152:155], v[108:111], a[224:239]
    ds_read_b64_tr_b16 v[136:137], v230 offset:24576
    ds_read_b64_tr_b16 v[138:139], v230 offset:25600
    s_waitcnt vmcnt(15)
    v_lshlrev_b32 v176, 16, v124
    v_and_b32 v177, 0xffff0000, v124
    v_fma_f32 v176, v176, v16, v24
    v_fma_f32 v177, v177, v17, v25
    v_cvt_pk_bf16_f32 v124, v176, v177
    v_lshlrev_b32 v178, 16, v125
    v_and_b32 v179, 0xffff0000, v125
    s_waitcnt lgkmcnt(6)
    v_mfma_f32_32x32x16_bf16 a[176:191], v[156:159], v[104:107], a[176:191]
    s_add_u32 m0, s42, 110592
    s_add_u32 s45, s38, 393216
    buffer_load_dwordx4 v223, s[16:19], s45 offen lds
    s_add_u32 s38, s38, 524288
    v_fma_f32 v178, v178, v18, v26
    v_fma_f32 v179, v179, v19, v27
    v_cvt_pk_bf16_f32 v125, v178, v179
    v_lshlrev_b32 v180, 16, v126
    v_and_b32 v181, 0xffff0000, v126
    v_fma_f32 v180, v180, v20, v28
    v_fma_f32 v181, v181, v21, v29
    v_mfma_f32_32x32x16_bf16 a[240:255], v[156:159], v[108:111], a[240:255]
    ds_read_b64_tr_b16 v[140:141], v231 offset:24576
    ds_read_b64_tr_b16 v[142:143], v231 offset:25600
    v_cvt_pk_bf16_f32 v126, v180, v181
    v_lshlrev_b32 v182, 16, v127
    v_and_b32 v183, 0xffff0000, v127
    v_fma_f32 v182, v182, v22, v30
    v_fma_f32 v183, v183, v23, v31
    v_cvt_pk_bf16_f32 v127, v182, v183
    s_waitcnt lgkmcnt(6)
    v_mfma_f32_32x32x16_bf16 a[128:143], v[128:131], v[112:115], a[128:143]
    ds_read_b128 v[0:3], v225 offset:2560
    ds_read_b128 v[4:7], v225 offset:2576
    ds_read_b128 v[8:11], v225 offset:512
    ds_read_b128 v[12:15], v225 offset:528
    ds_read_b128 v[16:19], v225 offset:2624
    ds_read_b128 v[20:23], v225 offset:2640
    ds_read_b128 v[24:27], v225 offset:576
    ds_read_b128 v[28:31], v225 offset:592
    s_add_u32 s47, s39, 12288
    buffer_load_dwordx4 v[96:99], v224, s[20:23], s47 offen offset:0
    v_mfma_f32_32x32x16_bf16 a[192:207], v[128:131], v[116:119], a[192:207]
    ds_read_b64_tr_b16 v[144:145], v228 offset:28672
    ds_read_b64_tr_b16 v[146:147], v228 offset:29696
    s_waitcnt lgkmcnt(14)
    v_mfma_f32_32x32x16_bf16 a[144:159], v[132:135], v[112:115], a[144:159]
    s_add_u32 s47, s39, 45056
    buffer_load_dwordx4 v[100:103], v224, s[20:23], s47 offen offset:0
    v_mfma_f32_32x32x16_bf16 a[208:223], v[132:135], v[116:119], a[208:223]
    ds_read_b64_tr_b16 v[148:149], v229 offset:28672
    ds_read_b64_tr_b16 v[150:151], v229 offset:29696
    s_waitcnt lgkmcnt(14)
    v_mfma_f32_32x32x16_bf16 a[160:175], v[136:139], v[112:115], a[160:175]
    s_add_u32 s47, s39, 12288
    buffer_load_dwordx4 v[104:107], v224, s[20:23], s47 offen offset:1024
    s_waitcnt vmcnt(14)
    v_lshlrev_b32 v176, 16, v64
    v_and_b32 v177, 0xffff0000, v64
    s_waitcnt lgkmcnt(9)
    v_fma_f32 v176, v176, v0, v8
    v_fma_f32 v177, v177, v1, v9
    v_cvt_pk_bf16_f32 v64, v176, v177
    v_lshlrev_b32 v178, 16, v65
    v_and_b32 v179, 0xffff0000, v65
    v_mfma_f32_32x32x16_bf16 a[224:239], v[136:139], v[116:119], a[224:239]
    ds_read_b64_tr_b16 v[152:153], v230 offset:28672
    ds_read_b64_tr_b16 v[154:155], v230 offset:29696
    v_fma_f32 v178, v178, v2, v10
    v_fma_f32 v179, v179, v3, v11
    v_cvt_pk_bf16_f32 v65, v178, v179
    v_lshlrev_b32 v180, 16, v66
    v_and_b32 v181, 0xffff0000, v66
    s_waitcnt lgkmcnt(10)
    v_fma_f32 v180, v180, v4, v12
    v_fma_f32 v181, v181, v5, v13
    v_mfma_f32_32x32x16_bf16 a[176:191], v[140:143], v[112:115], a[176:191]
    s_add_u32 s47, s39, 45056
    buffer_load_dwordx4 v[108:111], v224, s[20:23], s47 offen offset:1024
    v_cvt_pk_bf16_f32 v66, v180, v181
    v_lshlrev_b32 v182, 16, v67
    v_and_b32 v183, 0xffff0000, v67
    v_fma_f32 v182, v182, v6, v14
    v_fma_f32 v183, v183, v7, v15
    v_cvt_pk_bf16_f32 v67, v182, v183
    v_mfma_f32_32x32x16_bf16 a[240:255], v[140:143], v[116:119], a[240:255]
    ds_read_b64_tr_b16 v[156:157], v231 offset:28672
    ds_read_b64_tr_b16 v[158:159], v231 offset:29696
    s_waitcnt vmcnt(14)
    v_lshlrev_b32 v176, 16, v68
    v_and_b32 v177, 0xffff0000, v68
    v_fma_f32 v176, v176, v0, v8
    v_fma_f32 v177, v177, v1, v9
    v_cvt_pk_bf16_f32 v68, v176, v177
    v_lshlrev_b32 v178, 16, v69
    v_and_b32 v179, 0xffff0000, v69
    s_waitcnt lgkmcnt(6)
    v_mfma_f32_32x32x16_bf16 a[128:143], v[144:147], v[120:123], a[128:143]
    v_fma_f32 v178, v178, v2, v10
    v_fma_f32 v179, v179, v3, v11
    v_cvt_pk_bf16_f32 v69, v178, v179
    v_lshlrev_b32 v180, 16, v70
    v_and_b32 v181, 0xffff0000, v70
    v_fma_f32 v180, v180, v4, v12
    v_fma_f32 v181, v181, v5, v13
    v_mfma_f32_32x32x16_bf16 a[192:207], v[144:147], v[124:127], a[192:207]
    ds_read_b64_tr_b16 v[128:129], v228 offset:32768
    ds_read_b64_tr_b16 v[130:131], v228 offset:33792
    v_cvt_pk_bf16_f32 v70, v180, v181
    v_lshlrev_b32 v182, 16, v71
    v_and_b32 v183, 0xffff0000, v71
    v_fma_f32 v182, v182, v6, v14
    v_fma_f32 v183, v183, v7, v15
    v_cvt_pk_bf16_f32 v71, v182, v183
    s_waitcnt lgkmcnt(6)
    v_mfma_f32_32x32x16_bf16 a[144:159], v[148:151], v[120:123], a[144:159]
    s_waitcnt vmcnt(13)
    v_lshlrev_b32 v176, 16, v72
    v_and_b32 v177, 0xffff0000, v72
    v_fma_f32 v176, v176, v16, v24
    v_fma_f32 v177, v177, v17, v25
    v_cvt_pk_bf16_f32 v72, v176, v177
    v_lshlrev_b32 v178, 16, v73
    v_and_b32 v179, 0xffff0000, v73
    v_mfma_f32_32x32x16_bf16 a[208:223], v[148:151], v[124:127], a[208:223]
    ds_read_b64_tr_b16 v[132:133], v229 offset:32768
    ds_read_b64_tr_b16 v[134:135], v229 offset:33792
    v_fma_f32 v178, v178, v18, v26
    v_fma_f32 v179, v179, v19, v27
    v_cvt_pk_bf16_f32 v73, v178, v179
    v_lshlrev_b32 v180, 16, v74
    v_and_b32 v181, 0xffff0000, v74
    v_fma_f32 v180, v180, v20, v28
    v_fma_f32 v181, v181, v21, v29
    s_waitcnt lgkmcnt(6)
    v_mfma_f32_32x32x16_bf16 a[160:175], v[152:155], v[120:123], a[160:175]
    v_cvt_pk_bf16_f32 v74, v180, v181
    v_lshlrev_b32 v182, 16, v75
    v_and_b32 v183, 0xffff0000, v75
    v_fma_f32 v182, v182, v22, v30
    v_fma_f32 v183, v183, v23, v31
    v_cvt_pk_bf16_f32 v75, v182, v183
    v_mfma_f32_32x32x16_bf16 a[224:239], v[152:155], v[124:127], a[224:239]
    ds_read_b64_tr_b16 v[136:137], v230 offset:32768
    ds_read_b64_tr_b16 v[138:139], v230 offset:33792
    s_waitcnt vmcnt(12)
    v_lshlrev_b32 v176, 16, v76
    v_and_b32 v177, 0xffff0000, v76
    v_fma_f32 v176, v176, v16, v24
    v_fma_f32 v177, v177, v17, v25
    v_cvt_pk_bf16_f32 v76, v176, v177
    v_lshlrev_b32 v178, 16, v77
    v_and_b32 v179, 0xffff0000, v77
    s_waitcnt lgkmcnt(6)
    v_mfma_f32_32x32x16_bf16 a[176:191], v[156:159], v[120:123], a[176:191]
    v_fma_f32 v178, v178, v18, v26
    v_fma_f32 v179, v179, v19, v27
    v_cvt_pk_bf16_f32 v77, v178, v179
    v_lshlrev_b32 v180, 16, v78
    v_and_b32 v181, 0xffff0000, v78
    v_fma_f32 v180, v180, v20, v28
    v_fma_f32 v181, v181, v21, v29
    v_mfma_f32_32x32x16_bf16 a[240:255], v[156:159], v[124:127], a[240:255]
    ds_read_b64_tr_b16 v[140:141], v231 offset:32768
    ds_read_b64_tr_b16 v[142:143], v231 offset:33792
    v_cvt_pk_bf16_f32 v78, v180, v181
    v_lshlrev_b32 v182, 16, v79
    v_and_b32 v183, 0xffff0000, v79
    v_fma_f32 v182, v182, v22, v30
    v_fma_f32 v183, v183, v23, v31
    v_cvt_pk_bf16_f32 v79, v182, v183
    s_waitcnt vmcnt(16) lgkmcnt(0)
    s_barrier
    v_mfma_f32_32x32x16_bf16 a[128:143], v[128:131], v[64:67], a[128:143]
    ds_read_b128 v[0:3], v225 offset:2688
    ds_read_b128 v[4:7], v225 offset:2704
    ds_read_b128 v[8:11], v225 offset:640
    ds_read_b128 v[12:15], v225 offset:656
    ds_read_b128 v[16:19], v225 offset:2752
    ds_read_b128 v[20:23], v225 offset:2768
    ds_read_b128 v[24:27], v225 offset:704
    ds_read_b128 v[28:31], v225 offset:720
    s_add_u32 s47, s39, 14336
    buffer_load_dwordx4 v[112:115], v224, s[20:23], s47 offen offset:0
    v_mfma_f32_32x32x16_bf16 a[192:207], v[128:131], v[68:71], a[192:207]
    ds_read_b64_tr_b16 v[144:145], v228 offset:36864
    ds_read_b64_tr_b16 v[146:147], v228 offset:37888
    v_mfma_f32_32x32x16_bf16 a[144:159], v[132:135], v[64:67], a[144:159]
    s_add_u32 s47, s39, 47104
    buffer_load_dwordx4 v[116:119], v224, s[20:23], s47 offen offset:0
    v_mfma_f32_32x32x16_bf16 a[208:223], v[132:135], v[68:71], a[208:223]
    ds_read_b64_tr_b16 v[148:149], v229 offset:36864
    ds_read_b64_tr_b16 v[150:151], v229 offset:37888
    v_mfma_f32_32x32x16_bf16 a[160:175], v[136:139], v[64:67], a[160:175]
    s_add_u32 s47, s39, 14336
    buffer_load_dwordx4 v[120:123], v224, s[20:23], s47 offen offset:1024
    s_waitcnt vmcnt(14)
    v_lshlrev_b32 v176, 16, v80
    v_and_b32 v177, 0xffff0000, v80
    s_waitcnt lgkmcnt(9)
    v_fma_f32 v176, v176, v0, v8
    v_fma_f32 v177, v177, v1, v9
    v_cvt_pk_bf16_f32 v80, v176, v177
    v_lshlrev_b32 v178, 16, v81
    v_and_b32 v179, 0xffff0000, v81
    v_mfma_f32_32x32x16_bf16 a[224:239], v[136:139], v[68:71], a[224:239]
    ds_read_b64_tr_b16 v[152:153], v230 offset:36864
    ds_read_b64_tr_b16 v[154:155], v230 offset:37888
    v_fma_f32 v178, v178, v2, v10
    v_fma_f32 v179, v179, v3, v11
    v_cvt_pk_bf16_f32 v81, v178, v179
    v_lshlrev_b32 v180, 16, v82
    v_and_b32 v181, 0xffff0000, v82
    s_waitcnt lgkmcnt(10)
    v_fma_f32 v180, v180, v4, v12
    v_fma_f32 v181, v181, v5, v13
    v_mfma_f32_32x32x16_bf16 a[176:191], v[140:143], v[64:67], a[176:191]
    s_add_u32 s47, s39, 47104
    buffer_load_dwordx4 v[124:127], v224, s[20:23], s47 offen offset:1024
    v_cvt_pk_bf16_f32 v82, v180, v181
    v_lshlrev_b32 v182, 16, v83
    v_and_b32 v183, 0xffff0000, v83
    v_fma_f32 v182, v182, v6, v14
    v_fma_f32 v183, v183, v7, v15
    v_cvt_pk_bf16_f32 v83, v182, v183
    v_mfma_f32_32x32x16_bf16 a[240:255], v[140:143], v[68:71], a[240:255]
    ds_read_b64_tr_b16 v[156:157], v231 offset:36864
    ds_read_b64_tr_b16 v[158:159], v231 offset:37888
    s_waitcnt vmcnt(14)
    v_lshlrev_b32 v176, 16, v84
    v_and_b32 v177, 0xffff0000, v84
    v_fma_f32 v176, v176, v0, v8
    v_fma_f32 v177, v177, v1, v9
    v_cvt_pk_bf16_f32 v84, v176, v177
    v_lshlrev_b32 v178, 16, v85
    v_and_b32 v179, 0xffff0000, v85
    s_waitcnt lgkmcnt(6)
    v_mfma_f32_32x32x16_bf16 a[128:143], v[144:147], v[72:75], a[128:143]
    s_add_u32 m0, s42, 114688
    s_add_u32 s45, s38, 0
    buffer_load_dwordx4 v223, s[16:19], s45 offen lds
    v_fma_f32 v178, v178, v2, v10
    v_fma_f32 v179, v179, v3, v11
    v_cvt_pk_bf16_f32 v85, v178, v179
    v_lshlrev_b32 v180, 16, v86
    v_and_b32 v181, 0xffff0000, v86
    v_fma_f32 v180, v180, v4, v12
    v_fma_f32 v181, v181, v5, v13
    v_mfma_f32_32x32x16_bf16 a[192:207], v[144:147], v[76:79], a[192:207]
    ds_read_b64_tr_b16 v[128:129], v228 offset:40960
    ds_read_b64_tr_b16 v[130:131], v228 offset:41984
    v_cvt_pk_bf16_f32 v86, v180, v181
    v_lshlrev_b32 v182, 16, v87
    v_and_b32 v183, 0xffff0000, v87
    v_fma_f32 v182, v182, v6, v14
    v_fma_f32 v183, v183, v7, v15
    v_cvt_pk_bf16_f32 v87, v182, v183
    s_waitcnt lgkmcnt(6)
    v_mfma_f32_32x32x16_bf16 a[144:159], v[148:151], v[72:75], a[144:159]
    s_add_u32 m0, s42, 118784
    s_add_u32 s45, s38, 131072
    buffer_load_dwordx4 v223, s[16:19], s45 offen lds
    s_waitcnt vmcnt(15)
    v_lshlrev_b32 v176, 16, v88
    v_and_b32 v177, 0xffff0000, v88
    v_fma_f32 v176, v176, v16, v24
    v_fma_f32 v177, v177, v17, v25
    v_cvt_pk_bf16_f32 v88, v176, v177
    v_lshlrev_b32 v178, 16, v89
    v_and_b32 v179, 0xffff0000, v89
    v_mfma_f32_32x32x16_bf16 a[208:223], v[148:151], v[76:79], a[208:223]
    ds_read_b64_tr_b16 v[132:133], v229 offset:40960
    ds_read_b64_tr_b16 v[134:135], v229 offset:41984
    v_fma_f32 v178, v178, v18, v26
    v_fma_f32 v179, v179, v19, v27
    v_cvt_pk_bf16_f32 v89, v178, v179
    v_lshlrev_b32 v180, 16, v90
    v_and_b32 v181, 0xffff0000, v90
    v_fma_f32 v180, v180, v20, v28
    v_fma_f32 v181, v181, v21, v29
    s_waitcnt lgkmcnt(6)
    v_mfma_f32_32x32x16_bf16 a[160:175], v[152:155], v[72:75], a[160:175]
    s_add_u32 m0, s42, 122880
    s_add_u32 s45, s38, 262144
    buffer_load_dwordx4 v223, s[16:19], s45 offen lds
    v_cvt_pk_bf16_f32 v90, v180, v181
    v_lshlrev_b32 v182, 16, v91
    v_and_b32 v183, 0xffff0000, v91
    v_fma_f32 v182, v182, v22, v30
    v_fma_f32 v183, v183, v23, v31
    v_cvt_pk_bf16_f32 v91, v182, v183
    v_mfma_f32_32x32x16_bf16 a[224:239], v[152:155], v[76:79], a[224:239]
    ds_read_b64_tr_b16 v[136:137], v230 offset:40960
    ds_read_b64_tr_b16 v[138:139], v230 offset:41984
    s_waitcnt vmcnt(15)
    v_lshlrev_b32 v176, 16, v92
    v_and_b32 v177, 0xffff0000, v92
    v_fma_f32 v176, v176, v16, v24
    v_fma_f32 v177, v177, v17, v25
    v_cvt_pk_bf16_f32 v92, v176, v177
    v_lshlrev_b32 v178, 16, v93
    v_and_b32 v179, 0xffff0000, v93
    s_waitcnt lgkmcnt(6)
    v_mfma_f32_32x32x16_bf16 a[176:191], v[156:159], v[72:75], a[176:191]
    s_add_u32 m0, s42, 126976
    s_add_u32 s45, s38, 393216
    buffer_load_dwordx4 v223, s[16:19], s45 offen lds
    s_add_u32 s38, s38, 524288
    v_fma_f32 v178, v178, v18, v26
    v_fma_f32 v179, v179, v19, v27
    v_cvt_pk_bf16_f32 v93, v178, v179
    v_lshlrev_b32 v180, 16, v94
    v_and_b32 v181, 0xffff0000, v94
    v_fma_f32 v180, v180, v20, v28
    v_fma_f32 v181, v181, v21, v29
    v_mfma_f32_32x32x16_bf16 a[240:255], v[156:159], v[76:79], a[240:255]
    ds_read_b64_tr_b16 v[140:141], v231 offset:40960
    ds_read_b64_tr_b16 v[142:143], v231 offset:41984
    v_cvt_pk_bf16_f32 v94, v180, v181
    v_lshlrev_b32 v182, 16, v95
    v_and_b32 v183, 0xffff0000, v95
    v_fma_f32 v182, v182, v22, v30
    v_fma_f32 v183, v183, v23, v31
    v_cvt_pk_bf16_f32 v95, v182, v183
    s_waitcnt lgkmcnt(6)
    v_mfma_f32_32x32x16_bf16 a[128:143], v[128:131], v[80:83], a[128:143]
    ds_read_b128 v[0:3], v225 offset:2816
    ds_read_b128 v[4:7], v225 offset:2832
    ds_read_b128 v[8:11], v225 offset:768
    ds_read_b128 v[12:15], v225 offset:784
    ds_read_b128 v[16:19], v225 offset:2880
    ds_read_b128 v[20:23], v225 offset:2896
    ds_read_b128 v[24:27], v225 offset:832
    ds_read_b128 v[28:31], v225 offset:848
    s_add_u32 s47, s39, 16384
    buffer_load_dwordx4 v[64:67], v224, s[20:23], s47 offen offset:0
    v_mfma_f32_32x32x16_bf16 a[192:207], v[128:131], v[84:87], a[192:207]
    ds_read_b64_tr_b16 v[144:145], v228 offset:45056
    ds_read_b64_tr_b16 v[146:147], v228 offset:46080
    s_waitcnt lgkmcnt(14)
    v_mfma_f32_32x32x16_bf16 a[144:159], v[132:135], v[80:83], a[144:159]
    s_add_u32 s47, s39, 49152
    buffer_load_dwordx4 v[68:71], v224, s[20:23], s47 offen offset:0
    v_mfma_f32_32x32x16_bf16 a[208:223], v[132:135], v[84:87], a[208:223]
    ds_read_b64_tr_b16 v[148:149], v229 offset:45056
    ds_read_b64_tr_b16 v[150:151], v229 offset:46080
    s_waitcnt lgkmcnt(14)
    v_mfma_f32_32x32x16_bf16 a[160:175], v[136:139], v[80:83], a[160:175]
    s_add_u32 s47, s39, 16384
    buffer_load_dwordx4 v[72:75], v224, s[20:23], s47 offen offset:1024
    s_waitcnt vmcnt(14)
    v_lshlrev_b32 v176, 16, v96
    v_and_b32 v177, 0xffff0000, v96
    s_waitcnt lgkmcnt(9)
    v_fma_f32 v176, v176, v0, v8
    v_fma_f32 v177, v177, v1, v9
    v_cvt_pk_bf16_f32 v96, v176, v177
    v_lshlrev_b32 v178, 16, v97
    v_and_b32 v179, 0xffff0000, v97
    v_mfma_f32_32x32x16_bf16 a[224:239], v[136:139], v[84:87], a[224:239]
    ds_read_b64_tr_b16 v[152:153], v230 offset:45056
    ds_read_b64_tr_b16 v[154:155], v230 offset:46080
    v_fma_f32 v178, v178, v2, v10
    v_fma_f32 v179, v179, v3, v11
    v_cvt_pk_bf16_f32 v97, v178, v179
    v_lshlrev_b32 v180, 16, v98
    v_and_b32 v181, 0xffff0000, v98
    s_waitcnt lgkmcnt(10)
    v_fma_f32 v180, v180, v4, v12
    v_fma_f32 v181, v181, v5, v13
    v_mfma_f32_32x32x16_bf16 a[176:191], v[140:143], v[80:83], a[176:191]
    s_add_u32 s47, s39, 49152
    buffer_load_dwordx4 v[76:79], v224, s[20:23], s47 offen offset:1024
    v_cvt_pk_bf16_f32 v98, v180, v181
    v_lshlrev_b32 v182, 16, v99
    v_and_b32 v183, 0xffff0000, v99
    v_fma_f32 v182, v182, v6, v14
    v_fma_f32 v183, v183, v7, v15
    v_cvt_pk_bf16_f32 v99, v182, v183
    v_mfma_f32_32x32x16_bf16 a[240:255], v[140:143], v[84:87], a[240:255]
    ds_read_b64_tr_b16 v[156:157], v231 offset:45056
    ds_read_b64_tr_b16 v[158:159], v231 offset:46080
    s_waitcnt vmcnt(14)
    v_lshlrev_b32 v176, 16, v100
    v_and_b32 v177, 0xffff0000, v100
    v_fma_f32 v176, v176, v0, v8
    v_fma_f32 v177, v177, v1, v9
    v_cvt_pk_bf16_f32 v100, v176, v177
    v_lshlrev_b32 v178, 16, v101
    v_and_b32 v179, 0xffff0000, v101
    s_waitcnt lgkmcnt(6)
    v_mfma_f32_32x32x16_bf16 a[128:143], v[144:147], v[88:91], a[128:143]
    v_fma_f32 v178, v178, v2, v10
    v_fma_f32 v179, v179, v3, v11
    v_cvt_pk_bf16_f32 v101, v178, v179
    v_lshlrev_b32 v180, 16, v102
    v_and_b32 v181, 0xffff0000, v102
    v_fma_f32 v180, v180, v4, v12
    v_fma_f32 v181, v181, v5, v13
    v_mfma_f32_32x32x16_bf16 a[192:207], v[144:147], v[92:95], a[192:207]
    ds_read_b64_tr_b16 v[128:129], v228 offset:49152
    ds_read_b64_tr_b16 v[130:131], v228 offset:50176
    v_cvt_pk_bf16_f32 v102, v180, v181
    v_lshlrev_b32 v182, 16, v103
    v_and_b32 v183, 0xffff0000, v103
    v_fma_f32 v182, v182, v6, v14
    v_fma_f32 v183, v183, v7, v15
    v_cvt_pk_bf16_f32 v103, v182, v183
    s_waitcnt lgkmcnt(6)
    v_mfma_f32_32x32x16_bf16 a[144:159], v[148:151], v[88:91], a[144:159]
    s_waitcnt vmcnt(13)
    v_lshlrev_b32 v176, 16, v104
    v_and_b32 v177, 0xffff0000, v104
    v_fma_f32 v176, v176, v16, v24
    v_fma_f32 v177, v177, v17, v25
    v_cvt_pk_bf16_f32 v104, v176, v177
    v_lshlrev_b32 v178, 16, v105
    v_and_b32 v179, 0xffff0000, v105
    v_mfma_f32_32x32x16_bf16 a[208:223], v[148:151], v[92:95], a[208:223]
    ds_read_b64_tr_b16 v[132:133], v229 offset:49152
    ds_read_b64_tr_b16 v[134:135], v229 offset:50176
    v_fma_f32 v178, v178, v18, v26
    v_fma_f32 v179, v179, v19, v27
    v_cvt_pk_bf16_f32 v105, v178, v179
    v_lshlrev_b32 v180, 16, v106
    v_and_b32 v181, 0xffff0000, v106
    v_fma_f32 v180, v180, v20, v28
    v_fma_f32 v181, v181, v21, v29
    s_waitcnt lgkmcnt(6)
    v_mfma_f32_32x32x16_bf16 a[160:175], v[152:155], v[88:91], a[160:175]
    v_cvt_pk_bf16_f32 v106, v180, v181
    v_lshlrev_b32 v182, 16, v107
    v_and_b32 v183, 0xffff0000, v107
    v_fma_f32 v182, v182, v22, v30
    v_fma_f32 v183, v183, v23, v31
    v_cvt_pk_bf16_f32 v107, v182, v183
    v_mfma_f32_32x32x16_bf16 a[224:239], v[152:155], v[92:95], a[224:239]
    ds_read_b64_tr_b16 v[136:137], v230 offset:49152
    ds_read_b64_tr_b16 v[138:139], v230 offset:50176
    s_waitcnt vmcnt(12)
    v_lshlrev_b32 v176, 16, v108
    v_and_b32 v177, 0xffff0000, v108
    v_fma_f32 v176, v176, v16, v24
    v_fma_f32 v177, v177, v17, v25
    v_cvt_pk_bf16_f32 v108, v176, v177
    v_lshlrev_b32 v178, 16, v109
    v_and_b32 v179, 0xffff0000, v109
    s_waitcnt lgkmcnt(6)
    v_mfma_f32_32x32x16_bf16 a[176:191], v[156:159], v[88:91], a[176:191]
    v_fma_f32 v178, v178, v18, v26
    v_fma_f32 v179, v179, v19, v27
    v_cvt_pk_bf16_f32 v109, v178, v179
    v_lshlrev_b32 v180, 16, v110
    v_and_b32 v181, 0xffff0000, v110
    v_fma_f32 v180, v180, v20, v28
    v_fma_f32 v181, v181, v21, v29
    v_mfma_f32_32x32x16_bf16 a[240:255], v[156:159], v[92:95], a[240:255]
    ds_read_b64_tr_b16 v[140:141], v231 offset:49152
    ds_read_b64_tr_b16 v[142:143], v231 offset:50176
    v_cvt_pk_bf16_f32 v110, v180, v181
    v_lshlrev_b32 v182, 16, v111
    v_and_b32 v183, 0xffff0000, v111
    v_fma_f32 v182, v182, v22, v30
    v_fma_f32 v183, v183, v23, v31
    v_cvt_pk_bf16_f32 v111, v182, v183
    s_waitcnt vmcnt(16) lgkmcnt(0)
    s_barrier
    v_mfma_f32_32x32x16_bf16 a[128:143], v[128:131], v[96:99], a[128:143]
    ds_read_b128 v[0:3], v225 offset:2944
    ds_read_b128 v[4:7], v225 offset:2960
    ds_read_b128 v[8:11], v225 offset:896
    ds_read_b128 v[12:15], v225 offset:912
    ds_read_b128 v[16:19], v225 offset:3008
    ds_read_b128 v[20:23], v225 offset:3024
    ds_read_b128 v[24:27], v225 offset:960
    ds_read_b128 v[28:31], v225 offset:976
    s_add_u32 s47, s39, 18432
    buffer_load_dwordx4 v[80:83], v224, s[20:23], s47 offen offset:0
    v_mfma_f32_32x32x16_bf16 a[192:207], v[128:131], v[100:103], a[192:207]
    ds_read_b64_tr_b16 v[144:145], v228 offset:53248
    ds_read_b64_tr_b16 v[146:147], v228 offset:54272
    v_mfma_f32_32x32x16_bf16 a[144:159], v[132:135], v[96:99], a[144:159]
    s_add_u32 s47, s39, 51200
    buffer_load_dwordx4 v[84:87], v224, s[20:23], s47 offen offset:0
    v_mfma_f32_32x32x16_bf16 a[208:223], v[132:135], v[100:103], a[208:223]
    ds_read_b64_tr_b16 v[148:149], v229 offset:53248
    ds_read_b64_tr_b16 v[150:151], v229 offset:54272
    v_mfma_f32_32x32x16_bf16 a[160:175], v[136:139], v[96:99], a[160:175]
    s_add_u32 s47, s39, 18432
    buffer_load_dwordx4 v[88:91], v224, s[20:23], s47 offen offset:1024
    s_waitcnt vmcnt(14)
    v_lshlrev_b32 v176, 16, v112
    v_and_b32 v177, 0xffff0000, v112
    s_waitcnt lgkmcnt(9)
    v_fma_f32 v176, v176, v0, v8
    v_fma_f32 v177, v177, v1, v9
    v_cvt_pk_bf16_f32 v112, v176, v177
    v_lshlrev_b32 v178, 16, v113
    v_and_b32 v179, 0xffff0000, v113
    v_mfma_f32_32x32x16_bf16 a[224:239], v[136:139], v[100:103], a[224:239]
    ds_read_b64_tr_b16 v[152:153], v230 offset:53248
    ds_read_b64_tr_b16 v[154:155], v230 offset:54272
    v_fma_f32 v178, v178, v2, v10
    v_fma_f32 v179, v179, v3, v11
    v_cvt_pk_bf16_f32 v113, v178, v179
    v_lshlrev_b32 v180, 16, v114
    v_and_b32 v181, 0xffff0000, v114
    s_waitcnt lgkmcnt(10)
    v_fma_f32 v180, v180, v4, v12
    v_fma_f32 v181, v181, v5, v13
    v_mfma_f32_32x32x16_bf16 a[176:191], v[140:143], v[96:99], a[176:191]
    s_add_u32 s47, s39, 51200
    buffer_load_dwordx4 v[92:95], v224, s[20:23], s47 offen offset:1024
    v_cvt_pk_bf16_f32 v114, v180, v181
    v_lshlrev_b32 v182, 16, v115
    v_and_b32 v183, 0xffff0000, v115
    v_fma_f32 v182, v182, v6, v14
    v_fma_f32 v183, v183, v7, v15
    v_cvt_pk_bf16_f32 v115, v182, v183
    v_mfma_f32_32x32x16_bf16 a[240:255], v[140:143], v[100:103], a[240:255]
    ds_read_b64_tr_b16 v[156:157], v231 offset:53248
    ds_read_b64_tr_b16 v[158:159], v231 offset:54272
    s_waitcnt vmcnt(14)
    v_lshlrev_b32 v176, 16, v116
    v_and_b32 v177, 0xffff0000, v116
    v_fma_f32 v176, v176, v0, v8
    v_fma_f32 v177, v177, v1, v9
    v_cvt_pk_bf16_f32 v116, v176, v177
    v_lshlrev_b32 v178, 16, v117
    v_and_b32 v179, 0xffff0000, v117
    s_waitcnt lgkmcnt(6)
    v_mfma_f32_32x32x16_bf16 a[128:143], v[144:147], v[104:107], a[128:143]
    s_add_u32 m0, s42, 131072
    s_add_u32 s45, s38, 0
    buffer_load_dwordx4 v223, s[16:19], s45 offen lds
    v_fma_f32 v178, v178, v2, v10
    v_fma_f32 v179, v179, v3, v11
    v_cvt_pk_bf16_f32 v117, v178, v179
    v_lshlrev_b32 v180, 16, v118
    v_and_b32 v181, 0xffff0000, v118
    v_fma_f32 v180, v180, v4, v12
    v_fma_f32 v181, v181, v5, v13
    v_mfma_f32_32x32x16_bf16 a[192:207], v[144:147], v[108:111], a[192:207]
    ds_read_b64_tr_b16 v[128:129], v228 offset:57344
    ds_read_b64_tr_b16 v[130:131], v228 offset:58368
    v_cvt_pk_bf16_f32 v118, v180, v181
    v_lshlrev_b32 v182, 16, v119
    v_and_b32 v183, 0xffff0000, v119
    v_fma_f32 v182, v182, v6, v14
    v_fma_f32 v183, v183, v7, v15
    v_cvt_pk_bf16_f32 v119, v182, v183
    s_waitcnt lgkmcnt(6)
    v_mfma_f32_32x32x16_bf16 a[144:159], v[148:151], v[104:107], a[144:159]
    s_add_u32 m0, s42, 135168
    s_add_u32 s45, s38, 131072
    buffer_load_dwordx4 v223, s[16:19], s45 offen lds
    s_waitcnt vmcnt(15)
    v_lshlrev_b32 v176, 16, v120
    v_and_b32 v177, 0xffff0000, v120
    v_fma_f32 v176, v176, v16, v24
    v_fma_f32 v177, v177, v17, v25
    v_cvt_pk_bf16_f32 v120, v176, v177
    v_lshlrev_b32 v178, 16, v121
    v_and_b32 v179, 0xffff0000, v121
    v_mfma_f32_32x32x16_bf16 a[208:223], v[148:151], v[108:111], a[208:223]
    ds_read_b64_tr_b16 v[132:133], v229 offset:57344
    ds_read_b64_tr_b16 v[134:135], v229 offset:58368
    v_fma_f32 v178, v178, v18, v26
    v_fma_f32 v179, v179, v19, v27
    v_cvt_pk_bf16_f32 v121, v178, v179
    v_lshlrev_b32 v180, 16, v122
    v_and_b32 v181, 0xffff0000, v122
    v_fma_f32 v180, v180, v20, v28
    v_fma_f32 v181, v181, v21, v29
    s_waitcnt lgkmcnt(6)
    v_mfma_f32_32x32x16_bf16 a[160:175], v[152:155], v[104:107], a[160:175]
    s_add_u32 m0, s42, 139264
    s_add_u32 s45, s38, 262144
    buffer_load_dwordx4 v223, s[16:19], s45 offen lds
    v_cvt_pk_bf16_f32 v122, v180, v181
    v_lshlrev_b32 v182, 16, v123
    v_and_b32 v183, 0xffff0000, v123
    v_fma_f32 v182, v182, v22, v30
    v_fma_f32 v183, v183, v23, v31
    v_cvt_pk_bf16_f32 v123, v182, v183
    v_mfma_f32_32x32x16_bf16 a[224:239], v[152:155], v[108:111], a[224:239]
    ds_read_b64_tr_b16 v[136:137], v230 offset:57344
    ds_read_b64_tr_b16 v[138:139], v230 offset:58368
    s_waitcnt vmcnt(15)
    v_lshlrev_b32 v176, 16, v124
    v_and_b32 v177, 0xffff0000, v124
    v_fma_f32 v176, v176, v16, v24
    v_fma_f32 v177, v177, v17, v25
    v_cvt_pk_bf16_f32 v124, v176, v177
    v_lshlrev_b32 v178, 16, v125
    v_and_b32 v179, 0xffff0000, v125
    s_waitcnt lgkmcnt(6)
    v_mfma_f32_32x32x16_bf16 a[176:191], v[156:159], v[104:107], a[176:191]
    s_add_u32 m0, s42, 143360
    s_add_u32 s45, s38, 393216
    buffer_load_dwordx4 v223, s[16:19], s45 offen lds
    s_add_u32 s38, s38, 524288
    v_fma_f32 v178, v178, v18, v26
    v_fma_f32 v179, v179, v19, v27
    v_cvt_pk_bf16_f32 v125, v178, v179
    v_lshlrev_b32 v180, 16, v126
    v_and_b32 v181, 0xffff0000, v126
    v_fma_f32 v180, v180, v20, v28
    v_fma_f32 v181, v181, v21, v29
    v_mfma_f32_32x32x16_bf16 a[240:255], v[156:159], v[108:111], a[240:255]
    ds_read_b64_tr_b16 v[140:141], v231 offset:57344
    ds_read_b64_tr_b16 v[142:143], v231 offset:58368
    v_cvt_pk_bf16_f32 v126, v180, v181
    v_lshlrev_b32 v182, 16, v127
    v_and_b32 v183, 0xffff0000, v127
    v_fma_f32 v182, v182, v22, v30
    v_fma_f32 v183, v183, v23, v31
    v_cvt_pk_bf16_f32 v127, v182, v183
    s_waitcnt lgkmcnt(6)
    v_mfma_f32_32x32x16_bf16 a[128:143], v[128:131], v[112:115], a[128:143]
    ds_read_b128 v[0:3], v225 offset:3072
    ds_read_b128 v[4:7], v225 offset:3088
    ds_read_b128 v[8:11], v225 offset:1024
    ds_read_b128 v[12:15], v225 offset:1040
    ds_read_b128 v[16:19], v225 offset:3136
    ds_read_b128 v[20:23], v225 offset:3152
    ds_read_b128 v[24:27], v225 offset:1088
    ds_read_b128 v[28:31], v225 offset:1104
    s_add_u32 s47, s39, 20480
    buffer_load_dwordx4 v[96:99], v224, s[20:23], s47 offen offset:0
    v_mfma_f32_32x32x16_bf16 a[192:207], v[128:131], v[116:119], a[192:207]
    ds_read_b64_tr_b16 v[144:145], v228 offset:61440
    ds_read_b64_tr_b16 v[146:147], v228 offset:62464
    s_waitcnt lgkmcnt(14)
    v_mfma_f32_32x32x16_bf16 a[144:159], v[132:135], v[112:115], a[144:159]
    s_add_u32 s47, s39, 53248
    buffer_load_dwordx4 v[100:103], v224, s[20:23], s47 offen offset:0
    v_mfma_f32_32x32x16_bf16 a[208:223], v[132:135], v[116:119], a[208:223]
    ds_read_b64_tr_b16 v[148:149], v229 offset:61440
    ds_read_b64_tr_b16 v[150:151], v229 offset:62464
    s_waitcnt lgkmcnt(14)
    v_mfma_f32_32x32x16_bf16 a[160:175], v[136:139], v[112:115], a[160:175]
    s_add_u32 s47, s39, 20480
    buffer_load_dwordx4 v[104:107], v224, s[20:23], s47 offen offset:1024
    s_waitcnt vmcnt(14)
    v_lshlrev_b32 v176, 16, v64
    v_and_b32 v177, 0xffff0000, v64
    s_waitcnt lgkmcnt(9)
    v_fma_f32 v176, v176, v0, v8
    v_fma_f32 v177, v177, v1, v9
    v_cvt_pk_bf16_f32 v64, v176, v177
    v_lshlrev_b32 v178, 16, v65
    v_and_b32 v179, 0xffff0000, v65
    v_mfma_f32_32x32x16_bf16 a[224:239], v[136:139], v[116:119], a[224:239]
    ds_read_b64_tr_b16 v[152:153], v230 offset:61440
    ds_read_b64_tr_b16 v[154:155], v230 offset:62464
    v_fma_f32 v178, v178, v2, v10
    v_fma_f32 v179, v179, v3, v11
    v_cvt_pk_bf16_f32 v65, v178, v179
    v_lshlrev_b32 v180, 16, v66
    v_and_b32 v181, 0xffff0000, v66
    s_waitcnt lgkmcnt(10)
    v_fma_f32 v180, v180, v4, v12
    v_fma_f32 v181, v181, v5, v13
    v_mfma_f32_32x32x16_bf16 a[176:191], v[140:143], v[112:115], a[176:191]
    s_add_u32 s47, s39, 53248
    buffer_load_dwordx4 v[108:111], v224, s[20:23], s47 offen offset:1024
    v_cvt_pk_bf16_f32 v66, v180, v181
    v_lshlrev_b32 v182, 16, v67
    v_and_b32 v183, 0xffff0000, v67
    v_fma_f32 v182, v182, v6, v14
    v_fma_f32 v183, v183, v7, v15
    v_cvt_pk_bf16_f32 v67, v182, v183
    v_mfma_f32_32x32x16_bf16 a[240:255], v[140:143], v[116:119], a[240:255]
    ds_read_b64_tr_b16 v[156:157], v231 offset:61440
    ds_read_b64_tr_b16 v[158:159], v231 offset:62464
    s_waitcnt vmcnt(14)
    v_lshlrev_b32 v176, 16, v68
    v_and_b32 v177, 0xffff0000, v68
    v_fma_f32 v176, v176, v0, v8
    v_fma_f32 v177, v177, v1, v9
    v_cvt_pk_bf16_f32 v68, v176, v177
    v_lshlrev_b32 v178, 16, v69
    v_and_b32 v179, 0xffff0000, v69
    s_waitcnt lgkmcnt(6)
    v_mfma_f32_32x32x16_bf16 a[128:143], v[144:147], v[120:123], a[128:143]
    v_fma_f32 v178, v178, v2, v10
    v_fma_f32 v179, v179, v3, v11
    v_cvt_pk_bf16_f32 v69, v178, v179
    v_lshlrev_b32 v180, 16, v70
    v_and_b32 v181, 0xffff0000, v70
    v_fma_f32 v180, v180, v4, v12
    v_fma_f32 v181, v181, v5, v13
    v_mfma_f32_32x32x16_bf16 a[192:207], v[144:147], v[124:127], a[192:207]
    v_add_u32 v228, 0x10000, v228
    v_add_u32 v229, 0x10000, v229
    v_add_u32 v230, 0x10000, v230
    v_add_u32 v231, 0x10000, v231
    ds_read_b64_tr_b16 v[128:129], v228 offset:0
    ds_read_b64_tr_b16 v[130:131], v228 offset:1024
    v_cvt_pk_bf16_f32 v70, v180, v181
    v_lshlrev_b32 v182, 16, v71
    v_and_b32 v183, 0xffff0000, v71
    v_fma_f32 v182, v182, v6, v14
    v_fma_f32 v183, v183, v7, v15
    v_cvt_pk_bf16_f32 v71, v182, v183
    s_waitcnt lgkmcnt(6)
    v_mfma_f32_32x32x16_bf16 a[144:159], v[148:151], v[120:123], a[144:159]
    s_waitcnt vmcnt(13)
    v_lshlrev_b32 v176, 16, v72
    v_and_b32 v177, 0xffff0000, v72
    v_fma_f32 v176, v176, v16, v24
    v_fma_f32 v177, v177, v17, v25
    v_cvt_pk_bf16_f32 v72, v176, v177
    v_lshlrev_b32 v178, 16, v73
    v_and_b32 v179, 0xffff0000, v73
    v_mfma_f32_32x32x16_bf16 a[208:223], v[148:151], v[124:127], a[208:223]
    ds_read_b64_tr_b16 v[132:133], v229 offset:0
    ds_read_b64_tr_b16 v[134:135], v229 offset:1024
    v_fma_f32 v178, v178, v18, v26
    v_fma_f32 v179, v179, v19, v27
    v_cvt_pk_bf16_f32 v73, v178, v179
    v_lshlrev_b32 v180, 16, v74
    v_and_b32 v181, 0xffff0000, v74
    v_fma_f32 v180, v180, v20, v28
    v_fma_f32 v181, v181, v21, v29
    s_waitcnt lgkmcnt(6)
    v_mfma_f32_32x32x16_bf16 a[160:175], v[152:155], v[120:123], a[160:175]
    v_cvt_pk_bf16_f32 v74, v180, v181
    v_lshlrev_b32 v182, 16, v75
    v_and_b32 v183, 0xffff0000, v75
    v_fma_f32 v182, v182, v22, v30
    v_fma_f32 v183, v183, v23, v31
    v_cvt_pk_bf16_f32 v75, v182, v183
    v_mfma_f32_32x32x16_bf16 a[224:239], v[152:155], v[124:127], a[224:239]
    ds_read_b64_tr_b16 v[136:137], v230 offset:0
    ds_read_b64_tr_b16 v[138:139], v230 offset:1024
    s_waitcnt vmcnt(12)
    v_lshlrev_b32 v176, 16, v76
    v_and_b32 v177, 0xffff0000, v76
    v_fma_f32 v176, v176, v16, v24
    v_fma_f32 v177, v177, v17, v25
    v_cvt_pk_bf16_f32 v76, v176, v177
    v_lshlrev_b32 v178, 16, v77
    v_and_b32 v179, 0xffff0000, v77
    s_waitcnt lgkmcnt(6)
    v_mfma_f32_32x32x16_bf16 a[176:191], v[156:159], v[120:123], a[176:191]
    v_fma_f32 v178, v178, v18, v26
    v_fma_f32 v179, v179, v19, v27
    v_cvt_pk_bf16_f32 v77, v178, v179
    v_lshlrev_b32 v180, 16, v78
    v_and_b32 v181, 0xffff0000, v78
    v_fma_f32 v180, v180, v20, v28
    v_fma_f32 v181, v181, v21, v29
    v_mfma_f32_32x32x16_bf16 a[240:255], v[156:159], v[124:127], a[240:255]
    ds_read_b64_tr_b16 v[140:141], v231 offset:0
    ds_read_b64_tr_b16 v[142:143], v231 offset:1024
    v_cvt_pk_bf16_f32 v78, v180, v181
    v_lshlrev_b32 v182, 16, v79
    v_and_b32 v183, 0xffff0000, v79
    v_fma_f32 v182, v182, v22, v30
    v_fma_f32 v183, v183, v23, v31
    v_cvt_pk_bf16_f32 v79, v182, v183
    s_waitcnt vmcnt(16) lgkmcnt(0)
    s_barrier
    v_mfma_f32_32x32x16_bf16 a[128:143], v[128:131], v[64:67], a[128:143]
    ds_read_b128 v[0:3], v225 offset:3200
    ds_read_b128 v[4:7], v225 offset:3216
    ds_read_b128 v[8:11], v225 offset:1152
    ds_read_b128 v[12:15], v225 offset:1168
    ds_read_b128 v[16:19], v225 offset:3264
    ds_read_b128 v[20:23], v225 offset:3280
    ds_read_b128 v[24:27], v225 offset:1216
    ds_read_b128 v[28:31], v225 offset:1232
    s_add_u32 s47, s39, 22528
    buffer_load_dwordx4 v[112:115], v224, s[20:23], s47 offen offset:0
    v_mfma_f32_32x32x16_bf16 a[192:207], v[128:131], v[68:71], a[192:207]
    ds_read_b64_tr_b16 v[144:145], v228 offset:4096
    ds_read_b64_tr_b16 v[146:147], v228 offset:5120
    v_mfma_f32_32x32x16_bf16 a[144:159], v[132:135], v[64:67], a[144:159]
    s_add_u32 s47, s39, 55296
    buffer_load_dwordx4 v[116:119], v224, s[20:23], s47 offen offset:0
    v_mfma_f32_32x32x16_bf16 a[208:223], v[132:135], v[68:71], a[208:223]
    ds_read_b64_tr_b16 v[148:149], v229 offset:4096
    ds_read_b64_tr_b16 v[150:151], v229 offset:5120
    v_mfma_f32_32x32x16_bf16 a[160:175], v[136:139], v[64:67], a[160:175]
    s_add_u32 s47, s39, 22528
    buffer_load_dwordx4 v[120:123], v224, s[20:23], s47 offen offset:1024
    s_waitcnt vmcnt(14)
    v_lshlrev_b32 v176, 16, v80
    v_and_b32 v177, 0xffff0000, v80
    s_waitcnt lgkmcnt(9)
    v_fma_f32 v176, v176, v0, v8
    v_fma_f32 v177, v177, v1, v9
    v_cvt_pk_bf16_f32 v80, v176, v177
    v_lshlrev_b32 v178, 16, v81
    v_and_b32 v179, 0xffff0000, v81
    v_mfma_f32_32x32x16_bf16 a[224:239], v[136:139], v[68:71], a[224:239]
    ds_read_b64_tr_b16 v[152:153], v230 offset:4096
    ds_read_b64_tr_b16 v[154:155], v230 offset:5120
    v_fma_f32 v178, v178, v2, v10
    v_fma_f32 v179, v179, v3, v11
    v_cvt_pk_bf16_f32 v81, v178, v179
    v_lshlrev_b32 v180, 16, v82
    v_and_b32 v181, 0xffff0000, v82
    s_waitcnt lgkmcnt(10)
    v_fma_f32 v180, v180, v4, v12
    v_fma_f32 v181, v181, v5, v13
    v_mfma_f32_32x32x16_bf16 a[176:191], v[140:143], v[64:67], a[176:191]
    s_add_u32 s47, s39, 55296
    buffer_load_dwordx4 v[124:127], v224, s[20:23], s47 offen offset:1024
    v_cvt_pk_bf16_f32 v82, v180, v181
    v_lshlrev_b32 v182, 16, v83
    v_and_b32 v183, 0xffff0000, v83
    v_fma_f32 v182, v182, v6, v14
    v_fma_f32 v183, v183, v7, v15
    v_cvt_pk_bf16_f32 v83, v182, v183
    v_mfma_f32_32x32x16_bf16 a[240:255], v[140:143], v[68:71], a[240:255]
    ds_read_b64_tr_b16 v[156:157], v231 offset:4096
    ds_read_b64_tr_b16 v[158:159], v231 offset:5120
    s_waitcnt vmcnt(14)
    v_lshlrev_b32 v176, 16, v84
    v_and_b32 v177, 0xffff0000, v84
    v_fma_f32 v176, v176, v0, v8
    v_fma_f32 v177, v177, v1, v9
    v_cvt_pk_bf16_f32 v84, v176, v177
    v_lshlrev_b32 v178, 16, v85
    v_and_b32 v179, 0xffff0000, v85
    s_waitcnt lgkmcnt(6)
    v_mfma_f32_32x32x16_bf16 a[128:143], v[144:147], v[72:75], a[128:143]
    s_add_u32 m0, s42, 32768
    s_add_u32 s45, s38, 0
    buffer_load_dwordx4 v223, s[16:19], s45 offen lds
    v_fma_f32 v178, v178, v2, v10
    v_fma_f32 v179, v179, v3, v11
    v_cvt_pk_bf16_f32 v85, v178, v179
    v_lshlrev_b32 v180, 16, v86
    v_and_b32 v181, 0xffff0000, v86
    v_fma_f32 v180, v180, v4, v12
    v_fma_f32 v181, v181, v5, v13
    v_mfma_f32_32x32x16_bf16 a[192:207], v[144:147], v[76:79], a[192:207]
    ds_read_b64_tr_b16 v[128:129], v228 offset:8192
    ds_read_b64_tr_b16 v[130:131], v228 offset:9216
    v_cvt_pk_bf16_f32 v86, v180, v181
    v_lshlrev_b32 v182, 16, v87
    v_and_b32 v183, 0xffff0000, v87
    v_fma_f32 v182, v182, v6, v14
    v_fma_f32 v183, v183, v7, v15
    v_cvt_pk_bf16_f32 v87, v182, v183
    s_waitcnt lgkmcnt(6)
    v_mfma_f32_32x32x16_bf16 a[144:159], v[148:151], v[72:75], a[144:159]
    s_add_u32 m0, s42, 36864
    s_add_u32 s45, s38, 131072
    buffer_load_dwordx4 v223, s[16:19], s45 offen lds
    s_waitcnt vmcnt(15)
    v_lshlrev_b32 v176, 16, v88
    v_and_b32 v177, 0xffff0000, v88
    v_fma_f32 v176, v176, v16, v24
    v_fma_f32 v177, v177, v17, v25
    v_cvt_pk_bf16_f32 v88, v176, v177
    v_lshlrev_b32 v178, 16, v89
    v_and_b32 v179, 0xffff0000, v89
    v_mfma_f32_32x32x16_bf16 a[208:223], v[148:151], v[76:79], a[208:223]
    ds_read_b64_tr_b16 v[132:133], v229 offset:8192
    ds_read_b64_tr_b16 v[134:135], v229 offset:9216
    v_fma_f32 v178, v178, v18, v26
    v_fma_f32 v179, v179, v19, v27
    v_cvt_pk_bf16_f32 v89, v178, v179
    v_lshlrev_b32 v180, 16, v90
    v_and_b32 v181, 0xffff0000, v90
    v_fma_f32 v180, v180, v20, v28
    v_fma_f32 v181, v181, v21, v29
    s_waitcnt lgkmcnt(6)
    v_mfma_f32_32x32x16_bf16 a[160:175], v[152:155], v[72:75], a[160:175]
    s_add_u32 m0, s42, 40960
    s_add_u32 s45, s38, 262144
    buffer_load_dwordx4 v223, s[16:19], s45 offen lds
    v_cvt_pk_bf16_f32 v90, v180, v181
    v_lshlrev_b32 v182, 16, v91
    v_and_b32 v183, 0xffff0000, v91
    v_fma_f32 v182, v182, v22, v30
    v_fma_f32 v183, v183, v23, v31
    v_cvt_pk_bf16_f32 v91, v182, v183
    v_mfma_f32_32x32x16_bf16 a[224:239], v[152:155], v[76:79], a[224:239]
    ds_read_b64_tr_b16 v[136:137], v230 offset:8192
    ds_read_b64_tr_b16 v[138:139], v230 offset:9216
    s_waitcnt vmcnt(15)
    v_lshlrev_b32 v176, 16, v92
    v_and_b32 v177, 0xffff0000, v92
    v_fma_f32 v176, v176, v16, v24
    v_fma_f32 v177, v177, v17, v25
    v_cvt_pk_bf16_f32 v92, v176, v177
    v_lshlrev_b32 v178, 16, v93
    v_and_b32 v179, 0xffff0000, v93
    s_waitcnt lgkmcnt(6)
    v_mfma_f32_32x32x16_bf16 a[176:191], v[156:159], v[72:75], a[176:191]
    s_add_u32 m0, s42, 45056
    s_add_u32 s45, s38, 393216
    buffer_load_dwordx4 v223, s[16:19], s45 offen lds
    s_add_u32 s38, s38, 524288
    v_fma_f32 v178, v178, v18, v26
    v_fma_f32 v179, v179, v19, v27
    v_cvt_pk_bf16_f32 v93, v178, v179
    v_lshlrev_b32 v180, 16, v94
    v_and_b32 v181, 0xffff0000, v94
    v_fma_f32 v180, v180, v20, v28
    v_fma_f32 v181, v181, v21, v29
    v_mfma_f32_32x32x16_bf16 a[240:255], v[156:159], v[76:79], a[240:255]
    ds_read_b64_tr_b16 v[140:141], v231 offset:8192
    ds_read_b64_tr_b16 v[142:143], v231 offset:9216
    v_cvt_pk_bf16_f32 v94, v180, v181
    v_lshlrev_b32 v182, 16, v95
    v_and_b32 v183, 0xffff0000, v95
    v_fma_f32 v182, v182, v22, v30
    v_fma_f32 v183, v183, v23, v31
    v_cvt_pk_bf16_f32 v95, v182, v183
    s_waitcnt lgkmcnt(6)
    v_mfma_f32_32x32x16_bf16 a[128:143], v[128:131], v[80:83], a[128:143]
    ds_read_b128 v[0:3], v225 offset:3328
    ds_read_b128 v[4:7], v225 offset:3344
    ds_read_b128 v[8:11], v225 offset:1280
    ds_read_b128 v[12:15], v225 offset:1296
    ds_read_b128 v[16:19], v225 offset:3392
    ds_read_b128 v[20:23], v225 offset:3408
    ds_read_b128 v[24:27], v225 offset:1344
    ds_read_b128 v[28:31], v225 offset:1360
    s_add_u32 s47, s39, 24576
    buffer_load_dwordx4 v[64:67], v224, s[20:23], s47 offen offset:0
    v_mfma_f32_32x32x16_bf16 a[192:207], v[128:131], v[84:87], a[192:207]
    ds_read_b64_tr_b16 v[144:145], v228 offset:12288
    ds_read_b64_tr_b16 v[146:147], v228 offset:13312
    s_waitcnt lgkmcnt(14)
    v_mfma_f32_32x32x16_bf16 a[144:159], v[132:135], v[80:83], a[144:159]
    s_add_u32 s47, s39, 57344
    buffer_load_dwordx4 v[68:71], v224, s[20:23], s47 offen offset:0
    v_mfma_f32_32x32x16_bf16 a[208:223], v[132:135], v[84:87], a[208:223]
    ds_read_b64_tr_b16 v[148:149], v229 offset:12288
    ds_read_b64_tr_b16 v[150:151], v229 offset:13312
    s_waitcnt lgkmcnt(14)
    v_mfma_f32_32x32x16_bf16 a[160:175], v[136:139], v[80:83], a[160:175]
    s_add_u32 s47, s39, 24576
    buffer_load_dwordx4 v[72:75], v224, s[20:23], s47 offen offset:1024
    s_waitcnt vmcnt(14)
    v_lshlrev_b32 v176, 16, v96
    v_and_b32 v177, 0xffff0000, v96
    s_waitcnt lgkmcnt(9)
    v_fma_f32 v176, v176, v0, v8
    v_fma_f32 v177, v177, v1, v9
    v_cvt_pk_bf16_f32 v96, v176, v177
    v_lshlrev_b32 v178, 16, v97
    v_and_b32 v179, 0xffff0000, v97
    v_mfma_f32_32x32x16_bf16 a[224:239], v[136:139], v[84:87], a[224:239]
    ds_read_b64_tr_b16 v[152:153], v230 offset:12288
    ds_read_b64_tr_b16 v[154:155], v230 offset:13312
    v_fma_f32 v178, v178, v2, v10
    v_fma_f32 v179, v179, v3, v11
    v_cvt_pk_bf16_f32 v97, v178, v179
    v_lshlrev_b32 v180, 16, v98
    v_and_b32 v181, 0xffff0000, v98
    s_waitcnt lgkmcnt(10)
    v_fma_f32 v180, v180, v4, v12
    v_fma_f32 v181, v181, v5, v13
    v_mfma_f32_32x32x16_bf16 a[176:191], v[140:143], v[80:83], a[176:191]
    s_add_u32 s47, s39, 57344
    buffer_load_dwordx4 v[76:79], v224, s[20:23], s47 offen offset:1024
    v_cvt_pk_bf16_f32 v98, v180, v181
    v_lshlrev_b32 v182, 16, v99
    v_and_b32 v183, 0xffff0000, v99
    v_fma_f32 v182, v182, v6, v14
    v_fma_f32 v183, v183, v7, v15
    v_cvt_pk_bf16_f32 v99, v182, v183
    v_mfma_f32_32x32x16_bf16 a[240:255], v[140:143], v[84:87], a[240:255]
    ds_read_b64_tr_b16 v[156:157], v231 offset:12288
    ds_read_b64_tr_b16 v[158:159], v231 offset:13312
    s_waitcnt vmcnt(14)
    v_lshlrev_b32 v176, 16, v100
    v_and_b32 v177, 0xffff0000, v100
    v_fma_f32 v176, v176, v0, v8
    v_fma_f32 v177, v177, v1, v9
    v_cvt_pk_bf16_f32 v100, v176, v177
    v_lshlrev_b32 v178, 16, v101
    v_and_b32 v179, 0xffff0000, v101
    s_waitcnt lgkmcnt(6)
    v_mfma_f32_32x32x16_bf16 a[128:143], v[144:147], v[88:91], a[128:143]
    v_fma_f32 v178, v178, v2, v10
    v_fma_f32 v179, v179, v3, v11
    v_cvt_pk_bf16_f32 v101, v178, v179
    v_lshlrev_b32 v180, 16, v102
    v_and_b32 v181, 0xffff0000, v102
    v_fma_f32 v180, v180, v4, v12
    v_fma_f32 v181, v181, v5, v13
    v_mfma_f32_32x32x16_bf16 a[192:207], v[144:147], v[92:95], a[192:207]
    ds_read_b64_tr_b16 v[128:129], v228 offset:16384
    ds_read_b64_tr_b16 v[130:131], v228 offset:17408
    v_cvt_pk_bf16_f32 v102, v180, v181
    v_lshlrev_b32 v182, 16, v103
    v_and_b32 v183, 0xffff0000, v103
    v_fma_f32 v182, v182, v6, v14
    v_fma_f32 v183, v183, v7, v15
    v_cvt_pk_bf16_f32 v103, v182, v183
    s_waitcnt lgkmcnt(6)
    v_mfma_f32_32x32x16_bf16 a[144:159], v[148:151], v[88:91], a[144:159]
    s_waitcnt vmcnt(13)
    v_lshlrev_b32 v176, 16, v104
    v_and_b32 v177, 0xffff0000, v104
    v_fma_f32 v176, v176, v16, v24
    v_fma_f32 v177, v177, v17, v25
    v_cvt_pk_bf16_f32 v104, v176, v177
    v_lshlrev_b32 v178, 16, v105
    v_and_b32 v179, 0xffff0000, v105
    v_mfma_f32_32x32x16_bf16 a[208:223], v[148:151], v[92:95], a[208:223]
    ds_read_b64_tr_b16 v[132:133], v229 offset:16384
    ds_read_b64_tr_b16 v[134:135], v229 offset:17408
    v_fma_f32 v178, v178, v18, v26
    v_fma_f32 v179, v179, v19, v27
    v_cvt_pk_bf16_f32 v105, v178, v179
    v_lshlrev_b32 v180, 16, v106
    v_and_b32 v181, 0xffff0000, v106
    v_fma_f32 v180, v180, v20, v28
    v_fma_f32 v181, v181, v21, v29
    s_waitcnt lgkmcnt(6)
    v_mfma_f32_32x32x16_bf16 a[160:175], v[152:155], v[88:91], a[160:175]
    v_cvt_pk_bf16_f32 v106, v180, v181
    v_lshlrev_b32 v182, 16, v107
    v_and_b32 v183, 0xffff0000, v107
    v_fma_f32 v182, v182, v22, v30
    v_fma_f32 v183, v183, v23, v31
    v_cvt_pk_bf16_f32 v107, v182, v183
    v_mfma_f32_32x32x16_bf16 a[224:239], v[152:155], v[92:95], a[224:239]
    ds_read_b64_tr_b16 v[136:137], v230 offset:16384
    ds_read_b64_tr_b16 v[138:139], v230 offset:17408
    s_waitcnt vmcnt(12)
    v_lshlrev_b32 v176, 16, v108
    v_and_b32 v177, 0xffff0000, v108
    v_fma_f32 v176, v176, v16, v24
    v_fma_f32 v177, v177, v17, v25
    v_cvt_pk_bf16_f32 v108, v176, v177
    v_lshlrev_b32 v178, 16, v109
    v_and_b32 v179, 0xffff0000, v109
    s_waitcnt lgkmcnt(6)
    v_mfma_f32_32x32x16_bf16 a[176:191], v[156:159], v[88:91], a[176:191]
    v_fma_f32 v178, v178, v18, v26
    v_fma_f32 v179, v179, v19, v27
    v_cvt_pk_bf16_f32 v109, v178, v179
    v_lshlrev_b32 v180, 16, v110
    v_and_b32 v181, 0xffff0000, v110
    v_fma_f32 v180, v180, v20, v28
    v_fma_f32 v181, v181, v21, v29
    v_mfma_f32_32x32x16_bf16 a[240:255], v[156:159], v[92:95], a[240:255]
    ds_read_b64_tr_b16 v[140:141], v231 offset:16384
    ds_read_b64_tr_b16 v[142:143], v231 offset:17408
    v_cvt_pk_bf16_f32 v110, v180, v181
    v_lshlrev_b32 v182, 16, v111
    v_and_b32 v183, 0xffff0000, v111
    v_fma_f32 v182, v182, v22, v30
    v_fma_f32 v183, v183, v23, v31
    v_cvt_pk_bf16_f32 v111, v182, v183
    s_waitcnt vmcnt(16) lgkmcnt(0)
    s_barrier
    v_mfma_f32_32x32x16_bf16 a[128:143], v[128:131], v[96:99], a[128:143]
    ds_read_b128 v[0:3], v225 offset:3456
    ds_read_b128 v[4:7], v225 offset:3472
    ds_read_b128 v[8:11], v225 offset:1408
    ds_read_b128 v[12:15], v225 offset:1424
    ds_read_b128 v[16:19], v225 offset:3520
    ds_read_b128 v[20:23], v225 offset:3536
    ds_read_b128 v[24:27], v225 offset:1472
    ds_read_b128 v[28:31], v225 offset:1488
    s_add_u32 s47, s39, 26624
    buffer_load_dwordx4 v[80:83], v224, s[20:23], s47 offen offset:0
    s_add_u32 s47, s39, 59392
    buffer_load_dwordx4 v[84:87], v224, s[20:23], s47 offen offset:0
    v_mfma_f32_32x32x16_bf16 a[192:207], v[128:131], v[100:103], a[192:207]
    ds_read_b64_tr_b16 v[144:145], v228 offset:20480
    ds_read_b64_tr_b16 v[146:147], v228 offset:21504
    v_mfma_f32_32x32x16_bf16 a[144:159], v[132:135], v[96:99], a[144:159]
    s_add_u32 s47, s39, 26624
    buffer_load_dwordx4 v[88:91], v224, s[20:23], s47 offen offset:1024
    s_add_u32 s47, s39, 59392
    buffer_load_dwordx4 v[92:95], v224, s[20:23], s47 offen offset:1024
    v_mfma_f32_32x32x16_bf16 a[208:223], v[132:135], v[100:103], a[208:223]
    ds_read_b64_tr_b16 v[148:149], v229 offset:20480
    ds_read_b64_tr_b16 v[150:151], v229 offset:21504
    v_mfma_f32_32x32x16_bf16 a[160:175], v[136:139], v[96:99], a[160:175]
    s_add_u32 m0, s49, 0
    s_nop 0
    buffer_load_dwordx4 v240, s[8:11], s43 offen offset:0 lds
    buffer_load_dwordx4 v241, s[8:11], s43 offen offset:1024 lds
    s_waitcnt vmcnt(17)
    v_lshlrev_b32 v176, 16, v112
    v_and_b32 v177, 0xffff0000, v112
    s_waitcnt lgkmcnt(9)
    v_fma_f32 v176, v176, v0, v8
    v_fma_f32 v177, v177, v1, v9
    v_cvt_pk_bf16_f32 v112, v176, v177
    v_lshlrev_b32 v178, 16, v113
    v_and_b32 v179, 0xffff0000, v113
    v_mfma_f32_32x32x16_bf16 a[224:239], v[136:139], v[100:103], a[224:239]
    ds_read_b64_tr_b16 v[152:153], v230 offset:20480
    ds_read_b64_tr_b16 v[154:155], v230 offset:21504
    v_fma_f32 v178, v178, v2, v10
    v_fma_f32 v179, v179, v3, v11
    v_cvt_pk_bf16_f32 v113, v178, v179
    v_lshlrev_b32 v180, 16, v114
    v_and_b32 v181, 0xffff0000, v114
    s_waitcnt lgkmcnt(10)
    v_fma_f32 v180, v180, v4, v12
    v_fma_f32 v181, v181, v5, v13
    v_mfma_f32_32x32x16_bf16 a[176:191], v[140:143], v[96:99], a[176:191]
    buffer_load_dwordx4 v242, s[8:11], s43 offen offset:2048 lds
    buffer_load_dwordx4 v243, s[8:11], s43 offen offset:3072 lds
    s_add_u32 s43, s43, 16384
    v_cvt_pk_bf16_f32 v114, v180, v181
    v_lshlrev_b32 v182, 16, v115
    v_and_b32 v183, 0xffff0000, v115
    v_fma_f32 v182, v182, v6, v14
    v_fma_f32 v183, v183, v7, v15
    v_cvt_pk_bf16_f32 v115, v182, v183
    v_mfma_f32_32x32x16_bf16 a[240:255], v[140:143], v[100:103], a[240:255]
    ds_read_b64_tr_b16 v[156:157], v231 offset:20480
    ds_read_b64_tr_b16 v[158:159], v231 offset:21504
    s_waitcnt vmcnt(18)
    v_lshlrev_b32 v176, 16, v116
    v_and_b32 v177, 0xffff0000, v116
    v_fma_f32 v176, v176, v0, v8
    v_fma_f32 v177, v177, v1, v9
    v_cvt_pk_bf16_f32 v116, v176, v177
    v_lshlrev_b32 v178, 16, v117
    v_and_b32 v179, 0xffff0000, v117
    s_waitcnt lgkmcnt(6)
    v_mfma_f32_32x32x16_bf16 a[128:143], v[144:147], v[104:107], a[128:143]
    s_add_u32 m0, s49, 16384
    s_nop 0
    buffer_load_dwordx4 v240, s[8:11], s43 offen offset:0 lds
    v_fma_f32 v178, v178, v2, v10
    v_fma_f32 v179, v179, v3, v11
    v_cvt_pk_bf16_f32 v117, v178, v179
    v_lshlrev_b32 v180, 16, v118
    v_and_b32 v181, 0xffff0000, v118
    v_fma_f32 v180, v180, v4, v12
    v_fma_f32 v181, v181, v5, v13
    v_mfma_f32_32x32x16_bf16 a[192:207], v[144:147], v[108:111], a[192:207]
    ds_read_b64_tr_b16 v[128:129], v228 offset:24576
    ds_read_b64_tr_b16 v[130:131], v228 offset:25600
    v_cvt_pk_bf16_f32 v118, v180, v181
    v_lshlrev_b32 v182, 16, v119
    v_and_b32 v183, 0xffff0000, v119
    v_fma_f32 v182, v182, v6, v14
    v_fma_f32 v183, v183, v7, v15
    v_cvt_pk_bf16_f32 v119, v182, v183
    s_waitcnt lgkmcnt(6)
    v_mfma_f32_32x32x16_bf16 a[144:159], v[148:151], v[104:107], a[144:159]
    buffer_load_dwordx4 v241, s[8:11], s43 offen offset:1024 lds
    s_waitcnt vmcnt(19)
    v_lshlrev_b32 v176, 16, v120
    v_and_b32 v177, 0xffff0000, v120
    v_fma_f32 v176, v176, v16, v24
    v_fma_f32 v177, v177, v17, v25
    v_cvt_pk_bf16_f32 v120, v176, v177
    v_lshlrev_b32 v178, 16, v121
    v_and_b32 v179, 0xffff0000, v121
    v_mfma_f32_32x32x16_bf16 a[208:223], v[148:151], v[108:111], a[208:223]
    ds_read_b64_tr_b16 v[132:133], v229 offset:24576
    ds_read_b64_tr_b16 v[134:135], v229 offset:25600
    v_fma_f32 v178, v178, v18, v26
    v_fma_f32 v179, v179, v19, v27
    v_cvt_pk_bf16_f32 v121, v178, v179
    v_lshlrev_b32 v180, 16, v122
    v_and_b32 v181, 0xffff0000, v122
    v_fma_f32 v180, v180, v20, v28
    v_fma_f32 v181, v181, v21, v29
    s_waitcnt lgkmcnt(6)
    v_mfma_f32_32x32x16_bf16 a[160:175], v[152:155], v[104:107], a[160:175]
    buffer_load_dwordx4 v242, s[8:11], s43 offen offset:2048 lds
    v_cvt_pk_bf16_f32 v122, v180, v181
    v_lshlrev_b32 v182, 16, v123
    v_and_b32 v183, 0xffff0000, v123
    v_fma_f32 v182, v182, v22, v30
    v_fma_f32 v183, v183, v23, v31
    v_cvt_pk_bf16_f32 v123, v182, v183
    v_mfma_f32_32x32x16_bf16 a[224:239], v[152:155], v[108:111], a[224:239]
    ds_read_b64_tr_b16 v[136:137], v230 offset:24576
    ds_read_b64_tr_b16 v[138:139], v230 offset:25600
    s_waitcnt vmcnt(19)
    v_lshlrev_b32 v176, 16, v124
    v_and_b32 v177, 0xffff0000, v124
    v_fma_f32 v176, v176, v16, v24
    v_fma_f32 v177, v177, v17, v25
    v_cvt_pk_bf16_f32 v124, v176, v177
    v_lshlrev_b32 v178, 16, v125
    v_and_b32 v179, 0xffff0000, v125
    s_waitcnt lgkmcnt(6)
    v_mfma_f32_32x32x16_bf16 a[176:191], v[156:159], v[104:107], a[176:191]
    buffer_load_dwordx4 v243, s[8:11], s43 offen offset:3072 lds
    s_add_u32 s43, s43, 16384
    v_fma_f32 v178, v178, v18, v26
    v_fma_f32 v179, v179, v19, v27
    v_cvt_pk_bf16_f32 v125, v178, v179
    v_lshlrev_b32 v180, 16, v126
    v_and_b32 v181, 0xffff0000, v126
    v_fma_f32 v180, v180, v20, v28
    v_fma_f32 v181, v181, v21, v29
    v_mfma_f32_32x32x16_bf16 a[240:255], v[156:159], v[108:111], a[240:255]
    ds_read_b64_tr_b16 v[140:141], v231 offset:24576
    ds_read_b64_tr_b16 v[142:143], v231 offset:25600
    v_cvt_pk_bf16_f32 v126, v180, v181
    v_lshlrev_b32 v182, 16, v127
    v_and_b32 v183, 0xffff0000, v127
    v_fma_f32 v182, v182, v22, v30
    v_fma_f32 v183, v183, v23, v31
    v_cvt_pk_bf16_f32 v127, v182, v183
    s_waitcnt lgkmcnt(6)
    v_mfma_f32_32x32x16_bf16 a[128:143], v[128:131], v[112:115], a[128:143]
    ds_read_b128 v[0:3], v225 offset:3584
    ds_read_b128 v[4:7], v225 offset:3600
    ds_read_b128 v[8:11], v225 offset:1536
    ds_read_b128 v[12:15], v225 offset:1552
    ds_read_b128 v[16:19], v225 offset:3648
    ds_read_b128 v[20:23], v225 offset:3664
    ds_read_b128 v[24:27], v225 offset:1600
    ds_read_b128 v[28:31], v225 offset:1616
    s_add_u32 s47, s39, 28672
    buffer_load_dwordx4 v[96:99], v224, s[20:23], s47 offen offset:0
    v_mfma_f32_32x32x16_bf16 a[192:207], v[128:131], v[116:119], a[192:207]
    ds_read_b64_tr_b16 v[144:145], v228 offset:28672
    ds_read_b64_tr_b16 v[146:147], v228 offset:29696
    s_waitcnt lgkmcnt(14)
    v_mfma_f32_32x32x16_bf16 a[144:159], v[132:135], v[112:115], a[144:159]
    s_add_u32 s47, s39, 61440
    buffer_load_dwordx4 v[100:103], v224, s[20:23], s47 offen offset:0
    v_mfma_f32_32x32x16_bf16 a[208:223], v[132:135], v[116:119], a[208:223]
    ds_read_b64_tr_b16 v[148:149], v229 offset:28672
    ds_read_b64_tr_b16 v[150:151], v229 offset:29696
    s_waitcnt lgkmcnt(14)
    v_mfma_f32_32x32x16_bf16 a[160:175], v[136:139], v[112:115], a[160:175]
    s_add_u32 s47, s39, 28672
    buffer_load_dwordx4 v[104:107], v224, s[20:23], s47 offen offset:1024
    s_waitcnt vmcnt(18)
    v_lshlrev_b32 v176, 16, v64
    v_and_b32 v177, 0xffff0000, v64
    s_waitcnt lgkmcnt(9)
    v_fma_f32 v176, v176, v0, v8
    v_fma_f32 v177, v177, v1, v9
    v_cvt_pk_bf16_f32 v64, v176, v177
    v_lshlrev_b32 v178, 16, v65
    v_and_b32 v179, 0xffff0000, v65
    v_mfma_f32_32x32x16_bf16 a[224:239], v[136:139], v[116:119], a[224:239]
    ds_read_b64_tr_b16 v[152:153], v230 offset:28672
    ds_read_b64_tr_b16 v[154:155], v230 offset:29696
    v_fma_f32 v178, v178, v2, v10
    v_fma_f32 v179, v179, v3, v11
    v_cvt_pk_bf16_f32 v65, v178, v179
    v_lshlrev_b32 v180, 16, v66
    v_and_b32 v181, 0xffff0000, v66
    s_waitcnt lgkmcnt(10)
    v_fma_f32 v180, v180, v4, v12
    v_fma_f32 v181, v181, v5, v13
    v_mfma_f32_32x32x16_bf16 a[176:191], v[140:143], v[112:115], a[176:191]
    s_add_u32 s47, s39, 61440
    buffer_load_dwordx4 v[108:111], v224, s[20:23], s47 offen offset:1024
    v_cvt_pk_bf16_f32 v66, v180, v181
    v_lshlrev_b32 v182, 16, v67
    v_and_b32 v183, 0xffff0000, v67
    v_fma_f32 v182, v182, v6, v14
    v_fma_f32 v183, v183, v7, v15
    v_cvt_pk_bf16_f32 v67, v182, v183
    v_mfma_f32_32x32x16_bf16 a[240:255], v[140:143], v[116:119], a[240:255]
    ds_read_b64_tr_b16 v[156:157], v231 offset:28672
    ds_read_b64_tr_b16 v[158:159], v231 offset:29696
    s_waitcnt vmcnt(18)
    v_lshlrev_b32 v176, 16, v68
    v_and_b32 v177, 0xffff0000, v68
    v_fma_f32 v176, v176, v0, v8
    v_fma_f32 v177, v177, v1, v9
    v_cvt_pk_bf16_f32 v68, v176, v177
    v_lshlrev_b32 v178, 16, v69
    v_and_b32 v179, 0xffff0000, v69
    s_waitcnt lgkmcnt(6)
    v_mfma_f32_32x32x16_bf16 a[128:143], v[144:147], v[120:123], a[128:143]
    v_fma_f32 v178, v178, v2, v10
    v_fma_f32 v179, v179, v3, v11
    v_cvt_pk_bf16_f32 v69, v178, v179
    v_lshlrev_b32 v180, 16, v70
    v_and_b32 v181, 0xffff0000, v70
    v_fma_f32 v180, v180, v4, v12
    v_fma_f32 v181, v181, v5, v13
    v_mfma_f32_32x32x16_bf16 a[192:207], v[144:147], v[124:127], a[192:207]
    ds_read_b64_tr_b16 v[128:129], v228 offset:32768
    ds_read_b64_tr_b16 v[130:131], v228 offset:33792
    v_cvt_pk_bf16_f32 v70, v180, v181
    v_lshlrev_b32 v182, 16, v71
    v_and_b32 v183, 0xffff0000, v71
    v_fma_f32 v182, v182, v6, v14
    v_fma_f32 v183, v183, v7, v15
    v_cvt_pk_bf16_f32 v71, v182, v183
    s_waitcnt lgkmcnt(6)
    v_mfma_f32_32x32x16_bf16 a[144:159], v[148:151], v[120:123], a[144:159]
    s_waitcnt vmcnt(17)
    v_lshlrev_b32 v176, 16, v72
    v_and_b32 v177, 0xffff0000, v72
    v_fma_f32 v176, v176, v16, v24
    v_fma_f32 v177, v177, v17, v25
    v_cvt_pk_bf16_f32 v72, v176, v177
    v_lshlrev_b32 v178, 16, v73
    v_and_b32 v179, 0xffff0000, v73
    v_mfma_f32_32x32x16_bf16 a[208:223], v[148:151], v[124:127], a[208:223]
    ds_read_b64_tr_b16 v[132:133], v229 offset:32768
    ds_read_b64_tr_b16 v[134:135], v229 offset:33792
    v_fma_f32 v178, v178, v18, v26
    v_fma_f32 v179, v179, v19, v27
    v_cvt_pk_bf16_f32 v73, v178, v179
    v_lshlrev_b32 v180, 16, v74
    v_and_b32 v181, 0xffff0000, v74
    v_fma_f32 v180, v180, v20, v28
    v_fma_f32 v181, v181, v21, v29
    s_waitcnt lgkmcnt(6)
    v_mfma_f32_32x32x16_bf16 a[160:175], v[152:155], v[120:123], a[160:175]
    v_cvt_pk_bf16_f32 v74, v180, v181
    v_lshlrev_b32 v182, 16, v75
    v_and_b32 v183, 0xffff0000, v75
    v_fma_f32 v182, v182, v22, v30
    v_fma_f32 v183, v183, v23, v31
    v_cvt_pk_bf16_f32 v75, v182, v183
    v_mfma_f32_32x32x16_bf16 a[224:239], v[152:155], v[124:127], a[224:239]
    ds_read_b64_tr_b16 v[136:137], v230 offset:32768
    ds_read_b64_tr_b16 v[138:139], v230 offset:33792
    s_waitcnt vmcnt(16)
    v_lshlrev_b32 v176, 16, v76
    v_and_b32 v177, 0xffff0000, v76
    v_fma_f32 v176, v176, v16, v24
    v_fma_f32 v177, v177, v17, v25
    v_cvt_pk_bf16_f32 v76, v176, v177
    v_lshlrev_b32 v178, 16, v77
    v_and_b32 v179, 0xffff0000, v77
    s_waitcnt lgkmcnt(6)
    v_mfma_f32_32x32x16_bf16 a[176:191], v[156:159], v[120:123], a[176:191]
    v_fma_f32 v178, v178, v18, v26
    v_fma_f32 v179, v179, v19, v27
    v_cvt_pk_bf16_f32 v77, v178, v179
    v_lshlrev_b32 v180, 16, v78
    v_and_b32 v181, 0xffff0000, v78
    v_fma_f32 v180, v180, v20, v28
    v_fma_f32 v181, v181, v21, v29
    v_mfma_f32_32x32x16_bf16 a[240:255], v[156:159], v[124:127], a[240:255]
    ds_read_b64_tr_b16 v[140:141], v231 offset:32768
    ds_read_b64_tr_b16 v[142:143], v231 offset:33792
    v_cvt_pk_bf16_f32 v78, v180, v181
    v_lshlrev_b32 v182, 16, v79
    v_and_b32 v183, 0xffff0000, v79
    v_fma_f32 v182, v182, v22, v30
    v_fma_f32 v183, v183, v23, v31
    v_cvt_pk_bf16_f32 v79, v182, v183
    s_waitcnt vmcnt(20) lgkmcnt(0)
    s_barrier
    v_mfma_f32_32x32x16_bf16 a[128:143], v[128:131], v[64:67], a[128:143]
    ds_read_b128 v[0:3], v225 offset:3712
    ds_read_b128 v[4:7], v225 offset:3728
    ds_read_b128 v[8:11], v225 offset:1664
    ds_read_b128 v[12:15], v225 offset:1680
    ds_read_b128 v[16:19], v225 offset:3776
    ds_read_b128 v[20:23], v225 offset:3792
    ds_read_b128 v[24:27], v225 offset:1728
    ds_read_b128 v[28:31], v225 offset:1744
    s_add_u32 s47, s39, 30720
    buffer_load_dwordx4 v[112:115], v224, s[20:23], s47 offen offset:0
    s_add_u32 s47, s39, 63488
    buffer_load_dwordx4 v[116:119], v224, s[20:23], s47 offen offset:0
    v_mfma_f32_32x32x16_bf16 a[192:207], v[128:131], v[68:71], a[192:207]
    ds_read_b64_tr_b16 v[144:145], v228 offset:36864
    ds_read_b64_tr_b16 v[146:147], v228 offset:37888
    v_mfma_f32_32x32x16_bf16 a[144:159], v[132:135], v[64:67], a[144:159]
    s_add_u32 s47, s39, 30720
    buffer_load_dwordx4 v[120:123], v224, s[20:23], s47 offen offset:1024
    s_add_u32 s47, s39, 63488
    buffer_load_dwordx4 v[124:127], v224, s[20:23], s47 offen offset:1024
    v_mfma_f32_32x32x16_bf16 a[208:223], v[132:135], v[68:71], a[208:223]
    ds_read_b64_tr_b16 v[148:149], v229 offset:36864
    ds_read_b64_tr_b16 v[150:151], v229 offset:37888
    v_mfma_f32_32x32x16_bf16 a[160:175], v[136:139], v[64:67], a[160:175]
    s_add_u32 m0, s49, 65536
    s_nop 0
    buffer_load_dwordx4 v244, s[12:15], s44 offen offset:0 lds
    buffer_load_dwordx4 v245, s[12:15], s44 offen offset:1024 lds
    s_waitcnt vmcnt(21)
    v_lshlrev_b32 v176, 16, v80
    v_and_b32 v177, 0xffff0000, v80
    s_waitcnt lgkmcnt(9)
    v_fma_f32 v176, v176, v0, v8
    v_fma_f32 v177, v177, v1, v9
    v_cvt_pk_bf16_f32 v80, v176, v177
    v_lshlrev_b32 v178, 16, v81
    v_and_b32 v179, 0xffff0000, v81
    v_mfma_f32_32x32x16_bf16 a[224:239], v[136:139], v[68:71], a[224:239]
    ds_read_b64_tr_b16 v[152:153], v230 offset:36864
    ds_read_b64_tr_b16 v[154:155], v230 offset:37888
    v_fma_f32 v178, v178, v2, v10
    v_fma_f32 v179, v179, v3, v11
    v_cvt_pk_bf16_f32 v81, v178, v179
    v_lshlrev_b32 v180, 16, v82
    v_and_b32 v181, 0xffff0000, v82
    s_waitcnt lgkmcnt(10)
    v_fma_f32 v180, v180, v4, v12
    v_fma_f32 v181, v181, v5, v13
    v_mfma_f32_32x32x16_bf16 a[176:191], v[140:143], v[64:67], a[176:191]
    buffer_load_dwordx4 v244, s[12:15], s44 offen offset:2048 lds
    buffer_load_dwordx4 v245, s[12:15], s44 offen offset:3072 lds
    s_add_u32 s44, s44, 16384
    v_cvt_pk_bf16_f32 v82, v180, v181
    v_lshlrev_b32 v182, 16, v83
    v_and_b32 v183, 0xffff0000, v83
    v_fma_f32 v182, v182, v6, v14
    v_fma_f32 v183, v183, v7, v15
    v_cvt_pk_bf16_f32 v83, v182, v183
    v_mfma_f32_32x32x16_bf16 a[240:255], v[140:143], v[68:71], a[240:255]
    ds_read_b64_tr_b16 v[156:157], v231 offset:36864
    ds_read_b64_tr_b16 v[158:159], v231 offset:37888
    s_waitcnt vmcnt(22)
    v_lshlrev_b32 v176, 16, v84
    v_and_b32 v177, 0xffff0000, v84
    v_fma_f32 v176, v176, v0, v8
    v_fma_f32 v177, v177, v1, v9
    v_cvt_pk_bf16_f32 v84, v176, v177
    v_lshlrev_b32 v178, 16, v85
    v_and_b32 v179, 0xffff0000, v85
    s_waitcnt lgkmcnt(6)
    v_mfma_f32_32x32x16_bf16 a[128:143], v[144:147], v[72:75], a[128:143]
    s_add_u32 m0, s49, 81920
    s_nop 0
    buffer_load_dwordx4 v244, s[12:15], s44 offen offset:0 lds
    v_fma_f32 v178, v178, v2, v10
    v_fma_f32 v179, v179, v3, v11
    v_cvt_pk_bf16_f32 v85, v178, v179
    v_lshlrev_b32 v180, 16, v86
    v_and_b32 v181, 0xffff0000, v86
    v_fma_f32 v180, v180, v4, v12
    v_fma_f32 v181, v181, v5, v13
    v_mfma_f32_32x32x16_bf16 a[192:207], v[144:147], v[76:79], a[192:207]
    ds_read_b64_tr_b16 v[128:129], v228 offset:40960
    ds_read_b64_tr_b16 v[130:131], v228 offset:41984
    v_cvt_pk_bf16_f32 v86, v180, v181
    v_lshlrev_b32 v182, 16, v87
    v_and_b32 v183, 0xffff0000, v87
    v_fma_f32 v182, v182, v6, v14
    v_fma_f32 v183, v183, v7, v15
    v_cvt_pk_bf16_f32 v87, v182, v183
    s_waitcnt lgkmcnt(6)
    v_mfma_f32_32x32x16_bf16 a[144:159], v[148:151], v[72:75], a[144:159]
    buffer_load_dwordx4 v245, s[12:15], s44 offen offset:1024 lds
    s_waitcnt vmcnt(23)
    v_lshlrev_b32 v176, 16, v88
    v_and_b32 v177, 0xffff0000, v88
    v_fma_f32 v176, v176, v16, v24
    v_fma_f32 v177, v177, v17, v25
    v_cvt_pk_bf16_f32 v88, v176, v177
    v_lshlrev_b32 v178, 16, v89
    v_and_b32 v179, 0xffff0000, v89
    v_mfma_f32_32x32x16_bf16 a[208:223], v[148:151], v[76:79], a[208:223]
    ds_read_b64_tr_b16 v[132:133], v229 offset:40960
    ds_read_b64_tr_b16 v[134:135], v229 offset:41984
    v_fma_f32 v178, v178, v18, v26
    v_fma_f32 v179, v179, v19, v27
    v_cvt_pk_bf16_f32 v89, v178, v179
    v_lshlrev_b32 v180, 16, v90
    v_and_b32 v181, 0xffff0000, v90
    v_fma_f32 v180, v180, v20, v28
    v_fma_f32 v181, v181, v21, v29
    s_waitcnt lgkmcnt(6)
    v_mfma_f32_32x32x16_bf16 a[160:175], v[152:155], v[72:75], a[160:175]
    buffer_load_dwordx4 v244, s[12:15], s44 offen offset:2048 lds
    v_cvt_pk_bf16_f32 v90, v180, v181
    v_lshlrev_b32 v182, 16, v91
    v_and_b32 v183, 0xffff0000, v91
    v_fma_f32 v182, v182, v22, v30
    v_fma_f32 v183, v183, v23, v31
    v_cvt_pk_bf16_f32 v91, v182, v183
    v_mfma_f32_32x32x16_bf16 a[224:239], v[152:155], v[76:79], a[224:239]
    ds_read_b64_tr_b16 v[136:137], v230 offset:40960
    ds_read_b64_tr_b16 v[138:139], v230 offset:41984
    s_waitcnt vmcnt(23)
    v_lshlrev_b32 v176, 16, v92
    v_and_b32 v177, 0xffff0000, v92
    v_fma_f32 v176, v176, v16, v24
    v_fma_f32 v177, v177, v17, v25
    v_cvt_pk_bf16_f32 v92, v176, v177
    v_lshlrev_b32 v178, 16, v93
    v_and_b32 v179, 0xffff0000, v93
    s_waitcnt lgkmcnt(6)
    v_mfma_f32_32x32x16_bf16 a[176:191], v[156:159], v[72:75], a[176:191]
    buffer_load_dwordx4 v245, s[12:15], s44 offen offset:3072 lds
    s_add_u32 s44, s44, 16384
    v_fma_f32 v178, v178, v18, v26
    v_fma_f32 v179, v179, v19, v27
    v_cvt_pk_bf16_f32 v93, v178, v179
    v_lshlrev_b32 v180, 16, v94
    v_and_b32 v181, 0xffff0000, v94
    v_fma_f32 v180, v180, v20, v28
    v_fma_f32 v181, v181, v21, v29
    v_mfma_f32_32x32x16_bf16 a[240:255], v[156:159], v[76:79], a[240:255]
    ds_read_b64_tr_b16 v[140:141], v231 offset:40960
    ds_read_b64_tr_b16 v[142:143], v231 offset:41984
    v_cvt_pk_bf16_f32 v94, v180, v181
    v_lshlrev_b32 v182, 16, v95
    v_and_b32 v183, 0xffff0000, v95
    v_fma_f32 v182, v182, v22, v30
    v_fma_f32 v183, v183, v23, v31
    v_cvt_pk_bf16_f32 v95, v182, v183
    s_waitcnt lgkmcnt(6)
    v_mfma_f32_32x32x16_bf16 a[128:143], v[128:131], v[80:83], a[128:143]
    ds_read_b128 v[0:3], v225 offset:3840
    ds_read_b128 v[4:7], v225 offset:3856
    ds_read_b128 v[8:11], v225 offset:1792
    ds_read_b128 v[12:15], v225 offset:1808
    ds_read_b128 v[16:19], v225 offset:3904
    ds_read_b128 v[20:23], v225 offset:3920
    ds_read_b128 v[24:27], v225 offset:1856
    ds_read_b128 v[28:31], v225 offset:1872
    v_mfma_f32_32x32x16_bf16 a[192:207], v[128:131], v[84:87], a[192:207]
    ds_read_b64_tr_b16 v[144:145], v228 offset:45056
    ds_read_b64_tr_b16 v[146:147], v228 offset:46080
    s_waitcnt lgkmcnt(14)
    v_mfma_f32_32x32x16_bf16 a[144:159], v[132:135], v[80:83], a[144:159]
    v_mfma_f32_32x32x16_bf16 a[208:223], v[132:135], v[84:87], a[208:223]
    ds_read_b64_tr_b16 v[148:149], v229 offset:45056
    ds_read_b64_tr_b16 v[150:151], v229 offset:46080
    s_waitcnt lgkmcnt(14)
    v_mfma_f32_32x32x16_bf16 a[160:175], v[136:139], v[80:83], a[160:175]
    s_waitcnt vmcnt(15)
    v_lshlrev_b32 v176, 16, v96
    v_and_b32 v177, 0xffff0000, v96
    s_waitcnt lgkmcnt(9)
    v_fma_f32 v176, v176, v0, v8
    v_fma_f32 v177, v177, v1, v9
    v_cvt_pk_bf16_f32 v96, v176, v177
    v_lshlrev_b32 v178, 16, v97
    v_and_b32 v179, 0xffff0000, v97
    v_mfma_f32_32x32x16_bf16 a[224:239], v[136:139], v[84:87], a[224:239]
    ds_read_b64_tr_b16 v[152:153], v230 offset:45056
    ds_read_b64_tr_b16 v[154:155], v230 offset:46080
    v_fma_f32 v178, v178, v2, v10
    v_fma_f32 v179, v179, v3, v11
    v_cvt_pk_bf16_f32 v97, v178, v179
    v_lshlrev_b32 v180, 16, v98
    v_and_b32 v181, 0xffff0000, v98
    s_waitcnt lgkmcnt(10)
    v_fma_f32 v180, v180, v4, v12
    v_fma_f32 v181, v181, v5, v13
    v_mfma_f32_32x32x16_bf16 a[176:191], v[140:143], v[80:83], a[176:191]
    v_cvt_pk_bf16_f32 v98, v180, v181
    v_lshlrev_b32 v182, 16, v99
    v_and_b32 v183, 0xffff0000, v99
    v_fma_f32 v182, v182, v6, v14
    v_fma_f32 v183, v183, v7, v15
    v_cvt_pk_bf16_f32 v99, v182, v183
    v_mfma_f32_32x32x16_bf16 a[240:255], v[140:143], v[84:87], a[240:255]
    ds_read_b64_tr_b16 v[156:157], v231 offset:45056
    ds_read_b64_tr_b16 v[158:159], v231 offset:46080
    s_waitcnt vmcnt(14)
    v_lshlrev_b32 v176, 16, v100
    v_and_b32 v177, 0xffff0000, v100
    v_fma_f32 v176, v176, v0, v8
    v_fma_f32 v177, v177, v1, v9
    v_cvt_pk_bf16_f32 v100, v176, v177
    v_lshlrev_b32 v178, 16, v101
    v_and_b32 v179, 0xffff0000, v101
    s_waitcnt lgkmcnt(6)
    v_mfma_f32_32x32x16_bf16 a[128:143], v[144:147], v[88:91], a[128:143]
    v_fma_f32 v178, v178, v2, v10
    v_fma_f32 v179, v179, v3, v11
    v_cvt_pk_bf16_f32 v101, v178, v179
    v_lshlrev_b32 v180, 16, v102
    v_and_b32 v181, 0xffff0000, v102
    v_fma_f32 v180, v180, v4, v12
    v_fma_f32 v181, v181, v5, v13
    v_mfma_f32_32x32x16_bf16 a[192:207], v[144:147], v[92:95], a[192:207]
    v_subrev_u32 v228, 0x10000, v228
    v_subrev_u32 v229, 0x10000, v229
    v_subrev_u32 v230, 0x10000, v230
    v_subrev_u32 v231, 0x10000, v231
    ds_read_b64_tr_b16 v[128:129], v228 offset:0
    ds_read_b64_tr_b16 v[130:131], v228 offset:1024
    v_cvt_pk_bf16_f32 v102, v180, v181
    v_lshlrev_b32 v182, 16, v103
    v_and_b32 v183, 0xffff0000, v103
    v_fma_f32 v182, v182, v6, v14
    v_fma_f32 v183, v183, v7, v15
    v_cvt_pk_bf16_f32 v103, v182, v183
    s_waitcnt lgkmcnt(6)
    v_mfma_f32_32x32x16_bf16 a[144:159], v[148:151], v[88:91], a[144:159]
    s_waitcnt vmcnt(13)
    v_lshlrev_b32 v176, 16, v104
    v_and_b32 v177, 0xffff0000, v104
    v_fma_f32 v176, v176, v16, v24
    v_fma_f32 v177, v177, v17, v25
    v_cvt_pk_bf16_f32 v104, v176, v177
    v_lshlrev_b32 v178, 16, v105
    v_and_b32 v179, 0xffff0000, v105
    v_mfma_f32_32x32x16_bf16 a[208:223], v[148:151], v[92:95], a[208:223]
    ds_read_b64_tr_b16 v[132:133], v229 offset:0
    ds_read_b64_tr_b16 v[134:135], v229 offset:1024
    v_fma_f32 v178, v178, v18, v26
    v_fma_f32 v179, v179, v19, v27
    v_cvt_pk_bf16_f32 v105, v178, v179
    v_lshlrev_b32 v180, 16, v106
    v_and_b32 v181, 0xffff0000, v106
    v_fma_f32 v180, v180, v20, v28
    v_fma_f32 v181, v181, v21, v29
    s_waitcnt lgkmcnt(6)
    v_mfma_f32_32x32x16_bf16 a[160:175], v[152:155], v[88:91], a[160:175]
    v_cvt_pk_bf16_f32 v106, v180, v181
    v_lshlrev_b32 v182, 16, v107
    v_and_b32 v183, 0xffff0000, v107
    v_fma_f32 v182, v182, v22, v30
    v_fma_f32 v183, v183, v23, v31
    v_cvt_pk_bf16_f32 v107, v182, v183
    v_mfma_f32_32x32x16_bf16 a[224:239], v[152:155], v[92:95], a[224:239]
    ds_read_b64_tr_b16 v[136:137], v230 offset:0
    ds_read_b64_tr_b16 v[138:139], v230 offset:1024
    s_waitcnt vmcnt(12)
    v_lshlrev_b32 v176, 16, v108
    v_and_b32 v177, 0xffff0000, v108
    v_fma_f32 v176, v176, v16, v24
    v_fma_f32 v177, v177, v17, v25
    v_cvt_pk_bf16_f32 v108, v176, v177
    v_lshlrev_b32 v178, 16, v109
    v_and_b32 v179, 0xffff0000, v109
    s_waitcnt lgkmcnt(6)
    v_mfma_f32_32x32x16_bf16 a[176:191], v[156:159], v[88:91], a[176:191]
    v_fma_f32 v178, v178, v18, v26
    v_fma_f32 v179, v179, v19, v27
    v_cvt_pk_bf16_f32 v109, v178, v179
    v_lshlrev_b32 v180, 16, v110
    v_and_b32 v181, 0xffff0000, v110
    v_fma_f32 v180, v180, v20, v28
    v_fma_f32 v181, v181, v21, v29
    v_mfma_f32_32x32x16_bf16 a[240:255], v[156:159], v[92:95], a[240:255]
    ds_read_b64_tr_b16 v[140:141], v231 offset:0
    ds_read_b64_tr_b16 v[142:143], v231 offset:1024
    v_cvt_pk_bf16_f32 v110, v180, v181
    v_lshlrev_b32 v182, 16, v111
    v_and_b32 v183, 0xffff0000, v111
    v_fma_f32 v182, v182, v22, v30
    v_fma_f32 v183, v183, v23, v31
    v_cvt_pk_bf16_f32 v111, v182, v183
    s_waitcnt vmcnt(32) lgkmcnt(0)
    s_barrier
    v_mfma_f32_32x32x16_bf16 a[128:143], v[128:131], v[96:99], a[128:143]
    ds_read_b128 v[0:3], v225 offset:3968
    ds_read_b128 v[4:7], v225 offset:3984
    ds_read_b128 v[8:11], v225 offset:1920
    ds_read_b128 v[12:15], v225 offset:1936
    ds_read_b128 v[16:19], v225 offset:4032
    ds_read_b128 v[20:23], v225 offset:4048
    ds_read_b128 v[24:27], v225 offset:1984
    ds_read_b128 v[28:31], v225 offset:2000
    v_mfma_f32_32x32x16_bf16 a[192:207], v[128:131], v[100:103], a[192:207]
    ds_read_b64_tr_b16 v[144:145], v228 offset:4096
    ds_read_b64_tr_b16 v[146:147], v228 offset:5120
    v_mfma_f32_32x32x16_bf16 a[144:159], v[132:135], v[96:99], a[144:159]
    v_mfma_f32_32x32x16_bf16 a[208:223], v[132:135], v[100:103], a[208:223]
    ds_read_b64_tr_b16 v[148:149], v229 offset:4096
    ds_read_b64_tr_b16 v[150:151], v229 offset:5120
    v_mfma_f32_32x32x16_bf16 a[160:175], v[136:139], v[96:99], a[160:175]
    s_waitcnt vmcnt(11)
    v_lshlrev_b32 v176, 16, v112
    v_and_b32 v177, 0xffff0000, v112
    s_waitcnt lgkmcnt(9)
    v_fma_f32 v176, v176, v0, v8
    v_fma_f32 v177, v177, v1, v9
    v_cvt_pk_bf16_f32 v112, v176, v177
    v_lshlrev_b32 v178, 16, v113
    v_and_b32 v179, 0xffff0000, v113
    v_mfma_f32_32x32x16_bf16 a[224:239], v[136:139], v[100:103], a[224:239]
    ds_read_b64_tr_b16 v[152:153], v230 offset:4096
    ds_read_b64_tr_b16 v[154:155], v230 offset:5120
    v_fma_f32 v178, v178, v2, v10
    v_fma_f32 v179, v179, v3, v11
    v_cvt_pk_bf16_f32 v113, v178, v179
    v_lshlrev_b32 v180, 16, v114
    v_and_b32 v181, 0xffff0000, v114
    s_waitcnt lgkmcnt(10)
    v_fma_f32 v180, v180, v4, v12
    v_fma_f32 v181, v181, v5, v13
    v_mfma_f32_32x32x16_bf16 a[176:191], v[140:143], v[96:99], a[176:191]
    v_cvt_pk_bf16_f32 v114, v180, v181
    v_lshlrev_b32 v182, 16, v115
    v_and_b32 v183, 0xffff0000, v115
    v_fma_f32 v182, v182, v6, v14
    v_fma_f32 v183, v183, v7, v15
    v_cvt_pk_bf16_f32 v115, v182, v183
    v_mfma_f32_32x32x16_bf16 a[240:255], v[140:143], v[100:103], a[240:255]
    ds_read_b64_tr_b16 v[156:157], v231 offset:4096
    ds_read_b64_tr_b16 v[158:159], v231 offset:5120
    s_waitcnt vmcnt(10)
    v_lshlrev_b32 v176, 16, v116
    v_and_b32 v177, 0xffff0000, v116
    v_fma_f32 v176, v176, v0, v8
    v_fma_f32 v177, v177, v1, v9
    v_cvt_pk_bf16_f32 v116, v176, v177
    v_lshlrev_b32 v178, 16, v117
    v_and_b32 v179, 0xffff0000, v117
    s_waitcnt lgkmcnt(6)
    v_mfma_f32_32x32x16_bf16 a[128:143], v[144:147], v[104:107], a[128:143]
    v_fma_f32 v178, v178, v2, v10
    v_fma_f32 v179, v179, v3, v11
    v_cvt_pk_bf16_f32 v117, v178, v179
    v_lshlrev_b32 v180, 16, v118
    v_and_b32 v181, 0xffff0000, v118
    v_fma_f32 v180, v180, v4, v12
    v_fma_f32 v181, v181, v5, v13
    v_mfma_f32_32x32x16_bf16 a[192:207], v[144:147], v[108:111], a[192:207]
    ds_read_b64_tr_b16 v[128:129], v228 offset:8192
    ds_read_b64_tr_b16 v[130:131], v228 offset:9216
    v_cvt_pk_bf16_f32 v118, v180, v181
    v_lshlrev_b32 v182, 16, v119
    v_and_b32 v183, 0xffff0000, v119
    v_fma_f32 v182, v182, v6, v14
    v_fma_f32 v183, v183, v7, v15
    v_cvt_pk_bf16_f32 v119, v182, v183
    s_waitcnt lgkmcnt(6)
    v_mfma_f32_32x32x16_bf16 a[144:159], v[148:151], v[104:107], a[144:159]
    s_waitcnt vmcnt(9)
    v_lshlrev_b32 v176, 16, v120
    v_and_b32 v177, 0xffff0000, v120
    v_fma_f32 v176, v176, v16, v24
    v_fma_f32 v177, v177, v17, v25
    v_cvt_pk_bf16_f32 v120, v176, v177
    v_lshlrev_b32 v178, 16, v121
    v_and_b32 v179, 0xffff0000, v121
    v_mfma_f32_32x32x16_bf16 a[208:223], v[148:151], v[108:111], a[208:223]
    ds_read_b64_tr_b16 v[132:133], v229 offset:8192
    ds_read_b64_tr_b16 v[134:135], v229 offset:9216
    v_fma_f32 v178, v178, v18, v26
    v_fma_f32 v179, v179, v19, v27
    v_cvt_pk_bf16_f32 v121, v178, v179
    v_lshlrev_b32 v180, 16, v122
    v_and_b32 v181, 0xffff0000, v122
    v_fma_f32 v180, v180, v20, v28
    v_fma_f32 v181, v181, v21, v29
    s_waitcnt lgkmcnt(6)
    v_mfma_f32_32x32x16_bf16 a[160:175], v[152:155], v[104:107], a[160:175]
    v_cvt_pk_bf16_f32 v122, v180, v181
    v_lshlrev_b32 v182, 16, v123
    v_and_b32 v183, 0xffff0000, v123
    v_fma_f32 v182, v182, v22, v30
    v_fma_f32 v183, v183, v23, v31
    v_cvt_pk_bf16_f32 v123, v182, v183
    v_mfma_f32_32x32x16_bf16 a[224:239], v[152:155], v[108:111], a[224:239]
    ds_read_b64_tr_b16 v[136:137], v230 offset:8192
    ds_read_b64_tr_b16 v[138:139], v230 offset:9216
    s_waitcnt vmcnt(8)
    v_lshlrev_b32 v176, 16, v124
    v_and_b32 v177, 0xffff0000, v124
    v_fma_f32 v176, v176, v16, v24
    v_fma_f32 v177, v177, v17, v25
    v_cvt_pk_bf16_f32 v124, v176, v177
    v_lshlrev_b32 v178, 16, v125
    v_and_b32 v179, 0xffff0000, v125
    s_waitcnt lgkmcnt(6)
    v_mfma_f32_32x32x16_bf16 a[176:191], v[156:159], v[104:107], a[176:191]
    v_fma_f32 v178, v178, v18, v26
    v_fma_f32 v179, v179, v19, v27
    v_cvt_pk_bf16_f32 v125, v178, v179
    v_lshlrev_b32 v180, 16, v126
    v_and_b32 v181, 0xffff0000, v126
    v_fma_f32 v180, v180, v20, v28
    v_fma_f32 v181, v181, v21, v29
    v_mfma_f32_32x32x16_bf16 a[240:255], v[156:159], v[108:111], a[240:255]
    ds_read_b64_tr_b16 v[140:141], v231 offset:8192
    ds_read_b64_tr_b16 v[142:143], v231 offset:9216
    v_cvt_pk_bf16_f32 v126, v180, v181
    v_lshlrev_b32 v182, 16, v127
    v_and_b32 v183, 0xffff0000, v127
    v_fma_f32 v182, v182, v22, v30
    v_fma_f32 v183, v183, v23, v31
    v_cvt_pk_bf16_f32 v127, v182, v183
    s_waitcnt lgkmcnt(6)
    v_mfma_f32_32x32x16_bf16 a[128:143], v[128:131], v[112:115], a[128:143]
    v_mfma_f32_32x32x16_bf16 a[192:207], v[128:131], v[116:119], a[192:207]
    ds_read_b64_tr_b16 v[144:145], v228 offset:12288
    ds_read_b64_tr_b16 v[146:147], v228 offset:13312
    s_waitcnt lgkmcnt(6)
    v_mfma_f32_32x32x16_bf16 a[144:159], v[132:135], v[112:115], a[144:159]
    v_mfma_f32_32x32x16_bf16 a[208:223], v[132:135], v[116:119], a[208:223]
    ds_read_b64_tr_b16 v[148:149], v229 offset:12288
    ds_read_b64_tr_b16 v[150:151], v229 offset:13312
    s_waitcnt lgkmcnt(6)
    v_mfma_f32_32x32x16_bf16 a[160:175], v[136:139], v[112:115], a[160:175]
    v_mfma_f32_32x32x16_bf16 a[224:239], v[136:139], v[116:119], a[224:239]
    ds_read_b64_tr_b16 v[152:153], v230 offset:12288
    ds_read_b64_tr_b16 v[154:155], v230 offset:13312
    s_waitcnt lgkmcnt(6)
    v_mfma_f32_32x32x16_bf16 a[176:191], v[140:143], v[112:115], a[176:191]
    v_mfma_f32_32x32x16_bf16 a[240:255], v[140:143], v[116:119], a[240:255]
    ds_read_b64_tr_b16 v[156:157], v231 offset:12288
    ds_read_b64_tr_b16 v[158:159], v231 offset:13312
    s_waitcnt lgkmcnt(6)
    v_mfma_f32_32x32x16_bf16 a[128:143], v[144:147], v[120:123], a[128:143]
    v_mfma_f32_32x32x16_bf16 a[192:207], v[144:147], v[124:127], a[192:207]
    s_waitcnt lgkmcnt(4)
    v_mfma_f32_32x32x16_bf16 a[144:159], v[148:151], v[120:123], a[144:159]
    v_mfma_f32_32x32x16_bf16 a[208:223], v[148:151], v[124:127], a[208:223]
    s_waitcnt lgkmcnt(2)
    v_mfma_f32_32x32x16_bf16 a[160:175], v[152:155], v[120:123], a[160:175]
    v_mfma_f32_32x32x16_bf16 a[224:239], v[152:155], v[124:127], a[224:239]
    s_waitcnt lgkmcnt(0)
    v_mfma_f32_32x32x16_bf16 a[176:191], v[156:159], v[120:123], a[176:191]
    v_mfma_f32_32x32x16_bf16 a[240:255], v[156:159], v[124:127], a[240:255]
    s_nop 1
    v_accvgpr_read_b32 v176, a128
    v_accvgpr_read_b32 v177, a129
    v_cvt_pk_bf16_f32 v0, v176, v177
    v_accvgpr_read_b32 v178, a130
    v_accvgpr_read_b32 v179, a131
    v_cvt_pk_bf16_f32 v1, v178, v179
    v_accvgpr_read_b32 v180, a132
    v_accvgpr_read_b32 v181, a133
    v_cvt_pk_bf16_f32 v2, v180, v181
    v_accvgpr_read_b32 v182, a134
    v_accvgpr_read_b32 v183, a135
    v_cvt_pk_bf16_f32 v3, v182, v183
    v_accvgpr_read_b32 v176, a136
    v_accvgpr_read_b32 v177, a137
    v_cvt_pk_bf16_f32 v16, v176, v177
    v_accvgpr_read_b32 v178, a138
    v_accvgpr_read_b32 v179, a139
    v_cvt_pk_bf16_f32 v17, v178, v179
    v_accvgpr_read_b32 v180, a140
    v_accvgpr_read_b32 v181, a141
    v_cvt_pk_bf16_f32 v18, v180, v181
    v_accvgpr_read_b32 v182, a142
    v_accvgpr_read_b32 v183, a143
    v_cvt_pk_bf16_f32 v19, v182, v183
    v_permlane16_swap_b32 v0, v16
    v_permlane16_swap_b32 v1, v17
    v_permlane16_swap_b32 v2, v18
    v_permlane16_swap_b32 v3, v19
    v_accvgpr_read_b32 v176, a144
    v_accvgpr_read_b32 v177, a145
    v_cvt_pk_bf16_f32 v4, v176, v177
    v_accvgpr_read_b32 v178, a146
    v_accvgpr_read_b32 v179, a147
    v_cvt_pk_bf16_f32 v5, v178, v179
    v_accvgpr_read_b32 v180, a148
    v_accvgpr_read_b32 v181, a149
    v_cvt_pk_bf16_f32 v6, v180, v181
    v_accvgpr_read_b32 v182, a150
    v_accvgpr_read_b32 v183, a151
    v_cvt_pk_bf16_f32 v7, v182, v183
    v_accvgpr_read_b32 v176, a152
    v_accvgpr_read_b32 v177, a153
    v_cvt_pk_bf16_f32 v20, v176, v177
    v_accvgpr_read_b32 v178, a154
    v_accvgpr_read_b32 v179, a155
    v_cvt_pk_bf16_f32 v21, v178, v179
    v_accvgpr_read_b32 v180, a156
    v_accvgpr_read_b32 v181, a157
    v_cvt_pk_bf16_f32 v22, v180, v181
    v_accvgpr_read_b32 v182, a158
    v_accvgpr_read_b32 v183, a159
    v_cvt_pk_bf16_f32 v23, v182, v183
    v_permlane16_swap_b32 v4, v20
    v_permlane16_swap_b32 v5, v21
    v_permlane16_swap_b32 v6, v22
    v_permlane16_swap_b32 v7, v23
    v_accvgpr_read_b32 v176, a160
    v_accvgpr_read_b32 v177, a161
    v_cvt_pk_bf16_f32 v8, v176, v177
    v_accvgpr_read_b32 v178, a162
    v_accvgpr_read_b32 v179, a163
    v_cvt_pk_bf16_f32 v9, v178, v179
    v_accvgpr_read_b32 v180, a164
    v_accvgpr_read_b32 v181, a165
    v_cvt_pk_bf16_f32 v10, v180, v181
    v_accvgpr_read_b32 v182, a166
    v_accvgpr_read_b32 v183, a167
    v_cvt_pk_bf16_f32 v11, v182, v183
    v_accvgpr_read_b32 v176, a168
    v_accvgpr_read_b32 v177, a169
    v_cvt_pk_bf16_f32 v24, v176, v177
    v_accvgpr_read_b32 v178, a170
    v_accvgpr_read_b32 v179, a171
    v_cvt_pk_bf16_f32 v25, v178, v179
    v_accvgpr_read_b32 v180, a172
    v_accvgpr_read_b32 v181, a173
    v_cvt_pk_bf16_f32 v26, v180, v181
    v_accvgpr_read_b32 v182, a174
    v_accvgpr_read_b32 v183, a175
    v_cvt_pk_bf16_f32 v27, v182, v183
    v_permlane16_swap_b32 v8, v24
    v_permlane16_swap_b32 v9, v25
    v_permlane16_swap_b32 v10, v26
    v_permlane16_swap_b32 v11, v27
    v_accvgpr_read_b32 v176, a176
    v_accvgpr_read_b32 v177, a177
    v_cvt_pk_bf16_f32 v12, v176, v177
    v_accvgpr_read_b32 v178, a178
    v_accvgpr_read_b32 v179, a179
    v_cvt_pk_bf16_f32 v13, v178, v179
    v_accvgpr_read_b32 v180, a180
    v_accvgpr_read_b32 v181, a181
    v_cvt_pk_bf16_f32 v14, v180, v181
    v_accvgpr_read_b32 v182, a182
    v_accvgpr_read_b32 v183, a183
    v_cvt_pk_bf16_f32 v15, v182, v183
    v_accvgpr_read_b32 v176, a184
    v_accvgpr_read_b32 v177, a185
    v_cvt_pk_bf16_f32 v28, v176, v177
    v_accvgpr_read_b32 v178, a186
    v_accvgpr_read_b32 v179, a187
    v_cvt_pk_bf16_f32 v29, v178, v179
    v_accvgpr_read_b32 v180, a188
    v_accvgpr_read_b32 v181, a189
    v_cvt_pk_bf16_f32 v30, v180, v181
    v_accvgpr_read_b32 v182, a190
    v_accvgpr_read_b32 v183, a191
    v_cvt_pk_bf16_f32 v31, v182, v183
    v_permlane16_swap_b32 v12, v28
    v_permlane16_swap_b32 v13, v29
    v_permlane16_swap_b32 v14, v30
    v_permlane16_swap_b32 v15, v31
    v_accvgpr_read_b32 v176, a192
    v_accvgpr_read_b32 v177, a193
    v_cvt_pk_bf16_f32 v32, v176, v177
    v_accvgpr_read_b32 v178, a194
    v_accvgpr_read_b32 v179, a195
    v_cvt_pk_bf16_f32 v33, v178, v179
    v_accvgpr_read_b32 v180, a196
    v_accvgpr_read_b32 v181, a197
    v_cvt_pk_bf16_f32 v34, v180, v181
    v_accvgpr_read_b32 v182, a198
    v_accvgpr_read_b32 v183, a199
    v_cvt_pk_bf16_f32 v35, v182, v183
    v_accvgpr_read_b32 v176, a200
    v_accvgpr_read_b32 v177, a201
    v_cvt_pk_bf16_f32 v48, v176, v177
    v_accvgpr_read_b32 v178, a202
    v_accvgpr_read_b32 v179, a203
    v_cvt_pk_bf16_f32 v49, v178, v179
    v_accvgpr_read_b32 v180, a204
    v_accvgpr_read_b32 v181, a205
    v_cvt_pk_bf16_f32 v50, v180, v181
    v_accvgpr_read_b32 v182, a206
    v_accvgpr_read_b32 v183, a207
    v_cvt_pk_bf16_f32 v51, v182, v183
    v_permlane16_swap_b32 v32, v48
    v_permlane16_swap_b32 v33, v49
    v_permlane16_swap_b32 v34, v50
    v_permlane16_swap_b32 v35, v51
    v_accvgpr_read_b32 v176, a208
    v_accvgpr_read_b32 v177, a209
    v_cvt_pk_bf16_f32 v36, v176, v177
    v_accvgpr_read_b32 v178, a210
    v_accvgpr_read_b32 v179, a211
    v_cvt_pk_bf16_f32 v37, v178, v179
    v_accvgpr_read_b32 v180, a212
    v_accvgpr_read_b32 v181, a213
    v_cvt_pk_bf16_f32 v38, v180, v181
    v_accvgpr_read_b32 v182, a214
    v_accvgpr_read_b32 v183, a215
    v_cvt_pk_bf16_f32 v39, v182, v183
    v_accvgpr_read_b32 v176, a216
    v_accvgpr_read_b32 v177, a217
    v_cvt_pk_bf16_f32 v52, v176, v177
    v_accvgpr_read_b32 v178, a218
    v_accvgpr_read_b32 v179, a219
    v_cvt_pk_bf16_f32 v53, v178, v179
    v_accvgpr_read_b32 v180, a220
    v_accvgpr_read_b32 v181, a221
    v_cvt_pk_bf16_f32 v54, v180, v181
    v_accvgpr_read_b32 v182, a222
    v_accvgpr_read_b32 v183, a223
    v_cvt_pk_bf16_f32 v55, v182, v183
    v_permlane16_swap_b32 v36, v52
    v_permlane16_swap_b32 v37, v53
    v_permlane16_swap_b32 v38, v54
    v_permlane16_swap_b32 v39, v55
    v_accvgpr_read_b32 v176, a224
    v_accvgpr_read_b32 v177, a225
    v_cvt_pk_bf16_f32 v40, v176, v177
    v_accvgpr_read_b32 v178, a226
    v_accvgpr_read_b32 v179, a227
    v_cvt_pk_bf16_f32 v41, v178, v179
    v_accvgpr_read_b32 v180, a228
    v_accvgpr_read_b32 v181, a229
    v_cvt_pk_bf16_f32 v42, v180, v181
    v_accvgpr_read_b32 v182, a230
    v_accvgpr_read_b32 v183, a231
    v_cvt_pk_bf16_f32 v43, v182, v183
    v_accvgpr_read_b32 v176, a232
    v_accvgpr_read_b32 v177, a233
    v_cvt_pk_bf16_f32 v56, v176, v177
    v_accvgpr_read_b32 v178, a234
    v_accvgpr_read_b32 v179, a235
    v_cvt_pk_bf16_f32 v57, v178, v179
    v_accvgpr_read_b32 v180, a236
    v_accvgpr_read_b32 v181, a237
    v_cvt_pk_bf16_f32 v58, v180, v181
    v_accvgpr_read_b32 v182, a238
    v_accvgpr_read_b32 v183, a239
    v_cvt_pk_bf16_f32 v59, v182, v183
    v_permlane16_swap_b32 v40, v56
    v_permlane16_swap_b32 v41, v57
    v_permlane16_swap_b32 v42, v58
    v_permlane16_swap_b32 v43, v59
    v_accvgpr_read_b32 v176, a240
    v_accvgpr_read_b32 v177, a241
    v_cvt_pk_bf16_f32 v44, v176, v177
    v_accvgpr_read_b32 v178, a242
    v_accvgpr_read_b32 v179, a243
    v_cvt_pk_bf16_f32 v45, v178, v179
    v_accvgpr_read_b32 v180, a244
    v_accvgpr_read_b32 v181, a245
    v_cvt_pk_bf16_f32 v46, v180, v181
    v_accvgpr_read_b32 v182, a246
    v_accvgpr_read_b32 v183, a247
    v_cvt_pk_bf16_f32 v47, v182, v183
    v_accvgpr_read_b32 v176, a248
    v_accvgpr_read_b32 v177, a249
    v_cvt_pk_bf16_f32 v60, v176, v177
    v_accvgpr_read_b32 v178, a250
    v_accvgpr_read_b32 v179, a251
    v_cvt_pk_bf16_f32 v61, v178, v179
    v_accvgpr_read_b32 v180, a252
    v_accvgpr_read_b32 v181, a253
    v_cvt_pk_bf16_f32 v62, v180, v181
    v_accvgpr_read_b32 v182, a254
    v_accvgpr_read_b32 v183, a255
    v_cvt_pk_bf16_f32 v63, v182, v183
    v_permlane16_swap_b32 v44, v60
    v_permlane16_swap_b32 v45, v61
    v_permlane16_swap_b32 v46, v62
    v_permlane16_swap_b32 v47, v63
    v_mov_b32 v144, 0
    v_mov_b32 v145, 0
    v_mov_b32 v146, 0
    v_mov_b32 v147, 0
    v_mov_b32 v148, 0
    v_mov_b32 v149, 0
    v_mov_b32 v150, 0
    v_mov_b32 v151, 0
    v_mov_b32 v152, 0
    v_mov_b32 v153, 0
    v_mov_b32 v154, 0
    v_mov_b32 v155, 0
    v_mov_b32 v156, 0
    v_mov_b32 v157, 0
    v_mov_b32 v158, 0
    v_mov_b32 v159, 0
    v_mov_b32 v214, 0
    v_mov_b32 v215, 0
    v_mov_b32 v216, 0
    v_mov_b32 v217, 0
    v_mov_b32 v226, 0x42500000
    s_mov_b32 s41, 0x5d800000
    s_waitcnt vmcnt(4)
    s_barrier
    s_add_u32 m0, s49, 32768
    s_nop 0
    buffer_load_dwordx4 v240, s[8:11], s43 offen offset:0 lds
    buffer_load_dwordx4 v241, s[8:11], s43 offen offset:1024 lds
    buffer_load_dwordx4 v242, s[8:11], s43 offen offset:2048 lds
    buffer_load_dwordx4 v243, s[8:11], s43 offen offset:3072 lds
    s_add_u32 s43, s43, 16384
    ds_read_b128 a[128:131], v200 offset:0
    ds_read_b128 a[132:135], v201 offset:0
    ds_read_b128 a[136:139], v202 offset:0
    ds_read_b128 a[140:143], v203 offset:0
    ds_read_b128 a[144:147], v200 offset:4096
    ds_read_b128 a[148:151], v201 offset:4096
    ds_read_b128 a[152:155], v202 offset:4096
    ds_read_b128 a[156:159], v203 offset:4096
    s_waitcnt lgkmcnt(7)
    v_mfma_f32_16x16x32_bf16 v[64:67], a[128:131], v[0:3], 0
    v_mfma_f32_16x16x32_bf16 v[68:71], a[128:131], v[16:19], 0
    v_mfma_f32_16x16x32_bf16 v[72:75], a[128:131], v[32:35], 0
    v_mfma_f32_16x16x32_bf16 v[76:79], a[128:131], v[48:51], 0
    s_waitcnt lgkmcnt(6)
    v_mfma_f32_16x16x32_bf16 v[64:67], a[132:135], v[4:7], v[64:67]
    v_mfma_f32_16x16x32_bf16 v[68:71], a[132:135], v[20:23], v[68:71]
    v_mfma_f32_16x16x32_bf16 v[72:75], a[132:135], v[36:39], v[72:75]
    v_mfma_f32_16x16x32_bf16 v[76:79], a[132:135], v[52:55], v[76:79]
    s_waitcnt lgkmcnt(5)
    v_mfma_f32_16x16x32_bf16 v[64:67], a[136:139], v[8:11], v[64:67]
    v_mfma_f32_16x16x32_bf16 v[68:71], a[136:139], v[24:27], v[68:71]
    v_mfma_f32_16x16x32_bf16 v[72:75], a[136:139], v[40:43], v[72:75]
    v_mfma_f32_16x16x32_bf16 v[76:79], a[136:139], v[56:59], v[76:79]
    s_waitcnt lgkmcnt(4)
    v_mfma_f32_16x16x32_bf16 v[64:67], a[140:143], v[12:15], v[64:67]
    v_mfma_f32_16x16x32_bf16 v[68:71], a[140:143], v[28:31], v[68:71]
    v_mfma_f32_16x16x32_bf16 v[72:75], a[140:143], v[44:47], v[72:75]
    v_mfma_f32_16x16x32_bf16 v[76:79], a[140:143], v[60:63], v[76:79]
    s_waitcnt lgkmcnt(3)
    v_mfma_f32_16x16x32_bf16 v[80:83], a[144:147], v[0:3], 0
    v_mfma_f32_16x16x32_bf16 v[84:87], a[144:147], v[16:19], 0
    v_mfma_f32_16x16x32_bf16 v[88:91], a[144:147], v[32:35], 0
    v_mfma_f32_16x16x32_bf16 v[92:95], a[144:147], v[48:51], 0
    s_waitcnt lgkmcnt(2)
    v_mfma_f32_16x16x32_bf16 v[80:83], a[148:151], v[4:7], v[80:83]
    v_mfma_f32_16x16x32_bf16 v[84:87], a[148:151], v[20:23], v[84:87]
    v_mfma_f32_16x16x32_bf16 v[88:91], a[148:151], v[36:39], v[88:91]
    v_mfma_f32_16x16x32_bf16 v[92:95], a[148:151], v[52:55], v[92:95]
    s_waitcnt lgkmcnt(1)
    v_mfma_f32_16x16x32_bf16 v[80:83], a[152:155], v[8:11], v[80:83]
    v_mfma_f32_16x16x32_bf16 v[84:87], a[152:155], v[24:27], v[84:87]
    v_mfma_f32_16x16x32_bf16 v[88:91], a[152:155], v[40:43], v[88:91]
    v_mfma_f32_16x16x32_bf16 v[92:95], a[152:155], v[56:59], v[92:95]
    s_waitcnt lgkmcnt(0)
    v_mfma_f32_16x16x32_bf16 v[80:83], a[156:159], v[12:15], v[80:83]
    v_mfma_f32_16x16x32_bf16 v[84:87], a[156:159], v[28:31], v[84:87]
    v_mfma_f32_16x16x32_bf16 v[88:91], a[156:159], v[44:47], v[88:91]
    v_mfma_f32_16x16x32_bf16 v[92:95], a[156:159], v[60:63], v[92:95]
    ds_read_b128 a[128:131], v200 offset:8192
    ds_read_b128 a[132:135], v201 offset:8192
    ds_read_b128 a[136:139], v202 offset:8192
    ds_read_b128 a[140:143], v203 offset:8192
    ds_read_b128 a[144:147], v200 offset:12288
    ds_read_b128 a[148:151], v201 offset:12288
    ds_read_b128 a[152:155], v202 offset:12288
    v_max3_f32 v184, v64, v65, v66
    v_max3_f32 v184, v184, v67, v80
    v_max3_f32 v184, v184, v81, v82
    v_max_f32 v184, v184, v83
    v_mov_b32 v185, v184
    s_nop 1
    v_permlane16_swap_b32 v184, v185
    v_max_f32 v184, v184, v185
    v_mov_b32 v185, v184
    s_nop 1
    v_permlane32_swap_b32 v184, v185
    v_max_f32 v184, v184, v185
    v_add_f32 v185, 0x42c80000, v184
    v_sub_f32 v64, v64, v185
    v_sub_f32 v80, v80, v185
    v_sub_f32 v65, v65, v185
    v_sub_f32 v81, v81, v185
    v_sub_f32 v66, v66, v185
    v_sub_f32 v82, v82, v185
    v_sub_f32 v67, v67, v185
    v_sub_f32 v83, v83, v185
    v_sub_f32 v160, 0, v185
    v_sub_f32 v161, 0, v185
    v_sub_f32 v162, 0, v185
    v_sub_f32 v163, 0, v185
    v_max3_f32 v184, v68, v69, v70
    v_max3_f32 v184, v184, v71, v84
    v_max3_f32 v184, v184, v85, v86
    v_max_f32 v184, v184, v87
    v_mov_b32 v185, v184
    s_nop 1
    v_permlane16_swap_b32 v184, v185
    v_max_f32 v184, v184, v185
    v_mov_b32 v185, v184
    s_nop 1
    v_permlane32_swap_b32 v184, v185
    v_max_f32 v184, v184, v185
    v_add_f32 v185, 0x42c80000, v184
    v_sub_f32 v68, v68, v185
    v_sub_f32 v84, v84, v185
    v_sub_f32 v69, v69, v185
    v_sub_f32 v85, v85, v185
    v_sub_f32 v70, v70, v185
    v_sub_f32 v86, v86, v185
    v_sub_f32 v71, v71, v185
    v_sub_f32 v87, v87, v185
    v_sub_f32 v164, 0, v185
    v_sub_f32 v165, 0, v185
    v_sub_f32 v166, 0, v185
    v_sub_f32 v167, 0, v185
    v_max3_f32 v184, v72, v73, v74
    v_max3_f32 v184, v184, v75, v88
    v_max3_f32 v184, v184, v89, v90
    v_max_f32 v184, v184, v91
    v_mov_b32 v185, v184
    s_nop 1
    v_permlane16_swap_b32 v184, v185
    v_max_f32 v184, v184, v185
    v_mov_b32 v185, v184
    s_nop 1
    v_permlane32_swap_b32 v184, v185
    v_max_f32 v184, v184, v185
    v_add_f32 v185, 0x42c80000, v184
    v_sub_f32 v72, v72, v185
    v_sub_f32 v88, v88, v185
    v_sub_f32 v73, v73, v185
    v_sub_f32 v89, v89, v185
    v_sub_f32 v74, v74, v185
    v_sub_f32 v90, v90, v185
    v_sub_f32 v75, v75, v185
    v_sub_f32 v91, v91, v185
    v_sub_f32 v168, 0, v185
    v_sub_f32 v169, 0, v185
    v_sub_f32 v170, 0, v185
    v_sub_f32 v171, 0, v185
    v_max3_f32 v184, v76, v77, v78
    v_max3_f32 v184, v184, v79, v92
    v_max3_f32 v184, v184, v93, v94
    v_max_f32 v184, v184, v95
    v_mov_b32 v185, v184
    s_nop 1
    v_permlane16_swap_b32 v184, v185
    v_max_f32 v184, v184, v185
    v_mov_b32 v185, v184
    s_nop 1
    v_permlane32_swap_b32 v184, v185
    v_max_f32 v184, v184, v185
    v_add_f32 v185, 0x42c80000, v184
    v_sub_f32 v76, v76, v185
    v_sub_f32 v92, v92, v185
    v_sub_f32 v77, v77, v185
    v_sub_f32 v93, v93, v185
    v_sub_f32 v78, v78, v185
    v_sub_f32 v94, v94, v185
    v_sub_f32 v79, v79, v185
    v_sub_f32 v95, v95, v185
    v_sub_f32 v172, 0, v185
    v_sub_f32 v173, 0, v185
    v_sub_f32 v174, 0, v185
    v_sub_f32 v175, 0, v185
    s_load_dwordx2 s[54:55], s[0:1], 32
    s_load_dwordx4 s[56:59], s[0:1], 48
    s_load_dwordx2 s[50:51], s[0:1], 64
    s_lshl_b32 s6, s2, 2
    s_add_u32 s6, s6, s3
    s_lshl_b32 s7, s6, 12
    s_mul_i32 s6, s6, 1792
    s_waitcnt lgkmcnt(0)
    s_add_u32 s16, s54, s7
    s_addc_u32 s17, s55, 0
    s_mov_b32 s18, 0x1000
    s_mov_b32 s19, 0x00020000
    s_add_u32 s88, s56, s6
    s_addc_u32 s89, s57, 0
    s_mov_b32 s90, 0x700
    s_mov_b32 s91, 0x00020000
    s_add_u32 s92, s58, s6
    s_addc_u32 s93, s59, 0
    s_mov_b32 s94, 0x700
    s_mov_b32 s95, 0x00020000
    s_add_u32 s96, s50, s6
    s_addc_u32 s97, s51, 0
    s_mov_b32 s98, 0x700
    s_mov_b32 s99, 0x00020000
    s_mov_b32 s47, 0
    s_mov_b32 s46, 0
attn_loop:
    s_waitcnt lgkmcnt(3)
    v_mfma_f32_16x16x32_bf16 v[96:99], a[128:131], v[0:3], v[160:163]
    v_exp_f32 v176, v64
    v_mfma_f32_16x16x32_bf16 v[100:103], a[128:131], v[16:19], v[164:167]
    v_exp_f32 v177, v65
    v_mfma_f32_16x16x32_bf16 v[104:107], a[128:131], v[32:35], v[168:171]
    v_add_f32 v218, v176, v177
    v_cvt_pk_bf16_f32 v128, v176, v177
    v_mfma_f32_16x16x32_bf16 v[108:111], a[128:131], v[48:51], v[172:175]
    ds_read_b128 a[156:159], v203 offset:12288
    v_exp_f32 v178, v68
    v_mfma_f32_16x16x32_bf16 v[96:99], a[132:135], v[4:7], v[96:99]
    v_exp_f32 v179, v69
    v_mfma_f32_16x16x32_bf16 v[100:103], a[132:135], v[20:23], v[100:103]
    v_add_f32 v219, v178, v179
    v_cvt_pk_bf16_f32 v132, v178, v179
    v_mfma_f32_16x16x32_bf16 v[104:107], a[132:135], v[36:39], v[104:107]
    v_exp_f32 v180, v72
    v_mfma_f32_16x16x32_bf16 v[108:111], a[132:135], v[52:55], v[108:111]
    ds_read_b64_tr_b16 a[128:129], v204 offset:57344
    ds_read_b64_tr_b16 a[130:131], v204 offset:61440
    v_mfma_f32_16x16x32_bf16 v[96:99], a[136:139], v[8:11], v[96:99]
    s_add_u32 m0, s49, 49152
    v_exp_f32 v181, v73
    v_mfma_f32_16x16x32_bf16 v[100:103], a[136:139], v[24:27], v[100:103]
    buffer_load_dwordx4 v240, s[8:11], s43 offen offset:0 lds
    v_add_f32 v220, v180, v181
    v_mfma_f32_16x16x32_bf16 v[104:107], a[136:139], v[40:43], v[104:107]
    v_cvt_pk_bf16_f32 v136, v180, v181
    v_exp_f32 v182, v76
    v_mfma_f32_16x16x32_bf16 v[108:111], a[136:139], v[56:59], v[108:111]
    ds_read_b64_tr_b16 a[132:133], v205 offset:57344
    ds_read_b64_tr_b16 a[134:135], v205 offset:61440
    v_mfma_f32_16x16x32_bf16 v[96:99], a[140:143], v[12:15], v[96:99]
    v_exp_f32 v183, v77
    v_mfma_f32_16x16x32_bf16 v[100:103], a[140:143], v[28:31], v[100:103]
    v_add_f32 v221, v182, v183
    v_cvt_pk_bf16_f32 v140, v182, v183
    v_mfma_f32_16x16x32_bf16 v[104:107], a[140:143], v[44:47], v[104:107]
    v_exp_f32 v176, v66
    v_mfma_f32_16x16x32_bf16 v[108:111], a[140:143], v[60:63], v[108:111]
    ds_read_b64_tr_b16 a[136:137], v206 offset:57344
    ds_read_b64_tr_b16 a[138:139], v206 offset:61440
    s_waitcnt lgkmcnt(6)
    v_mfma_f32_16x16x32_bf16 v[112:115], a[144:147], v[0:3], v[160:163]
    v_exp_f32 v177, v67
    v_add_f32 v218, v218, v176
    v_mfma_f32_16x16x32_bf16 v[116:119], a[144:147], v[16:19], v[164:167]
    v_add_f32 v218, v218, v177
    v_cvt_pk_bf16_f32 v129, v176, v177
    v_mfma_f32_16x16x32_bf16 v[120:123], a[144:147], v[32:35], v[168:171]
    v_exp_f32 v178, v70
    v_mfma_f32_16x16x32_bf16 v[124:127], a[144:147], v[48:51], v[172:175]
    ds_read_b64_tr_b16 a[140:141], v207 offset:57344
    ds_read_b64_tr_b16 a[142:143], v207 offset:61440
    v_mfma_f32_16x16x32_bf16 v[112:115], a[148:151], v[4:7], v[112:115]
    v_exp_f32 v179, v71
    v_add_f32 v219, v219, v178
    v_mfma_f32_16x16x32_bf16 v[116:119], a[148:151], v[20:23], v[116:119]
    buffer_load_dwordx4 v241, s[8:11], s43 offen offset:1024 lds
    v_add_f32 v219, v219, v179
    v_mfma_f32_16x16x32_bf16 v[120:123], a[148:151], v[36:39], v[120:123]
    v_cvt_pk_bf16_f32 v133, v178, v179
    v_exp_f32 v180, v74
    v_mfma_f32_16x16x32_bf16 v[124:127], a[148:151], v[52:55], v[124:127]
    ds_read_b64_tr_b16 a[144:145], v208 offset:57344
    ds_read_b64_tr_b16 a[146:147], v208 offset:61440
    v_mfma_f32_16x16x32_bf16 v[112:115], a[152:155], v[8:11], v[112:115]
    v_exp_f32 v181, v75
    v_mfma_f32_16x16x32_bf16 v[116:119], a[152:155], v[24:27], v[116:119]
    v_add_f32 v220, v220, v180
    v_add_f32 v220, v220, v181
    v_mfma_f32_16x16x32_bf16 v[120:123], a[152:155], v[40:43], v[120:123]
    v_cvt_pk_bf16_f32 v137, v180, v181
    v_exp_f32 v182, v78
    v_mfma_f32_16x16x32_bf16 v[124:127], a[152:155], v[56:59], v[124:127]
    ds_read_b64_tr_b16 a[148:149], v209 offset:57344
    ds_read_b64_tr_b16 a[150:151], v209 offset:61440
    v_mfma_f32_16x16x32_bf16 v[112:115], a[156:159], v[12:15], v[112:115]
    v_exp_f32 v183, v79
    v_mfma_f32_16x16x32_bf16 v[116:119], a[156:159], v[28:31], v[116:119]
    v_add_f32 v221, v221, v182
    v_add_f32 v221, v221, v183
    v_mfma_f32_16x16x32_bf16 v[120:123], a[156:159], v[44:47], v[120:123]
    v_cvt_pk_bf16_f32 v141, v182, v183
    v_exp_f32 v176, v80
    v_mfma_f32_16x16x32_bf16 v[124:127], a[156:159], v[60:63], v[124:127]
    ds_read_b64_tr_b16 a[152:153], v210 offset:57344
    ds_read_b64_tr_b16 a[154:155], v210 offset:61440
    s_waitcnt lgkmcnt(6)
    v_mfma_f32_16x16x32_bf16 a[0:3], a[128:131], v[144:147], a[0:3]
    v_exp_f32 v177, v81
    v_mfma_f32_16x16x32_bf16 a[4:7], a[128:131], v[148:151], a[4:7]
    v_add_f32 v218, v218, v176
    v_add_f32 v218, v218, v177
    v_mfma_f32_16x16x32_bf16 a[8:11], a[128:131], v[152:155], a[8:11]
    v_cvt_pk_bf16_f32 v130, v176, v177
    v_exp_f32 v178, v84
    v_mfma_f32_16x16x32_bf16 a[12:15], a[128:131], v[156:159], a[12:15]
    ds_read_b64_tr_b16 a[156:157], v211 offset:57344
    ds_read_b64_tr_b16 a[158:159], v211 offset:61440
    v_mfma_f32_16x16x32_bf16 a[16:19], a[132:135], v[144:147], a[16:19]
    v_exp_f32 v179, v85
    v_mfma_f32_16x16x32_bf16 a[20:23], a[132:135], v[148:151], a[20:23]
    buffer_load_dwordx4 v242, s[8:11], s43 offen offset:2048 lds
    v_add_f32 v219, v219, v178
    v_mfma_f32_16x16x32_bf16 a[24:27], a[132:135], v[152:155], a[24:27]
    v_add_f32 v219, v219, v179
    v_cvt_pk_bf16_f32 v134, v178, v179
    v_mfma_f32_16x16x32_bf16 a[28:31], a[132:135], v[156:159], a[28:31]
    ds_read_b128 a[128:131], v200 offset:16384
    v_exp_f32 v180, v88
    v_mfma_f32_16x16x32_bf16 a[32:35], a[136:139], v[144:147], a[32:35]
    v_exp_f32 v181, v89
    v_mfma_f32_16x16x32_bf16 a[36:39], a[136:139], v[148:151], a[36:39]
    v_add_f32 v220, v220, v180
    v_add_f32 v220, v220, v181
    v_mfma_f32_16x16x32_bf16 a[40:43], a[136:139], v[152:155], a[40:43]
    v_cvt_pk_bf16_f32 v138, v180, v181
    v_exp_f32 v182, v92
    v_mfma_f32_16x16x32_bf16 a[44:47], a[136:139], v[156:159], a[44:47]
    ds_read_b128 a[132:135], v201 offset:16384
    v_exp_f32 v183, v93
    v_mfma_f32_16x16x32_bf16 a[48:51], a[140:143], v[144:147], a[48:51]
    v_add_f32 v221, v221, v182
    v_add_f32 v221, v221, v183
    v_mfma_f32_16x16x32_bf16 a[52:55], a[140:143], v[148:151], a[52:55]
    v_cvt_pk_bf16_f32 v142, v182, v183
    v_exp_f32 v176, v82
    v_mfma_f32_16x16x32_bf16 a[56:59], a[140:143], v[152:155], a[56:59]
    v_exp_f32 v177, v83
    v_mfma_f32_16x16x32_bf16 a[60:63], a[140:143], v[156:159], a[60:63]
    ds_read_b128 a[136:139], v202 offset:16384
    s_waitcnt lgkmcnt(3)
    v_mfma_f32_16x16x32_bf16 a[64:67], a[144:147], v[144:147], a[64:67]
    v_add_f32 v218, v218, v176
    v_add_f32 v218, v218, v177
    v_mfma_f32_16x16x32_bf16 a[68:71], a[144:147], v[148:151], a[68:71]
    buffer_load_dwordx4 v243, s[8:11], s43 offen offset:3072 lds
    s_add_u32 s43, s43, 16384
    v_mfma_f32_16x16x32_bf16 a[72:75], a[144:147], v[152:155], a[72:75]
    v_cvt_pk_bf16_f32 v131, v176, v177
    v_exp_f32 v178, v86
    v_mfma_f32_16x16x32_bf16 a[76:79], a[144:147], v[156:159], a[76:79]
    ds_read_b128 a[140:143], v203 offset:16384
    v_exp_f32 v179, v87
    v_mfma_f32_16x16x32_bf16 a[80:83], a[148:151], v[144:147], a[80:83]
    v_add_f32 v219, v219, v178
    v_add_f32 v219, v219, v179
    v_mfma_f32_16x16x32_bf16 a[84:87], a[148:151], v[148:151], a[84:87]
    v_cvt_pk_bf16_f32 v135, v178, v179
    v_exp_f32 v180, v90
    v_mfma_f32_16x16x32_bf16 a[88:91], a[148:151], v[152:155], a[88:91]
    v_exp_f32 v181, v91
    v_mfma_f32_16x16x32_bf16 a[92:95], a[148:151], v[156:159], a[92:95]
    ds_read_b128 a[144:147], v200 offset:20480
    v_add_f32 v220, v220, v180
    v_mfma_f32_16x16x32_bf16 a[96:99], a[152:155], v[144:147], a[96:99]
    v_add_f32 v220, v220, v181
    v_cvt_pk_bf16_f32 v139, v180, v181
    v_mfma_f32_16x16x32_bf16 a[100:103], a[152:155], v[148:151], a[100:103]
    v_exp_f32 v182, v94
    v_mfma_f32_16x16x32_bf16 a[104:107], a[152:155], v[152:155], a[104:107]
    v_exp_f32 v183, v95
    v_mfma_f32_16x16x32_bf16 a[108:111], a[152:155], v[156:159], a[108:111]
    ds_read_b128 a[148:151], v201 offset:20480
    v_add_f32 v221, v221, v182
    v_mfma_f32_16x16x32_bf16 a[112:115], a[156:159], v[144:147], a[112:115]
    v_add_f32 v221, v221, v183
    v_cvt_pk_bf16_f32 v143, v182, v183
    v_mfma_f32_16x16x32_bf16 a[116:119], a[156:159], v[148:151], a[116:119]
    v_max3_f32 v176, v218, v219, v220
    v_max_f32 v176, v176, v221
    v_cmp_le_f32 vcc, s41, v176
    v_mfma_f32_16x16x32_bf16 a[120:123], a[156:159], v[152:155], a[120:123]
    v_mfma_f32_16x16x32_bf16 a[124:127], a[156:159], v[156:159], a[124:127]
    ds_read_b128 a[152:155], v202 offset:20480
    s_cbranch_vccnz attn_rare1
attn_back2:
    v_add_f32 v214, v214, v218
    v_add_f32 v215, v215, v219
    v_add_f32 v216, v216, v220
    v_add_f32 v217, v217, v221
    s_waitcnt lgkmcnt(3)
    v_mfma_f32_16x16x32_bf16 v[64:67], a[128:131], v[0:3], v[160:163]
    v_exp_f32 v176, v96
    v_mfma_f32_16x16x32_bf16 v[68:71], a[128:131], v[16:19], v[164:167]
    v_exp_f32 v177, v97
    v_mfma_f32_16x16x32_bf16 v[72:75], a[128:131], v[32:35], v[168:171]
    v_add_f32 v218, v176, v177
    v_cvt_pk_bf16_f32 v144, v176, v177
    v_mfma_f32_16x16x32_bf16 v[76:79], a[128:131], v[48:51], v[172:175]
    ds_read_b128 a[156:159], v203 offset:20480
    v_exp_f32 v178, v100
    v_mfma_f32_16x16x32_bf16 v[64:67], a[132:135], v[4:7], v[64:67]
    v_exp_f32 v179, v101
    v_mfma_f32_16x16x32_bf16 v[68:71], a[132:135], v[20:23], v[68:71]
    v_add_f32 v219, v178, v179
    v_cvt_pk_bf16_f32 v148, v178, v179
    v_mfma_f32_16x16x32_bf16 v[72:75], a[132:135], v[36:39], v[72:75]
    v_exp_f32 v180, v104
    v_mfma_f32_16x16x32_bf16 v[76:79], a[132:135], v[52:55], v[76:79]
    ds_read_b64_tr_b16 a[128:129], v204 offset:0
    ds_read_b64_tr_b16 a[130:131], v204 offset:4096
    v_mfma_f32_16x16x32_bf16 v[64:67], a[136:139], v[8:11], v[64:67]
    s_add_u32 m0, s49, 98304
    v_exp_f32 v181, v105
    v_mfma_f32_16x16x32_bf16 v[68:71], a[136:139], v[24:27], v[68:71]
    buffer_load_dwordx4 v244, s[12:15], s44 offen offset:0 lds
    v_add_f32 v220, v180, v181
    v_mfma_f32_16x16x32_bf16 v[72:75], a[136:139], v[40:43], v[72:75]
    v_cvt_pk_bf16_f32 v152, v180, v181
    v_exp_f32 v182, v108
    v_mfma_f32_16x16x32_bf16 v[76:79], a[136:139], v[56:59], v[76:79]
    ds_read_b64_tr_b16 a[132:133], v205 offset:0
    ds_read_b64_tr_b16 a[134:135], v205 offset:4096
    v_mfma_f32_16x16x32_bf16 v[64:67], a[140:143], v[12:15], v[64:67]
    v_exp_f32 v183, v109
    v_mfma_f32_16x16x32_bf16 v[68:71], a[140:143], v[28:31], v[68:71]
    v_add_f32 v221, v182, v183
    v_cvt_pk_bf16_f32 v156, v182, v183
    v_mfma_f32_16x16x32_bf16 v[72:75], a[140:143], v[44:47], v[72:75]
    v_exp_f32 v176, v98
    v_mfma_f32_16x16x32_bf16 v[76:79], a[140:143], v[60:63], v[76:79]
    ds_read_b64_tr_b16 a[136:137], v206 offset:0
    ds_read_b64_tr_b16 a[138:139], v206 offset:4096
    s_waitcnt lgkmcnt(6)
    v_mfma_f32_16x16x32_bf16 v[80:83], a[144:147], v[0:3], v[160:163]
    v_exp_f32 v177, v99
    v_add_f32 v218, v218, v176
    v_mfma_f32_16x16x32_bf16 v[84:87], a[144:147], v[16:19], v[164:167]
    v_add_f32 v218, v218, v177
    v_cvt_pk_bf16_f32 v145, v176, v177
    v_mfma_f32_16x16x32_bf16 v[88:91], a[144:147], v[32:35], v[168:171]
    v_exp_f32 v178, v102
    v_mfma_f32_16x16x32_bf16 v[92:95], a[144:147], v[48:51], v[172:175]
    ds_read_b64_tr_b16 a[140:141], v207 offset:0
    ds_read_b64_tr_b16 a[142:143], v207 offset:4096
    v_mfma_f32_16x16x32_bf16 v[80:83], a[148:151], v[4:7], v[80:83]
    v_exp_f32 v179, v103
    v_add_f32 v219, v219, v178
    v_mfma_f32_16x16x32_bf16 v[84:87], a[148:151], v[20:23], v[84:87]
    buffer_load_dwordx4 v245, s[12:15], s44 offen offset:1024 lds
    v_add_f32 v219, v219, v179
    v_mfma_f32_16x16x32_bf16 v[88:91], a[148:151], v[36:39], v[88:91]
    v_cvt_pk_bf16_f32 v149, v178, v179
    v_exp_f32 v180, v106
    v_mfma_f32_16x16x32_bf16 v[92:95], a[148:151], v[52:55], v[92:95]
    ds_read_b64_tr_b16 a[144:145], v208 offset:0
    ds_read_b64_tr_b16 a[146:147], v208 offset:4096
    v_mfma_f32_16x16x32_bf16 v[80:83], a[152:155], v[8:11], v[80:83]
    v_exp_f32 v181, v107
    v_mfma_f32_16x16x32_bf16 v[84:87], a[152:155], v[24:27], v[84:87]
    v_add_f32 v220, v220, v180
    v_add_f32 v220, v220, v181
    v_mfma_f32_16x16x32_bf16 v[88:91], a[152:155], v[40:43], v[88:91]
    v_cvt_pk_bf16_f32 v153, v180, v181
    v_exp_f32 v182, v110
    v_mfma_f32_16x16x32_bf16 v[92:95], a[152:155], v[56:59], v[92:95]
    ds_read_b64_tr_b16 a[148:149], v209 offset:0
    ds_read_b64_tr_b16 a[150:151], v209 offset:4096
    v_mfma_f32_16x16x32_bf16 v[80:83], a[156:159], v[12:15], v[80:83]
    v_exp_f32 v183, v111
    v_mfma_f32_16x16x32_bf16 v[84:87], a[156:159], v[28:31], v[84:87]
    v_add_f32 v221, v221, v182
    v_add_f32 v221, v221, v183
    v_mfma_f32_16x16x32_bf16 v[88:91], a[156:159], v[44:47], v[88:91]
    v_cvt_pk_bf16_f32 v157, v182, v183
    v_exp_f32 v176, v112
    v_mfma_f32_16x16x32_bf16 v[92:95], a[156:159], v[60:63], v[92:95]
    ds_read_b64_tr_b16 a[152:153], v210 offset:0
    ds_read_b64_tr_b16 a[154:155], v210 offset:4096
    s_waitcnt lgkmcnt(6)
    v_mfma_f32_16x16x32_bf16 a[0:3], a[128:131], v[128:131], a[0:3]
    v_exp_f32 v177, v113
    v_mfma_f32_16x16x32_bf16 a[4:7], a[128:131], v[132:135], a[4:7]
    v_add_f32 v218, v218, v176
    v_add_f32 v218, v218, v177
    v_mfma_f32_16x16x32_bf16 a[8:11], a[128:131], v[136:139], a[8:11]
    v_cvt_pk_bf16_f32 v146, v176, v177
    v_exp_f32 v178, v116
    v_mfma_f32_16x16x32_bf16 a[12:15], a[128:131], v[140:143], a[12:15]
    ds_read_b64_tr_b16 a[156:157], v211 offset:0
    ds_read_b64_tr_b16 a[158:159], v211 offset:4096
    v_mfma_f32_16x16x32_bf16 a[16:19], a[132:135], v[128:131], a[16:19]
    v_exp_f32 v179, v117
    v_mfma_f32_16x16x32_bf16 a[20:23], a[132:135], v[132:135], a[20:23]
    buffer_load_dwordx4 v244, s[12:15], s44 offen offset:2048 lds
    v_add_f32 v219, v219, v178
    v_mfma_f32_16x16x32_bf16 a[24:27], a[132:135], v[136:139], a[24:27]
    v_add_f32 v219, v219, v179
    v_cvt_pk_bf16_f32 v150, v178, v179
    v_mfma_f32_16x16x32_bf16 a[28:31], a[132:135], v[140:143], a[28:31]
    ds_read_b128 a[128:131], v200 offset:24576
    v_exp_f32 v180, v120
    v_mfma_f32_16x16x32_bf16 a[32:35], a[136:139], v[128:131], a[32:35]
    v_exp_f32 v181, v121
    v_mfma_f32_16x16x32_bf16 a[36:39], a[136:139], v[132:135], a[36:39]
    v_add_f32 v220, v220, v180
    v_add_f32 v220, v220, v181
    v_mfma_f32_16x16x32_bf16 a[40:43], a[136:139], v[136:139], a[40:43]
    v_cvt_pk_bf16_f32 v154, v180, v181
    v_exp_f32 v182, v124
    v_mfma_f32_16x16x32_bf16 a[44:47], a[136:139], v[140:143], a[44:47]
    ds_read_b128 a[132:135], v201 offset:24576
    v_exp_f32 v183, v125
    v_mfma_f32_16x16x32_bf16 a[48:51], a[140:143], v[128:131], a[48:51]
    v_add_f32 v221, v221, v182
    v_add_f32 v221, v221, v183
    v_mfma_f32_16x16x32_bf16 a[52:55], a[140:143], v[132:135], a[52:55]
    v_cvt_pk_bf16_f32 v158, v182, v183
    v_exp_f32 v176, v114
    v_mfma_f32_16x16x32_bf16 a[56:59], a[140:143], v[136:139], a[56:59]
    v_exp_f32 v177, v115
    v_mfma_f32_16x16x32_bf16 a[60:63], a[140:143], v[140:143], a[60:63]
    ds_read_b128 a[136:139], v202 offset:24576
    s_waitcnt lgkmcnt(3)
    v_mfma_f32_16x16x32_bf16 a[64:67], a[144:147], v[128:131], a[64:67]
    v_add_f32 v218, v218, v176
    v_add_f32 v218, v218, v177
    v_mfma_f32_16x16x32_bf16 a[68:71], a[144:147], v[132:135], a[68:71]
    buffer_load_dwordx4 v245, s[12:15], s44 offen offset:3072 lds
    s_add_u32 s44, s44, 16384
    v_mfma_f32_16x16x32_bf16 a[72:75], a[144:147], v[136:139], a[72:75]
    v_cvt_pk_bf16_f32 v147, v176, v177
    v_exp_f32 v178, v118
    v_mfma_f32_16x16x32_bf16 a[76:79], a[144:147], v[140:143], a[76:79]
    ds_read_b128 a[140:143], v203 offset:24576
    v_exp_f32 v179, v119
    v_mfma_f32_16x16x32_bf16 a[80:83], a[148:151], v[128:131], a[80:83]
    v_add_f32 v219, v219, v178
    v_add_f32 v219, v219, v179
    v_mfma_f32_16x16x32_bf16 a[84:87], a[148:151], v[132:135], a[84:87]
    v_cvt_pk_bf16_f32 v151, v178, v179
    v_exp_f32 v180, v122
    v_mfma_f32_16x16x32_bf16 a[88:91], a[148:151], v[136:139], a[88:91]
    v_exp_f32 v181, v123
    v_mfma_f32_16x16x32_bf16 a[92:95], a[148:151], v[140:143], a[92:95]
    ds_read_b128 a[144:147], v200 offset:28672
    v_add_f32 v220, v220, v180
    v_mfma_f32_16x16x32_bf16 a[96:99], a[152:155], v[128:131], a[96:99]
    v_add_f32 v220, v220, v181
    v_cvt_pk_bf16_f32 v155, v180, v181
    v_mfma_f32_16x16x32_bf16 a[100:103], a[152:155], v[132:135], a[100:103]
    v_exp_f32 v182, v126
    v_mfma_f32_16x16x32_bf16 a[104:107], a[152:155], v[136:139], a[104:107]
    v_exp_f32 v183, v127
    v_mfma_f32_16x16x32_bf16 a[108:111], a[152:155], v[140:143], a[108:111]
    ds_read_b128 a[148:151], v201 offset:28672
    v_add_f32 v221, v221, v182
    v_mfma_f32_16x16x32_bf16 a[112:115], a[156:159], v[128:131], a[112:115]
    v_add_f32 v221, v221, v183
    v_cvt_pk_bf16_f32 v159, v182, v183
    v_mfma_f32_16x16x32_bf16 a[116:119], a[156:159], v[132:135], a[116:119]
    v_max3_f32 v176, v218, v219, v220
    v_max_f32 v176, v176, v221
    v_cmp_le_f32 vcc, s41, v176
    v_mfma_f32_16x16x32_bf16 a[120:123], a[156:159], v[136:139], a[120:123]
    v_mfma_f32_16x16x32_bf16 a[124:127], a[156:159], v[140:143], a[124:127]
    ds_read_b128 a[152:155], v202 offset:28672
    s_cbranch_vccnz attn_rare3
attn_back4:
    v_add_f32 v214, v214, v218
    v_add_f32 v215, v215, v219
    v_add_f32 v216, v216, v220
    v_add_f32 v217, v217, v221
    buffer_load_dwordx4 v[248:251], v224, s[16:19], s47 offen
    s_waitcnt vmcnt(10)
    s_barrier
    s_waitcnt lgkmcnt(3)
    v_mfma_f32_16x16x32_bf16 v[96:99], a[128:131], v[0:3], v[160:163]
    v_exp_f32 v176, v64
    v_mfma_f32_16x16x32_bf16 v[100:103], a[128:131], v[16:19], v[164:167]
    v_exp_f32 v177, v65
    v_mfma_f32_16x16x32_bf16 v[104:107], a[128:131], v[32:35], v[168:171]
    v_add_f32 v218, v176, v177
    v_cvt_pk_bf16_f32 v128, v176, v177
    v_mfma_f32_16x16x32_bf16 v[108:111], a[128:131], v[48:51], v[172:175]
    ds_read_b128 a[156:159], v203 offset:28672
    v_exp_f32 v178, v68
    v_mfma_f32_16x16x32_bf16 v[96:99], a[132:135], v[4:7], v[96:99]
    v_exp_f32 v179, v69
    v_mfma_f32_16x16x32_bf16 v[100:103], a[132:135], v[20:23], v[100:103]
    v_add_f32 v219, v178, v179
    v_cvt_pk_bf16_f32 v132, v178, v179
    v_mfma_f32_16x16x32_bf16 v[104:107], a[132:135], v[36:39], v[104:107]
    v_exp_f32 v180, v72
    v_mfma_f32_16x16x32_bf16 v[108:111], a[132:135], v[52:55], v[108:111]
    ds_read_b64_tr_b16 a[128:129], v204 offset:8192
    ds_read_b64_tr_b16 a[130:131], v204 offset:12288
    v_mfma_f32_16x16x32_bf16 v[96:99], a[136:139], v[8:11], v[96:99]
    s_add_u32 m0, s49, 0
    v_exp_f32 v181, v73
    v_mfma_f32_16x16x32_bf16 v[100:103], a[136:139], v[24:27], v[100:103]
    buffer_load_dwordx4 v240, s[8:11], s43 offen offset:0 lds
    v_add_f32 v220, v180, v181
    v_mfma_f32_16x16x32_bf16 v[104:107], a[136:139], v[40:43], v[104:107]
    v_cvt_pk_bf16_f32 v136, v180, v181
    v_exp_f32 v182, v76
    v_mfma_f32_16x16x32_bf16 v[108:111], a[136:139], v[56:59], v[108:111]
    ds_read_b64_tr_b16 a[132:133], v205 offset:8192
    ds_read_b64_tr_b16 a[134:135], v205 offset:12288
    v_mfma_f32_16x16x32_bf16 v[96:99], a[140:143], v[12:15], v[96:99]
    v_exp_f32 v183, v77
    v_mfma_f32_16x16x32_bf16 v[100:103], a[140:143], v[28:31], v[100:103]
    v_add_f32 v221, v182, v183
    v_cvt_pk_bf16_f32 v140, v182, v183
    v_mfma_f32_16x16x32_bf16 v[104:107], a[140:143], v[44:47], v[104:107]
    v_exp_f32 v176, v66
    v_mfma_f32_16x16x32_bf16 v[108:111], a[140:143], v[60:63], v[108:111]
    ds_read_b64_tr_b16 a[136:137], v206 offset:8192
    ds_read_b64_tr_b16 a[138:139], v206 offset:12288
    s_waitcnt lgkmcnt(6)
    v_mfma_f32_16x16x32_bf16 v[112:115], a[144:147], v[0:3], v[160:163]
    v_exp_f32 v177, v67
    v_add_f32 v218, v218, v176
    v_mfma_f32_16x16x32_bf16 v[116:119], a[144:147], v[16:19], v[164:167]
    v_add_f32 v218, v218, v177
    v_cvt_pk_bf16_f32 v129, v176, v177
    v_mfma_f32_16x16x32_bf16 v[120:123], a[144:147], v[32:35], v[168:171]
    v_exp_f32 v178, v70
    v_mfma_f32_16x16x32_bf16 v[124:127], a[144:147], v[48:51], v[172:175]
    ds_read_b64_tr_b16 a[140:141], v207 offset:8192
    ds_read_b64_tr_b16 a[142:143], v207 offset:12288
    v_mfma_f32_16x16x32_bf16 v[112:115], a[148:151], v[4:7], v[112:115]
    v_exp_f32 v179, v71
    v_add_f32 v219, v219, v178
    v_mfma_f32_16x16x32_bf16 v[116:119], a[148:151], v[20:23], v[116:119]
    buffer_load_dwordx4 v241, s[8:11], s43 offen offset:1024 lds
    v_add_f32 v219, v219, v179
    v_mfma_f32_16x16x32_bf16 v[120:123], a[148:151], v[36:39], v[120:123]
    v_cvt_pk_bf16_f32 v133, v178, v179
    v_exp_f32 v180, v74
    v_mfma_f32_16x16x32_bf16 v[124:127], a[148:151], v[52:55], v[124:127]
    ds_read_b64_tr_b16 a[144:145], v208 offset:8192
    ds_read_b64_tr_b16 a[146:147], v208 offset:12288
    v_mfma_f32_16x16x32_bf16 v[112:115], a[152:155], v[8:11], v[112:115]
    v_exp_f32 v181, v75
    v_mfma_f32_16x16x32_bf16 v[116:119], a[152:155], v[24:27], v[116:119]
    v_add_f32 v220, v220, v180
    v_add_f32 v220, v220, v181
    v_mfma_f32_16x16x32_bf16 v[120:123], a[152:155], v[40:43], v[120:123]
    v_cvt_pk_bf16_f32 v137, v180, v181
    v_exp_f32 v182, v78
    v_mfma_f32_16x16x32_bf16 v[124:127], a[152:155], v[56:59], v[124:127]
    ds_read_b64_tr_b16 a[148:149], v209 offset:8192
    ds_read_b64_tr_b16 a[150:151], v209 offset:12288
    v_mfma_f32_16x16x32_bf16 v[112:115], a[156:159], v[12:15], v[112:115]
    v_exp_f32 v183, v79
    v_mfma_f32_16x16x32_bf16 v[116:119], a[156:159], v[28:31], v[116:119]
    v_add_f32 v221, v221, v182
    v_add_f32 v221, v221, v183
    v_mfma_f32_16x16x32_bf16 v[120:123], a[156:159], v[44:47], v[120:123]
    v_cvt_pk_bf16_f32 v141, v182, v183
    v_exp_f32 v176, v80
    v_mfma_f32_16x16x32_bf16 v[124:127], a[156:159], v[60:63], v[124:127]
    ds_read_b64_tr_b16 a[152:153], v210 offset:8192
    ds_read_b64_tr_b16 a[154:155], v210 offset:12288
    s_waitcnt lgkmcnt(6)
    v_mfma_f32_16x16x32_bf16 a[0:3], a[128:131], v[144:147], a[0:3]
    v_exp_f32 v177, v81
    v_mfma_f32_16x16x32_bf16 a[4:7], a[128:131], v[148:151], a[4:7]
    v_add_f32 v218, v218, v176
    v_add_f32 v218, v218, v177
    v_mfma_f32_16x16x32_bf16 a[8:11], a[128:131], v[152:155], a[8:11]
    v_cvt_pk_bf16_f32 v130, v176, v177
    v_exp_f32 v178, v84
    v_mfma_f32_16x16x32_bf16 a[12:15], a[128:131], v[156:159], a[12:15]
    ds_read_b64_tr_b16 a[156:157], v211 offset:8192
    ds_read_b64_tr_b16 a[158:159], v211 offset:12288
    v_mfma_f32_16x16x32_bf16 a[16:19], a[132:135], v[144:147], a[16:19]
    v_exp_f32 v179, v85
    v_mfma_f32_16x16x32_bf16 a[20:23], a[132:135], v[148:151], a[20:23]
    buffer_load_dwordx4 v242, s[8:11], s43 offen offset:2048 lds
    v_add_f32 v219, v219, v178
    v_mfma_f32_16x16x32_bf16 a[24:27], a[132:135], v[152:155], a[24:27]
    v_add_f32 v219, v219, v179
    v_cvt_pk_bf16_f32 v134, v178, v179
    v_mfma_f32_16x16x32_bf16 a[28:31], a[132:135], v[156:159], a[28:31]
    ds_read_b128 a[128:131], v200 offset:32768
    v_exp_f32 v180, v88
    v_mfma_f32_16x16x32_bf16 a[32:35], a[136:139], v[144:147], a[32:35]
    v_exp_f32 v181, v89
    v_mfma_f32_16x16x32_bf16 a[36:39], a[136:139], v[148:151], a[36:39]
    v_add_f32 v220, v220, v180
    v_add_f32 v220, v220, v181
    v_mfma_f32_16x16x32_bf16 a[40:43], a[136:139], v[152:155], a[40:43]
    v_cvt_pk_bf16_f32 v138, v180, v181
    v_exp_f32 v182, v92
    v_mfma_f32_16x16x32_bf16 a[44:47], a[136:139], v[156:159], a[44:47]
    ds_read_b128 a[132:135], v201 offset:32768
    v_exp_f32 v183, v93
    v_mfma_f32_16x16x32_bf16 a[48:51], a[140:143], v[144:147], a[48:51]
    v_add_f32 v221, v221, v182
    v_add_f32 v221, v221, v183
    v_mfma_f32_16x16x32_bf16 a[52:55], a[140:143], v[148:151], a[52:55]
    v_cvt_pk_bf16_f32 v142, v182, v183
    v_exp_f32 v176, v82
    v_mfma_f32_16x16x32_bf16 a[56:59], a[140:143], v[152:155], a[56:59]
    v_exp_f32 v177, v83
    v_mfma_f32_16x16x32_bf16 a[60:63], a[140:143], v[156:159], a[60:63]
    ds_read_b128 a[136:139], v202 offset:32768
    s_waitcnt lgkmcnt(3)
    v_mfma_f32_16x16x32_bf16 a[64:67], a[144:147], v[144:147], a[64:67]
    v_add_f32 v218, v218, v176
    v_add_f32 v218, v218, v177
    v_mfma_f32_16x16x32_bf16 a[68:71], a[144:147], v[148:151], a[68:71]
    buffer_load_dwordx4 v243, s[8:11], s43 offen offset:3072 lds
    s_add_u32 s43, s43, 16384
    v_mfma_f32_16x16x32_bf16 a[72:75], a[144:147], v[152:155], a[72:75]
    v_cvt_pk_bf16_f32 v131, v176, v177
    v_exp_f32 v178, v86
    v_mfma_f32_16x16x32_bf16 a[76:79], a[144:147], v[156:159], a[76:79]
    ds_read_b128 a[140:143], v203 offset:32768
    v_exp_f32 v179, v87
    v_mfma_f32_16x16x32_bf16 a[80:83], a[148:151], v[144:147], a[80:83]
    v_add_f32 v219, v219, v178
    v_add_f32 v219, v219, v179
    v_mfma_f32_16x16x32_bf16 a[84:87], a[148:151], v[148:151], a[84:87]
    v_cvt_pk_bf16_f32 v135, v178, v179
    v_exp_f32 v180, v90
    v_mfma_f32_16x16x32_bf16 a[88:91], a[148:151], v[152:155], a[88:91]
    v_exp_f32 v181, v91
    v_mfma_f32_16x16x32_bf16 a[92:95], a[148:151], v[156:159], a[92:95]
    ds_read_b128 a[144:147], v200 offset:36864
    v_add_f32 v220, v220, v180
    v_mfma_f32_16x16x32_bf16 a[96:99], a[152:155], v[144:147], a[96:99]
    v_add_f32 v220, v220, v181
    v_cvt_pk_bf16_f32 v139, v180, v181
    v_mfma_f32_16x16x32_bf16 a[100:103], a[152:155], v[148:151], a[100:103]
    v_exp_f32 v182, v94
    v_mfma_f32_16x16x32_bf16 a[104:107], a[152:155], v[152:155], a[104:107]
    v_exp_f32 v183, v95
    v_mfma_f32_16x16x32_bf16 a[108:111], a[152:155], v[156:159], a[108:111]
    ds_read_b128 a[148:151], v201 offset:36864
    v_add_f32 v221, v221, v182
    v_mfma_f32_16x16x32_bf16 a[112:115], a[156:159], v[144:147], a[112:115]
    v_add_f32 v221, v221, v183
    v_cvt_pk_bf16_f32 v143, v182, v183
    v_mfma_f32_16x16x32_bf16 a[116:119], a[156:159], v[148:151], a[116:119]
    v_max3_f32 v176, v218, v219, v220
    v_max_f32 v176, v176, v221
    v_cmp_le_f32 vcc, s41, v176
    v_mfma_f32_16x16x32_bf16 a[120:123], a[156:159], v[152:155], a[120:123]
    v_mfma_f32_16x16x32_bf16 a[124:127], a[156:159], v[156:159], a[124:127]
    ds_read_b128 a[152:155], v202 offset:36864
    s_cbranch_vccnz attn_rare5
attn_back6:
    v_add_f32 v214, v214, v218
    v_add_f32 v215, v215, v219
    v_add_f32 v216, v216, v220
    v_add_f32 v217, v217, v221
    s_waitcnt lgkmcnt(3)
    v_mfma_f32_16x16x32_bf16 v[64:67], a[128:131], v[0:3], v[160:163]
    v_exp_f32 v176, v96
    v_mfma_f32_16x16x32_bf16 v[68:71], a[128:131], v[16:19], v[164:167]
    v_exp_f32 v177, v97
    v_mfma_f32_16x16x32_bf16 v[72:75], a[128:131], v[32:35], v[168:171]
    v_add_f32 v218, v176, v177
    v_cvt_pk_bf16_f32 v144, v176, v177
    v_mfma_f32_16x16x32_bf16 v[76:79], a[128:131], v[48:51], v[172:175]
    ds_read_b128 a[156:159], v203 offset:36864
    v_exp_f32 v178, v100
    v_mfma_f32_16x16x32_bf16 v[64:67], a[132:135], v[4:7], v[64:67]
    v_exp_f32 v179, v101
    v_mfma_f32_16x16x32_bf16 v[68:71], a[132:135], v[20:23], v[68:71]
    v_add_f32 v219, v178, v179
    v_cvt_pk_bf16_f32 v148, v178, v179
    v_mfma_f32_16x16x32_bf16 v[72:75], a[132:135], v[36:39], v[72:75]
    v_exp_f32 v180, v104
    v_mfma_f32_16x16x32_bf16 v[76:79], a[132:135], v[52:55], v[76:79]
    ds_read_b64_tr_b16 a[128:129], v204 offset:16384
    ds_read_b64_tr_b16 a[130:131], v204 offset:20480
    v_mfma_f32_16x16x32_bf16 v[64:67], a[136:139], v[8:11], v[64:67]
    s_add_u32 m0, s49, 114688
    v_exp_f32 v181, v105
    v_mfma_f32_16x16x32_bf16 v[68:71], a[136:139], v[24:27], v[68:71]
    buffer_load_dwordx4 v244, s[12:15], s44 offen offset:0 lds
    v_add_f32 v220, v180, v181
    v_mfma_f32_16x16x32_bf16 v[72:75], a[136:139], v[40:43], v[72:75]
    v_cvt_pk_bf16_f32 v152, v180, v181
    v_exp_f32 v182, v108
    v_mfma_f32_16x16x32_bf16 v[76:79], a[136:139], v[56:59], v[76:79]
    ds_read_b64_tr_b16 a[132:133], v205 offset:16384
    ds_read_b64_tr_b16 a[134:135], v205 offset:20480
    v_mfma_f32_16x16x32_bf16 v[64:67], a[140:143], v[12:15], v[64:67]
    v_exp_f32 v183, v109
    v_mfma_f32_16x16x32_bf16 v[68:71], a[140:143], v[28:31], v[68:71]
    v_add_f32 v221, v182, v183
    v_cvt_pk_bf16_f32 v156, v182, v183
    v_mfma_f32_16x16x32_bf16 v[72:75], a[140:143], v[44:47], v[72:75]
    v_exp_f32 v176, v98
    v_mfma_f32_16x16x32_bf16 v[76:79], a[140:143], v[60:63], v[76:79]
    ds_read_b64_tr_b16 a[136:137], v206 offset:16384
    ds_read_b64_tr_b16 a[138:139], v206 offset:20480
    s_waitcnt lgkmcnt(6)
    v_mfma_f32_16x16x32_bf16 v[80:83], a[144:147], v[0:3], v[160:163]
    v_exp_f32 v177, v99
    v_add_f32 v218, v218, v176
    v_mfma_f32_16x16x32_bf16 v[84:87], a[144:147], v[16:19], v[164:167]
    v_add_f32 v218, v218, v177
    v_cvt_pk_bf16_f32 v145, v176, v177
    v_mfma_f32_16x16x32_bf16 v[88:91], a[144:147], v[32:35], v[168:171]
    v_exp_f32 v178, v102
    v_mfma_f32_16x16x32_bf16 v[92:95], a[144:147], v[48:51], v[172:175]
    ds_read_b64_tr_b16 a[140:141], v207 offset:16384
    ds_read_b64_tr_b16 a[142:143], v207 offset:20480
    v_mfma_f32_16x16x32_bf16 v[80:83], a[148:151], v[4:7], v[80:83]
    v_exp_f32 v179, v103
    v_add_f32 v219, v219, v178
    v_mfma_f32_16x16x32_bf16 v[84:87], a[148:151], v[20:23], v[84:87]
    buffer_load_dwordx4 v245, s[12:15], s44 offen offset:1024 lds
    v_add_f32 v219, v219, v179
    v_mfma_f32_16x16x32_bf16 v[88:91], a[148:151], v[36:39], v[88:91]
    v_cvt_pk_bf16_f32 v149, v178, v179
    v_exp_f32 v180, v106
    v_mfma_f32_16x16x32_bf16 v[92:95], a[148:151], v[52:55], v[92:95]
    ds_read_b64_tr_b16 a[144:145], v208 offset:16384
    ds_read_b64_tr_b16 a[146:147], v208 offset:20480
    v_mfma_f32_16x16x32_bf16 v[80:83], a[152:155], v[8:11], v[80:83]
    v_exp_f32 v181, v107
    v_mfma_f32_16x16x32_bf16 v[84:87], a[152:155], v[24:27], v[84:87]
    v_add_f32 v220, v220, v180
    v_add_f32 v220, v220, v181
    v_mfma_f32_16x16x32_bf16 v[88:91], a[152:155], v[40:43], v[88:91]
    v_cvt_pk_bf16_f32 v153, v180, v181
    v_exp_f32 v182, v110
    v_mfma_f32_16x16x32_bf16 v[92:95], a[152:155], v[56:59], v[92:95]
    ds_read_b64_tr_b16 a[148:149], v209 offset:16384
    ds_read_b64_tr_b16 a[150:151], v209 offset:20480
    v_mfma_f32_16x16x32_bf16 v[80:83], a[156:159], v[12:15], v[80:83]
    v_exp_f32 v183, v111
    v_mfma_f32_16x16x32_bf16 v[84:87], a[156:159], v[28:31], v[84:87]
    v_add_f32 v221, v221, v182
    v_add_f32 v221, v221, v183
    v_mfma_f32_16x16x32_bf16 v[88:91], a[156:159], v[44:47], v[88:91]
    v_cvt_pk_bf16_f32 v157, v182, v183
    v_exp_f32 v176, v112
    v_mfma_f32_16x16x32_bf16 v[92:95], a[156:159], v[60:63], v[92:95]
    ds_read_b64_tr_b16 a[152:153], v210 offset:16384
    ds_read_b64_tr_b16 a[154:155], v210 offset:20480
    s_waitcnt lgkmcnt(6)
    v_mfma_f32_16x16x32_bf16 a[0:3], a[128:131], v[128:131], a[0:3]
    v_exp_f32 v177, v113
    v_mfma_f32_16x16x32_bf16 a[4:7], a[128:131], v[132:135], a[4:7]
    v_add_f32 v218, v218, v176
    v_add_f32 v218, v218, v177
    v_mfma_f32_16x16x32_bf16 a[8:11], a[128:131], v[136:139], a[8:11]
    v_cvt_pk_bf16_f32 v146, v176, v177
    v_exp_f32 v178, v116
    v_mfma_f32_16x16x32_bf16 a[12:15], a[128:131], v[140:143], a[12:15]
    ds_read_b64_tr_b16 a[156:157], v211 offset:16384
    ds_read_b64_tr_b16 a[158:159], v211 offset:20480
    v_mfma_f32_16x16x32_bf16 a[16:19], a[132:135], v[128:131], a[16:19]
    v_exp_f32 v179, v117
    v_mfma_f32_16x16x32_bf16 a[20:23], a[132:135], v[132:135], a[20:23]
    buffer_load_dwordx4 v244, s[12:15], s44 offen offset:2048 lds
    v_add_f32 v219, v219, v178
    v_mfma_f32_16x16x32_bf16 a[24:27], a[132:135], v[136:139], a[24:27]
    v_add_f32 v219, v219, v179
    v_cvt_pk_bf16_f32 v150, v178, v179
    v_mfma_f32_16x16x32_bf16 a[28:31], a[132:135], v[140:143], a[28:31]
    ds_read_b128 a[128:131], v200 offset:40960
    v_exp_f32 v180, v120
    v_mfma_f32_16x16x32_bf16 a[32:35], a[136:139], v[128:131], a[32:35]
    v_exp_f32 v181, v121
    v_mfma_f32_16x16x32_bf16 a[36:39], a[136:139], v[132:135], a[36:39]
    v_add_f32 v220, v220, v180
    v_add_f32 v220, v220, v181
    v_mfma_f32_16x16x32_bf16 a[40:43], a[136:139], v[136:139], a[40:43]
    v_cvt_pk_bf16_f32 v154, v180, v181
    v_exp_f32 v182, v124
    v_mfma_f32_16x16x32_bf16 a[44:47], a[136:139], v[140:143], a[44:47]
    ds_read_b128 a[132:135], v201 offset:40960
    v_exp_f32 v183, v125
    v_mfma_f32_16x16x32_bf16 a[48:51], a[140:143], v[128:131], a[48:51]
    v_add_f32 v221, v221, v182
    v_add_f32 v221, v221, v183
    v_mfma_f32_16x16x32_bf16 a[52:55], a[140:143], v[132:135], a[52:55]
    v_cvt_pk_bf16_f32 v158, v182, v183
    v_exp_f32 v176, v114
    v_mfma_f32_16x16x32_bf16 a[56:59], a[140:143], v[136:139], a[56:59]
    v_exp_f32 v177, v115
    v_mfma_f32_16x16x32_bf16 a[60:63], a[140:143], v[140:143], a[60:63]
    ds_read_b128 a[136:139], v202 offset:40960
    s_waitcnt lgkmcnt(3)
    v_mfma_f32_16x16x32_bf16 a[64:67], a[144:147], v[128:131], a[64:67]
    v_add_f32 v218, v218, v176
    v_add_f32 v218, v218, v177
    v_mfma_f32_16x16x32_bf16 a[68:71], a[144:147], v[132:135], a[68:71]
    buffer_load_dwordx4 v245, s[12:15], s44 offen offset:3072 lds
    s_add_u32 s44, s44, 16384
    v_mfma_f32_16x16x32_bf16 a[72:75], a[144:147], v[136:139], a[72:75]
    v_cvt_pk_bf16_f32 v147, v176, v177
    v_exp_f32 v178, v118
    v_mfma_f32_16x16x32_bf16 a[76:79], a[144:147], v[140:143], a[76:79]
    ds_read_b128 a[140:143], v203 offset:40960
    v_exp_f32 v179, v119
    v_mfma_f32_16x16x32_bf16 a[80:83], a[148:151], v[128:131], a[80:83]
    v_add_f32 v219, v219, v178
    v_add_f32 v219, v219, v179
    v_mfma_f32_16x16x32_bf16 a[84:87], a[148:151], v[132:135], a[84:87]
    v_cvt_pk_bf16_f32 v151, v178, v179
    v_exp_f32 v180, v122
    v_mfma_f32_16x16x32_bf16 a[88:91], a[148:151], v[136:139], a[88:91]
    v_exp_f32 v181, v123
    v_mfma_f32_16x16x32_bf16 a[92:95], a[148:151], v[140:143], a[92:95]
    ds_read_b128 a[144:147], v200 offset:45056
    v_add_f32 v220, v220, v180
    v_mfma_f32_16x16x32_bf16 a[96:99], a[152:155], v[128:131], a[96:99]
    v_add_f32 v220, v220, v181
    v_cvt_pk_bf16_f32 v155, v180, v181
    v_mfma_f32_16x16x32_bf16 a[100:103], a[152:155], v[132:135], a[100:103]
    v_exp_f32 v182, v126
    v_mfma_f32_16x16x32_bf16 a[104:107], a[152:155], v[136:139], a[104:107]
    v_exp_f32 v183, v127
    v_mfma_f32_16x16x32_bf16 a[108:111], a[152:155], v[140:143], a[108:111]
    ds_read_b128 a[148:151], v201 offset:45056
    v_add_f32 v221, v221, v182
    v_mfma_f32_16x16x32_bf16 a[112:115], a[156:159], v[128:131], a[112:115]
    v_add_f32 v221, v221, v183
    v_cvt_pk_bf16_f32 v159, v182, v183
    v_mfma_f32_16x16x32_bf16 a[116:119], a[156:159], v[132:135], a[116:119]
    v_max3_f32 v176, v218, v219, v220
    v_max_f32 v176, v176, v221
    v_cmp_le_f32 vcc, s41, v176
    v_mfma_f32_16x16x32_bf16 a[120:123], a[156:159], v[136:139], a[120:123]
    v_mfma_f32_16x16x32_bf16 a[124:127], a[156:159], v[140:143], a[124:127]
    ds_read_b128 a[152:155], v202 offset:45056
    s_cbranch_vccnz attn_rare7
attn_back8:
    v_add_f32 v214, v214, v218
    v_add_f32 v215, v215, v219
    v_add_f32 v216, v216, v220
    v_add_f32 v217, v217, v221
    buffer_load_dwordx4 v[248:251], v224, s[88:91], s47 offen
    s_waitcnt vmcnt(10)
    s_barrier
    s_waitcnt lgkmcnt(3)
    v_mfma_f32_16x16x32_bf16 v[96:99], a[128:131], v[0:3], v[160:163]
    v_exp_f32 v176, v64
    v_mfma_f32_16x16x32_bf16 v[100:103], a[128:131], v[16:19], v[164:167]
    v_exp_f32 v177, v65
    v_mfma_f32_16x16x32_bf16 v[104:107], a[128:131], v[32:35], v[168:171]
    v_add_f32 v218, v176, v177
    v_cvt_pk_bf16_f32 v128, v176, v177
    v_mfma_f32_16x16x32_bf16 v[108:111], a[128:131], v[48:51], v[172:175]
    ds_read_b128 a[156:159], v203 offset:45056
    v_exp_f32 v178, v68
    v_mfma_f32_16x16x32_bf16 v[96:99], a[132:135], v[4:7], v[96:99]
    v_exp_f32 v179, v69
    v_mfma_f32_16x16x32_bf16 v[100:103], a[132:135], v[20:23], v[100:103]
    v_add_f32 v219, v178, v179
    v_cvt_pk_bf16_f32 v132, v178, v179
    v_mfma_f32_16x16x32_bf16 v[104:107], a[132:135], v[36:39], v[104:107]
    v_exp_f32 v180, v72
    v_mfma_f32_16x16x32_bf16 v[108:111], a[132:135], v[52:55], v[108:111]
    ds_read_b64_tr_b16 a[128:129], v204 offset:24576
    ds_read_b64_tr_b16 a[130:131], v204 offset:28672
    v_mfma_f32_16x16x32_bf16 v[96:99], a[136:139], v[8:11], v[96:99]
    s_add_u32 m0, s49, 16384
    v_exp_f32 v181, v73
    v_mfma_f32_16x16x32_bf16 v[100:103], a[136:139], v[24:27], v[100:103]
    buffer_load_dwordx4 v240, s[8:11], s43 offen offset:0 lds
    v_add_f32 v220, v180, v181
    v_mfma_f32_16x16x32_bf16 v[104:107], a[136:139], v[40:43], v[104:107]
    v_cvt_pk_bf16_f32 v136, v180, v181
    v_exp_f32 v182, v76
    v_mfma_f32_16x16x32_bf16 v[108:111], a[136:139], v[56:59], v[108:111]
    ds_read_b64_tr_b16 a[132:133], v205 offset:24576
    ds_read_b64_tr_b16 a[134:135], v205 offset:28672
    v_mfma_f32_16x16x32_bf16 v[96:99], a[140:143], v[12:15], v[96:99]
    v_exp_f32 v183, v77
    v_mfma_f32_16x16x32_bf16 v[100:103], a[140:143], v[28:31], v[100:103]
    v_add_f32 v221, v182, v183
    v_cvt_pk_bf16_f32 v140, v182, v183
    v_mfma_f32_16x16x32_bf16 v[104:107], a[140:143], v[44:47], v[104:107]
    v_exp_f32 v176, v66
    v_mfma_f32_16x16x32_bf16 v[108:111], a[140:143], v[60:63], v[108:111]
    ds_read_b64_tr_b16 a[136:137], v206 offset:24576
    ds_read_b64_tr_b16 a[138:139], v206 offset:28672
    s_waitcnt lgkmcnt(6)
    v_mfma_f32_16x16x32_bf16 v[112:115], a[144:147], v[0:3], v[160:163]
    v_exp_f32 v177, v67
    v_add_f32 v218, v218, v176
    v_mfma_f32_16x16x32_bf16 v[116:119], a[144:147], v[16:19], v[164:167]
    v_add_f32 v218, v218, v177
    v_cvt_pk_bf16_f32 v129, v176, v177
    v_mfma_f32_16x16x32_bf16 v[120:123], a[144:147], v[32:35], v[168:171]
    v_exp_f32 v178, v70
    v_mfma_f32_16x16x32_bf16 v[124:127], a[144:147], v[48:51], v[172:175]
    ds_read_b64_tr_b16 a[140:141], v207 offset:24576
    ds_read_b64_tr_b16 a[142:143], v207 offset:28672
    v_mfma_f32_16x16x32_bf16 v[112:115], a[148:151], v[4:7], v[112:115]
    v_exp_f32 v179, v71
    v_add_f32 v219, v219, v178
    v_mfma_f32_16x16x32_bf16 v[116:119], a[148:151], v[20:23], v[116:119]
    buffer_load_dwordx4 v241, s[8:11], s43 offen offset:1024 lds
    v_add_f32 v219, v219, v179
    v_mfma_f32_16x16x32_bf16 v[120:123], a[148:151], v[36:39], v[120:123]
    v_cvt_pk_bf16_f32 v133, v178, v179
    v_exp_f32 v180, v74
    v_mfma_f32_16x16x32_bf16 v[124:127], a[148:151], v[52:55], v[124:127]
    ds_read_b64_tr_b16 a[144:145], v208 offset:24576
    ds_read_b64_tr_b16 a[146:147], v208 offset:28672
    v_mfma_f32_16x16x32_bf16 v[112:115], a[152:155], v[8:11], v[112:115]
    v_exp_f32 v181, v75
    v_mfma_f32_16x16x32_bf16 v[116:119], a[152:155], v[24:27], v[116:119]
    v_add_f32 v220, v220, v180
    v_add_f32 v220, v220, v181
    v_mfma_f32_16x16x32_bf16 v[120:123], a[152:155], v[40:43], v[120:123]
    v_cvt_pk_bf16_f32 v137, v180, v181
    v_exp_f32 v182, v78
    v_mfma_f32_16x16x32_bf16 v[124:127], a[152:155], v[56:59], v[124:127]
    ds_read_b64_tr_b16 a[148:149], v209 offset:24576
    ds_read_b64_tr_b16 a[150:151], v209 offset:28672
    v_mfma_f32_16x16x32_bf16 v[112:115], a[156:159], v[12:15], v[112:115]
    v_exp_f32 v183, v79
    v_mfma_f32_16x16x32_bf16 v[116:119], a[156:159], v[28:31], v[116:119]
    v_add_f32 v221, v221, v182
    v_add_f32 v221, v221, v183
    v_mfma_f32_16x16x32_bf16 v[120:123], a[156:159], v[44:47], v[120:123]
    v_cvt_pk_bf16_f32 v141, v182, v183
    v_exp_f32 v176, v80
    v_mfma_f32_16x16x32_bf16 v[124:127], a[156:159], v[60:63], v[124:127]
    ds_read_b64_tr_b16 a[152:153], v210 offset:24576
    ds_read_b64_tr_b16 a[154:155], v210 offset:28672
    s_waitcnt lgkmcnt(6)
    v_mfma_f32_16x16x32_bf16 a[0:3], a[128:131], v[144:147], a[0:3]
    v_exp_f32 v177, v81
    v_mfma_f32_16x16x32_bf16 a[4:7], a[128:131], v[148:151], a[4:7]
    v_add_f32 v218, v218, v176
    v_add_f32 v218, v218, v177
    v_mfma_f32_16x16x32_bf16 a[8:11], a[128:131], v[152:155], a[8:11]
    v_cvt_pk_bf16_f32 v130, v176, v177
    v_exp_f32 v178, v84
    v_mfma_f32_16x16x32_bf16 a[12:15], a[128:131], v[156:159], a[12:15]
    ds_read_b64_tr_b16 a[156:157], v211 offset:24576
    ds_read_b64_tr_b16 a[158:159], v211 offset:28672
    v_mfma_f32_16x16x32_bf16 a[16:19], a[132:135], v[144:147], a[16:19]
    v_exp_f32 v179, v85
    v_mfma_f32_16x16x32_bf16 a[20:23], a[132:135], v[148:151], a[20:23]
    buffer_load_dwordx4 v242, s[8:11], s43 offen offset:2048 lds
    v_add_f32 v219, v219, v178
    v_mfma_f32_16x16x32_bf16 a[24:27], a[132:135], v[152:155], a[24:27]
    v_add_f32 v219, v219, v179
    v_cvt_pk_bf16_f32 v134, v178, v179
    v_mfma_f32_16x16x32_bf16 a[28:31], a[132:135], v[156:159], a[28:31]
    ds_read_b128 a[128:131], v200 offset:49152
    v_exp_f32 v180, v88
    v_mfma_f32_16x16x32_bf16 a[32:35], a[136:139], v[144:147], a[32:35]
    v_exp_f32 v181, v89
    v_mfma_f32_16x16x32_bf16 a[36:39], a[136:139], v[148:151], a[36:39]
    v_add_f32 v220, v220, v180
    v_add_f32 v220, v220, v181
    v_mfma_f32_16x16x32_bf16 a[40:43], a[136:139], v[152:155], a[40:43]
    v_cvt_pk_bf16_f32 v138, v180, v181
    v_exp_f32 v182, v92
    v_mfma_f32_16x16x32_bf16 a[44:47], a[136:139], v[156:159], a[44:47]
    ds_read_b128 a[132:135], v201 offset:49152
    v_exp_f32 v183, v93
    v_mfma_f32_16x16x32_bf16 a[48:51], a[140:143], v[144:147], a[48:51]
    v_add_f32 v221, v221, v182
    v_add_f32 v221, v221, v183
    v_mfma_f32_16x16x32_bf16 a[52:55], a[140:143], v[148:151], a[52:55]
    v_cvt_pk_bf16_f32 v142, v182, v183
    v_exp_f32 v176, v82
    v_mfma_f32_16x16x32_bf16 a[56:59], a[140:143], v[152:155], a[56:59]
    v_exp_f32 v177, v83
    v_mfma_f32_16x16x32_bf16 a[60:63], a[140:143], v[156:159], a[60:63]
    ds_read_b128 a[136:139], v202 offset:49152
    s_waitcnt lgkmcnt(3)
    v_mfma_f32_16x16x32_bf16 a[64:67], a[144:147], v[144:147], a[64:67]
    v_add_f32 v218, v218, v176
    v_add_f32 v218, v218, v177
    v_mfma_f32_16x16x32_bf16 a[68:71], a[144:147], v[148:151], a[68:71]
    buffer_load_dwordx4 v243, s[8:11], s43 offen offset:3072 lds
    s_add_u32 s43, s43, 16384
    v_mfma_f32_16x16x32_bf16 a[72:75], a[144:147], v[152:155], a[72:75]
    v_cvt_pk_bf16_f32 v131, v176, v177
    v_exp_f32 v178, v86
    v_mfma_f32_16x16x32_bf16 a[76:79], a[144:147], v[156:159], a[76:79]
    ds_read_b128 a[140:143], v203 offset:49152
    v_exp_f32 v179, v87
    v_mfma_f32_16x16x32_bf16 a[80:83], a[148:151], v[144:147], a[80:83]
    v_add_f32 v219, v219, v178
    v_add_f32 v219, v219, v179
    v_mfma_f32_16x16x32_bf16 a[84:87], a[148:151], v[148:151], a[84:87]
    v_cvt_pk_bf16_f32 v135, v178, v179
    v_exp_f32 v180, v90
    v_mfma_f32_16x16x32_bf16 a[88:91], a[148:151], v[152:155], a[88:91]
    v_exp_f32 v181, v91
    v_mfma_f32_16x16x32_bf16 a[92:95], a[148:151], v[156:159], a[92:95]
    ds_read_b128 a[144:147], v200 offset:53248
    v_add_f32 v220, v220, v180
    v_mfma_f32_16x16x32_bf16 a[96:99], a[152:155], v[144:147], a[96:99]
    v_add_f32 v220, v220, v181
    v_cvt_pk_bf16_f32 v139, v180, v181
    v_mfma_f32_16x16x32_bf16 a[100:103], a[152:155], v[148:151], a[100:103]
    v_exp_f32 v182, v94
    v_mfma_f32_16x16x32_bf16 a[104:107], a[152:155], v[152:155], a[104:107]
    v_exp_f32 v183, v95
    v_mfma_f32_16x16x32_bf16 a[108:111], a[152:155], v[156:159], a[108:111]
    ds_read_b128 a[148:151], v201 offset:53248
    v_add_f32 v221, v221, v182
    v_mfma_f32_16x16x32_bf16 a[112:115], a[156:159], v[144:147], a[112:115]
    v_add_f32 v221, v221, v183
    v_cvt_pk_bf16_f32 v143, v182, v183
    v_mfma_f32_16x16x32_bf16 a[116:119], a[156:159], v[148:151], a[116:119]
    v_max3_f32 v176, v218, v219, v220
    v_max_f32 v176, v176, v221
    v_cmp_le_f32 vcc, s41, v176
    v_mfma_f32_16x16x32_bf16 a[120:123], a[156:159], v[152:155], a[120:123]
    v_mfma_f32_16x16x32_bf16 a[124:127], a[156:159], v[156:159], a[124:127]
    ds_read_b128 a[152:155], v202 offset:53248
    s_cbranch_vccnz attn_rare9
attn_back10:
    v_add_f32 v214, v214, v218
    v_add_f32 v215, v215, v219
    v_add_f32 v216, v216, v220
    v_add_f32 v217, v217, v221
    s_waitcnt lgkmcnt(3)
    v_mfma_f32_16x16x32_bf16 v[64:67], a[128:131], v[0:3], v[160:163]
    v_exp_f32 v176, v96
    v_mfma_f32_16x16x32_bf16 v[68:71], a[128:131], v[16:19], v[164:167]
    v_exp_f32 v177, v97
    v_mfma_f32_16x16x32_bf16 v[72:75], a[128:131], v[32:35], v[168:171]
    v_add_f32 v218, v176, v177
    v_cvt_pk_bf16_f32 v144, v176, v177
    v_mfma_f32_16x16x32_bf16 v[76:79], a[128:131], v[48:51], v[172:175]
    ds_read_b128 a[156:159], v203 offset:53248
    v_exp_f32 v178, v100
    v_mfma_f32_16x16x32_bf16 v[64:67], a[132:135], v[4:7], v[64:67]
    v_exp_f32 v179, v101
    v_mfma_f32_16x16x32_bf16 v[68:71], a[132:135], v[20:23], v[68:71]
    v_add_f32 v219, v178, v179
    v_cvt_pk_bf16_f32 v148, v178, v179
    v_mfma_f32_16x16x32_bf16 v[72:75], a[132:135], v[36:39], v[72:75]
    v_exp_f32 v180, v104
    v_mfma_f32_16x16x32_bf16 v[76:79], a[132:135], v[52:55], v[76:79]
    ds_read_b64_tr_b16 a[128:129], v204 offset:32768
    ds_read_b64_tr_b16 a[130:131], v204 offset:36864
    v_mfma_f32_16x16x32_bf16 v[64:67], a[136:139], v[8:11], v[64:67]
    s_add_u32 m0, s49, 65536
    v_exp_f32 v181, v105
    v_mfma_f32_16x16x32_bf16 v[68:71], a[136:139], v[24:27], v[68:71]
    buffer_load_dwordx4 v244, s[12:15], s44 offen offset:0 lds
    v_add_f32 v220, v180, v181
    v_mfma_f32_16x16x32_bf16 v[72:75], a[136:139], v[40:43], v[72:75]
    v_cvt_pk_bf16_f32 v152, v180, v181
    v_exp_f32 v182, v108
    v_mfma_f32_16x16x32_bf16 v[76:79], a[136:139], v[56:59], v[76:79]
    ds_read_b64_tr_b16 a[132:133], v205 offset:32768
    ds_read_b64_tr_b16 a[134:135], v205 offset:36864
    v_mfma_f32_16x16x32_bf16 v[64:67], a[140:143], v[12:15], v[64:67]
    v_exp_f32 v183, v109
    v_mfma_f32_16x16x32_bf16 v[68:71], a[140:143], v[28:31], v[68:71]
    v_add_f32 v221, v182, v183
    v_cvt_pk_bf16_f32 v156, v182, v183
    v_mfma_f32_16x16x32_bf16 v[72:75], a[140:143], v[44:47], v[72:75]
    v_exp_f32 v176, v98
    v_mfma_f32_16x16x32_bf16 v[76:79], a[140:143], v[60:63], v[76:79]
    ds_read_b64_tr_b16 a[136:137], v206 offset:32768
    ds_read_b64_tr_b16 a[138:139], v206 offset:36864
    s_waitcnt lgkmcnt(6)
    v_mfma_f32_16x16x32_bf16 v[80:83], a[144:147], v[0:3], v[160:163]
    v_exp_f32 v177, v99
    v_add_f32 v218, v218, v176
    v_mfma_f32_16x16x32_bf16 v[84:87], a[144:147], v[16:19], v[164:167]
    v_add_f32 v218, v218, v177
    v_cvt_pk_bf16_f32 v145, v176, v177
    v_mfma_f32_16x16x32_bf16 v[88:91], a[144:147], v[32:35], v[168:171]
    v_exp_f32 v178, v102
    v_mfma_f32_16x16x32_bf16 v[92:95], a[144:147], v[48:51], v[172:175]
    ds_read_b64_tr_b16 a[140:141], v207 offset:32768
    ds_read_b64_tr_b16 a[142:143], v207 offset:36864
    v_mfma_f32_16x16x32_bf16 v[80:83], a[148:151], v[4:7], v[80:83]
    v_exp_f32 v179, v103
    v_add_f32 v219, v219, v178
    v_mfma_f32_16x16x32_bf16 v[84:87], a[148:151], v[20:23], v[84:87]
    buffer_load_dwordx4 v245, s[12:15], s44 offen offset:1024 lds
    v_add_f32 v219, v219, v179
    v_mfma_f32_16x16x32_bf16 v[88:91], a[148:151], v[36:39], v[88:91]
    v_cvt_pk_bf16_f32 v149, v178, v179
    v_exp_f32 v180, v106
    v_mfma_f32_16x16x32_bf16 v[92:95], a[148:151], v[52:55], v[92:95]
    ds_read_b64_tr_b16 a[144:145], v208 offset:32768
    ds_read_b64_tr_b16 a[146:147], v208 offset:36864
    v_mfma_f32_16x16x32_bf16 v[80:83], a[152:155], v[8:11], v[80:83]
    v_exp_f32 v181, v107
    v_mfma_f32_16x16x32_bf16 v[84:87], a[152:155], v[24:27], v[84:87]
    v_add_f32 v220, v220, v180
    v_add_f32 v220, v220, v181
    v_mfma_f32_16x16x32_bf16 v[88:91], a[152:155], v[40:43], v[88:91]
    v_cvt_pk_bf16_f32 v153, v180, v181
    v_exp_f32 v182, v110
    v_mfma_f32_16x16x32_bf16 v[92:95], a[152:155], v[56:59], v[92:95]
    ds_read_b64_tr_b16 a[148:149], v209 offset:32768
    ds_read_b64_tr_b16 a[150:151], v209 offset:36864
    v_mfma_f32_16x16x32_bf16 v[80:83], a[156:159], v[12:15], v[80:83]
    v_exp_f32 v183, v111
    v_mfma_f32_16x16x32_bf16 v[84:87], a[156:159], v[28:31], v[84:87]
    v_add_f32 v221, v221, v182
    v_add_f32 v221, v221, v183
    v_mfma_f32_16x16x32_bf16 v[88:91], a[156:159], v[44:47], v[88:91]
    v_cvt_pk_bf16_f32 v157, v182, v183
    v_exp_f32 v176, v112
    v_mfma_f32_16x16x32_bf16 v[92:95], a[156:159], v[60:63], v[92:95]
    ds_read_b64_tr_b16 a[152:153], v210 offset:32768
    ds_read_b64_tr_b16 a[154:155], v210 offset:36864
    s_waitcnt lgkmcnt(6)
    v_mfma_f32_16x16x32_bf16 a[0:3], a[128:131], v[128:131], a[0:3]
    v_exp_f32 v177, v113
    v_mfma_f32_16x16x32_bf16 a[4:7], a[128:131], v[132:135], a[4:7]
    v_add_f32 v218, v218, v176
    v_add_f32 v218, v218, v177
    v_mfma_f32_16x16x32_bf16 a[8:11], a[128:131], v[136:139], a[8:11]
    v_cvt_pk_bf16_f32 v146, v176, v177
    v_exp_f32 v178, v116
    v_mfma_f32_16x16x32_bf16 a[12:15], a[128:131], v[140:143], a[12:15]
    ds_read_b64_tr_b16 a[156:157], v211 offset:32768
    ds_read_b64_tr_b16 a[158:159], v211 offset:36864
    v_mfma_f32_16x16x32_bf16 a[16:19], a[132:135], v[128:131], a[16:19]
    v_exp_f32 v179, v117
    v_mfma_f32_16x16x32_bf16 a[20:23], a[132:135], v[132:135], a[20:23]
    buffer_load_dwordx4 v244, s[12:15], s44 offen offset:2048 lds
    v_add_f32 v219, v219, v178
    v_mfma_f32_16x16x32_bf16 a[24:27], a[132:135], v[136:139], a[24:27]
    v_add_f32 v219, v219, v179
    v_cvt_pk_bf16_f32 v150, v178, v179
    v_mfma_f32_16x16x32_bf16 a[28:31], a[132:135], v[140:143], a[28:31]
    ds_read_b128 a[128:131], v200 offset:57344
    v_exp_f32 v180, v120
    v_mfma_f32_16x16x32_bf16 a[32:35], a[136:139], v[128:131], a[32:35]
    v_exp_f32 v181, v121
    v_mfma_f32_16x16x32_bf16 a[36:39], a[136:139], v[132:135], a[36:39]
    v_add_f32 v220, v220, v180
    v_add_f32 v220, v220, v181
    v_mfma_f32_16x16x32_bf16 a[40:43], a[136:139], v[136:139], a[40:43]
    v_cvt_pk_bf16_f32 v154, v180, v181
    v_exp_f32 v182, v124
    v_mfma_f32_16x16x32_bf16 a[44:47], a[136:139], v[140:143], a[44:47]
    ds_read_b128 a[132:135], v201 offset:57344
    v_exp_f32 v183, v125
    v_mfma_f32_16x16x32_bf16 a[48:51], a[140:143], v[128:131], a[48:51]
    v_add_f32 v221, v221, v182
    v_add_f32 v221, v221, v183
    v_mfma_f32_16x16x32_bf16 a[52:55], a[140:143], v[132:135], a[52:55]
    v_cvt_pk_bf16_f32 v158, v182, v183
    v_exp_f32 v176, v114
    v_mfma_f32_16x16x32_bf16 a[56:59], a[140:143], v[136:139], a[56:59]
    v_exp_f32 v177, v115
    v_mfma_f32_16x16x32_bf16 a[60:63], a[140:143], v[140:143], a[60:63]
    ds_read_b128 a[136:139], v202 offset:57344
    s_waitcnt lgkmcnt(3)
    v_mfma_f32_16x16x32_bf16 a[64:67], a[144:147], v[128:131], a[64:67]
    v_add_f32 v218, v218, v176
    v_add_f32 v218, v218, v177
    v_mfma_f32_16x16x32_bf16 a[68:71], a[144:147], v[132:135], a[68:71]
    buffer_load_dwordx4 v245, s[12:15], s44 offen offset:3072 lds
    s_add_u32 s44, s44, 16384
    v_mfma_f32_16x16x32_bf16 a[72:75], a[144:147], v[136:139], a[72:75]
    v_cvt_pk_bf16_f32 v147, v176, v177
    v_exp_f32 v178, v118
    v_mfma_f32_16x16x32_bf16 a[76:79], a[144:147], v[140:143], a[76:79]
    ds_read_b128 a[140:143], v203 offset:57344
    v_exp_f32 v179, v119
    v_mfma_f32_16x16x32_bf16 a[80:83], a[148:151], v[128:131], a[80:83]
    v_add_f32 v219, v219, v178
    v_add_f32 v219, v219, v179
    v_mfma_f32_16x16x32_bf16 a[84:87], a[148:151], v[132:135], a[84:87]
    v_cvt_pk_bf16_f32 v151, v178, v179
    v_exp_f32 v180, v122
    v_mfma_f32_16x16x32_bf16 a[88:91], a[148:151], v[136:139], a[88:91]
    v_exp_f32 v181, v123
    v_mfma_f32_16x16x32_bf16 a[92:95], a[148:151], v[140:143], a[92:95]
    ds_read_b128 a[144:147], v200 offset:61440
    v_add_f32 v220, v220, v180
    v_mfma_f32_16x16x32_bf16 a[96:99], a[152:155], v[128:131], a[96:99]
    v_add_f32 v220, v220, v181
    v_cvt_pk_bf16_f32 v155, v180, v181
    v_mfma_f32_16x16x32_bf16 a[100:103], a[152:155], v[132:135], a[100:103]
    v_exp_f32 v182, v126
    v_mfma_f32_16x16x32_bf16 a[104:107], a[152:155], v[136:139], a[104:107]
    v_exp_f32 v183, v127
    v_mfma_f32_16x16x32_bf16 a[108:111], a[152:155], v[140:143], a[108:111]
    ds_read_b128 a[148:151], v201 offset:61440
    v_add_f32 v221, v221, v182
    v_mfma_f32_16x16x32_bf16 a[112:115], a[156:159], v[128:131], a[112:115]
    v_add_f32 v221, v221, v183
    v_cvt_pk_bf16_f32 v159, v182, v183
    v_mfma_f32_16x16x32_bf16 a[116:119], a[156:159], v[132:135], a[116:119]
    v_max3_f32 v176, v218, v219, v220
    v_max_f32 v176, v176, v221
    v_cmp_le_f32 vcc, s41, v176
    v_mfma_f32_16x16x32_bf16 a[120:123], a[156:159], v[136:139], a[120:123]
    v_mfma_f32_16x16x32_bf16 a[124:127], a[156:159], v[140:143], a[124:127]
    ds_read_b128 a[152:155], v202 offset:61440
    s_cbranch_vccnz attn_rare11
attn_back12:
    v_add_f32 v214, v214, v218
    v_add_f32 v215, v215, v219
    v_add_f32 v216, v216, v220
    v_add_f32 v217, v217, v221
    buffer_load_dwordx4 v[248:251], v224, s[92:95], s47 offen
    s_waitcnt vmcnt(10)
    s_barrier
    s_waitcnt lgkmcnt(3)
    v_mfma_f32_16x16x32_bf16 v[96:99], a[128:131], v[0:3], v[160:163]
    v_exp_f32 v176, v64
    v_mfma_f32_16x16x32_bf16 v[100:103], a[128:131], v[16:19], v[164:167]
    v_exp_f32 v177, v65
    v_mfma_f32_16x16x32_bf16 v[104:107], a[128:131], v[32:35], v[168:171]
    v_add_f32 v218, v176, v177
    v_cvt_pk_bf16_f32 v128, v176, v177
    v_mfma_f32_16x16x32_bf16 v[108:111], a[128:131], v[48:51], v[172:175]
    ds_read_b128 a[156:159], v203 offset:61440
    v_exp_f32 v178, v68
    v_mfma_f32_16x16x32_bf16 v[96:99], a[132:135], v[4:7], v[96:99]
    v_exp_f32 v179, v69
    v_mfma_f32_16x16x32_bf16 v[100:103], a[132:135], v[20:23], v[100:103]
    v_add_f32 v219, v178, v179
    v_cvt_pk_bf16_f32 v132, v178, v179
    v_mfma_f32_16x16x32_bf16 v[104:107], a[132:135], v[36:39], v[104:107]
    v_exp_f32 v180, v72
    v_mfma_f32_16x16x32_bf16 v[108:111], a[132:135], v[52:55], v[108:111]
    ds_read_b64_tr_b16 a[128:129], v204 offset:40960
    ds_read_b64_tr_b16 a[130:131], v204 offset:45056
    v_mfma_f32_16x16x32_bf16 v[96:99], a[136:139], v[8:11], v[96:99]
    s_add_u32 m0, s49, 32768
    v_exp_f32 v181, v73
    v_mfma_f32_16x16x32_bf16 v[100:103], a[136:139], v[24:27], v[100:103]
    buffer_load_dwordx4 v240, s[8:11], s43 offen offset:0 lds
    v_add_f32 v220, v180, v181
    v_mfma_f32_16x16x32_bf16 v[104:107], a[136:139], v[40:43], v[104:107]
    v_cvt_pk_bf16_f32 v136, v180, v181
    v_exp_f32 v182, v76
    v_mfma_f32_16x16x32_bf16 v[108:111], a[136:139], v[56:59], v[108:111]
    ds_read_b64_tr_b16 a[132:133], v205 offset:40960
    ds_read_b64_tr_b16 a[134:135], v205 offset:45056
    v_mfma_f32_16x16x32_bf16 v[96:99], a[140:143], v[12:15], v[96:99]
    v_exp_f32 v183, v77
    v_mfma_f32_16x16x32_bf16 v[100:103], a[140:143], v[28:31], v[100:103]
    v_add_f32 v221, v182, v183
    v_cvt_pk_bf16_f32 v140, v182, v183
    v_mfma_f32_16x16x32_bf16 v[104:107], a[140:143], v[44:47], v[104:107]
    v_exp_f32 v176, v66
    v_mfma_f32_16x16x32_bf16 v[108:111], a[140:143], v[60:63], v[108:111]
    ds_read_b64_tr_b16 a[136:137], v206 offset:40960
    ds_read_b64_tr_b16 a[138:139], v206 offset:45056
    s_waitcnt lgkmcnt(6)
    v_mfma_f32_16x16x32_bf16 v[112:115], a[144:147], v[0:3], v[160:163]
    v_exp_f32 v177, v67
    v_add_f32 v218, v218, v176
    v_mfma_f32_16x16x32_bf16 v[116:119], a[144:147], v[16:19], v[164:167]
    v_add_f32 v218, v218, v177
    v_cvt_pk_bf16_f32 v129, v176, v177
    v_mfma_f32_16x16x32_bf16 v[120:123], a[144:147], v[32:35], v[168:171]
    v_exp_f32 v178, v70
    v_mfma_f32_16x16x32_bf16 v[124:127], a[144:147], v[48:51], v[172:175]
    ds_read_b64_tr_b16 a[140:141], v207 offset:40960
    ds_read_b64_tr_b16 a[142:143], v207 offset:45056
    v_mfma_f32_16x16x32_bf16 v[112:115], a[148:151], v[4:7], v[112:115]
    v_exp_f32 v179, v71
    v_add_f32 v219, v219, v178
    v_mfma_f32_16x16x32_bf16 v[116:119], a[148:151], v[20:23], v[116:119]
    buffer_load_dwordx4 v241, s[8:11], s43 offen offset:1024 lds
    v_add_f32 v219, v219, v179
    v_mfma_f32_16x16x32_bf16 v[120:123], a[148:151], v[36:39], v[120:123]
    v_cvt_pk_bf16_f32 v133, v178, v179
    v_exp_f32 v180, v74
    v_mfma_f32_16x16x32_bf16 v[124:127], a[148:151], v[52:55], v[124:127]
    ds_read_b64_tr_b16 a[144:145], v208 offset:40960
    ds_read_b64_tr_b16 a[146:147], v208 offset:45056
    v_mfma_f32_16x16x32_bf16 v[112:115], a[152:155], v[8:11], v[112:115]
    v_exp_f32 v181, v75
    v_mfma_f32_16x16x32_bf16 v[116:119], a[152:155], v[24:27], v[116:119]
    v_add_f32 v220, v220, v180
    v_add_f32 v220, v220, v181
    v_mfma_f32_16x16x32_bf16 v[120:123], a[152:155], v[40:43], v[120:123]
    v_cvt_pk_bf16_f32 v137, v180, v181
    v_exp_f32 v182, v78
    v_mfma_f32_16x16x32_bf16 v[124:127], a[152:155], v[56:59], v[124:127]
    ds_read_b64_tr_b16 a[148:149], v209 offset:40960
    ds_read_b64_tr_b16 a[150:151], v209 offset:45056
    v_mfma_f32_16x16x32_bf16 v[112:115], a[156:159], v[12:15], v[112:115]
    v_exp_f32 v183, v79
    v_mfma_f32_16x16x32_bf16 v[116:119], a[156:159], v[28:31], v[116:119]
    v_add_f32 v221, v221, v182
    v_add_f32 v221, v221, v183
    v_mfma_f32_16x16x32_bf16 v[120:123], a[156:159], v[44:47], v[120:123]
    v_cvt_pk_bf16_f32 v141, v182, v183
    v_exp_f32 v176, v80
    v_mfma_f32_16x16x32_bf16 v[124:127], a[156:159], v[60:63], v[124:127]
    ds_read_b64_tr_b16 a[152:153], v210 offset:40960
    ds_read_b64_tr_b16 a[154:155], v210 offset:45056
    s_waitcnt lgkmcnt(6)
    v_mfma_f32_16x16x32_bf16 a[0:3], a[128:131], v[144:147], a[0:3]
    v_exp_f32 v177, v81
    v_mfma_f32_16x16x32_bf16 a[4:7], a[128:131], v[148:151], a[4:7]
    v_add_f32 v218, v218, v176
    v_add_f32 v218, v218, v177
    v_mfma_f32_16x16x32_bf16 a[8:11], a[128:131], v[152:155], a[8:11]
    v_cvt_pk_bf16_f32 v130, v176, v177
    v_exp_f32 v178, v84
    v_mfma_f32_16x16x32_bf16 a[12:15], a[128:131], v[156:159], a[12:15]
    ds_read_b64_tr_b16 a[156:157], v211 offset:40960
    ds_read_b64_tr_b16 a[158:159], v211 offset:45056
    v_mfma_f32_16x16x32_bf16 a[16:19], a[132:135], v[144:147], a[16:19]
    v_exp_f32 v179, v85
    v_mfma_f32_16x16x32_bf16 a[20:23], a[132:135], v[148:151], a[20:23]
    buffer_load_dwordx4 v242, s[8:11], s43 offen offset:2048 lds
    v_add_f32 v219, v219, v178
    v_mfma_f32_16x16x32_bf16 a[24:27], a[132:135], v[152:155], a[24:27]
    v_add_f32 v219, v219, v179
    v_cvt_pk_bf16_f32 v134, v178, v179
    v_mfma_f32_16x16x32_bf16 a[28:31], a[132:135], v[156:159], a[28:31]
    ds_read_b128 a[128:131], v200 offset:0
    v_exp_f32 v180, v88
    v_mfma_f32_16x16x32_bf16 a[32:35], a[136:139], v[144:147], a[32:35]
    v_exp_f32 v181, v89
    v_mfma_f32_16x16x32_bf16 a[36:39], a[136:139], v[148:151], a[36:39]
    v_add_f32 v220, v220, v180
    v_add_f32 v220, v220, v181
    v_mfma_f32_16x16x32_bf16 a[40:43], a[136:139], v[152:155], a[40:43]
    v_cvt_pk_bf16_f32 v138, v180, v181
    v_exp_f32 v182, v92
    v_mfma_f32_16x16x32_bf16 a[44:47], a[136:139], v[156:159], a[44:47]
    ds_read_b128 a[132:135], v201 offset:0
    v_exp_f32 v183, v93
    v_mfma_f32_16x16x32_bf16 a[48:51], a[140:143], v[144:147], a[48:51]
    v_add_f32 v221, v221, v182
    v_add_f32 v221, v221, v183
    v_mfma_f32_16x16x32_bf16 a[52:55], a[140:143], v[148:151], a[52:55]
    v_cvt_pk_bf16_f32 v142, v182, v183
    v_exp_f32 v176, v82
    v_mfma_f32_16x16x32_bf16 a[56:59], a[140:143], v[152:155], a[56:59]
    v_exp_f32 v177, v83
    v_mfma_f32_16x16x32_bf16 a[60:63], a[140:143], v[156:159], a[60:63]
    ds_read_b128 a[136:139], v202 offset:0
    s_waitcnt lgkmcnt(3)
    v_mfma_f32_16x16x32_bf16 a[64:67], a[144:147], v[144:147], a[64:67]
    v_add_f32 v218, v218, v176
    v_add_f32 v218, v218, v177
    v_mfma_f32_16x16x32_bf16 a[68:71], a[144:147], v[148:151], a[68:71]
    buffer_load_dwordx4 v243, s[8:11], s43 offen offset:3072 lds
    s_add_u32 s43, s43, 16384
    v_mfma_f32_16x16x32_bf16 a[72:75], a[144:147], v[152:155], a[72:75]
    v_cvt_pk_bf16_f32 v131, v176, v177
    v_exp_f32 v178, v86
    v_mfma_f32_16x16x32_bf16 a[76:79], a[144:147], v[156:159], a[76:79]
    ds_read_b128 a[140:143], v203 offset:0
    v_exp_f32 v179, v87
    v_mfma_f32_16x16x32_bf16 a[80:83], a[148:151], v[144:147], a[80:83]
    v_add_f32 v219, v219, v178
    v_add_f32 v219, v219, v179
    v_mfma_f32_16x16x32_bf16 a[84:87], a[148:151], v[148:151], a[84:87]
    v_cvt_pk_bf16_f32 v135, v178, v179
    v_exp_f32 v180, v90
    v_mfma_f32_16x16x32_bf16 a[88:91], a[148:151], v[152:155], a[88:91]
    v_exp_f32 v181, v91
    v_mfma_f32_16x16x32_bf16 a[92:95], a[148:151], v[156:159], a[92:95]
    ds_read_b128 a[144:147], v200 offset:4096
    v_add_f32 v220, v220, v180
    v_mfma_f32_16x16x32_bf16 a[96:99], a[152:155], v[144:147], a[96:99]
    v_add_f32 v220, v220, v181
    v_cvt_pk_bf16_f32 v139, v180, v181
    v_mfma_f32_16x16x32_bf16 a[100:103], a[152:155], v[148:151], a[100:103]
    v_exp_f32 v182, v94
    v_mfma_f32_16x16x32_bf16 a[104:107], a[152:155], v[152:155], a[104:107]
    v_exp_f32 v183, v95
    v_mfma_f32_16x16x32_bf16 a[108:111], a[152:155], v[156:159], a[108:111]
    ds_read_b128 a[148:151], v201 offset:4096
    v_add_f32 v221, v221, v182
    v_mfma_f32_16x16x32_bf16 a[112:115], a[156:159], v[144:147], a[112:115]
    v_add_f32 v221, v221, v183
    v_cvt_pk_bf16_f32 v143, v182, v183
    v_mfma_f32_16x16x32_bf16 a[116:119], a[156:159], v[148:151], a[116:119]
    v_max3_f32 v176, v218, v219, v220
    v_max_f32 v176, v176, v221
    v_cmp_le_f32 vcc, s41, v176
    v_mfma_f32_16x16x32_bf16 a[120:123], a[156:159], v[152:155], a[120:123]
    v_mfma_f32_16x16x32_bf16 a[124:127], a[156:159], v[156:159], a[124:127]
    ds_read_b128 a[152:155], v202 offset:4096
    s_cbranch_vccnz attn_rare13
attn_back14:
    v_add_f32 v214, v214, v218
    v_add_f32 v215, v215, v219
    v_add_f32 v216, v216, v220
    v_add_f32 v217, v217, v221
    s_waitcnt lgkmcnt(3)
    v_mfma_f32_16x16x32_bf16 v[64:67], a[128:131], v[0:3], v[160:163]
    v_exp_f32 v176, v96
    v_mfma_f32_16x16x32_bf16 v[68:71], a[128:131], v[16:19], v[164:167]
    v_exp_f32 v177, v97
    v_mfma_f32_16x16x32_bf16 v[72:75], a[128:131], v[32:35], v[168:171]
    v_add_f32 v218, v176, v177
    v_cvt_pk_bf16_f32 v144, v176, v177
    v_mfma_f32_16x16x32_bf16 v[76:79], a[128:131], v[48:51], v[172:175]
    ds_read_b128 a[156:159], v203 offset:4096
    v_exp_f32 v178, v100
    v_mfma_f32_16x16x32_bf16 v[64:67], a[132:135], v[4:7], v[64:67]
    v_exp_f32 v179, v101
    v_mfma_f32_16x16x32_bf16 v[68:71], a[132:135], v[20:23], v[68:71]
    v_add_f32 v219, v178, v179
    v_cvt_pk_bf16_f32 v148, v178, v179
    v_mfma_f32_16x16x32_bf16 v[72:75], a[132:135], v[36:39], v[72:75]
    v_exp_f32 v180, v104
    v_mfma_f32_16x16x32_bf16 v[76:79], a[132:135], v[52:55], v[76:79]
    ds_read_b64_tr_b16 a[128:129], v204 offset:49152
    ds_read_b64_tr_b16 a[130:131], v204 offset:53248
    v_mfma_f32_16x16x32_bf16 v[64:67], a[136:139], v[8:11], v[64:67]
    s_add_u32 m0, s49, 81920
    v_exp_f32 v181, v105
    v_mfma_f32_16x16x32_bf16 v[68:71], a[136:139], v[24:27], v[68:71]
    buffer_load_dwordx4 v244, s[12:15], s44 offen offset:0 lds
    v_add_f32 v220, v180, v181
    v_mfma_f32_16x16x32_bf16 v[72:75], a[136:139], v[40:43], v[72:75]
    v_cvt_pk_bf16_f32 v152, v180, v181
    v_exp_f32 v182, v108
    v_mfma_f32_16x16x32_bf16 v[76:79], a[136:139], v[56:59], v[76:79]
    ds_read_b64_tr_b16 a[132:133], v205 offset:49152
    ds_read_b64_tr_b16 a[134:135], v205 offset:53248
    v_mfma_f32_16x16x32_bf16 v[64:67], a[140:143], v[12:15], v[64:67]
    v_exp_f32 v183, v109
    v_mfma_f32_16x16x32_bf16 v[68:71], a[140:143], v[28:31], v[68:71]
    v_add_f32 v221, v182, v183
    v_cvt_pk_bf16_f32 v156, v182, v183
    v_mfma_f32_16x16x32_bf16 v[72:75], a[140:143], v[44:47], v[72:75]
    v_exp_f32 v176, v98
    v_mfma_f32_16x16x32_bf16 v[76:79], a[140:143], v[60:63], v[76:79]
    ds_read_b64_tr_b16 a[136:137], v206 offset:49152
    ds_read_b64_tr_b16 a[138:139], v206 offset:53248
    s_waitcnt lgkmcnt(6)
    v_mfma_f32_16x16x32_bf16 v[80:83], a[144:147], v[0:3], v[160:163]
    v_exp_f32 v177, v99
    v_add_f32 v218, v218, v176
    v_mfma_f32_16x16x32_bf16 v[84:87], a[144:147], v[16:19], v[164:167]
    v_add_f32 v218, v218, v177
    v_cvt_pk_bf16_f32 v145, v176, v177
    v_mfma_f32_16x16x32_bf16 v[88:91], a[144:147], v[32:35], v[168:171]
    v_exp_f32 v178, v102
    v_mfma_f32_16x16x32_bf16 v[92:95], a[144:147], v[48:51], v[172:175]
    ds_read_b64_tr_b16 a[140:141], v207 offset:49152
    ds_read_b64_tr_b16 a[142:143], v207 offset:53248
    v_mfma_f32_16x16x32_bf16 v[80:83], a[148:151], v[4:7], v[80:83]
    v_exp_f32 v179, v103
    v_add_f32 v219, v219, v178
    v_mfma_f32_16x16x32_bf16 v[84:87], a[148:151], v[20:23], v[84:87]
    buffer_load_dwordx4 v245, s[12:15], s44 offen offset:1024 lds
    v_add_f32 v219, v219, v179
    v_mfma_f32_16x16x32_bf16 v[88:91], a[148:151], v[36:39], v[88:91]
    v_cvt_pk_bf16_f32 v149, v178, v179
    v_exp_f32 v180, v106
    v_mfma_f32_16x16x32_bf16 v[92:95], a[148:151], v[52:55], v[92:95]
    ds_read_b64_tr_b16 a[144:145], v208 offset:49152
    ds_read_b64_tr_b16 a[146:147], v208 offset:53248
    v_mfma_f32_16x16x32_bf16 v[80:83], a[152:155], v[8:11], v[80:83]
    v_exp_f32 v181, v107
    v_mfma_f32_16x16x32_bf16 v[84:87], a[152:155], v[24:27], v[84:87]
    v_add_f32 v220, v220, v180
    v_add_f32 v220, v220, v181
    v_mfma_f32_16x16x32_bf16 v[88:91], a[152:155], v[40:43], v[88:91]
    v_cvt_pk_bf16_f32 v153, v180, v181
    v_exp_f32 v182, v110
    v_mfma_f32_16x16x32_bf16 v[92:95], a[152:155], v[56:59], v[92:95]
    ds_read_b64_tr_b16 a[148:149], v209 offset:49152
    ds_read_b64_tr_b16 a[150:151], v209 offset:53248
    v_mfma_f32_16x16x32_bf16 v[80:83], a[156:159], v[12:15], v[80:83]
    v_exp_f32 v183, v111
    v_mfma_f32_16x16x32_bf16 v[84:87], a[156:159], v[28:31], v[84:87]
    v_add_f32 v221, v221, v182
    v_add_f32 v221, v221, v183
    v_mfma_f32_16x16x32_bf16 v[88:91], a[156:159], v[44:47], v[88:91]
    v_cvt_pk_bf16_f32 v157, v182, v183
    v_exp_f32 v176, v112
    v_mfma_f32_16x16x32_bf16 v[92:95], a[156:159], v[60:63], v[92:95]
    ds_read_b64_tr_b16 a[152:153], v210 offset:49152
    ds_read_b64_tr_b16 a[154:155], v210 offset:53248
    s_waitcnt lgkmcnt(6)
    v_mfma_f32_16x16x32_bf16 a[0:3], a[128:131], v[128:131], a[0:3]
    v_exp_f32 v177, v113
    v_mfma_f32_16x16x32_bf16 a[4:7], a[128:131], v[132:135], a[4:7]
    v_add_f32 v218, v218, v176
    v_add_f32 v218, v218, v177
    v_mfma_f32_16x16x32_bf16 a[8:11], a[128:131], v[136:139], a[8:11]
    v_cvt_pk_bf16_f32 v146, v176, v177
    v_exp_f32 v178, v116
    v_mfma_f32_16x16x32_bf16 a[12:15], a[128:131], v[140:143], a[12:15]
    ds_read_b64_tr_b16 a[156:157], v211 offset:49152
    ds_read_b64_tr_b16 a[158:159], v211 offset:53248
    v_mfma_f32_16x16x32_bf16 a[16:19], a[132:135], v[128:131], a[16:19]
    v_exp_f32 v179, v117
    v_mfma_f32_16x16x32_bf16 a[20:23], a[132:135], v[132:135], a[20:23]
    buffer_load_dwordx4 v244, s[12:15], s44 offen offset:2048 lds
    v_add_f32 v219, v219, v178
    v_mfma_f32_16x16x32_bf16 a[24:27], a[132:135], v[136:139], a[24:27]
    v_add_f32 v219, v219, v179
    v_cvt_pk_bf16_f32 v150, v178, v179
    v_mfma_f32_16x16x32_bf16 a[28:31], a[132:135], v[140:143], a[28:31]
    ds_read_b128 a[128:131], v200 offset:8192
    v_exp_f32 v180, v120
    v_mfma_f32_16x16x32_bf16 a[32:35], a[136:139], v[128:131], a[32:35]
    v_exp_f32 v181, v121
    v_mfma_f32_16x16x32_bf16 a[36:39], a[136:139], v[132:135], a[36:39]
    v_add_f32 v220, v220, v180
    v_add_f32 v220, v220, v181
    v_mfma_f32_16x16x32_bf16 a[40:43], a[136:139], v[136:139], a[40:43]
    v_cvt_pk_bf16_f32 v154, v180, v181
    v_exp_f32 v182, v124
    v_mfma_f32_16x16x32_bf16 a[44:47], a[136:139], v[140:143], a[44:47]
    ds_read_b128 a[132:135], v201 offset:8192
    v_exp_f32 v183, v125
    v_mfma_f32_16x16x32_bf16 a[48:51], a[140:143], v[128:131], a[48:51]
    v_add_f32 v221, v221, v182
    v_add_f32 v221, v221, v183
    v_mfma_f32_16x16x32_bf16 a[52:55], a[140:143], v[132:135], a[52:55]
    v_cvt_pk_bf16_f32 v158, v182, v183
    v_exp_f32 v176, v114
    v_mfma_f32_16x16x32_bf16 a[56:59], a[140:143], v[136:139], a[56:59]
    v_exp_f32 v177, v115
    v_mfma_f32_16x16x32_bf16 a[60:63], a[140:143], v[140:143], a[60:63]
    ds_read_b128 a[136:139], v202 offset:8192
    s_waitcnt lgkmcnt(3)
    v_mfma_f32_16x16x32_bf16 a[64:67], a[144:147], v[128:131], a[64:67]
    v_add_f32 v218, v218, v176
    v_add_f32 v218, v218, v177
    v_mfma_f32_16x16x32_bf16 a[68:71], a[144:147], v[132:135], a[68:71]
    buffer_load_dwordx4 v245, s[12:15], s44 offen offset:3072 lds
    s_add_u32 s44, s44, 16384
    v_mfma_f32_16x16x32_bf16 a[72:75], a[144:147], v[136:139], a[72:75]
    v_cvt_pk_bf16_f32 v147, v176, v177
    v_exp_f32 v178, v118
    v_mfma_f32_16x16x32_bf16 a[76:79], a[144:147], v[140:143], a[76:79]
    ds_read_b128 a[140:143], v203 offset:8192
    v_exp_f32 v179, v119
    v_mfma_f32_16x16x32_bf16 a[80:83], a[148:151], v[128:131], a[80:83]
    v_add_f32 v219, v219, v178
    v_add_f32 v219, v219, v179
    v_mfma_f32_16x16x32_bf16 a[84:87], a[148:151], v[132:135], a[84:87]
    v_cvt_pk_bf16_f32 v151, v178, v179
    v_exp_f32 v180, v122
    v_mfma_f32_16x16x32_bf16 a[88:91], a[148:151], v[136:139], a[88:91]
    v_exp_f32 v181, v123
    v_mfma_f32_16x16x32_bf16 a[92:95], a[148:151], v[140:143], a[92:95]
    ds_read_b128 a[144:147], v200 offset:12288
    v_add_f32 v220, v220, v180
    v_mfma_f32_16x16x32_bf16 a[96:99], a[152:155], v[128:131], a[96:99]
    v_add_f32 v220, v220, v181
    v_cvt_pk_bf16_f32 v155, v180, v181
    v_mfma_f32_16x16x32_bf16 a[100:103], a[152:155], v[132:135], a[100:103]
    v_exp_f32 v182, v126
    v_mfma_f32_16x16x32_bf16 a[104:107], a[152:155], v[136:139], a[104:107]
    v_exp_f32 v183, v127
    v_mfma_f32_16x16x32_bf16 a[108:111], a[152:155], v[140:143], a[108:111]
    ds_read_b128 a[148:151], v201 offset:12288
    v_add_f32 v221, v221, v182
    v_mfma_f32_16x16x32_bf16 a[112:115], a[156:159], v[128:131], a[112:115]
    v_add_f32 v221, v221, v183
    v_cvt_pk_bf16_f32 v159, v182, v183
    v_mfma_f32_16x16x32_bf16 a[116:119], a[156:159], v[132:135], a[116:119]
    v_max3_f32 v176, v218, v219, v220
    v_max_f32 v176, v176, v221
    v_cmp_le_f32 vcc, s41, v176
    v_mfma_f32_16x16x32_bf16 a[120:123], a[156:159], v[136:139], a[120:123]
    v_mfma_f32_16x16x32_bf16 a[124:127], a[156:159], v[140:143], a[124:127]
    ds_read_b128 a[152:155], v202 offset:12288
    s_cbranch_vccnz attn_rare15
attn_back16:
    v_add_f32 v214, v214, v218
    v_add_f32 v215, v215, v219
    v_add_f32 v216, v216, v220
    v_add_f32 v217, v217, v221
    buffer_load_dwordx4 v[248:251], v224, s[96:99], s47 offen
    s_add_u32 s47, s47, 1024
    s_waitcnt vmcnt(10)
    s_barrier
    s_add_u32 s46, s46, 1
    s_cmp_lt_u32 s46, 8
    s_cbranch_scc1 attn_loop
    s_waitcnt vmcnt(0) lgkmcnt(0)
    s_barrier
    ds_read_b64_tr_b16 a[128:129], v204 offset:57344
    ds_read_b64_tr_b16 a[130:131], v204 offset:61440
    ds_read_b64_tr_b16 a[132:133], v205 offset:57344
    ds_read_b64_tr_b16 a[134:135], v205 offset:61440
    ds_read_b64_tr_b16 a[136:137], v206 offset:57344
    ds_read_b64_tr_b16 a[138:139], v206 offset:61440
    ds_read_b64_tr_b16 a[140:141], v207 offset:57344
    ds_read_b64_tr_b16 a[142:143], v207 offset:61440
    ds_read_b64_tr_b16 a[144:145], v208 offset:57344
    ds_read_b64_tr_b16 a[146:147], v208 offset:61440
    ds_read_b64_tr_b16 a[148:149], v209 offset:57344
    ds_read_b64_tr_b16 a[150:151], v209 offset:61440
    ds_read_b64_tr_b16 a[152:153], v210 offset:57344
    ds_read_b64_tr_b16 a[154:155], v210 offset:61440
    ds_read_b64_tr_b16 a[156:157], v211 offset:57344
    ds_read_b64_tr_b16 a[158:159], v211 offset:61440
    s_lshl_b32 s48, s3, 14
    v_bfe_u32 v236, v222, 1, 3
    v_lshrrev_b32 v237, 1, v233
    v_xor_b32 v236, v236, v237
    v_and_b32 v237, 1, v233
    v_lshlrev_b32 v237, 3, v237
    v_lshl_add_u32 v237, v232, 7, v237
    v_add_u32 v237, s48, v237
    v_xor_b32 v235, 0, v236
    v_lshl_add_u32 v200, v235, 4, v237
    v_xor_b32 v235, 2, v236
    v_lshl_add_u32 v201, v235, 4, v237
    v_xor_b32 v235, 4, v236
    v_lshl_add_u32 v202, v235, 4, v237
    v_xor_b32 v235, 6, v236
    v_lshl_add_u32 v203, v235, 4, v237
    s_lshl_b32 s6, s3, 6
    s_lshr_b32 s7, s6, 7
    s_lshl_b32 s7, s7, 20
    s_and_b32 s6, s6, 127
    s_lshl_b32 s6, s6, 7
    s_add_u32 s6, s6, s7
    v_mov_b32 v184, v214
    v_mov_b32 v185, v215
    v_mov_b32 v186, v216
    v_mov_b32 v187, v217
    v_permlane16_swap_b32 v214, v184
    v_permlane16_swap_b32 v215, v185
    v_permlane16_swap_b32 v216, v186
    v_permlane16_swap_b32 v217, v187
    v_add_f32 v214, v214, v184
    v_add_f32 v215, v215, v185
    v_add_f32 v216, v216, v186
    v_add_f32 v217, v217, v187
    v_mov_b32 v184, v214
    v_mov_b32 v185, v215
    v_mov_b32 v186, v216
    v_mov_b32 v187, v217
    v_permlane32_swap_b32 v214, v184
    v_permlane32_swap_b32 v215, v185
    v_permlane32_swap_b32 v216, v186
    v_permlane32_swap_b32 v217, v187
    v_add_f32 v214, v214, v184
    v_add_f32 v215, v215, v185
    v_add_f32 v216, v216, v186
    v_add_f32 v217, v217, v187
    v_rcp_f32 v176, v214
    v_rcp_f32 v178, v215
    v_rcp_f32 v180, v216
    v_rcp_f32 v182, v217
    v_mov_b32 v177, v176
    v_mov_b32 v179, v178
    v_mov_b32 v181, v180
    v_mov_b32 v183, v182
    s_waitcnt lgkmcnt(14)
    v_mfma_f32_16x16x32_bf16 a[0:3], a[128:131], v[144:147], a[0:3]
    v_mfma_f32_16x16x32_bf16 a[4:7], a[128:131], v[148:151], a[4:7]
    v_mfma_f32_16x16x32_bf16 a[8:11], a[128:131], v[152:155], a[8:11]
    v_mfma_f32_16x16x32_bf16 a[12:15], a[128:131], v[156:159], a[12:15]
    s_waitcnt lgkmcnt(12)
    v_mfma_f32_16x16x32_bf16 a[16:19], a[132:135], v[144:147], a[16:19]
    v_mfma_f32_16x16x32_bf16 a[20:23], a[132:135], v[148:151], a[20:23]
    v_mfma_f32_16x16x32_bf16 a[24:27], a[132:135], v[152:155], a[24:27]
    v_mfma_f32_16x16x32_bf16 a[28:31], a[132:135], v[156:159], a[28:31]
    s_waitcnt lgkmcnt(10)
    v_mfma_f32_16x16x32_bf16 a[32:35], a[136:139], v[144:147], a[32:35]
    v_accvgpr_read_b32 v64, a0
    v_accvgpr_read_b32 v65, a1
    v_accvgpr_read_b32 v66, a2
    v_accvgpr_read_b32 v67, a3
    v_pk_mul_f32 v[64:65], v[64:65], v[176:177]
    v_pk_mul_f32 v[66:67], v[66:67], v[176:177]
    v_cvt_pk_bf16_f32 v96, v64, v65
    v_cvt_pk_bf16_f32 v97, v66, v67
    v_mfma_f32_16x16x32_bf16 a[36:39], a[136:139], v[148:151], a[36:39]
    v_accvgpr_read_b32 v68, a4
    v_accvgpr_read_b32 v69, a5
    v_accvgpr_read_b32 v70, a6
    v_accvgpr_read_b32 v71, a7
    v_pk_mul_f32 v[68:69], v[68:69], v[178:179]
    v_pk_mul_f32 v[70:71], v[70:71], v[178:179]
    v_cvt_pk_bf16_f32 v98, v68, v69
    v_cvt_pk_bf16_f32 v99, v70, v71
    s_nop 0
    v_permlane16_swap_b32 v96, v98
    v_permlane16_swap_b32 v97, v99
    s_add_u32 s7, s6, 0
    buffer_store_dwordx4 v[96:99], v224, s[24:27], s7 offen sc0 sc1
    v_mfma_f32_16x16x32_bf16 a[40:43], a[136:139], v[152:155], a[40:43]
    v_accvgpr_read_b32 v72, a8
    v_accvgpr_read_b32 v73, a9
    v_accvgpr_read_b32 v74, a10
    v_accvgpr_read_b32 v75, a11
    v_pk_mul_f32 v[72:73], v[72:73], v[180:181]
    v_pk_mul_f32 v[74:75], v[74:75], v[180:181]
    v_cvt_pk_bf16_f32 v100, v72, v73
    v_cvt_pk_bf16_f32 v101, v74, v75
    v_mfma_f32_16x16x32_bf16 a[44:47], a[136:139], v[156:159], a[44:47]
    v_accvgpr_read_b32 v76, a12
    v_accvgpr_read_b32 v77, a13
    v_accvgpr_read_b32 v78, a14
    v_accvgpr_read_b32 v79, a15
    v_pk_mul_f32 v[76:77], v[76:77], v[182:183]
    v_pk_mul_f32 v[78:79], v[78:79], v[182:183]
    v_cvt_pk_bf16_f32 v102, v76, v77
    v_cvt_pk_bf16_f32 v103, v78, v79
    s_nop 0
    v_permlane16_swap_b32 v100, v102
    v_permlane16_swap_b32 v101, v103
    s_add_u32 s7, s6, 4096
    buffer_store_dwordx4 v[100:103], v224, s[24:27], s7 offen sc0 sc1
    s_waitcnt lgkmcnt(8)
    v_mfma_f32_16x16x32_bf16 a[48:51], a[140:143], v[144:147], a[48:51]
    v_accvgpr_read_b32 v80, a16
    v_accvgpr_read_b32 v81, a17
    v_accvgpr_read_b32 v82, a18
    v_accvgpr_read_b32 v83, a19
    v_pk_mul_f32 v[80:81], v[80:81], v[176:177]
    v_pk_mul_f32 v[82:83], v[82:83], v[176:177]
    v_cvt_pk_bf16_f32 v104, v80, v81
    v_cvt_pk_bf16_f32 v105, v82, v83
    v_mfma_f32_16x16x32_bf16 a[52:55], a[140:143], v[148:151], a[52:55]
    v_accvgpr_read_b32 v84, a20
    v_accvgpr_read_b32 v85, a21
    v_accvgpr_read_b32 v86, a22
    v_accvgpr_read_b32 v87, a23
    v_pk_mul_f32 v[84:85], v[84:85], v[178:179]
    v_pk_mul_f32 v[86:87], v[86:87], v[178:179]
    v_cvt_pk_bf16_f32 v106, v84, v85
    v_cvt_pk_bf16_f32 v107, v86, v87
    s_nop 0
    v_permlane16_swap_b32 v104, v106
    v_permlane16_swap_b32 v105, v107
    s_add_u32 s7, s6, 1024
    buffer_store_dwordx4 v[104:107], v224, s[24:27], s7 offen sc0 sc1
    v_mfma_f32_16x16x32_bf16 a[56:59], a[140:143], v[152:155], a[56:59]
    v_accvgpr_read_b32 v88, a24
    v_accvgpr_read_b32 v89, a25
    v_accvgpr_read_b32 v90, a26
    v_accvgpr_read_b32 v91, a27
    v_pk_mul_f32 v[88:89], v[88:89], v[180:181]
    v_pk_mul_f32 v[90:91], v[90:91], v[180:181]
    v_cvt_pk_bf16_f32 v108, v88, v89
    v_cvt_pk_bf16_f32 v109, v90, v91
    v_mfma_f32_16x16x32_bf16 a[60:63], a[140:143], v[156:159], a[60:63]
    v_accvgpr_read_b32 v92, a28
    v_accvgpr_read_b32 v93, a29
    v_accvgpr_read_b32 v94, a30
    v_accvgpr_read_b32 v95, a31
    v_pk_mul_f32 v[92:93], v[92:93], v[182:183]
    v_pk_mul_f32 v[94:95], v[94:95], v[182:183]
    v_cvt_pk_bf16_f32 v110, v92, v93
    v_cvt_pk_bf16_f32 v111, v94, v95
    s_nop 0
    v_permlane16_swap_b32 v108, v110
    v_permlane16_swap_b32 v109, v111
    s_add_u32 s7, s6, 5120
    buffer_store_dwordx4 v[108:111], v224, s[24:27], s7 offen sc0 sc1
    s_waitcnt lgkmcnt(6)
    v_mfma_f32_16x16x32_bf16 a[64:67], a[144:147], v[144:147], a[64:67]
    v_accvgpr_read_b32 v64, a32
    v_accvgpr_read_b32 v65, a33
    v_accvgpr_read_b32 v66, a34
    v_accvgpr_read_b32 v67, a35
    v_pk_mul_f32 v[64:65], v[64:65], v[176:177]
    v_pk_mul_f32 v[66:67], v[66:67], v[176:177]
    v_cvt_pk_bf16_f32 v96, v64, v65
    v_cvt_pk_bf16_f32 v97, v66, v67
    v_mfma_f32_16x16x32_bf16 a[68:71], a[144:147], v[148:151], a[68:71]
    v_accvgpr_read_b32 v68, a36
    v_accvgpr_read_b32 v69, a37
    v_accvgpr_read_b32 v70, a38
    v_accvgpr_read_b32 v71, a39
    v_pk_mul_f32 v[68:69], v[68:69], v[178:179]
    v_pk_mul_f32 v[70:71], v[70:71], v[178:179]
    v_cvt_pk_bf16_f32 v98, v68, v69
    v_cvt_pk_bf16_f32 v99, v70, v71
    s_nop 0
    v_permlane16_swap_b32 v96, v98
    v_permlane16_swap_b32 v97, v99
    s_add_u32 s7, s6, 2048
    buffer_store_dwordx4 v[96:99], v224, s[24:27], s7 offen sc0 sc1
    v_mfma_f32_16x16x32_bf16 a[72:75], a[144:147], v[152:155], a[72:75]
    v_accvgpr_read_b32 v72, a40
    v_accvgpr_read_b32 v73, a41
    v_accvgpr_read_b32 v74, a42
    v_accvgpr_read_b32 v75, a43
    v_pk_mul_f32 v[72:73], v[72:73], v[180:181]
    v_pk_mul_f32 v[74:75], v[74:75], v[180:181]
    v_cvt_pk_bf16_f32 v100, v72, v73
    v_cvt_pk_bf16_f32 v101, v74, v75
    v_mfma_f32_16x16x32_bf16 a[76:79], a[144:147], v[156:159], a[76:79]
    v_accvgpr_read_b32 v76, a44
    v_accvgpr_read_b32 v77, a45
    v_accvgpr_read_b32 v78, a46
    v_accvgpr_read_b32 v79, a47
    v_pk_mul_f32 v[76:77], v[76:77], v[182:183]
    v_pk_mul_f32 v[78:79], v[78:79], v[182:183]
    v_cvt_pk_bf16_f32 v102, v76, v77
    v_cvt_pk_bf16_f32 v103, v78, v79
    s_nop 0
    v_permlane16_swap_b32 v100, v102
    v_permlane16_swap_b32 v101, v103
    s_add_u32 s7, s6, 6144
    buffer_store_dwordx4 v[100:103], v224, s[24:27], s7 offen sc0 sc1
    s_waitcnt lgkmcnt(4)
    v_mfma_f32_16x16x32_bf16 a[80:83], a[148:151], v[144:147], a[80:83]
    v_accvgpr_read_b32 v80, a48
    v_accvgpr_read_b32 v81, a49
    v_accvgpr_read_b32 v82, a50
    v_accvgpr_read_b32 v83, a51
    v_pk_mul_f32 v[80:81], v[80:81], v[176:177]
    v_pk_mul_f32 v[82:83], v[82:83], v[176:177]
    v_cvt_pk_bf16_f32 v104, v80, v81
    v_cvt_pk_bf16_f32 v105, v82, v83
    v_mfma_f32_16x16x32_bf16 a[84:87], a[148:151], v[148:151], a[84:87]
    v_accvgpr_read_b32 v84, a52
    v_accvgpr_read_b32 v85, a53
    v_accvgpr_read_b32 v86, a54
    v_accvgpr_read_b32 v87, a55
    v_pk_mul_f32 v[84:85], v[84:85], v[178:179]
    v_pk_mul_f32 v[86:87], v[86:87], v[178:179]
    v_cvt_pk_bf16_f32 v106, v84, v85
    v_cvt_pk_bf16_f32 v107, v86, v87
    s_nop 0
    v_permlane16_swap_b32 v104, v106
    v_permlane16_swap_b32 v105, v107
    s_add_u32 s7, s6, 3072
    buffer_store_dwordx4 v[104:107], v224, s[24:27], s7 offen sc0 sc1
    v_mfma_f32_16x16x32_bf16 a[88:91], a[148:151], v[152:155], a[88:91]
    v_accvgpr_read_b32 v88, a56
    v_accvgpr_read_b32 v89, a57
    v_accvgpr_read_b32 v90, a58
    v_accvgpr_read_b32 v91, a59
    v_pk_mul_f32 v[88:89], v[88:89], v[180:181]
    v_pk_mul_f32 v[90:91], v[90:91], v[180:181]
    v_cvt_pk_bf16_f32 v108, v88, v89
    v_cvt_pk_bf16_f32 v109, v90, v91
    v_mfma_f32_16x16x32_bf16 a[92:95], a[148:151], v[156:159], a[92:95]
    v_accvgpr_read_b32 v92, a60
    v_accvgpr_read_b32 v93, a61
    v_accvgpr_read_b32 v94, a62
    v_accvgpr_read_b32 v95, a63
    v_pk_mul_f32 v[92:93], v[92:93], v[182:183]
    v_pk_mul_f32 v[94:95], v[94:95], v[182:183]
    v_cvt_pk_bf16_f32 v110, v92, v93
    v_cvt_pk_bf16_f32 v111, v94, v95
    s_nop 0
    v_permlane16_swap_b32 v108, v110
    v_permlane16_swap_b32 v109, v111
    s_add_u32 s7, s6, 7168
    buffer_store_dwordx4 v[108:111], v224, s[24:27], s7 offen sc0 sc1
    s_waitcnt lgkmcnt(2)
    v_mfma_f32_16x16x32_bf16 a[96:99], a[152:155], v[144:147], a[96:99]
    v_accvgpr_read_b32 v64, a64
    v_accvgpr_read_b32 v65, a65
    v_accvgpr_read_b32 v66, a66
    v_accvgpr_read_b32 v67, a67
    v_pk_mul_f32 v[64:65], v[64:65], v[176:177]
    v_pk_mul_f32 v[66:67], v[66:67], v[176:177]
    v_cvt_pk_bf16_f32 v96, v64, v65
    v_cvt_pk_bf16_f32 v97, v66, v67
    v_mfma_f32_16x16x32_bf16 a[100:103], a[152:155], v[148:151], a[100:103]
    v_accvgpr_read_b32 v68, a68
    v_accvgpr_read_b32 v69, a69
    v_accvgpr_read_b32 v70, a70
    v_accvgpr_read_b32 v71, a71
    v_pk_mul_f32 v[68:69], v[68:69], v[178:179]
    v_pk_mul_f32 v[70:71], v[70:71], v[178:179]
    v_cvt_pk_bf16_f32 v98, v68, v69
    v_cvt_pk_bf16_f32 v99, v70, v71
    s_nop 0
    v_permlane16_swap_b32 v96, v98
    v_permlane16_swap_b32 v97, v99
    s_add_u32 s7, s6, 16384
    buffer_store_dwordx4 v[96:99], v224, s[24:27], s7 offen sc0 sc1
    v_mfma_f32_16x16x32_bf16 a[104:107], a[152:155], v[152:155], a[104:107]
    v_accvgpr_read_b32 v72, a72
    v_accvgpr_read_b32 v73, a73
    v_accvgpr_read_b32 v74, a74
    v_accvgpr_read_b32 v75, a75
    v_pk_mul_f32 v[72:73], v[72:73], v[180:181]
    v_pk_mul_f32 v[74:75], v[74:75], v[180:181]
    v_cvt_pk_bf16_f32 v100, v72, v73
    v_cvt_pk_bf16_f32 v101, v74, v75
    v_mfma_f32_16x16x32_bf16 a[108:111], a[152:155], v[156:159], a[108:111]
    v_accvgpr_read_b32 v76, a76
    v_accvgpr_read_b32 v77, a77
    v_accvgpr_read_b32 v78, a78
    v_accvgpr_read_b32 v79, a79
    v_pk_mul_f32 v[76:77], v[76:77], v[182:183]
    v_pk_mul_f32 v[78:79], v[78:79], v[182:183]
    v_cvt_pk_bf16_f32 v102, v76, v77
    v_cvt_pk_bf16_f32 v103, v78, v79
    s_nop 0
    v_permlane16_swap_b32 v100, v102
    v_permlane16_swap_b32 v101, v103
    s_add_u32 s7, s6, 20480
    buffer_store_dwordx4 v[100:103], v224, s[24:27], s7 offen sc0 sc1
    s_waitcnt lgkmcnt(0)
    v_mfma_f32_16x16x32_bf16 a[112:115], a[156:159], v[144:147], a[112:115]
    v_accvgpr_read_b32 v80, a80
    v_accvgpr_read_b32 v81, a81
    v_accvgpr_read_b32 v82, a82
    v_accvgpr_read_b32 v83, a83
    v_pk_mul_f32 v[80:81], v[80:81], v[176:177]
    v_pk_mul_f32 v[82:83], v[82:83], v[176:177]
    v_cvt_pk_bf16_f32 v104, v80, v81
    v_cvt_pk_bf16_f32 v105, v82, v83
    v_mfma_f32_16x16x32_bf16 a[116:119], a[156:159], v[148:151], a[116:119]
    v_accvgpr_read_b32 v84, a84
    v_accvgpr_read_b32 v85, a85
    v_accvgpr_read_b32 v86, a86
    v_accvgpr_read_b32 v87, a87
    v_pk_mul_f32 v[84:85], v[84:85], v[178:179]
    v_pk_mul_f32 v[86:87], v[86:87], v[178:179]
    v_cvt_pk_bf16_f32 v106, v84, v85
    v_cvt_pk_bf16_f32 v107, v86, v87
    s_nop 0
    v_permlane16_swap_b32 v104, v106
    v_permlane16_swap_b32 v105, v107
    s_add_u32 s7, s6, 17408
    buffer_store_dwordx4 v[104:107], v224, s[24:27], s7 offen sc0 sc1
    v_mfma_f32_16x16x32_bf16 a[120:123], a[156:159], v[152:155], a[120:123]
    v_accvgpr_read_b32 v88, a88
    v_accvgpr_read_b32 v89, a89
    v_accvgpr_read_b32 v90, a90
    v_accvgpr_read_b32 v91, a91
    v_pk_mul_f32 v[88:89], v[88:89], v[180:181]
    v_pk_mul_f32 v[90:91], v[90:91], v[180:181]
    v_cvt_pk_bf16_f32 v108, v88, v89
    v_cvt_pk_bf16_f32 v109, v90, v91
    v_mfma_f32_16x16x32_bf16 a[124:127], a[156:159], v[156:159], a[124:127]
    v_accvgpr_read_b32 v92, a92
    v_accvgpr_read_b32 v93, a93
    v_accvgpr_read_b32 v94, a94
    v_accvgpr_read_b32 v95, a95
    v_pk_mul_f32 v[92:93], v[92:93], v[182:183]
    v_pk_mul_f32 v[94:95], v[94:95], v[182:183]
    v_cvt_pk_bf16_f32 v110, v92, v93
    v_cvt_pk_bf16_f32 v111, v94, v95
    s_nop 0
    v_permlane16_swap_b32 v108, v110
    v_permlane16_swap_b32 v109, v111
    s_add_u32 s7, s6, 21504
    buffer_store_dwordx4 v[108:111], v224, s[24:27], s7 offen sc0 sc1
    v_accvgpr_read_b32 v64, a96
    v_accvgpr_read_b32 v65, a97
    v_accvgpr_read_b32 v66, a98
    v_accvgpr_read_b32 v67, a99
    v_pk_mul_f32 v[64:65], v[64:65], v[176:177]
    v_pk_mul_f32 v[66:67], v[66:67], v[176:177]
    v_cvt_pk_bf16_f32 v96, v64, v65
    v_cvt_pk_bf16_f32 v97, v66, v67
    v_accvgpr_read_b32 v68, a100
    v_accvgpr_read_b32 v69, a101
    v_accvgpr_read_b32 v70, a102
    v_accvgpr_read_b32 v71, a103
    v_pk_mul_f32 v[68:69], v[68:69], v[178:179]
    v_pk_mul_f32 v[70:71], v[70:71], v[178:179]
    v_cvt_pk_bf16_f32 v98, v68, v69
    v_cvt_pk_bf16_f32 v99, v70, v71
    s_nop 0
    v_permlane16_swap_b32 v96, v98
    v_permlane16_swap_b32 v97, v99
    s_add_u32 s7, s6, 18432
    buffer_store_dwordx4 v[96:99], v224, s[24:27], s7 offen sc0 sc1
    v_accvgpr_read_b32 v72, a104
    v_accvgpr_read_b32 v73, a105
    v_accvgpr_read_b32 v74, a106
    v_accvgpr_read_b32 v75, a107
    v_pk_mul_f32 v[72:73], v[72:73], v[180:181]
    v_pk_mul_f32 v[74:75], v[74:75], v[180:181]
    v_cvt_pk_bf16_f32 v100, v72, v73
    v_cvt_pk_bf16_f32 v101, v74, v75
    v_accvgpr_read_b32 v76, a108
    v_accvgpr_read_b32 v77, a109
    v_accvgpr_read_b32 v78, a110
    v_accvgpr_read_b32 v79, a111
    v_pk_mul_f32 v[76:77], v[76:77], v[182:183]
    v_pk_mul_f32 v[78:79], v[78:79], v[182:183]
    v_cvt_pk_bf16_f32 v102, v76, v77
    v_cvt_pk_bf16_f32 v103, v78, v79
    s_nop 0
    v_permlane16_swap_b32 v100, v102
    v_permlane16_swap_b32 v101, v103
    s_add_u32 s7, s6, 22528
    buffer_store_dwordx4 v[100:103], v224, s[24:27], s7 offen sc0 sc1
    v_accvgpr_read_b32 v80, a112
    v_accvgpr_read_b32 v81, a113
    v_accvgpr_read_b32 v82, a114
    v_accvgpr_read_b32 v83, a115
    v_pk_mul_f32 v[80:81], v[80:81], v[176:177]
    v_pk_mul_f32 v[82:83], v[82:83], v[176:177]
    v_cvt_pk_bf16_f32 v104, v80, v81
    v_cvt_pk_bf16_f32 v105, v82, v83
    v_accvgpr_read_b32 v84, a116
    v_accvgpr_read_b32 v85, a117
    v_accvgpr_read_b32 v86, a118
    v_accvgpr_read_b32 v87, a119
    v_pk_mul_f32 v[84:85], v[84:85], v[178:179]
    v_pk_mul_f32 v[86:87], v[86:87], v[178:179]
    v_cvt_pk_bf16_f32 v106, v84, v85
    v_cvt_pk_bf16_f32 v107, v86, v87
    s_nop 0
    v_permlane16_swap_b32 v104, v106
    v_permlane16_swap_b32 v105, v107
    s_add_u32 s7, s6, 19456
    buffer_store_dwordx4 v[104:107], v224, s[24:27], s7 offen sc0 sc1
    v_accvgpr_read_b32 v88, a120
    v_accvgpr_read_b32 v89, a121
    v_accvgpr_read_b32 v90, a122
    v_accvgpr_read_b32 v91, a123
    v_pk_mul_f32 v[88:89], v[88:89], v[180:181]
    v_pk_mul_f32 v[90:91], v[90:91], v[180:181]
    v_cvt_pk_bf16_f32 v108, v88, v89
    v_cvt_pk_bf16_f32 v109, v90, v91
    v_accvgpr_read_b32 v92, a124
    v_accvgpr_read_b32 v93, a125
    v_accvgpr_read_b32 v94, a126
    v_accvgpr_read_b32 v95, a127
    v_pk_mul_f32 v[92:93], v[92:93], v[182:183]
    v_pk_mul_f32 v[94:95], v[94:95], v[182:183]
    v_cvt_pk_bf16_f32 v110, v92, v93
    v_cvt_pk_bf16_f32 v111, v94, v95
    s_nop 0
    v_permlane16_swap_b32 v108, v110
    v_permlane16_swap_b32 v109, v111
    s_add_u32 s7, s6, 23552
    buffer_store_dwordx4 v[108:111], v224, s[24:27], s7 offen sc0 sc1
    v_mov_b32 v255, v222
    s_mov_b32 s84, s4
    s_mov_b32 s85, s5
    s_add_u32 s80, s34, 0x80000
    s_addc_u32 s81, s35, 0
    s_mov_b32 s82, 0x2000
    s_mov_b32 s83, 0x00020000
    s_load_dwordx2 s[28:29], s[0:1], 32
    s_lshr_b32 s48, s84, 3
    s_lshl_b32 s86, s85, 2
    s_add_u32 s86, s86, s48
    s_lshl_b32 s86, s86, 7
    s_and_b32 s5, s84, 3
    s_bfe_u32 s6, s84, 0x10002
    s_lshl_b32 s4, s85, 1
    s_add_u32 s4, s4, s6
    s_lshl_b32 s87, s4, 7
    s_add_u32 s87, s87, 4096
    s_waitcnt lgkmcnt(0)
    v_and_b32 v186, 31, v255
    v_lshrrev_b32 v187, 5, v255
    v_bfe_u32 v188, v255, 2, 2
    v_bfe_u32 v189, v255, 4, 1
    v_and_b32 v190, 3, v255
    s_lshl_b32 s6, s4, 20
    s_lshl_b32 s7, s48, 18
    s_add_u32 s6, s6, s7
    s_add_u32 s6, s6, 0x400000
    s_add_u32 s8, s34, s6
    s_addc_u32 s9, s35, 0
    s_mov_b32 s10, 0x40000
    s_mov_b32 s11, 0x00020000
    s_lshl_b32 s6, s5, 8
    s_lshl_b32 s7, s48, 20
    s_add_u32 s6, s6, s7
    s_sub_u32 s7, 0x400000, s6
    s_add_u32 s12, s28, s6
    s_addc_u32 s13, s29, 0
    s_mov_b32 s14, s7
    s_mov_b32 s15, 0x00020000
    s_lshl_b32 s6, s48, 21
    s_lshl_b32 s7, s4, 17
    s_add_u32 s6, s6, s7
    s_lshl_b32 s7, s5, 15
    s_add_u32 s6, s6, s7
    s_add_u32 s6, s6, 0x2000000
    s_add_u32 s24, s34, s6
    s_addc_u32 s25, s35, 0
    s_mov_b32 s26, 0x8000
    s_mov_b32 s27, 0x00020000
    s_and_b32 s50, s3, 1
    s_lshr_b32 s51, s3, 1
    v_lshlrev_b32 v184, 4, v255
    v_lshrrev_b32 v191, 4, v255
    v_lshlrev_b32 v192, 2, v191
    v_and_b32 v185, 15, v255
    v_xor_b32 v185, v185, v192
    v_lshlrev_b32 v185, 4, v185
    v_mul_u32_u24 v191, 1024, v191
    v_add_u32 v185, v185, v191
    s_mul_i32 s52, s3, 16384
    s_lshl_b32 s49, s3, 12
    s_lshl_b32 s6, s50, 13
    v_bfe_u32 v191, v255, 1, 3
    v_xor_b32 v191, v191, v187
    v_lshlrev_b32 v191, 4, v191
    v_lshl_add_u32 v191, v186, 7, v191
    v_add_u32 v191, s6, v191
    v_xor_b32 v176, 0, v191
    v_xor_b32 v177, 32, v191
    v_xor_b32 v178, 64, v191
    v_xor_b32 v179, 96, v191
    v_add_u32 v191, s6, v184
    v_add_u32 v176, 0, v191
    v_add_u32 v177, 1024, v191
    v_add_u32 v178, 2048, v191
    v_add_u32 v179, 3072, v191
    v_lshl_add_u32 v191, v187, 3, v188
    v_lshlrev_b32 v191, 8, v191
    v_add_u32 v191, 81920, v191
    v_lshrrev_b32 v192, 1, v190
    v_lshl_add_u32 v192, v189, 1, v192
    v_lshl_add_u32 v191, v192, 4, v191
    v_and_b32 v192, 1, v190
    v_lshl_add_u32 v191, v192, 3, v191
    s_lshl_b32 s6, s51, 1
    v_xor_b32 v192, s6, v188
    v_lshl_add_u32 v180, v192, 6, v191
    v_xor_b32 v192, 1, v192
    v_lshl_add_u32 v181, v192, 6, v191
    v_add_u32 v216, 0x10000, v176
    v_add_u32 v217, 0x10000, v177
    v_add_u32 v218, 0x10000, v178
    v_add_u32 v219, 0x10000, v179
    v_add_u32 v220, 0x10000, v180
    v_add_u32 v221, 0x10000, v181
    s_waitcnt vmcnt(0) lgkmcnt(0)
    s_barrier
    s_cmp_lg_u32 s3, 0
    s_cbranch_scc1 attn_sig17
    v_mov_b32 v250, 1
    v_mov_b32 v251, 0
    v_cmp_eq_u32 vcc, 0, v255
    s_nop 0
    s_and_saveexec_b64 s[58:59], vcc
    buffer_atomic_add v250, v251, s[80:83], s86 offen sc1
    s_mov_b64 exec, s[58:59]
attn_sig17:
    s_add_u32 m0, s49, 81920
    s_add_u32 s53, s52, 0
    buffer_load_dwordx4 v185, s[12:15], s53 offen lds
    s_add_u32 m0, s49, 82944
    s_add_u32 s53, s52, 4096
    buffer_load_dwordx4 v185, s[12:15], s53 offen lds
    s_add_u32 m0, s49, 83968
    s_add_u32 s53, s52, 8192
    buffer_load_dwordx4 v185, s[12:15], s53 offen lds
    s_add_u32 m0, s49, 84992
    s_add_u32 s53, s52, 12288
    buffer_load_dwordx4 v185, s[12:15], s53 offen lds
    s_add_u32 m0, s49, 98304
    s_add_u32 s53, s52, 65536
    buffer_load_dwordx4 v185, s[12:15], s53 offen lds
    s_add_u32 m0, s49, 99328
    s_add_u32 s53, s52, 69632
    buffer_load_dwordx4 v185, s[12:15], s53 offen lds
    s_add_u32 m0, s49, 100352
    s_add_u32 s53, s52, 73728
    buffer_load_dwordx4 v185, s[12:15], s53 offen lds
    s_add_u32 m0, s49, 101376
    s_add_u32 s53, s52, 77824
    buffer_load_dwordx4 v185, s[12:15], s53 offen lds
    s_add_u32 m0, s49, 114688
    s_add_u32 s53, s52, 131072
    buffer_load_dwordx4 v185, s[12:15], s53 offen lds
    s_add_u32 m0, s49, 115712
    s_add_u32 s53, s52, 135168
    buffer_load_dwordx4 v185, s[12:15], s53 offen lds
    s_add_u32 m0, s49, 116736
    s_add_u32 s53, s52, 139264
    buffer_load_dwordx4 v185, s[12:15], s53 offen lds
    s_add_u32 m0, s49, 117760
    s_add_u32 s53, s52, 143360
    buffer_load_dwordx4 v185, s[12:15], s53 offen lds
    s_add_u32 m0, s49, 131072
    s_add_u32 s53, s52, 196608
    buffer_load_dwordx4 v185, s[12:15], s53 offen lds
    s_add_u32 m0, s49, 132096
    s_add_u32 s53, s52, 200704
    buffer_load_dwordx4 v185, s[12:15], s53 offen lds
    s_add_u32 m0, s49, 133120
    s_add_u32 s53, s52, 204800
    buffer_load_dwordx4 v185, s[12:15], s53 offen lds
    s_add_u32 m0, s49, 134144
    s_add_u32 s53, s52, 208896
    buffer_load_dwordx4 v185, s[12:15], s53 offen lds
    s_cmp_lg_u32 s3, 0
    s_cbranch_scc1 attn_wd19
    v_mov_b32 v251, 0
    s_mov_b32 s57, 0
attn_wt18:
    buffer_load_dword v250, v251, s[80:83], s86 offen sc0 sc1
    s_waitcnt vmcnt(0)
    v_readfirstlane_b32 s58, v250
    s_nop 0
    s_cmp_ge_u32 s58, 8
    s_cbranch_scc1 attn_wd19
    s_sleep 1
    s_add_u32 s57, s57, 1
    s_cmp_lt_u32 s57, 0x40000
    s_cbranch_scc1 attn_wt18
attn_wd19:
    s_barrier
    s_add_u32 m0, s49, 0
    s_add_u32 s45, s49, 0
    buffer_load_dwordx4 v184, s[8:11], s45 offen offset:0 lds
    buffer_load_dwordx4 v184, s[8:11], s45 offen offset:1024 lds
    buffer_load_dwordx4 v184, s[8:11], s45 offen offset:2048 lds
    buffer_load_dwordx4 v184, s[8:11], s45 offen offset:3072 lds
    s_add_u32 m0, s49, 16384
    s_add_u32 s45, s49, 16384
    buffer_load_dwordx4 v184, s[8:11], s45 offen offset:0 lds
    buffer_load_dwordx4 v184, s[8:11], s45 offen offset:1024 lds
    buffer_load_dwordx4 v184, s[8:11], s45 offen offset:2048 lds
    buffer_load_dwordx4 v184, s[8:11], s45 offen offset:3072 lds
    s_add_u32 m0, s49, 32768
    s_add_u32 s45, s49, 32768
    buffer_load_dwordx4 v184, s[8:11], s45 offen offset:0 lds
    buffer_load_dwordx4 v184, s[8:11], s45 offen offset:1024 lds
    buffer_load_dwordx4 v184, s[8:11], s45 offen offset:2048 lds
    buffer_load_dwordx4 v184, s[8:11], s45 offen offset:3072 lds
    s_add_u32 m0, s49, 49152
    s_add_u32 s45, s49, 49152
    buffer_load_dwordx4 v184, s[8:11], s45 offen offset:0 lds
    buffer_load_dwordx4 v184, s[8:11], s45 offen offset:1024 lds
    buffer_load_dwordx4 v184, s[8:11], s45 offen offset:2048 lds
    buffer_load_dwordx4 v184, s[8:11], s45 offen offset:3072 lds
    s_waitcnt vmcnt(8)
    s_barrier
    ds_read_b128 v[128:131], v176 offset:0
    ds_read_b128 v[132:135], v176 offset:4096
    ds_read_b64_tr_b16 v[136:137], v180 offset:0
    ds_read_b64_tr_b16 v[138:139], v180 offset:1024
    ds_read_b64_tr_b16 v[140:141], v181 offset:0
    ds_read_b64_tr_b16 v[142:143], v181 offset:1024
    s_waitcnt lgkmcnt(2)
    v_mfma_f32_32x32x16_bf16 v[0:15], v[136:139], v[128:131], 0
    ds_read_b128 v[144:147], v177 offset:0
    v_mfma_f32_32x32x16_bf16 v[16:31], v[136:139], v[132:135], 0
    ds_read_b128 v[148:151], v177 offset:4096
    s_add_u32 m0, s49, 65536
    s_add_u32 s45, s49, 65536
    buffer_load_dwordx4 v184, s[8:11], s45 offen offset:0 lds
    s_waitcnt lgkmcnt(2)
    v_mfma_f32_32x32x16_bf16 v[32:47], v[140:143], v[128:131], 0
    ds_read_b64_tr_b16 v[152:153], v180 offset:4096
    ds_read_b64_tr_b16 v[154:155], v180 offset:5120
    v_mfma_f32_32x32x16_bf16 v[48:63], v[140:143], v[132:135], 0
    ds_read_b64_tr_b16 v[156:157], v181 offset:4096
    ds_read_b64_tr_b16 v[158:159], v181 offset:5120
    buffer_load_dwordx4 v184, s[8:11], s45 offen offset:1024 lds
    s_waitcnt lgkmcnt(2)
    v_mfma_f32_32x32x16_bf16 v[0:15], v[152:155], v[144:147], v[0:15]
    ds_read_b128 v[128:131], v178 offset:0
    v_mfma_f32_32x32x16_bf16 v[16:31], v[152:155], v[148:151], v[16:31]
    ds_read_b128 v[132:135], v178 offset:4096
    buffer_load_dwordx4 v184, s[8:11], s45 offen offset:2048 lds
    s_waitcnt lgkmcnt(2)
    v_mfma_f32_32x32x16_bf16 v[32:47], v[156:159], v[144:147], v[32:47]
    ds_read_b64_tr_b16 v[136:137], v180 offset:8192
    ds_read_b64_tr_b16 v[138:139], v180 offset:9216
    v_mfma_f32_32x32x16_bf16 v[48:63], v[156:159], v[148:151], v[48:63]
    ds_read_b64_tr_b16 v[140:141], v181 offset:8192
    ds_read_b64_tr_b16 v[142:143], v181 offset:9216
    buffer_load_dwordx4 v184, s[8:11], s45 offen offset:3072 lds
    s_waitcnt lgkmcnt(2)
    v_mfma_f32_32x32x16_bf16 v[0:15], v[136:139], v[128:131], v[0:15]
    ds_read_b128 v[144:147], v179 offset:0
    v_mfma_f32_32x32x16_bf16 v[16:31], v[136:139], v[132:135], v[16:31]
    ds_read_b128 v[148:151], v179 offset:4096
    s_add_u32 m0, s49, 147456
    s_add_u32 s53, s52, 262144
    buffer_load_dwordx4 v185, s[12:15], s53 offen lds
    s_waitcnt lgkmcnt(2)
    v_mfma_f32_32x32x16_bf16 v[32:47], v[140:143], v[128:131], v[32:47]
    ds_read_b64_tr_b16 v[152:153], v180 offset:12288
    ds_read_b64_tr_b16 v[154:155], v180 offset:13312
    v_mfma_f32_32x32x16_bf16 v[48:63], v[140:143], v[132:135], v[48:63]
    ds_read_b64_tr_b16 v[156:157], v181 offset:12288
    ds_read_b64_tr_b16 v[158:159], v181 offset:13312
    s_add_u32 m0, s49, 148480
    s_add_u32 s53, s52, 266240
    buffer_load_dwordx4 v185, s[12:15], s53 offen lds
    s_waitcnt lgkmcnt(2)
    v_mfma_f32_32x32x16_bf16 v[0:15], v[152:155], v[144:147], v[0:15]
    ds_read_b128 v[128:131], v176 offset:16384
    v_mfma_f32_32x32x16_bf16 v[16:31], v[152:155], v[148:151], v[16:31]
    ds_read_b128 v[132:135], v176 offset:20480
    s_add_u32 m0, s49, 149504
    s_add_u32 s53, s52, 270336
    buffer_load_dwordx4 v185, s[12:15], s53 offen lds
    s_waitcnt lgkmcnt(2)
    v_mfma_f32_32x32x16_bf16 v[32:47], v[156:159], v[144:147], v[32:47]
    ds_read_b64_tr_b16 v[136:137], v180 offset:16384
    ds_read_b64_tr_b16 v[138:139], v180 offset:17408
    v_mfma_f32_32x32x16_bf16 v[48:63], v[156:159], v[148:151], v[48:63]
    ds_read_b64_tr_b16 v[140:141], v181 offset:16384
    ds_read_b64_tr_b16 v[142:143], v181 offset:17408
    s_add_u32 m0, s49, 150528
    s_add_u32 s53, s52, 274432
    buffer_load_dwordx4 v185, s[12:15], s53 offen lds
    s_waitcnt vmcnt(12)
    s_barrier
    s_waitcnt lgkmcnt(2)
    v_mfma_f32_32x32x16_bf16 v[0:15], v[136:139], v[128:131], v[0:15]
    ds_read_b128 v[144:147], v177 offset:16384
    v_mfma_f32_32x32x16_bf16 v[16:31], v[136:139], v[132:135], v[16:31]
    ds_read_b128 v[148:151], v177 offset:20480
    s_add_u32 m0, s49, 0
    s_add_u32 s45, s49, 81920
    buffer_load_dwordx4 v184, s[8:11], s45 offen offset:0 lds
    s_waitcnt lgkmcnt(2)
    v_mfma_f32_32x32x16_bf16 v[32:47], v[140:143], v[128:131], v[32:47]
    ds_read_b64_tr_b16 v[152:153], v180 offset:20480
    ds_read_b64_tr_b16 v[154:155], v180 offset:21504
    v_mfma_f32_32x32x16_bf16 v[48:63], v[140:143], v[132:135], v[48:63]
    ds_read_b64_tr_b16 v[156:157], v181 offset:20480
    ds_read_b64_tr_b16 v[158:159], v181 offset:21504
    buffer_load_dwordx4 v184, s[8:11], s45 offen offset:1024 lds
    s_waitcnt lgkmcnt(2)
    v_mfma_f32_32x32x16_bf16 v[0:15], v[152:155], v[144:147], v[0:15]
    ds_read_b128 v[128:131], v178 offset:16384
    v_mfma_f32_32x32x16_bf16 v[16:31], v[152:155], v[148:151], v[16:31]
    ds_read_b128 v[132:135], v178 offset:20480
    buffer_load_dwordx4 v184, s[8:11], s45 offen offset:2048 lds
    s_waitcnt lgkmcnt(2)
    v_mfma_f32_32x32x16_bf16 v[32:47], v[156:159], v[144:147], v[32:47]
    ds_read_b64_tr_b16 v[136:137], v180 offset:24576
    ds_read_b64_tr_b16 v[138:139], v180 offset:25600
    v_mfma_f32_32x32x16_bf16 v[48:63], v[156:159], v[148:151], v[48:63]
    ds_read_b64_tr_b16 v[140:141], v181 offset:24576
    ds_read_b64_tr_b16 v[142:143], v181 offset:25600
    buffer_load_dwordx4 v184, s[8:11], s45 offen offset:3072 lds
    s_waitcnt lgkmcnt(2)
    v_mfma_f32_32x32x16_bf16 v[0:15], v[136:139], v[128:131], v[0:15]
    ds_read_b128 v[144:147], v179 offset:16384
    v_mfma_f32_32x32x16_bf16 v[16:31], v[136:139], v[132:135], v[16:31]
    ds_read_b128 v[148:151], v179 offset:20480
    s_add_u32 m0, s49, 81920
    s_add_u32 s53, s52, 327680
    buffer_load_dwordx4 v185, s[12:15], s53 offen lds
    s_waitcnt lgkmcnt(2)
    v_mfma_f32_32x32x16_bf16 v[32:47], v[140:143], v[128:131], v[32:47]
    ds_read_b64_tr_b16 v[152:153], v180 offset:28672
    ds_read_b64_tr_b16 v[154:155], v180 offset:29696
    v_mfma_f32_32x32x16_bf16 v[48:63], v[140:143], v[132:135], v[48:63]
    ds_read_b64_tr_b16 v[156:157], v181 offset:28672
    ds_read_b64_tr_b16 v[158:159], v181 offset:29696
    s_add_u32 m0, s49, 82944
    s_add_u32 s53, s52, 331776
    buffer_load_dwordx4 v185, s[12:15], s53 offen lds
    s_waitcnt lgkmcnt(2)
    v_mfma_f32_32x32x16_bf16 v[0:15], v[152:155], v[144:147], v[0:15]
    ds_read_b128 v[128:131], v176 offset:32768
    v_mfma_f32_32x32x16_bf16 v[16:31], v[152:155], v[148:151], v[16:31]
    ds_read_b128 v[132:135], v176 offset:36864
    s_add_u32 m0, s49, 83968
    s_add_u32 s53, s52, 335872
    buffer_load_dwordx4 v185, s[12:15], s53 offen lds
    s_waitcnt lgkmcnt(2)
    v_mfma_f32_32x32x16_bf16 v[32:47], v[156:159], v[144:147], v[32:47]
    ds_read_b64_tr_b16 v[136:137], v180 offset:32768
    ds_read_b64_tr_b16 v[138:139], v180 offset:33792
    v_mfma_f32_32x32x16_bf16 v[48:63], v[156:159], v[148:151], v[48:63]
    ds_read_b64_tr_b16 v[140:141], v181 offset:32768
    ds_read_b64_tr_b16 v[142:143], v181 offset:33792
    s_add_u32 m0, s49, 84992
    s_add_u32 s53, s52, 339968
    buffer_load_dwordx4 v185, s[12:15], s53 offen lds
    s_waitcnt vmcnt(16)
    s_barrier
    s_waitcnt lgkmcnt(2)
    v_mfma_f32_32x32x16_bf16 v[0:15], v[136:139], v[128:131], v[0:15]
    ds_read_b128 v[144:147], v177 offset:32768
    v_mfma_f32_32x32x16_bf16 v[16:31], v[136:139], v[132:135], v[16:31]
    ds_read_b128 v[148:151], v177 offset:36864
    s_add_u32 m0, s49, 16384
    s_add_u32 s45, s49, 98304
    buffer_load_dwordx4 v184, s[8:11], s45 offen offset:0 lds
    s_waitcnt lgkmcnt(2)
    v_mfma_f32_32x32x16_bf16 v[32:47], v[140:143], v[128:131], v[32:47]
    ds_read_b64_tr_b16 v[152:153], v180 offset:36864
    ds_read_b64_tr_b16 v[154:155], v180 offset:37888
    v_mfma_f32_32x32x16_bf16 v[48:63], v[140:143], v[132:135], v[48:63]
    ds_read_b64_tr_b16 v[156:157], v181 offset:36864
    ds_read_b64_tr_b16 v[158:159], v181 offset:37888
    buffer_load_dwordx4 v184, s[8:11], s45 offen offset:1024 lds
    s_waitcnt lgkmcnt(2)
    v_mfma_f32_32x32x16_bf16 v[0:15], v[152:155], v[144:147], v[0:15]
    ds_read_b128 v[128:131], v178 offset:32768
    v_mfma_f32_32x32x16_bf16 v[16:31], v[152:155], v[148:151], v[16:31]
    ds_read_b128 v[132:135], v178 offset:36864
    buffer_load_dwordx4 v184, s[8:11], s45 offen offset:2048 lds
    s_waitcnt lgkmcnt(2)
    v_mfma_f32_32x32x16_bf16 v[32:47], v[156:159], v[144:147], v[32:47]
    ds_read_b64_tr_b16 v[136:137], v180 offset:40960
    ds_read_b64_tr_b16 v[138:139], v180 offset:41984
    v_mfma_f32_32x32x16_bf16 v[48:63], v[156:159], v[148:151], v[48:63]
    ds_read_b64_tr_b16 v[140:141], v181 offset:40960
    ds_read_b64_tr_b16 v[142:143], v181 offset:41984
    buffer_load_dwordx4 v184, s[8:11], s45 offen offset:3072 lds
    s_waitcnt lgkmcnt(2)
    v_mfma_f32_32x32x16_bf16 v[0:15], v[136:139], v[128:131], v[0:15]
    ds_read_b128 v[144:147], v179 offset:32768
    v_mfma_f32_32x32x16_bf16 v[16:31], v[136:139], v[132:135], v[16:31]
    ds_read_b128 v[148:151], v179 offset:36864
    s_add_u32 m0, s49, 98304
    s_add_u32 s53, s52, 393216
    buffer_load_dwordx4 v185, s[12:15], s53 offen lds
    s_waitcnt lgkmcnt(2)
    v_mfma_f32_32x32x16_bf16 v[32:47], v[140:143], v[128:131], v[32:47]
    ds_read_b64_tr_b16 v[152:153], v180 offset:45056
    ds_read_b64_tr_b16 v[154:155], v180 offset:46080
    v_mfma_f32_32x32x16_bf16 v[48:63], v[140:143], v[132:135], v[48:63]
    ds_read_b64_tr_b16 v[156:157], v181 offset:45056
    ds_read_b64_tr_b16 v[158:159], v181 offset:46080
    s_add_u32 m0, s49, 99328
    s_add_u32 s53, s52, 397312
    buffer_load_dwordx4 v185, s[12:15], s53 offen lds
    s_waitcnt lgkmcnt(2)
    v_mfma_f32_32x32x16_bf16 v[0:15], v[152:155], v[144:147], v[0:15]
    ds_read_b128 v[128:131], v176 offset:49152
    v_mfma_f32_32x32x16_bf16 v[16:31], v[152:155], v[148:151], v[16:31]
    ds_read_b128 v[132:135], v176 offset:53248
    s_add_u32 m0, s49, 100352
    s_add_u32 s53, s52, 401408
    buffer_load_dwordx4 v185, s[12:15], s53 offen lds
    s_waitcnt lgkmcnt(2)
    v_mfma_f32_32x32x16_bf16 v[32:47], v[156:159], v[144:147], v[32:47]
    ds_read_b64_tr_b16 v[136:137], v180 offset:49152
    ds_read_b64_tr_b16 v[138:139], v180 offset:50176
    v_mfma_f32_32x32x16_bf16 v[48:63], v[156:159], v[148:151], v[48:63]
    ds_read_b64_tr_b16 v[140:141], v181 offset:49152
    ds_read_b64_tr_b16 v[142:143], v181 offset:50176
    s_add_u32 m0, s49, 101376
    s_add_u32 s53, s52, 405504
    buffer_load_dwordx4 v185, s[12:15], s53 offen lds
    s_waitcnt vmcnt(16)
    s_barrier
    s_waitcnt lgkmcnt(2)
    v_mfma_f32_32x32x16_bf16 v[0:15], v[136:139], v[128:131], v[0:15]
    ds_read_b128 v[144:147], v177 offset:49152
    v_mfma_f32_32x32x16_bf16 v[16:31], v[136:139], v[132:135], v[16:31]
    ds_read_b128 v[148:151], v177 offset:53248
    s_add_u32 m0, s49, 32768
    s_add_u32 s45, s49, 114688
    buffer_load_dwordx4 v184, s[8:11], s45 offen offset:0 lds
    s_waitcnt lgkmcnt(2)
    v_mfma_f32_32x32x16_bf16 v[32:47], v[140:143], v[128:131], v[32:47]
    ds_read_b64_tr_b16 v[152:153], v180 offset:53248
    ds_read_b64_tr_b16 v[154:155], v180 offset:54272
    v_mfma_f32_32x32x16_bf16 v[48:63], v[140:143], v[132:135], v[48:63]
    ds_read_b64_tr_b16 v[156:157], v181 offset:53248
    ds_read_b64_tr_b16 v[158:159], v181 offset:54272
    buffer_load_dwordx4 v184, s[8:11], s45 offen offset:1024 lds
    s_waitcnt lgkmcnt(2)
    v_mfma_f32_32x32x16_bf16 v[0:15], v[152:155], v[144:147], v[0:15]
    ds_read_b128 v[128:131], v178 offset:49152
    v_mfma_f32_32x32x16_bf16 v[16:31], v[152:155], v[148:151], v[16:31]
    ds_read_b128 v[132:135], v178 offset:53248
    buffer_load_dwordx4 v184, s[8:11], s45 offen offset:2048 lds
    s_waitcnt lgkmcnt(2)
    v_mfma_f32_32x32x16_bf16 v[32:47], v[156:159], v[144:147], v[32:47]
    ds_read_b64_tr_b16 v[136:137], v180 offset:57344
    ds_read_b64_tr_b16 v[138:139], v180 offset:58368
    v_mfma_f32_32x32x16_bf16 v[48:63], v[156:159], v[148:151], v[48:63]
    ds_read_b64_tr_b16 v[140:141], v181 offset:57344
    ds_read_b64_tr_b16 v[142:143], v181 offset:58368
    buffer_load_dwordx4 v184, s[8:11], s45 offen offset:3072 lds
    s_waitcnt lgkmcnt(2)
    v_mfma_f32_32x32x16_bf16 v[0:15], v[136:139], v[128:131], v[0:15]
    ds_read_b128 v[144:147], v179 offset:49152
    v_mfma_f32_32x32x16_bf16 v[16:31], v[136:139], v[132:135], v[16:31]
    ds_read_b128 v[148:151], v179 offset:53248
    s_add_u32 m0, s49, 114688
    s_add_u32 s53, s52, 458752
    buffer_load_dwordx4 v185, s[12:15], s53 offen lds
    s_waitcnt lgkmcnt(2)
    v_mfma_f32_32x32x16_bf16 v[32:47], v[140:143], v[128:131], v[32:47]
    ds_read_b64_tr_b16 v[152:153], v180 offset:61440
    ds_read_b64_tr_b16 v[154:155], v180 offset:62464
    v_mfma_f32_32x32x16_bf16 v[48:63], v[140:143], v[132:135], v[48:63]
    ds_read_b64_tr_b16 v[156:157], v181 offset:61440
    ds_read_b64_tr_b16 v[158:159], v181 offset:62464
    s_add_u32 m0, s49, 115712
    s_add_u32 s53, s52, 462848
    buffer_load_dwordx4 v185, s[12:15], s53 offen lds
    s_waitcnt lgkmcnt(2)
    v_mfma_f32_32x32x16_bf16 v[0:15], v[152:155], v[144:147], v[0:15]
    ds_read_b128 v[128:131], v216 offset:0
    v_mfma_f32_32x32x16_bf16 v[16:31], v[152:155], v[148:151], v[16:31]
    ds_read_b128 v[132:135], v216 offset:4096
    s_add_u32 m0, s49, 116736
    s_add_u32 s53, s52, 466944
    buffer_load_dwordx4 v185, s[12:15], s53 offen lds
    s_waitcnt lgkmcnt(2)
    v_mfma_f32_32x32x16_bf16 v[32:47], v[156:159], v[144:147], v[32:47]
    ds_read_b64_tr_b16 v[136:137], v220 offset:0
    ds_read_b64_tr_b16 v[138:139], v220 offset:1024
    v_mfma_f32_32x32x16_bf16 v[48:63], v[156:159], v[148:151], v[48:63]
    ds_read_b64_tr_b16 v[140:141], v221 offset:0
    ds_read_b64_tr_b16 v[142:143], v221 offset:1024
    s_add_u32 m0, s49, 117760
    s_add_u32 s53, s52, 471040
    buffer_load_dwordx4 v185, s[12:15], s53 offen lds
    s_waitcnt vmcnt(16)
    s_barrier
    s_waitcnt lgkmcnt(2)
    v_mfma_f32_32x32x16_bf16 v[0:15], v[136:139], v[128:131], v[0:15]
    ds_read_b128 v[144:147], v217 offset:0
    v_mfma_f32_32x32x16_bf16 v[16:31], v[136:139], v[132:135], v[16:31]
    ds_read_b128 v[148:151], v217 offset:4096
    s_add_u32 m0, s49, 49152
    s_add_u32 s45, s49, 131072
    buffer_load_dwordx4 v184, s[8:11], s45 offen offset:0 lds
    s_waitcnt lgkmcnt(2)
    v_mfma_f32_32x32x16_bf16 v[32:47], v[140:143], v[128:131], v[32:47]
    ds_read_b64_tr_b16 v[152:153], v220 offset:4096
    ds_read_b64_tr_b16 v[154:155], v220 offset:5120
    v_mfma_f32_32x32x16_bf16 v[48:63], v[140:143], v[132:135], v[48:63]
    ds_read_b64_tr_b16 v[156:157], v221 offset:4096
    ds_read_b64_tr_b16 v[158:159], v221 offset:5120
    buffer_load_dwordx4 v184, s[8:11], s45 offen offset:1024 lds
    s_waitcnt lgkmcnt(2)
    v_mfma_f32_32x32x16_bf16 v[0:15], v[152:155], v[144:147], v[0:15]
    ds_read_b128 v[128:131], v218 offset:0
    v_mfma_f32_32x32x16_bf16 v[16:31], v[152:155], v[148:151], v[16:31]
    ds_read_b128 v[132:135], v218 offset:4096
    buffer_load_dwordx4 v184, s[8:11], s45 offen offset:2048 lds
    s_waitcnt lgkmcnt(2)
    v_mfma_f32_32x32x16_bf16 v[32:47], v[156:159], v[144:147], v[32:47]
    ds_read_b64_tr_b16 v[136:137], v220 offset:8192
    ds_read_b64_tr_b16 v[138:139], v220 offset:9216
    v_mfma_f32_32x32x16_bf16 v[48:63], v[156:159], v[148:151], v[48:63]
    ds_read_b64_tr_b16 v[140:141], v221 offset:8192
    ds_read_b64_tr_b16 v[142:143], v221 offset:9216
    buffer_load_dwordx4 v184, s[8:11], s45 offen offset:3072 lds
    s_waitcnt lgkmcnt(2)
    v_mfma_f32_32x32x16_bf16 v[0:15], v[136:139], v[128:131], v[0:15]
    ds_read_b128 v[144:147], v219 offset:0
    v_mfma_f32_32x32x16_bf16 v[16:31], v[136:139], v[132:135], v[16:31]
    ds_read_b128 v[148:151], v219 offset:4096
    s_add_u32 m0, s49, 131072
    s_add_u32 s53, s52, 524288
    buffer_load_dwordx4 v185, s[12:15], s53 offen lds
    s_waitcnt lgkmcnt(2)
    v_mfma_f32_32x32x16_bf16 v[32:47], v[140:143], v[128:131], v[32:47]
    ds_read_b64_tr_b16 v[152:153], v220 offset:12288
    ds_read_b64_tr_b16 v[154:155], v220 offset:13312
    v_mfma_f32_32x32x16_bf16 v[48:63], v[140:143], v[132:135], v[48:63]
    ds_read_b64_tr_b16 v[156:157], v221 offset:12288
    ds_read_b64_tr_b16 v[158:159], v221 offset:13312
    s_add_u32 m0, s49, 132096
    s_add_u32 s53, s52, 528384
    buffer_load_dwordx4 v185, s[12:15], s53 offen lds
    s_waitcnt lgkmcnt(2)
    v_mfma_f32_32x32x16_bf16 v[0:15], v[152:155], v[144:147], v[0:15]
    ds_read_b128 v[128:131], v176 offset:0
    v_mfma_f32_32x32x16_bf16 v[16:31], v[152:155], v[148:151], v[16:31]
    ds_read_b128 v[132:135], v176 offset:4096
    s_add_u32 m0, s49, 133120
    s_add_u32 s53, s52, 532480
    buffer_load_dwordx4 v185, s[12:15], s53 offen lds
    s_waitcnt lgkmcnt(2)
    v_mfma_f32_32x32x16_bf16 v[32:47], v[156:159], v[144:147], v[32:47]
    ds_read_b64_tr_b16 v[136:137], v180 offset:0
    ds_read_b64_tr_b16 v[138:139], v180 offset:1024
    v_mfma_f32_32x32x16_bf16 v[48:63], v[156:159], v[148:151], v[48:63]
    ds_read_b64_tr_b16 v[140:141], v181 offset:0
    ds_read_b64_tr_b16 v[142:143], v181 offset:1024
    s_add_u32 m0, s49, 134144
    s_add_u32 s53, s52, 536576
    buffer_load_dwordx4 v185, s[12:15], s53 offen lds
    s_waitcnt vmcnt(16)
    s_barrier
    s_waitcnt lgkmcnt(2)
    v_mfma_f32_32x32x16_bf16 v[0:15], v[136:139], v[128:131], v[0:15]
    ds_read_b128 v[144:147], v177 offset:0
    v_mfma_f32_32x32x16_bf16 v[16:31], v[136:139], v[132:135], v[16:31]
    ds_read_b128 v[148:151], v177 offset:4096
    s_add_u32 m0, s49, 65536
    s_add_u32 s45, s49, 147456
    buffer_load_dwordx4 v184, s[8:11], s45 offen offset:0 lds
    s_waitcnt lgkmcnt(2)
    v_mfma_f32_32x32x16_bf16 v[32:47], v[140:143], v[128:131], v[32:47]
    ds_read_b64_tr_b16 v[152:153], v180 offset:4096
    ds_read_b64_tr_b16 v[154:155], v180 offset:5120
    v_mfma_f32_32x32x16_bf16 v[48:63], v[140:143], v[132:135], v[48:63]
    ds_read_b64_tr_b16 v[156:157], v181 offset:4096
    ds_read_b64_tr_b16 v[158:159], v181 offset:5120
    buffer_load_dwordx4 v184, s[8:11], s45 offen offset:1024 lds
    s_waitcnt lgkmcnt(2)
    v_mfma_f32_32x32x16_bf16 v[0:15], v[152:155], v[144:147], v[0:15]
    ds_read_b128 v[128:131], v178 offset:0
    v_mfma_f32_32x32x16_bf16 v[16:31], v[152:155], v[148:151], v[16:31]
    ds_read_b128 v[132:135], v178 offset:4096
    buffer_load_dwordx4 v184, s[8:11], s45 offen offset:2048 lds
    s_waitcnt lgkmcnt(2)
    v_mfma_f32_32x32x16_bf16 v[32:47], v[156:159], v[144:147], v[32:47]
    ds_read_b64_tr_b16 v[136:137], v180 offset:8192
    ds_read_b64_tr_b16 v[138:139], v180 offset:9216
    v_mfma_f32_32x32x16_bf16 v[48:63], v[156:159], v[148:151], v[48:63]
    ds_read_b64_tr_b16 v[140:141], v181 offset:8192
    ds_read_b64_tr_b16 v[142:143], v181 offset:9216
    buffer_load_dwordx4 v184, s[8:11], s45 offen offset:3072 lds
    s_waitcnt lgkmcnt(2)
    v_mfma_f32_32x32x16_bf16 v[0:15], v[136:139], v[128:131], v[0:15]
    ds_read_b128 v[144:147], v179 offset:0
    v_mfma_f32_32x32x16_bf16 v[16:31], v[136:139], v[132:135], v[16:31]
    ds_read_b128 v[148:151], v179 offset:4096
    s_add_u32 m0, s49, 147456
    s_add_u32 s53, s52, 589824
    buffer_load_dwordx4 v185, s[12:15], s53 offen lds
    s_waitcnt lgkmcnt(2)
    v_mfma_f32_32x32x16_bf16 v[32:47], v[140:143], v[128:131], v[32:47]
    ds_read_b64_tr_b16 v[152:153], v180 offset:12288
    ds_read_b64_tr_b16 v[154:155], v180 offset:13312
    v_mfma_f32_32x32x16_bf16 v[48:63], v[140:143], v[132:135], v[48:63]
    ds_read_b64_tr_b16 v[156:157], v181 offset:12288
    ds_read_b64_tr_b16 v[158:159], v181 offset:13312
    s_add_u32 m0, s49, 148480
    s_add_u32 s53, s52, 593920
    buffer_load_dwordx4 v185, s[12:15], s53 offen lds
    s_waitcnt lgkmcnt(2)
    v_mfma_f32_32x32x16_bf16 v[0:15], v[152:155], v[144:147], v[0:15]
    ds_read_b128 v[128:131], v176 offset:16384
    v_mfma_f32_32x32x16_bf16 v[16:31], v[152:155], v[148:151], v[16:31]
    ds_read_b128 v[132:135], v176 offset:20480
    s_add_u32 m0, s49, 149504
    s_add_u32 s53, s52, 598016
    buffer_load_dwordx4 v185, s[12:15], s53 offen lds
    s_waitcnt lgkmcnt(2)
    v_mfma_f32_32x32x16_bf16 v[32:47], v[156:159], v[144:147], v[32:47]
    ds_read_b64_tr_b16 v[136:137], v180 offset:16384
    ds_read_b64_tr_b16 v[138:139], v180 offset:17408
    v_mfma_f32_32x32x16_bf16 v[48:63], v[156:159], v[148:151], v[48:63]
    ds_read_b64_tr_b16 v[140:141], v181 offset:16384
    ds_read_b64_tr_b16 v[142:143], v181 offset:17408
    s_add_u32 m0, s49, 150528
    s_add_u32 s53, s52, 602112
    buffer_load_dwordx4 v185, s[12:15], s53 offen lds
    s_waitcnt vmcnt(16)
    s_barrier
    s_waitcnt lgkmcnt(2)
    v_mfma_f32_32x32x16_bf16 v[0:15], v[136:139], v[128:131], v[0:15]
    ds_read_b128 v[144:147], v177 offset:16384
    v_mfma_f32_32x32x16_bf16 v[16:31], v[136:139], v[132:135], v[16:31]
    ds_read_b128 v[148:151], v177 offset:20480
    s_add_u32 m0, s49, 0
    s_add_u32 s45, s49, 163840
    buffer_load_dwordx4 v184, s[8:11], s45 offen offset:0 lds
    s_waitcnt lgkmcnt(2)
    v_mfma_f32_32x32x16_bf16 v[32:47], v[140:143], v[128:131], v[32:47]
    ds_read_b64_tr_b16 v[152:153], v180 offset:20480
    ds_read_b64_tr_b16 v[154:155], v180 offset:21504
    v_mfma_f32_32x32x16_bf16 v[48:63], v[140:143], v[132:135], v[48:63]
    ds_read_b64_tr_b16 v[156:157], v181 offset:20480
    ds_read_b64_tr_b16 v[158:159], v181 offset:21504
    buffer_load_dwordx4 v184, s[8:11], s45 offen offset:1024 lds
    s_waitcnt lgkmcnt(2)
    v_mfma_f32_32x32x16_bf16 v[0:15], v[152:155], v[144:147], v[0:15]
    ds_read_b128 v[128:131], v178 offset:16384
    v_mfma_f32_32x32x16_bf16 v[16:31], v[152:155], v[148:151], v[16:31]
    ds_read_b128 v[132:135], v178 offset:20480
    buffer_load_dwordx4 v184, s[8:11], s45 offen offset:2048 lds
    s_waitcnt lgkmcnt(2)
    v_mfma_f32_32x32x16_bf16 v[32:47], v[156:159], v[144:147], v[32:47]
    ds_read_b64_tr_b16 v[136:137], v180 offset:24576
    ds_read_b64_tr_b16 v[138:139], v180 offset:25600
    v_mfma_f32_32x32x16_bf16 v[48:63], v[156:159], v[148:151], v[48:63]
    ds_read_b64_tr_b16 v[140:141], v181 offset:24576
    ds_read_b64_tr_b16 v[142:143], v181 offset:25600
    buffer_load_dwordx4 v184, s[8:11], s45 offen offset:3072 lds
    s_waitcnt lgkmcnt(2)
    v_mfma_f32_32x32x16_bf16 v[0:15], v[136:139], v[128:131], v[0:15]
    ds_read_b128 v[144:147], v179 offset:16384
    v_mfma_f32_32x32x16_bf16 v[16:31], v[136:139], v[132:135], v[16:31]
    ds_read_b128 v[148:151], v179 offset:20480
    s_add_u32 m0, s49, 81920
    s_add_u32 s53, s52, 655360
    buffer_load_dwordx4 v185, s[12:15], s53 offen lds
    s_waitcnt lgkmcnt(2)
    v_mfma_f32_32x32x16_bf16 v[32:47], v[140:143], v[128:131], v[32:47]
    ds_read_b64_tr_b16 v[152:153], v180 offset:28672
    ds_read_b64_tr_b16 v[154:155], v180 offset:29696
    v_mfma_f32_32x32x16_bf16 v[48:63], v[140:143], v[132:135], v[48:63]
    ds_read_b64_tr_b16 v[156:157], v181 offset:28672
    ds_read_b64_tr_b16 v[158:159], v181 offset:29696
    s_add_u32 m0, s49, 82944
    s_add_u32 s53, s52, 659456
    buffer_load_dwordx4 v185, s[12:15], s53 offen lds
    s_waitcnt lgkmcnt(2)
    v_mfma_f32_32x32x16_bf16 v[0:15], v[152:155], v[144:147], v[0:15]
    ds_read_b128 v[128:131], v176 offset:32768
    v_mfma_f32_32x32x16_bf16 v[16:31], v[152:155], v[148:151], v[16:31]
    ds_read_b128 v[132:135], v176 offset:36864
    s_add_u32 m0, s49, 83968
    s_add_u32 s53, s52, 663552
    buffer_load_dwordx4 v185, s[12:15], s53 offen lds
    s_waitcnt lgkmcnt(2)
    v_mfma_f32_32x32x16_bf16 v[32:47], v[156:159], v[144:147], v[32:47]
    ds_read_b64_tr_b16 v[136:137], v180 offset:32768
    ds_read_b64_tr_b16 v[138:139], v180 offset:33792
    v_mfma_f32_32x32x16_bf16 v[48:63], v[156:159], v[148:151], v[48:63]
    ds_read_b64_tr_b16 v[140:141], v181 offset:32768
    ds_read_b64_tr_b16 v[142:143], v181 offset:33792
    s_add_u32 m0, s49, 84992
    s_add_u32 s53, s52, 667648
    buffer_load_dwordx4 v185, s[12:15], s53 offen lds
    s_waitcnt vmcnt(16)
    s_barrier
    s_waitcnt lgkmcnt(2)
    v_mfma_f32_32x32x16_bf16 v[0:15], v[136:139], v[128:131], v[0:15]
    ds_read_b128 v[144:147], v177 offset:32768
    v_mfma_f32_32x32x16_bf16 v[16:31], v[136:139], v[132:135], v[16:31]
    ds_read_b128 v[148:151], v177 offset:36864
    s_add_u32 m0, s49, 16384
    s_add_u32 s45, s49, 180224
    buffer_load_dwordx4 v184, s[8:11], s45 offen offset:0 lds
    s_waitcnt lgkmcnt(2)
    v_mfma_f32_32x32x16_bf16 v[32:47], v[140:143], v[128:131], v[32:47]
    ds_read_b64_tr_b16 v[152:153], v180 offset:36864
    ds_read_b64_tr_b16 v[154:155], v180 offset:37888
    v_mfma_f32_32x32x16_bf16 v[48:63], v[140:143], v[132:135], v[48:63]
    ds_read_b64_tr_b16 v[156:157], v181 offset:36864
    ds_read_b64_tr_b16 v[158:159], v181 offset:37888
    buffer_load_dwordx4 v184, s[8:11], s45 offen offset:1024 lds
    s_waitcnt lgkmcnt(2)
    v_mfma_f32_32x32x16_bf16 v[0:15], v[152:155], v[144:147], v[0:15]
    ds_read_b128 v[128:131], v178 offset:32768
    v_mfma_f32_32x32x16_bf16 v[16:31], v[152:155], v[148:151], v[16:31]
    ds_read_b128 v[132:135], v178 offset:36864
    buffer_load_dwordx4 v184, s[8:11], s45 offen offset:2048 lds
    s_waitcnt lgkmcnt(2)
    v_mfma_f32_32x32x16_bf16 v[32:47], v[156:159], v[144:147], v[32:47]
    ds_read_b64_tr_b16 v[136:137], v180 offset:40960
    ds_read_b64_tr_b16 v[138:139], v180 offset:41984
    v_mfma_f32_32x32x16_bf16 v[48:63], v[156:159], v[148:151], v[48:63]
    ds_read_b64_tr_b16 v[140:141], v181 offset:40960
    ds_read_b64_tr_b16 v[142:143], v181 offset:41984
    buffer_load_dwordx4 v184, s[8:11], s45 offen offset:3072 lds
    s_waitcnt lgkmcnt(2)
    v_mfma_f32_32x32x16_bf16 v[0:15], v[136:139], v[128:131], v[0:15]
    ds_read_b128 v[144:147], v179 offset:32768
    v_mfma_f32_32x32x16_bf16 v[16:31], v[136:139], v[132:135], v[16:31]
    ds_read_b128 v[148:151], v179 offset:36864
    s_add_u32 m0, s49, 98304
    s_add_u32 s53, s52, 720896
    buffer_load_dwordx4 v185, s[12:15], s53 offen lds
    s_waitcnt lgkmcnt(2)
    v_mfma_f32_32x32x16_bf16 v[32:47], v[140:143], v[128:131], v[32:47]
    ds_read_b64_tr_b16 v[152:153], v180 offset:45056
    ds_read_b64_tr_b16 v[154:155], v180 offset:46080
    v_mfma_f32_32x32x16_bf16 v[48:63], v[140:143], v[132:135], v[48:63]
    ds_read_b64_tr_b16 v[156:157], v181 offset:45056
    ds_read_b64_tr_b16 v[158:159], v181 offset:46080
    s_add_u32 m0, s49, 99328
    s_add_u32 s53, s52, 724992
    buffer_load_dwordx4 v185, s[12:15], s53 offen lds
    s_waitcnt lgkmcnt(2)
    v_mfma_f32_32x32x16_bf16 v[0:15], v[152:155], v[144:147], v[0:15]
    ds_read_b128 v[128:131], v176 offset:49152
    v_mfma_f32_32x32x16_bf16 v[16:31], v[152:155], v[148:151], v[16:31]
    ds_read_b128 v[132:135], v176 offset:53248
    s_add_u32 m0, s49, 100352
    s_add_u32 s53, s52, 729088
    buffer_load_dwordx4 v185, s[12:15], s53 offen lds
    s_waitcnt lgkmcnt(2)
    v_mfma_f32_32x32x16_bf16 v[32:47], v[156:159], v[144:147], v[32:47]
    ds_read_b64_tr_b16 v[136:137], v180 offset:49152
    ds_read_b64_tr_b16 v[138:139], v180 offset:50176
    v_mfma_f32_32x32x16_bf16 v[48:63], v[156:159], v[148:151], v[48:63]
    ds_read_b64_tr_b16 v[140:141], v181 offset:49152
    ds_read_b64_tr_b16 v[142:143], v181 offset:50176
    s_add_u32 m0, s49, 101376
    s_add_u32 s53, s52, 733184
    buffer_load_dwordx4 v185, s[12:15], s53 offen lds
    s_waitcnt vmcnt(16)
    s_barrier
    s_waitcnt lgkmcnt(2)
    v_mfma_f32_32x32x16_bf16 v[0:15], v[136:139], v[128:131], v[0:15]
    ds_read_b128 v[144:147], v177 offset:49152
    v_mfma_f32_32x32x16_bf16 v[16:31], v[136:139], v[132:135], v[16:31]
    ds_read_b128 v[148:151], v177 offset:53248
    s_add_u32 m0, s49, 32768
    s_add_u32 s45, s49, 196608
    buffer_load_dwordx4 v184, s[8:11], s45 offen offset:0 lds
    s_waitcnt lgkmcnt(2)
    v_mfma_f32_32x32x16_bf16 v[32:47], v[140:143], v[128:131], v[32:47]
    ds_read_b64_tr_b16 v[152:153], v180 offset:53248
    ds_read_b64_tr_b16 v[154:155], v180 offset:54272
    v_mfma_f32_32x32x16_bf16 v[48:63], v[140:143], v[132:135], v[48:63]
    ds_read_b64_tr_b16 v[156:157], v181 offset:53248
    ds_read_b64_tr_b16 v[158:159], v181 offset:54272
    buffer_load_dwordx4 v184, s[8:11], s45 offen offset:1024 lds
    s_waitcnt lgkmcnt(2)
    v_mfma_f32_32x32x16_bf16 v[0:15], v[152:155], v[144:147], v[0:15]
    ds_read_b128 v[128:131], v178 offset:49152
    v_mfma_f32_32x32x16_bf16 v[16:31], v[152:155], v[148:151], v[16:31]
    ds_read_b128 v[132:135], v178 offset:53248
    buffer_load_dwordx4 v184, s[8:11], s45 offen offset:2048 lds
    s_waitcnt lgkmcnt(2)
    v_mfma_f32_32x32x16_bf16 v[32:47], v[156:159], v[144:147], v[32:47]
    ds_read_b64_tr_b16 v[136:137], v180 offset:57344
    ds_read_b64_tr_b16 v[138:139], v180 offset:58368
    v_mfma_f32_32x32x16_bf16 v[48:63], v[156:159], v[148:151], v[48:63]
    ds_read_b64_tr_b16 v[140:141], v181 offset:57344
    ds_read_b64_tr_b16 v[142:143], v181 offset:58368
    buffer_load_dwordx4 v184, s[8:11], s45 offen offset:3072 lds
    s_waitcnt lgkmcnt(2)
    v_mfma_f32_32x32x16_bf16 v[0:15], v[136:139], v[128:131], v[0:15]
    ds_read_b128 v[144:147], v179 offset:49152
    v_mfma_f32_32x32x16_bf16 v[16:31], v[136:139], v[132:135], v[16:31]
    ds_read_b128 v[148:151], v179 offset:53248
    s_add_u32 m0, s49, 114688
    s_add_u32 s53, s52, 786432
    buffer_load_dwordx4 v185, s[12:15], s53 offen lds
    s_waitcnt lgkmcnt(2)
    v_mfma_f32_32x32x16_bf16 v[32:47], v[140:143], v[128:131], v[32:47]
    ds_read_b64_tr_b16 v[152:153], v180 offset:61440
    ds_read_b64_tr_b16 v[154:155], v180 offset:62464
    v_mfma_f32_32x32x16_bf16 v[48:63], v[140:143], v[132:135], v[48:63]
    ds_read_b64_tr_b16 v[156:157], v181 offset:61440
    ds_read_b64_tr_b16 v[158:159], v181 offset:62464
    s_add_u32 m0, s49, 115712
    s_add_u32 s53, s52, 790528
    buffer_load_dwordx4 v185, s[12:15], s53 offen lds
    s_waitcnt lgkmcnt(2)
    v_mfma_f32_32x32x16_bf16 v[0:15], v[152:155], v[144:147], v[0:15]
    ds_read_b128 v[128:131], v216 offset:0
    v_mfma_f32_32x32x16_bf16 v[16:31], v[152:155], v[148:151], v[16:31]
    ds_read_b128 v[132:135], v216 offset:4096
    s_add_u32 m0, s49, 116736
    s_add_u32 s53, s52, 794624
    buffer_load_dwordx4 v185, s[12:15], s53 offen lds
    s_waitcnt lgkmcnt(2)
    v_mfma_f32_32x32x16_bf16 v[32:47], v[156:159], v[144:147], v[32:47]
    ds_read_b64_tr_b16 v[136:137], v220 offset:0
    ds_read_b64_tr_b16 v[138:139], v220 offset:1024
    v_mfma_f32_32x32x16_bf16 v[48:63], v[156:159], v[148:151], v[48:63]
    ds_read_b64_tr_b16 v[140:141], v221 offset:0
    ds_read_b64_tr_b16 v[142:143], v221 offset:1024
    s_add_u32 m0, s49, 117760
    s_add_u32 s53, s52, 798720
    buffer_load_dwordx4 v185, s[12:15], s53 offen lds
    s_waitcnt vmcnt(16)
    s_barrier
    s_waitcnt lgkmcnt(2)
    v_mfma_f32_32x32x16_bf16 v[0:15], v[136:139], v[128:131], v[0:15]
    ds_read_b128 v[144:147], v217 offset:0
    v_mfma_f32_32x32x16_bf16 v[16:31], v[136:139], v[132:135], v[16:31]
    ds_read_b128 v[148:151], v217 offset:4096
    s_add_u32 m0, s49, 49152
    s_add_u32 s45, s49, 212992
    buffer_load_dwordx4 v184, s[8:11], s45 offen offset:0 lds
    s_waitcnt lgkmcnt(2)
    v_mfma_f32_32x32x16_bf16 v[32:47], v[140:143], v[128:131], v[32:47]
    ds_read_b64_tr_b16 v[152:153], v220 offset:4096
    ds_read_b64_tr_b16 v[154:155], v220 offset:5120
    v_mfma_f32_32x32x16_bf16 v[48:63], v[140:143], v[132:135], v[48:63]
    ds_read_b64_tr_b16 v[156:157], v221 offset:4096
    ds_read_b64_tr_b16 v[158:159], v221 offset:5120
    buffer_load_dwordx4 v184, s[8:11], s45 offen offset:1024 lds
    s_waitcnt lgkmcnt(2)
    v_mfma_f32_32x32x16_bf16 v[0:15], v[152:155], v[144:147], v[0:15]
    ds_read_b128 v[128:131], v218 offset:0
    v_mfma_f32_32x32x16_bf16 v[16:31], v[152:155], v[148:151], v[16:31]
    ds_read_b128 v[132:135], v218 offset:4096
    buffer_load_dwordx4 v184, s[8:11], s45 offen offset:2048 lds
    s_waitcnt lgkmcnt(2)
    v_mfma_f32_32x32x16_bf16 v[32:47], v[156:159], v[144:147], v[32:47]
    ds_read_b64_tr_b16 v[136:137], v220 offset:8192
    ds_read_b64_tr_b16 v[138:139], v220 offset:9216
    v_mfma_f32_32x32x16_bf16 v[48:63], v[156:159], v[148:151], v[48:63]
    ds_read_b64_tr_b16 v[140:141], v221 offset:8192
    ds_read_b64_tr_b16 v[142:143], v221 offset:9216
    buffer_load_dwordx4 v184, s[8:11], s45 offen offset:3072 lds
    s_waitcnt lgkmcnt(2)
    v_mfma_f32_32x32x16_bf16 v[0:15], v[136:139], v[128:131], v[0:15]
    ds_read_b128 v[144:147], v219 offset:0
    v_mfma_f32_32x32x16_bf16 v[16:31], v[136:139], v[132:135], v[16:31]
    ds_read_b128 v[148:151], v219 offset:4096
    s_add_u32 m0, s49, 131072
    s_add_u32 s53, s52, 851968
    buffer_load_dwordx4 v185, s[12:15], s53 offen lds
    s_waitcnt lgkmcnt(2)
    v_mfma_f32_32x32x16_bf16 v[32:47], v[140:143], v[128:131], v[32:47]
    ds_read_b64_tr_b16 v[152:153], v220 offset:12288
    ds_read_b64_tr_b16 v[154:155], v220 offset:13312
    v_mfma_f32_32x32x16_bf16 v[48:63], v[140:143], v[132:135], v[48:63]
    ds_read_b64_tr_b16 v[156:157], v221 offset:12288
    ds_read_b64_tr_b16 v[158:159], v221 offset:13312
    s_add_u32 m0, s49, 132096
    s_add_u32 s53, s52, 856064
    buffer_load_dwordx4 v185, s[12:15], s53 offen lds
    s_waitcnt lgkmcnt(2)
    v_mfma_f32_32x32x16_bf16 v[0:15], v[152:155], v[144:147], v[0:15]
    ds_read_b128 v[128:131], v176 offset:0
    v_mfma_f32_32x32x16_bf16 v[16:31], v[152:155], v[148:151], v[16:31]
    ds_read_b128 v[132:135], v176 offset:4096
    s_add_u32 m0, s49, 133120
    s_add_u32 s53, s52, 860160
    buffer_load_dwordx4 v185, s[12:15], s53 offen lds
    s_waitcnt lgkmcnt(2)
    v_mfma_f32_32x32x16_bf16 v[32:47], v[156:159], v[144:147], v[32:47]
    ds_read_b64_tr_b16 v[136:137], v180 offset:0
    ds_read_b64_tr_b16 v[138:139], v180 offset:1024
    v_mfma_f32_32x32x16_bf16 v[48:63], v[156:159], v[148:151], v[48:63]
    ds_read_b64_tr_b16 v[140:141], v181 offset:0
    ds_read_b64_tr_b16 v[142:143], v181 offset:1024
    s_add_u32 m0, s49, 134144
    s_add_u32 s53, s52, 864256
    buffer_load_dwordx4 v185, s[12:15], s53 offen lds
    s_waitcnt vmcnt(16)
    s_barrier
    s_waitcnt lgkmcnt(2)
    v_mfma_f32_32x32x16_bf16 v[0:15], v[136:139], v[128:131], v[0:15]
    ds_read_b128 v[144:147], v177 offset:0
    v_mfma_f32_32x32x16_bf16 v[16:31], v[136:139], v[132:135], v[16:31]
    ds_read_b128 v[148:151], v177 offset:4096
    s_add_u32 m0, s49, 65536
    s_add_u32 s45, s49, 229376
    buffer_load_dwordx4 v184, s[8:11], s45 offen offset:0 lds
    s_waitcnt lgkmcnt(2)
    v_mfma_f32_32x32x16_bf16 v[32:47], v[140:143], v[128:131], v[32:47]
    ds_read_b64_tr_b16 v[152:153], v180 offset:4096
    ds_read_b64_tr_b16 v[154:155], v180 offset:5120
    v_mfma_f32_32x32x16_bf16 v[48:63], v[140:143], v[132:135], v[48:63]
    ds_read_b64_tr_b16 v[156:157], v181 offset:4096
    ds_read_b64_tr_b16 v[158:159], v181 offset:5120
    buffer_load_dwordx4 v184, s[8:11], s45 offen offset:1024 lds
    s_waitcnt lgkmcnt(2)
    v_mfma_f32_32x32x16_bf16 v[0:15], v[152:155], v[144:147], v[0:15]
    ds_read_b128 v[128:131], v178 offset:0
    v_mfma_f32_32x32x16_bf16 v[16:31], v[152:155], v[148:151], v[16:31]
    ds_read_b128 v[132:135], v178 offset:4096
    buffer_load_dwordx4 v184, s[8:11], s45 offen offset:2048 lds
    s_waitcnt lgkmcnt(2)
    v_mfma_f32_32x32x16_bf16 v[32:47], v[156:159], v[144:147], v[32:47]
    ds_read_b64_tr_b16 v[136:137], v180 offset:8192
    ds_read_b64_tr_b16 v[138:139], v180 offset:9216
    v_mfma_f32_32x32x16_bf16 v[48:63], v[156:159], v[148:151], v[48:63]
    ds_read_b64_tr_b16 v[140:141], v181 offset:8192
    ds_read_b64_tr_b16 v[142:143], v181 offset:9216
    buffer_load_dwordx4 v184, s[8:11], s45 offen offset:3072 lds
    s_waitcnt lgkmcnt(2)
    v_mfma_f32_32x32x16_bf16 v[0:15], v[136:139], v[128:131], v[0:15]
    ds_read_b128 v[144:147], v179 offset:0
    v_mfma_f32_32x32x16_bf16 v[16:31], v[136:139], v[132:135], v[16:31]
    ds_read_b128 v[148:151], v179 offset:4096
    s_add_u32 m0, s49, 147456
    s_add_u32 s53, s52, 917504
    buffer_load_dwordx4 v185, s[12:15], s53 offen lds
    s_waitcnt lgkmcnt(2)
    v_mfma_f32_32x32x16_bf16 v[32:47], v[140:143], v[128:131], v[32:47]
    ds_read_b64_tr_b16 v[152:153], v180 offset:12288
    ds_read_b64_tr_b16 v[154:155], v180 offset:13312
    v_mfma_f32_32x32x16_bf16 v[48:63], v[140:143], v[132:135], v[48:63]
    ds_read_b64_tr_b16 v[156:157], v181 offset:12288
    ds_read_b64_tr_b16 v[158:159], v181 offset:13312
    s_add_u32 m0, s49, 148480
    s_add_u32 s53, s52, 921600
    buffer_load_dwordx4 v185, s[12:15], s53 offen lds
    s_waitcnt lgkmcnt(2)
    v_mfma_f32_32x32x16_bf16 v[0:15], v[152:155], v[144:147], v[0:15]
    ds_read_b128 v[128:131], v176 offset:16384
    v_mfma_f32_32x32x16_bf16 v[16:31], v[152:155], v[148:151], v[16:31]
    ds_read_b128 v[132:135], v176 offset:20480
    s_add_u32 m0, s49, 149504
    s_add_u32 s53, s52, 925696
    buffer_load_dwordx4 v185, s[12:15], s53 offen lds
    s_waitcnt lgkmcnt(2)
    v_mfma_f32_32x32x16_bf16 v[32:47], v[156:159], v[144:147], v[32:47]
    ds_read_b64_tr_b16 v[136:137], v180 offset:16384
    ds_read_b64_tr_b16 v[138:139], v180 offset:17408
    v_mfma_f32_32x32x16_bf16 v[48:63], v[156:159], v[148:151], v[48:63]
    ds_read_b64_tr_b16 v[140:141], v181 offset:16384
    ds_read_b64_tr_b16 v[142:143], v181 offset:17408
    s_add_u32 m0, s49, 150528
    s_add_u32 s53, s52, 929792
    buffer_load_dwordx4 v185, s[12:15], s53 offen lds
    s_waitcnt vmcnt(16)
    s_barrier
    s_waitcnt lgkmcnt(2)
    v_mfma_f32_32x32x16_bf16 v[0:15], v[136:139], v[128:131], v[0:15]
    ds_read_b128 v[144:147], v177 offset:16384
    v_mfma_f32_32x32x16_bf16 v[16:31], v[136:139], v[132:135], v[16:31]
    ds_read_b128 v[148:151], v177 offset:20480
    s_add_u32 m0, s49, 0
    s_add_u32 s45, s49, 245760
    buffer_load_dwordx4 v184, s[8:11], s45 offen offset:0 lds
    s_waitcnt lgkmcnt(2)
    v_mfma_f32_32x32x16_bf16 v[32:47], v[140:143], v[128:131], v[32:47]
    ds_read_b64_tr_b16 v[152:153], v180 offset:20480
    ds_read_b64_tr_b16 v[154:155], v180 offset:21504
    v_mfma_f32_32x32x16_bf16 v[48:63], v[140:143], v[132:135], v[48:63]
    ds_read_b64_tr_b16 v[156:157], v181 offset:20480
    ds_read_b64_tr_b16 v[158:159], v181 offset:21504
    buffer_load_dwordx4 v184, s[8:11], s45 offen offset:1024 lds
    s_waitcnt lgkmcnt(2)
    v_mfma_f32_32x32x16_bf16 v[0:15], v[152:155], v[144:147], v[0:15]
    ds_read_b128 v[128:131], v178 offset:16384
    v_mfma_f32_32x32x16_bf16 v[16:31], v[152:155], v[148:151], v[16:31]
    ds_read_b128 v[132:135], v178 offset:20480
    buffer_load_dwordx4 v184, s[8:11], s45 offen offset:2048 lds
    s_waitcnt lgkmcnt(2)
    v_mfma_f32_32x32x16_bf16 v[32:47], v[156:159], v[144:147], v[32:47]
    ds_read_b64_tr_b16 v[136:137], v180 offset:24576
    ds_read_b64_tr_b16 v[138:139], v180 offset:25600
    v_mfma_f32_32x32x16_bf16 v[48:63], v[156:159], v[148:151], v[48:63]
    ds_read_b64_tr_b16 v[140:141], v181 offset:24576
    ds_read_b64_tr_b16 v[142:143], v181 offset:25600
    buffer_load_dwordx4 v184, s[8:11], s45 offen offset:3072 lds
    s_waitcnt lgkmcnt(2)
    v_mfma_f32_32x32x16_bf16 v[0:15], v[136:139], v[128:131], v[0:15]
    ds_read_b128 v[144:147], v179 offset:16384
    v_mfma_f32_32x32x16_bf16 v[16:31], v[136:139], v[132:135], v[16:31]
    ds_read_b128 v[148:151], v179 offset:20480
    s_add_u32 m0, s49, 81920
    s_add_u32 s53, s52, 983040
    buffer_load_dwordx4 v185, s[12:15], s53 offen lds
    s_waitcnt lgkmcnt(2)
    v_mfma_f32_32x32x16_bf16 v[32:47], v[140:143], v[128:131], v[32:47]
    ds_read_b64_tr_b16 v[152:153], v180 offset:28672
    ds_read_b64_tr_b16 v[154:155], v180 offset:29696
    v_mfma_f32_32x32x16_bf16 v[48:63], v[140:143], v[132:135], v[48:63]
    ds_read_b64_tr_b16 v[156:157], v181 offset:28672
    ds_read_b64_tr_b16 v[158:159], v181 offset:29696
    s_add_u32 m0, s49, 82944
    s_add_u32 s53, s52, 987136
    buffer_load_dwordx4 v185, s[12:15], s53 offen lds
    s_waitcnt lgkmcnt(2)
    v_mfma_f32_32x32x16_bf16 v[0:15], v[152:155], v[144:147], v[0:15]
    ds_read_b128 v[128:131], v176 offset:32768
    v_mfma_f32_32x32x16_bf16 v[16:31], v[152:155], v[148:151], v[16:31]
    ds_read_b128 v[132:135], v176 offset:36864
    s_add_u32 m0, s49, 83968
    s_add_u32 s53, s52, 991232
    buffer_load_dwordx4 v185, s[12:15], s53 offen lds
    s_waitcnt lgkmcnt(2)
    v_mfma_f32_32x32x16_bf16 v[32:47], v[156:159], v[144:147], v[32:47]
    ds_read_b64_tr_b16 v[136:137], v180 offset:32768
    ds_read_b64_tr_b16 v[138:139], v180 offset:33792
    v_mfma_f32_32x32x16_bf16 v[48:63], v[156:159], v[148:151], v[48:63]
    ds_read_b64_tr_b16 v[140:141], v181 offset:32768
    ds_read_b64_tr_b16 v[142:143], v181 offset:33792
    s_add_u32 m0, s49, 84992
    s_add_u32 s53, s52, 995328
    buffer_load_dwordx4 v185, s[12:15], s53 offen lds
    s_waitcnt vmcnt(16)
    s_barrier
    s_waitcnt lgkmcnt(2)
    v_mfma_f32_32x32x16_bf16 v[0:15], v[136:139], v[128:131], v[0:15]
    ds_read_b128 v[144:147], v177 offset:32768
    v_mfma_f32_32x32x16_bf16 v[16:31], v[136:139], v[132:135], v[16:31]
    ds_read_b128 v[148:151], v177 offset:36864
    s_waitcnt lgkmcnt(2)
    v_mfma_f32_32x32x16_bf16 v[32:47], v[140:143], v[128:131], v[32:47]
    ds_read_b64_tr_b16 v[152:153], v180 offset:36864
    ds_read_b64_tr_b16 v[154:155], v180 offset:37888
    v_mfma_f32_32x32x16_bf16 v[48:63], v[140:143], v[132:135], v[48:63]
    ds_read_b64_tr_b16 v[156:157], v181 offset:36864
    ds_read_b64_tr_b16 v[158:159], v181 offset:37888
    s_waitcnt lgkmcnt(2)
    v_mfma_f32_32x32x16_bf16 v[0:15], v[152:155], v[144:147], v[0:15]
    ds_read_b128 v[128:131], v178 offset:32768
    v_mfma_f32_32x32x16_bf16 v[16:31], v[152:155], v[148:151], v[16:31]
    ds_read_b128 v[132:135], v178 offset:36864
    s_waitcnt lgkmcnt(2)
    v_mfma_f32_32x32x16_bf16 v[32:47], v[156:159], v[144:147], v[32:47]
    ds_read_b64_tr_b16 v[136:137], v180 offset:40960
    ds_read_b64_tr_b16 v[138:139], v180 offset:41984
    v_mfma_f32_32x32x16_bf16 v[48:63], v[156:159], v[148:151], v[48:63]
    ds_read_b64_tr_b16 v[140:141], v181 offset:40960
    ds_read_b64_tr_b16 v[142:143], v181 offset:41984
    s_waitcnt lgkmcnt(2)
    v_mfma_f32_32x32x16_bf16 v[0:15], v[136:139], v[128:131], v[0:15]
    ds_read_b128 v[144:147], v179 offset:32768
    v_mfma_f32_32x32x16_bf16 v[16:31], v[136:139], v[132:135], v[16:31]
    ds_read_b128 v[148:151], v179 offset:36864
    s_waitcnt lgkmcnt(2)
    v_mfma_f32_32x32x16_bf16 v[32:47], v[140:143], v[128:131], v[32:47]
    ds_read_b64_tr_b16 v[152:153], v180 offset:45056
    ds_read_b64_tr_b16 v[154:155], v180 offset:46080
    v_mfma_f32_32x32x16_bf16 v[48:63], v[140:143], v[132:135], v[48:63]
    ds_read_b64_tr_b16 v[156:157], v181 offset:45056
    ds_read_b64_tr_b16 v[158:159], v181 offset:46080
    s_waitcnt lgkmcnt(2)
    v_mfma_f32_32x32x16_bf16 v[0:15], v[152:155], v[144:147], v[0:15]
    ds_read_b128 v[128:131], v176 offset:49152
    v_mfma_f32_32x32x16_bf16 v[16:31], v[152:155], v[148:151], v[16:31]
    ds_read_b128 v[132:135], v176 offset:53248
    s_waitcnt lgkmcnt(2)
    v_mfma_f32_32x32x16_bf16 v[32:47], v[156:159], v[144:147], v[32:47]
    ds_read_b64_tr_b16 v[136:137], v180 offset:49152
    ds_read_b64_tr_b16 v[138:139], v180 offset:50176
    v_mfma_f32_32x32x16_bf16 v[48:63], v[156:159], v[148:151], v[48:63]
    ds_read_b64_tr_b16 v[140:141], v181 offset:49152
    ds_read_b64_tr_b16 v[142:143], v181 offset:50176
    s_waitcnt vmcnt(8)
    s_barrier
    s_waitcnt lgkmcnt(2)
    v_mfma_f32_32x32x16_bf16 v[0:15], v[136:139], v[128:131], v[0:15]
    ds_read_b128 v[144:147], v177 offset:49152
    v_mfma_f32_32x32x16_bf16 v[16:31], v[136:139], v[132:135], v[16:31]
    ds_read_b128 v[148:151], v177 offset:53248
    s_waitcnt lgkmcnt(2)
    v_mfma_f32_32x32x16_bf16 v[32:47], v[140:143], v[128:131], v[32:47]
    ds_read_b64_tr_b16 v[152:153], v180 offset:53248
    ds_read_b64_tr_b16 v[154:155], v180 offset:54272
    v_mfma_f32_32x32x16_bf16 v[48:63], v[140:143], v[132:135], v[48:63]
    ds_read_b64_tr_b16 v[156:157], v181 offset:53248
    ds_read_b64_tr_b16 v[158:159], v181 offset:54272
    s_waitcnt lgkmcnt(2)
    v_mfma_f32_32x32x16_bf16 v[0:15], v[152:155], v[144:147], v[0:15]
    ds_read_b128 v[128:131], v178 offset:49152
    v_mfma_f32_32x32x16_bf16 v[16:31], v[152:155], v[148:151], v[16:31]
    ds_read_b128 v[132:135], v178 offset:53248
    s_waitcnt lgkmcnt(2)
    v_mfma_f32_32x32x16_bf16 v[32:47], v[156:159], v[144:147], v[32:47]
    ds_read_b64_tr_b16 v[136:137], v180 offset:57344
    ds_read_b64_tr_b16 v[138:139], v180 offset:58368
    v_mfma_f32_32x32x16_bf16 v[48:63], v[156:159], v[148:151], v[48:63]
    ds_read_b64_tr_b16 v[140:141], v181 offset:57344
    ds_read_b64_tr_b16 v[142:143], v181 offset:58368
    s_waitcnt lgkmcnt(2)
    v_mfma_f32_32x32x16_bf16 v[0:15], v[136:139], v[128:131], v[0:15]
    ds_read_b128 v[144:147], v179 offset:49152
    v_mfma_f32_32x32x16_bf16 v[16:31], v[136:139], v[132:135], v[16:31]
    ds_read_b128 v[148:151], v179 offset:53248
    s_waitcnt lgkmcnt(2)
    v_mfma_f32_32x32x16_bf16 v[32:47], v[140:143], v[128:131], v[32:47]
    ds_read_b64_tr_b16 v[152:153], v180 offset:61440
    ds_read_b64_tr_b16 v[154:155], v180 offset:62464
    v_mfma_f32_32x32x16_bf16 v[48:63], v[140:143], v[132:135], v[48:63]
    ds_read_b64_tr_b16 v[156:157], v181 offset:61440
    ds_read_b64_tr_b16 v[158:159], v181 offset:62464
    s_waitcnt lgkmcnt(2)
    v_mfma_f32_32x32x16_bf16 v[0:15], v[152:155], v[144:147], v[0:15]
    ds_read_b128 v[128:131], v216 offset:0
    v_mfma_f32_32x32x16_bf16 v[16:31], v[152:155], v[148:151], v[16:31]
    ds_read_b128 v[132:135], v216 offset:4096
    s_waitcnt lgkmcnt(2)
    v_mfma_f32_32x32x16_bf16 v[32:47], v[156:159], v[144:147], v[32:47]
    ds_read_b64_tr_b16 v[136:137], v220 offset:0
    ds_read_b64_tr_b16 v[138:139], v220 offset:1024
    v_mfma_f32_32x32x16_bf16 v[48:63], v[156:159], v[148:151], v[48:63]
    ds_read_b64_tr_b16 v[140:141], v221 offset:0
    ds_read_b64_tr_b16 v[142:143], v221 offset:1024
    s_waitcnt vmcnt(0)
    s_barrier
    s_waitcnt lgkmcnt(2)
    v_mfma_f32_32x32x16_bf16 v[0:15], v[136:139], v[128:131], v[0:15]
    ds_read_b128 v[144:147], v217 offset:0
    v_mfma_f32_32x32x16_bf16 v[16:31], v[136:139], v[132:135], v[16:31]
    ds_read_b128 v[148:151], v217 offset:4096
    s_waitcnt lgkmcnt(2)
    v_mfma_f32_32x32x16_bf16 v[32:47], v[140:143], v[128:131], v[32:47]
    ds_read_b64_tr_b16 v[152:153], v220 offset:4096
    ds_read_b64_tr_b16 v[154:155], v220 offset:5120
    v_mfma_f32_32x32x16_bf16 v[48:63], v[140:143], v[132:135], v[48:63]
    ds_read_b64_tr_b16 v[156:157], v221 offset:4096
    ds_read_b64_tr_b16 v[158:159], v221 offset:5120
    s_waitcnt lgkmcnt(2)
    v_mfma_f32_32x32x16_bf16 v[0:15], v[152:155], v[144:147], v[0:15]
    ds_read_b128 v[128:131], v218 offset:0
    v_mfma_f32_32x32x16_bf16 v[16:31], v[152:155], v[148:151], v[16:31]
    ds_read_b128 v[132:135], v218 offset:4096
    s_waitcnt lgkmcnt(2)
    v_mfma_f32_32x32x16_bf16 v[32:47], v[156:159], v[144:147], v[32:47]
    ds_read_b64_tr_b16 v[136:137], v220 offset:8192
    ds_read_b64_tr_b16 v[138:139], v220 offset:9216
    v_mfma_f32_32x32x16_bf16 v[48:63], v[156:159], v[148:151], v[48:63]
    ds_read_b64_tr_b16 v[140:141], v221 offset:8192
    ds_read_b64_tr_b16 v[142:143], v221 offset:9216
    s_waitcnt lgkmcnt(2)
    v_mfma_f32_32x32x16_bf16 v[0:15], v[136:139], v[128:131], v[0:15]
    ds_read_b128 v[144:147], v219 offset:0
    v_mfma_f32_32x32x16_bf16 v[16:31], v[136:139], v[132:135], v[16:31]
    ds_read_b128 v[148:151], v219 offset:4096
    s_waitcnt lgkmcnt(2)
    v_mfma_f32_32x32x16_bf16 v[32:47], v[140:143], v[128:131], v[32:47]
    ds_read_b64_tr_b16 v[152:153], v220 offset:12288
    ds_read_b64_tr_b16 v[154:155], v220 offset:13312
    v_mfma_f32_32x32x16_bf16 v[48:63], v[140:143], v[132:135], v[48:63]
    ds_read_b64_tr_b16 v[156:157], v221 offset:12288
    ds_read_b64_tr_b16 v[158:159], v221 offset:13312
    s_waitcnt lgkmcnt(2)
    v_mfma_f32_32x32x16_bf16 v[0:15], v[152:155], v[144:147], v[0:15]
    ds_read_b128 v[128:131], v176 offset:0
    v_mfma_f32_32x32x16_bf16 v[16:31], v[152:155], v[148:151], v[16:31]
    ds_read_b128 v[132:135], v176 offset:4096
    s_waitcnt lgkmcnt(2)
    v_mfma_f32_32x32x16_bf16 v[32:47], v[156:159], v[144:147], v[32:47]
    ds_read_b64_tr_b16 v[136:137], v180 offset:0
    ds_read_b64_tr_b16 v[138:139], v180 offset:1024
    v_mfma_f32_32x32x16_bf16 v[48:63], v[156:159], v[148:151], v[48:63]
    ds_read_b64_tr_b16 v[140:141], v181 offset:0
    ds_read_b64_tr_b16 v[142:143], v181 offset:1024
    s_waitcnt vmcnt(0)
    s_barrier
    s_waitcnt lgkmcnt(2)
    v_mfma_f32_32x32x16_bf16 v[0:15], v[136:139], v[128:131], v[0:15]
    ds_read_b128 v[144:147], v177 offset:0
    v_mfma_f32_32x32x16_bf16 v[16:31], v[136:139], v[132:135], v[16:31]
    ds_read_b128 v[148:151], v177 offset:4096
    s_waitcnt lgkmcnt(2)
    v_mfma_f32_32x32x16_bf16 v[32:47], v[140:143], v[128:131], v[32:47]
    ds_read_b64_tr_b16 v[152:153], v180 offset:4096
    ds_read_b64_tr_b16 v[154:155], v180 offset:5120
    v_mfma_f32_32x32x16_bf16 v[48:63], v[140:143], v[132:135], v[48:63]
    ds_read_b64_tr_b16 v[156:157], v181 offset:4096
    ds_read_b64_tr_b16 v[158:159], v181 offset:5120
    s_waitcnt lgkmcnt(2)
    v_mfma_f32_32x32x16_bf16 v[0:15], v[152:155], v[144:147], v[0:15]
    ds_read_b128 v[128:131], v178 offset:0
    v_mfma_f32_32x32x16_bf16 v[16:31], v[152:155], v[148:151], v[16:31]
    ds_read_b128 v[132:135], v178 offset:4096
    s_waitcnt lgkmcnt(2)
    v_mfma_f32_32x32x16_bf16 v[32:47], v[156:159], v[144:147], v[32:47]
    ds_read_b64_tr_b16 v[136:137], v180 offset:8192
    ds_read_b64_tr_b16 v[138:139], v180 offset:9216
    v_mfma_f32_32x32x16_bf16 v[48:63], v[156:159], v[148:151], v[48:63]
    ds_read_b64_tr_b16 v[140:141], v181 offset:8192
    ds_read_b64_tr_b16 v[142:143], v181 offset:9216
    s_waitcnt lgkmcnt(2)
    v_mfma_f32_32x32x16_bf16 v[0:15], v[136:139], v[128:131], v[0:15]
    ds_read_b128 v[144:147], v179 offset:0
    v_mfma_f32_32x32x16_bf16 v[16:31], v[136:139], v[132:135], v[16:31]
    ds_read_b128 v[148:151], v179 offset:4096
    s_waitcnt lgkmcnt(2)
    v_mfma_f32_32x32x16_bf16 v[32:47], v[140:143], v[128:131], v[32:47]
    ds_read_b64_tr_b16 v[152:153], v180 offset:12288
    ds_read_b64_tr_b16 v[154:155], v180 offset:13312
    v_mfma_f32_32x32x16_bf16 v[48:63], v[140:143], v[132:135], v[48:63]
    ds_read_b64_tr_b16 v[156:157], v181 offset:12288
    ds_read_b64_tr_b16 v[158:159], v181 offset:13312
    s_waitcnt lgkmcnt(2)
    v_mfma_f32_32x32x16_bf16 v[0:15], v[152:155], v[144:147], v[0:15]
    v_mfma_f32_32x32x16_bf16 v[16:31], v[152:155], v[148:151], v[16:31]
    s_waitcnt lgkmcnt(0)
    v_mfma_f32_32x32x16_bf16 v[32:47], v[156:159], v[144:147], v[32:47]
    v_mfma_f32_32x32x16_bf16 v[48:63], v[156:159], v[148:151], v[48:63]
    s_load_dwordx2 s[30:31], s[0:1], 0
    s_barrier
    v_and_b32 v191, 15, v255
    v_xor_b32 v191, v191, v187
    s_lshl_b32 s6, s51, 3
    v_xor_b32 v191, s6, v191
    s_lshl_b32 s6, s50, 14
    v_xor_b32 v192, 0, v191
    v_lshlrev_b32 v192, 4, v192
    v_lshl_add_u32 v192, v186, 8, v192
    v_add_u32 v194, s6, v192
    v_xor_b32 v192, 2, v191
    v_lshlrev_b32 v192, 4, v192
    v_lshl_add_u32 v192, v186, 8, v192
    v_add_u32 v195, s6, v192
    v_xor_b32 v192, 4, v191
    v_lshlrev_b32 v192, 4, v192
    v_lshl_add_u32 v192, v186, 8, v192
    v_add_u32 v196, s6, v192
    v_xor_b32 v192, 6, v191
    v_lshlrev_b32 v192, 4, v192
    v_lshl_add_u32 v192, v186, 8, v192
    v_add_u32 v197, s6, v192
    v_cvt_pk_bf16_f32 v128, v0, v1
    v_cvt_pk_bf16_f32 v129, v2, v3
    v_cvt_pk_bf16_f32 v130, v4, v5
    v_cvt_pk_bf16_f32 v131, v6, v7
    s_nop 0
    v_permlane32_swap_b32 v128, v130
    v_permlane32_swap_b32 v129, v131
    ds_write_b128 v194, v[128:131] offset:0
    v_cvt_pk_bf16_f32 v132, v8, v9
    v_cvt_pk_bf16_f32 v133, v10, v11
    v_cvt_pk_bf16_f32 v134, v12, v13
    v_cvt_pk_bf16_f32 v135, v14, v15
    s_nop 0
    v_permlane32_swap_b32 v132, v134
    v_permlane32_swap_b32 v133, v135
    ds_write_b128 v195, v[132:135] offset:0
    v_cvt_pk_bf16_f32 v136, v16, v17
    v_cvt_pk_bf16_f32 v137, v18, v19
    v_cvt_pk_bf16_f32 v138, v20, v21
    v_cvt_pk_bf16_f32 v139, v22, v23
    s_nop 0
    v_permlane32_swap_b32 v136, v138
    v_permlane32_swap_b32 v137, v139
    ds_write_b128 v194, v[136:139] offset:8192
    v_cvt_pk_bf16_f32 v140, v24, v25
    v_cvt_pk_bf16_f32 v141, v26, v27
    v_cvt_pk_bf16_f32 v142, v28, v29
    v_cvt_pk_bf16_f32 v143, v30, v31
    s_nop 0
    v_permlane32_swap_b32 v140, v142
    v_permlane32_swap_b32 v141, v143
    ds_write_b128 v195, v[140:143] offset:8192
    v_cvt_pk_bf16_f32 v144, v32, v33
    v_cvt_pk_bf16_f32 v145, v34, v35
    v_cvt_pk_bf16_f32 v146, v36, v37
    v_cvt_pk_bf16_f32 v147, v38, v39
    s_nop 0
    v_permlane32_swap_b32 v144, v146
    v_permlane32_swap_b32 v145, v147
    ds_write_b128 v196, v[144:147] offset:0
    v_cvt_pk_bf16_f32 v148, v40, v41
    v_cvt_pk_bf16_f32 v149, v42, v43
    v_cvt_pk_bf16_f32 v150, v44, v45
    v_cvt_pk_bf16_f32 v151, v46, v47
    s_nop 0
    v_permlane32_swap_b32 v148, v150
    v_permlane32_swap_b32 v149, v151
    ds_write_b128 v197, v[148:151] offset:0
    v_cvt_pk_bf16_f32 v152, v48, v49
    v_cvt_pk_bf16_f32 v153, v50, v51
    v_cvt_pk_bf16_f32 v154, v52, v53
    v_cvt_pk_bf16_f32 v155, v54, v55
    s_nop 0
    v_permlane32_swap_b32 v152, v154
    v_permlane32_swap_b32 v153, v155
    ds_write_b128 v196, v[152:155] offset:8192
    v_cvt_pk_bf16_f32 v156, v56, v57
    v_cvt_pk_bf16_f32 v157, v58, v59
    v_cvt_pk_bf16_f32 v158, v60, v61
    v_cvt_pk_bf16_f32 v159, v62, v63
    s_nop 0
    v_permlane32_swap_b32 v156, v158
    v_permlane32_swap_b32 v157, v159
    ds_write_b128 v197, v[156:159] offset:8192
    s_waitcnt lgkmcnt(0)
    s_barrier
    v_lshrrev_b32 v191, 4, v255
    v_and_b32 v192, 15, v255
    s_lshl_b32 s6, s3, 13
    v_add_u32 v193, 0, v191
    v_xor_b32 v193, v193, v192
    v_lshlrev_b32 v193, 4, v193
    v_lshl_add_u32 v193, v191, 8, v193
    v_add_u32 v194, s6, v193
    v_add_u32 v193, 4, v191
    v_xor_b32 v193, v193, v192
    v_lshlrev_b32 v193, 4, v193
    v_lshl_add_u32 v193, v191, 8, v193
    v_add_u32 v195, s6, v193
    v_add_u32 v193, 8, v191
    v_xor_b32 v193, v193, v192
    v_lshlrev_b32 v193, 4, v193
    v_lshl_add_u32 v193, v191, 8, v193
    v_add_u32 v196, s6, v193
    v_add_u32 v193, 12, v191
    v_xor_b32 v193, v193, v192
    v_lshlrev_b32 v193, 4, v193
    v_lshl_add_u32 v193, v191, 8, v193
    v_add_u32 v197, s6, v193
    ds_read_b128 v[0:3], v194 offset:0
    ds_read_b128 v[4:7], v195 offset:1024
    ds_read_b128 v[8:11], v196 offset:2048
    ds_read_b128 v[12:15], v197 offset:3072
    ds_read_b128 v[16:19], v194 offset:4096
    ds_read_b128 v[20:23], v195 offset:5120
    ds_read_b128 v[24:27], v196 offset:6144
    ds_read_b128 v[28:31], v197 offset:7168
    s_add_u32 s7, s6, 0
    s_waitcnt lgkmcnt(7)
    buffer_store_dwordx4 v[0:3], v184, s[24:27], s7 offen sc0 sc1
    s_add_u32 s7, s6, 1024
    s_waitcnt lgkmcnt(6)
    buffer_store_dwordx4 v[4:7], v184, s[24:27], s7 offen sc0 sc1
    s_add_u32 s7, s6, 2048
    s_waitcnt lgkmcnt(5)
    buffer_store_dwordx4 v[8:11], v184, s[24:27], s7 offen sc0 sc1
    s_add_u32 s7, s6, 3072
    s_waitcnt lgkmcnt(4)
    buffer_store_dwordx4 v[12:15], v184, s[24:27], s7 offen sc0 sc1
    s_add_u32 s7, s6, 4096
    s_waitcnt lgkmcnt(3)
    buffer_store_dwordx4 v[16:19], v184, s[24:27], s7 offen sc0 sc1
    s_add_u32 s7, s6, 5120
    s_waitcnt lgkmcnt(2)
    buffer_store_dwordx4 v[20:23], v184, s[24:27], s7 offen sc0 sc1
    s_add_u32 s7, s6, 6144
    s_waitcnt lgkmcnt(1)
    buffer_store_dwordx4 v[24:27], v184, s[24:27], s7 offen sc0 sc1
    s_add_u32 s7, s6, 7168
    s_waitcnt lgkmcnt(0)
    buffer_store_dwordx4 v[28:31], v184, s[24:27], s7 offen sc0 sc1
    s_lshl_b32 s4, s85, 8
    s_lshl_b32 s5, s84, 3
    s_add_u32 s4, s4, s5
    s_lshr_b32 s86, s4, 7
    s_lshl_b32 s86, s86, 7
    s_add_u32 s86, s86, 4096
    s_lshl_b32 s5, s3, 1
    s_add_u32 s4, s4, s5
    s_waitcnt lgkmcnt(0)
    v_lshlrev_b32 v3, 4, v255
    v_lshlrev_b32 v2, 5, v255
    s_mov_b32 s12, s30
    s_mov_b32 s13, s31
    s_mov_b32 s14, 0x200000
    s_mov_b32 s15, 0x00020000
    s_mov_b32 s16, s34
    s_mov_b32 s17, s35
    s_mov_b32 s18, 0x3000
    s_mov_b32 s19, 0x00020000
    s_add_u32 s20, s34, 0x1600000
    s_addc_u32 s21, s35, 0
    s_mov_b32 s22, 0x200000
    s_mov_b32 s23, 0x00020000
    s_add_u32 s24, s34, 0x1400000
    s_addc_u32 s25, s35, 0
    s_mov_b32 s26, 0x200000
    s_mov_b32 s27, 0x00020000
    s_add_u32 s8, s34, 0x2000000
    s_addc_u32 s9, s35, 0
    s_mov_b32 s10, 0x800000
    s_mov_b32 s11, 0x00020000
    v_lshrrev_b32 v22, 4, v255
    v_and_b32 v23, 15, v255
    v_lshlrev_b32 v23, 4, v23
    v_lshl_add_u32 v22, v22, 15, v23
    s_waitcnt vmcnt(0) lgkmcnt(0)
    s_barrier
    s_cmp_lg_u32 s3, 0
    s_cbranch_scc1 attn_sig20
    v_mov_b32 v250, 1
    v_mov_b32 v251, 0
    v_cmp_eq_u32 vcc, 0, v255
    s_nop 0
    s_and_saveexec_b64 s[58:59], vcc
    buffer_atomic_add v250, v251, s[80:83], s87 offen sc1
    s_mov_b64 exec, s[58:59]
attn_sig20:
    s_add_u32 s5, s4, 0
    s_lshl_b32 s6, s5, 10
    buffer_load_dwordx4 v[80:83], v3, s[12:15], s6 offen
    s_add_u32 s5, s4, 1
    s_lshl_b32 s6, s5, 10
    buffer_load_dwordx4 v[120:123], v3, s[12:15], s6 offen
    s_mov_b32 s7, 4096
    buffer_load_dwordx4 v[40:43], v2, s[16:19], s7 offen
    buffer_load_dwordx4 v[44:47], v2, s[16:19], s7 offen offset:16
    s_mov_b32 s7, 8192
    buffer_load_dwordx4 v[24:27], v2, s[16:19], s7 offen
    buffer_load_dwordx4 v[28:31], v2, s[16:19], s7 offen offset:16
    s_mov_b32 s7, 6144
    buffer_load_dwordx4 v[32:35], v2, s[16:19], s7 offen
    buffer_load_dwordx4 v[36:39], v2, s[16:19], s7 offen offset:16
    s_waitcnt vmcnt(3)
    v_add_f32 v24, 1.0, v24
    v_add_f32 v25, 1.0, v25
    v_add_f32 v26, 1.0, v26
    v_add_f32 v27, 1.0, v27
    s_waitcnt vmcnt(2)
    v_add_f32 v28, 1.0, v28
    v_add_f32 v29, 1.0, v29
    v_add_f32 v30, 1.0, v30
    v_add_f32 v31, 1.0, v31
    v_and_b32 v60, 7, v255
    v_lshrrev_b32 v61, 3, v255
    s_cmp_lg_u32 s3, 0
    s_cbranch_scc1 attn_wd22
    v_mov_b32 v251, 0
    s_mov_b32 s57, 0
attn_wt21:
    buffer_load_dword v250, v251, s[80:83], s86 offen sc0 sc1
    s_waitcnt vmcnt(0)
    v_readfirstlane_b32 s58, v250
    s_nop 0
    s_cmp_ge_u32 s58, 16
    s_cbranch_scc1 attn_wd22
    s_sleep 1
    s_add_u32 s57, s57, 1
    s_cmp_lt_u32 s57, 0x40000
    s_cbranch_scc1 attn_wt21
attn_wd22:
    s_barrier
    s_load_dwordx4 s[28:31], s[0:1], 48
    s_add_u32 s5, s4, 0
    s_lshr_b32 s6, s5, 7
    s_lshl_b32 s6, s6, 17
    s_and_b32 s7, s5, 127
    s_lshl_b32 s7, s7, 8
    s_add_u32 s6, s6, s7
    s_add_u32 s7, s6, 0
    buffer_load_dwordx4 v[64:67], v22, s[8:11], s7 offen
    s_add_u32 s7, s6, 2097152
    buffer_load_dwordx4 v[68:71], v22, s[8:11], s7 offen
    s_add_u32 s7, s6, 4194304
    buffer_load_dwordx4 v[72:75], v22, s[8:11], s7 offen
    s_add_u32 s7, s6, 6291456
    buffer_load_dwordx4 v[76:79], v22, s[8:11], s7 offen
    s_add_u32 s5, s4, 1
    s_lshr_b32 s6, s5, 7
    s_lshl_b32 s6, s6, 17
    s_and_b32 s7, s5, 127
    s_lshl_b32 s7, s7, 8
    s_add_u32 s6, s6, s7
    s_add_u32 s7, s6, 0
    buffer_load_dwordx4 v[104:107], v22, s[8:11], s7 offen
    s_add_u32 s7, s6, 2097152
    buffer_load_dwordx4 v[108:111], v22, s[8:11], s7 offen
    s_add_u32 s7, s6, 4194304
    buffer_load_dwordx4 v[112:115], v22, s[8:11], s7 offen
    s_add_u32 s7, s6, 6291456
    buffer_load_dwordx4 v[116:119], v22, s[8:11], s7 offen
    s_waitcnt vmcnt(7)
    v_lshlrev_b32 v84, 16, v64
    s_waitcnt vmcnt(3)
    v_lshlrev_b32 v124, 16, v104
    v_and_b32 v85, 0xffff0000, v64
    v_and_b32 v125, 0xffff0000, v104
    v_lshlrev_b32 v86, 16, v65
    v_lshlrev_b32 v126, 16, v105
    v_and_b32 v87, 0xffff0000, v65
    v_and_b32 v127, 0xffff0000, v105
    v_lshlrev_b32 v88, 16, v66
    v_lshlrev_b32 v128, 16, v106
    v_and_b32 v89, 0xffff0000, v66
    v_and_b32 v129, 0xffff0000, v106
    v_lshlrev_b32 v90, 16, v67
    v_lshlrev_b32 v130, 16, v107
    v_and_b32 v91, 0xffff0000, v67
    v_and_b32 v131, 0xffff0000, v107
    v_lshlrev_b32 v92, 16, v68
    s_waitcnt vmcnt(2)
    v_lshlrev_b32 v132, 16, v108
    v_and_b32 v93, 0xffff0000, v68
    v_and_b32 v133, 0xffff0000, v108
    v_add_f32 v84, v84, v92
    v_add_f32 v124, v124, v132
    v_add_f32 v85, v85, v93
    v_add_f32 v125, v125, v133
    v_lshlrev_b32 v92, 16, v69
    v_lshlrev_b32 v132, 16, v109
    v_and_b32 v93, 0xffff0000, v69
    v_and_b32 v133, 0xffff0000, v109
    v_add_f32 v86, v86, v92
    v_add_f32 v126, v126, v132
    v_add_f32 v87, v87, v93
    v_add_f32 v127, v127, v133
    v_lshlrev_b32 v92, 16, v70
    v_lshlrev_b32 v132, 16, v110
    v_and_b32 v93, 0xffff0000, v70
    v_and_b32 v133, 0xffff0000, v110
    v_add_f32 v88, v88, v92
    v_add_f32 v128, v128, v132
    v_add_f32 v89, v89, v93
    v_add_f32 v129, v129, v133
    v_lshlrev_b32 v92, 16, v71
    v_lshlrev_b32 v132, 16, v111
    v_and_b32 v93, 0xffff0000, v71
    v_and_b32 v133, 0xffff0000, v111
    v_add_f32 v90, v90, v92
    v_add_f32 v130, v130, v132
    v_add_f32 v91, v91, v93
    v_add_f32 v131, v131, v133
    v_lshlrev_b32 v92, 16, v72
    s_waitcnt vmcnt(1)
    v_lshlrev_b32 v132, 16, v112
    v_and_b32 v93, 0xffff0000, v72
    v_and_b32 v133, 0xffff0000, v112
    v_add_f32 v84, v84, v92
    v_add_f32 v124, v124, v132
    v_add_f32 v85, v85, v93
    v_add_f32 v125, v125, v133
    v_lshlrev_b32 v92, 16, v73
    v_lshlrev_b32 v132, 16, v113
    v_and_b32 v93, 0xffff0000, v73
    v_and_b32 v133, 0xffff0000, v113
    v_add_f32 v86, v86, v92
    v_add_f32 v126, v126, v132
    v_add_f32 v87, v87, v93
    v_add_f32 v127, v127, v133
    v_lshlrev_b32 v92, 16, v74
    v_lshlrev_b32 v132, 16, v114
    v_and_b32 v93, 0xffff0000, v74
    v_and_b32 v133, 0xffff0000, v114
    v_add_f32 v88, v88, v92
    v_add_f32 v128, v128, v132
    v_add_f32 v89, v89, v93
    v_add_f32 v129, v129, v133
    v_lshlrev_b32 v92, 16, v75
    v_lshlrev_b32 v132, 16, v115
    v_and_b32 v93, 0xffff0000, v75
    v_and_b32 v133, 0xffff0000, v115
    v_add_f32 v90, v90, v92
    v_add_f32 v130, v130, v132
    v_add_f32 v91, v91, v93
    v_add_f32 v131, v131, v133
    v_lshlrev_b32 v92, 16, v76
    s_waitcnt vmcnt(0)
    v_lshlrev_b32 v132, 16, v116
    v_and_b32 v93, 0xffff0000, v76
    v_and_b32 v133, 0xffff0000, v116
    v_add_f32 v84, v84, v92
    v_add_f32 v124, v124, v132
    v_add_f32 v85, v85, v93
    v_add_f32 v125, v125, v133
    v_lshlrev_b32 v92, 16, v77
    v_lshlrev_b32 v132, 16, v117
    v_and_b32 v93, 0xffff0000, v77
    v_and_b32 v133, 0xffff0000, v117
    v_add_f32 v86, v86, v92
    v_add_f32 v126, v126, v132
    v_add_f32 v87, v87, v93
    v_add_f32 v127, v127, v133
    v_lshlrev_b32 v92, 16, v78
    v_lshlrev_b32 v132, 16, v118
    v_and_b32 v93, 0xffff0000, v78
    v_and_b32 v133, 0xffff0000, v118
    v_add_f32 v88, v88, v92
    v_add_f32 v128, v128, v132
    v_add_f32 v89, v89, v93
    v_add_f32 v129, v129, v133
    v_lshlrev_b32 v92, 16, v79
    v_lshlrev_b32 v132, 16, v119
    v_and_b32 v93, 0xffff0000, v79
    v_and_b32 v133, 0xffff0000, v119
    v_add_f32 v90, v90, v92
    v_add_f32 v130, v130, v132
    v_add_f32 v91, v91, v93
    v_add_f32 v131, v131, v133
    v_lshlrev_b32 v92, 16, v80
    v_lshlrev_b32 v132, 16, v120
    v_and_b32 v93, 0xffff0000, v80
    v_and_b32 v133, 0xffff0000, v120
    v_fma_f32 v84, v84, v40, v92
    v_fma_f32 v124, v124, v40, v132
    v_fma_f32 v85, v85, v41, v93
    v_fma_f32 v125, v125, v41, v133
    v_cvt_pk_bf16_f32 v96, v84, v85
    v_cvt_pk_bf16_f32 v136, v124, v125
    v_lshlrev_b32 v84, 16, v96
    v_lshlrev_b32 v124, 16, v136
    v_and_b32 v85, 0xffff0000, v96
    v_and_b32 v125, 0xffff0000, v136
    v_lshlrev_b32 v92, 16, v81
    v_lshlrev_b32 v132, 16, v121
    v_and_b32 v93, 0xffff0000, v81
    v_and_b32 v133, 0xffff0000, v121
    v_fma_f32 v86, v86, v42, v92
    v_fma_f32 v126, v126, v42, v132
    v_fma_f32 v87, v87, v43, v93
    v_fma_f32 v127, v127, v43, v133
    v_cvt_pk_bf16_f32 v97, v86, v87
    v_cvt_pk_bf16_f32 v137, v126, v127
    v_lshlrev_b32 v86, 16, v97
    v_lshlrev_b32 v126, 16, v137
    v_and_b32 v87, 0xffff0000, v97
    v_and_b32 v127, 0xffff0000, v137
    v_lshlrev_b32 v92, 16, v82
    v_lshlrev_b32 v132, 16, v122
    v_and_b32 v93, 0xffff0000, v82
    v_and_b32 v133, 0xffff0000, v122
    v_fma_f32 v88, v88, v44, v92
    v_fma_f32 v128, v128, v44, v132
    v_fma_f32 v89, v89, v45, v93
    v_fma_f32 v129, v129, v45, v133
    v_cvt_pk_bf16_f32 v98, v88, v89
    v_cvt_pk_bf16_f32 v138, v128, v129
    v_lshlrev_b32 v88, 16, v98
    v_lshlrev_b32 v128, 16, v138
    v_and_b32 v89, 0xffff0000, v98
    v_and_b32 v129, 0xffff0000, v138
    v_lshlrev_b32 v92, 16, v83
    v_lshlrev_b32 v132, 16, v123
    v_and_b32 v93, 0xffff0000, v83
    v_and_b32 v133, 0xffff0000, v123
    v_fma_f32 v90, v90, v46, v92
    v_fma_f32 v130, v130, v46, v132
    v_fma_f32 v91, v91, v47, v93
    v_fma_f32 v131, v131, v47, v133
    v_cvt_pk_bf16_f32 v99, v90, v91
    v_cvt_pk_bf16_f32 v139, v130, v131
    v_lshlrev_b32 v90, 16, v99
    v_lshlrev_b32 v130, 16, v139
    v_and_b32 v91, 0xffff0000, v99
    v_and_b32 v131, 0xffff0000, v139
    s_add_u32 s36, s4, 0
    s_add_u32 s37, s4, 1
    s_lshl_b32 s38, s36, 10
    s_lshl_b32 s39, s37, 10
    buffer_store_dwordx4 v[96:99], v3, s[24:27], s38 offen sc0 sc1
    buffer_store_dwordx4 v[136:139], v3, s[24:27], s39 offen sc0 sc1
    v_add_f32 v94, v84, v85
    v_add_f32 v134, v124, v125
    v_add_f32 v92, v86, v87
    v_add_f32 v132, v126, v127
    v_add_f32 v93, v88, v89
    v_add_f32 v133, v128, v129
    v_add_f32 v95, v90, v91
    v_add_f32 v135, v130, v131
    v_add_f32 v94, v94, v92
    v_add_f32 v134, v134, v132
    v_add_f32 v93, v93, v95
    v_add_f32 v133, v133, v135
    v_add_f32 v94, v94, v93
    v_add_f32 v134, v134, v133
    s_nop 0
    v_add_f32_dpp v94, v94, v94 quad_perm:[1,0,3,2] row_mask:0xf bank_mask:0xf
    v_add_f32_dpp v134, v134, v134 quad_perm:[1,0,3,2] row_mask:0xf bank_mask:0xf
    s_nop 0
    v_add_f32_dpp v94, v94, v94 quad_perm:[2,3,0,1] row_mask:0xf bank_mask:0xf
    v_add_f32_dpp v134, v134, v134 quad_perm:[2,3,0,1] row_mask:0xf bank_mask:0xf
    s_nop 0
    v_add_f32_dpp v94, v94, v94 row_half_mirror row_mask:0xf bank_mask:0xf
    v_add_f32_dpp v134, v134, v134 row_half_mirror row_mask:0xf bank_mask:0xf
    s_nop 0
    v_add_f32_dpp v94, v94, v94 row_mirror row_mask:0xf bank_mask:0xf
    v_add_f32_dpp v134, v134, v134 row_mirror row_mask:0xf bank_mask:0xf
    v_mov_b32 v92, v94
    v_mov_b32 v132, v134
    s_nop 0
    v_permlane16_swap_b32 v94, v92
    v_permlane16_swap_b32 v134, v132
    v_add_f32 v94, v94, v92
    v_add_f32 v134, v134, v132
    v_mov_b32 v92, v94
    v_mov_b32 v132, v134
    s_nop 0
    v_permlane32_swap_b32 v94, v92
    v_permlane32_swap_b32 v134, v132
    v_add_f32 v94, v94, v92
    v_add_f32 v134, v134, v132
    v_mul_f32 v94, 0x3b000000, v94
    v_mul_f32 v134, 0x3b000000, v134
    v_sub_f32 v84, v84, v94
    v_sub_f32 v124, v124, v134
    v_sub_f32 v85, v85, v94
    v_sub_f32 v125, v125, v134
    v_sub_f32 v86, v86, v94
    v_sub_f32 v126, v126, v134
    v_sub_f32 v87, v87, v94
    v_sub_f32 v127, v127, v134
    v_sub_f32 v88, v88, v94
    v_sub_f32 v128, v128, v134
    v_sub_f32 v89, v89, v94
    v_sub_f32 v129, v129, v134
    v_sub_f32 v90, v90, v94
    v_sub_f32 v130, v130, v134
    v_sub_f32 v91, v91, v94
    v_sub_f32 v131, v131, v134
    v_mul_f32 v95, v84, v84
    v_mul_f32 v135, v124, v124
    v_mul_f32 v93, v85, v85
    v_mul_f32 v133, v125, v125
    v_fmac_f32 v95, v86, v86
    v_fmac_f32 v135, v126, v126
    v_fmac_f32 v93, v87, v87
    v_fmac_f32 v133, v127, v127
    v_fmac_f32 v95, v88, v88
    v_fmac_f32 v135, v128, v128
    v_fmac_f32 v93, v89, v89
    v_fmac_f32 v133, v129, v129
    v_fmac_f32 v95, v90, v90
    v_fmac_f32 v135, v130, v130
    v_fmac_f32 v93, v91, v91
    v_fmac_f32 v133, v131, v131
    v_add_f32 v95, v95, v93
    v_add_f32 v135, v135, v133
    s_nop 0
    v_add_f32_dpp v95, v95, v95 quad_perm:[1,0,3,2] row_mask:0xf bank_mask:0xf
    v_add_f32_dpp v135, v135, v135 quad_perm:[1,0,3,2] row_mask:0xf bank_mask:0xf
    s_nop 0
    v_add_f32_dpp v95, v95, v95 quad_perm:[2,3,0,1] row_mask:0xf bank_mask:0xf
    v_add_f32_dpp v135, v135, v135 quad_perm:[2,3,0,1] row_mask:0xf bank_mask:0xf
    s_nop 0
    v_add_f32_dpp v95, v95, v95 row_half_mirror row_mask:0xf bank_mask:0xf
    v_add_f32_dpp v135, v135, v135 row_half_mirror row_mask:0xf bank_mask:0xf
    s_nop 0
    v_add_f32_dpp v95, v95, v95 row_mirror row_mask:0xf bank_mask:0xf
    v_add_f32_dpp v135, v135, v135 row_mirror row_mask:0xf bank_mask:0xf
    v_mov_b32 v92, v95
    v_mov_b32 v132, v135
    s_nop 0
    v_permlane16_swap_b32 v95, v92
    v_permlane16_swap_b32 v135, v132
    v_add_f32 v95, v95, v92
    v_add_f32 v135, v135, v132
    v_mov_b32 v92, v95
    v_mov_b32 v132, v135
    s_nop 0
    v_permlane32_swap_b32 v95, v92
    v_permlane32_swap_b32 v135, v132
    v_add_f32 v95, v95, v92
    v_add_f32 v135, v135, v132
    v_mov_b32 v92, 0x3727c5ac
    v_mov_b32 v132, 0x3727c5ac
    v_fmac_f32 v92, 0x3b000000, v95
    v_fmac_f32 v132, 0x3b000000, v135
    v_rsq_f32 v95, v92
    v_rsq_f32 v135, v132
    v_mul_f32 v84, v84, v95
    v_mul_f32 v124, v124, v135
    v_fma_f32 v84, v84, v24, v32
    v_fma_f32 v124, v124, v24, v32
    v_mul_f32 v85, v85, v95
    v_mul_f32 v125, v125, v135
    v_fma_f32 v85, v85, v25, v33
    v_fma_f32 v125, v125, v25, v33
    v_mul_f32 v86, v86, v95
    v_mul_f32 v126, v126, v135
    v_fma_f32 v86, v86, v26, v34
    v_fma_f32 v126, v126, v26, v34
    v_mul_f32 v87, v87, v95
    v_mul_f32 v127, v127, v135
    v_fma_f32 v87, v87, v27, v35
    v_fma_f32 v127, v127, v27, v35
    v_mul_f32 v88, v88, v95
    v_mul_f32 v128, v128, v135
    v_fma_f32 v88, v88, v28, v36
    v_fma_f32 v128, v128, v28, v36
    v_mul_f32 v89, v89, v95
    v_mul_f32 v129, v129, v135
    v_fma_f32 v89, v89, v29, v37
    v_fma_f32 v129, v129, v29, v37
    v_mul_f32 v90, v90, v95
    v_mul_f32 v130, v130, v135
    v_fma_f32 v90, v90, v30, v38
    v_fma_f32 v130, v130, v30, v38
    v_mul_f32 v91, v91, v95
    v_mul_f32 v131, v131, v135
    v_fma_f32 v91, v91, v31, v39
    v_fma_f32 v131, v131, v31, v39
    v_cvt_pk_bf16_f32 v64, v84, v85
    v_cvt_pk_bf16_f32 v104, v124, v125
    v_cvt_pk_bf16_f32 v65, v86, v87
    v_cvt_pk_bf16_f32 v105, v126, v127
    v_cvt_pk_bf16_f32 v66, v88, v89
    v_cvt_pk_bf16_f32 v106, v128, v129
    v_cvt_pk_bf16_f32 v67, v90, v91
    v_cvt_pk_bf16_f32 v107, v130, v131
    s_and_b32 s38, s36, 127
    s_and_b32 s39, s37, 127
    s_lshr_b32 s40, s38, 1
    s_lshr_b32 s41, s39, 1
    s_and_b32 s40, s40, 7
    s_and_b32 s41, s41, 7
    v_xor_b32 v93, s40, v60
    v_xor_b32 v133, s41, v60
    v_lshlrev_b32 v93, 4, v93
    v_lshlrev_b32 v133, 4, v133
    v_lshl_add_u32 v93, v61, 14, v93
    v_lshl_add_u32 v133, v61, 14, v133
    s_lshl_b32 s38, s38, 7
    s_lshl_b32 s39, s39, 7
    s_lshr_b32 s40, s36, 7
    s_lshr_b32 s41, s37, 7
    s_lshl_b32 s40, s40, 17
    s_lshl_b32 s41, s41, 17
    s_add_u32 s38, s38, s40
    s_add_u32 s39, s39, s41
    buffer_store_dwordx4 v[64:67], v93, s[20:23], s38 offen sc0 sc1
    buffer_store_dwordx4 v[104:107], v133, s[20:23], s39 offen sc0 sc1
    s_cmp_ge_u32 s84, 28
    s_cbranch_scc1 attn_noffn23
    s_and_b32 s6, s84, 1
    s_lshl_b32 s4, s85, 1
    s_add_u32 s4, s4, s6
    s_lshr_b32 s5, s84, 1
    s_lshl_b32 s87, s4, 7
    s_add_u32 s87, s87, 4096
    s_waitcnt lgkmcnt(0)
    v_and_b32 v186, 31, v255
    v_lshrrev_b32 v187, 5, v255
    v_bfe_u32 v188, v255, 2, 2
    v_bfe_u32 v189, v255, 4, 1
    v_and_b32 v190, 3, v255
    s_lshl_b32 s6, s4, 17
    s_add_u32 s6, s6, 0x1600000
    s_add_u32 s8, s34, s6
    s_addc_u32 s9, s35, 0
    s_mov_b32 s10, 0x20000
    s_mov_b32 s11, 0x00020000
    s_lshl_b32 s6, s5, 8
    s_sub_u32 s7, 1835008, s6
    s_add_u32 s12, s28, s6
    s_addc_u32 s13, s29, 0
    s_mov_b32 s14, s7
    s_mov_b32 s15, 0x00020000
    s_add_u32 s16, s30, s6
    s_addc_u32 s17, s31, 0
    s_mov_b32 s18, s7
    s_mov_b32 s19, 0x00020000
    s_mul_i32 s6, s4, 458752
    s_lshl_b32 s7, s5, 14
    s_add_u32 s6, s6, s7
    s_add_u32 s6, s6, 0x1800000
    s_add_u32 s24, s34, s6
    s_addc_u32 s25, s35, 0
    s_mov_b32 s26, 0x3c000
    s_mov_b32 s27, 0x00020000
    s_and_b32 s50, s3, 1
    s_lshr_b32 s51, s3, 1
    v_lshlrev_b32 v184, 4, v255
    v_lshrrev_b32 v191, 4, v255
    v_lshlrev_b32 v192, 2, v191
    v_and_b32 v185, 15, v255
    v_xor_b32 v185, v185, v192
    v_lshlrev_b32 v185, 4, v185
    v_mul_u32_u24 v191, 3584, v191
    v_add_u32 v185, v185, v191
    s_mul_i32 s52, s3, 57344
    s_lshl_b32 s49, s3, 12
    s_lshl_b32 s6, s50, 13
    v_bfe_u32 v191, v255, 1, 3
    v_xor_b32 v191, v191, v187
    v_lshlrev_b32 v191, 4, v191
    v_lshl_add_u32 v191, v186, 7, v191
    v_add_u32 v191, s6, v191
    v_xor_b32 v176, 0, v191
    v_xor_b32 v177, 32, v191
    v_xor_b32 v178, 64, v191
    v_xor_b32 v179, 96, v191
    v_lshl_add_u32 v191, v187, 3, v188
    v_lshlrev_b32 v191, 8, v191
    v_add_u32 v191, 49152, v191
    v_lshrrev_b32 v192, 1, v190
    v_lshl_add_u32 v192, v189, 1, v192
    v_lshl_add_u32 v191, v192, 4, v191
    v_and_b32 v192, 1, v190
    v_lshl_add_u32 v191, v192, 3, v191
    s_lshl_b32 s6, s51, 1
    v_xor_b32 v192, s6, v188
    v_lshl_add_u32 v180, v192, 6, v191
    v_xor_b32 v192, 1, v192
    v_lshl_add_u32 v181, v192, 6, v191
    v_add_u32 v182, 49152, v180
    v_add_u32 v183, 49152, v181
    s_waitcnt vmcnt(0) lgkmcnt(0)
    s_barrier
    s_cmp_lg_u32 s3, 0
    s_cbranch_scc1 attn_sig25
    v_mov_b32 v250, 1
    v_mov_b32 v251, 0
    v_cmp_eq_u32 vcc, 0, v255
    s_nop 0
    s_and_saveexec_b64 s[58:59], vcc
    buffer_atomic_add v250, v251, s[80:83], s86 offen sc1
    s_mov_b64 exec, s[58:59]
attn_sig25:
    s_add_u32 m0, s49, 49152
    s_add_u32 s53, s52, 0
    buffer_load_dwordx4 v185, s[12:15], s53 offen lds
    s_add_u32 m0, s49, 50176
    s_add_u32 s53, s52, 14336
    buffer_load_dwordx4 v185, s[12:15], s53 offen lds
    s_add_u32 m0, s49, 51200
    s_add_u32 s53, s52, 28672
    buffer_load_dwordx4 v185, s[12:15], s53 offen lds
    s_add_u32 m0, s49, 52224
    s_add_u32 s53, s52, 43008
    buffer_load_dwordx4 v185, s[12:15], s53 offen lds
    s_add_u32 m0, s49, 98304
    s_add_u32 s53, s52, 0
    buffer_load_dwordx4 v185, s[16:19], s53 offen lds
    s_add_u32 m0, s49, 99328
    s_add_u32 s53, s52, 14336
    buffer_load_dwordx4 v185, s[16:19], s53 offen lds
    s_add_u32 m0, s49, 100352
    s_add_u32 s53, s52, 28672
    buffer_load_dwordx4 v185, s[16:19], s53 offen lds
    s_add_u32 m0, s49, 101376
    s_add_u32 s53, s52, 43008
    buffer_load_dwordx4 v185, s[16:19], s53 offen lds
    s_add_u32 m0, s49, 65536
    s_add_u32 s53, s52, 229376
    buffer_load_dwordx4 v185, s[12:15], s53 offen lds
    s_add_u32 m0, s49, 66560
    s_add_u32 s53, s52, 243712
    buffer_load_dwordx4 v185, s[12:15], s53 offen lds
    s_add_u32 m0, s49, 67584
    s_add_u32 s53, s52, 258048
    buffer_load_dwordx4 v185, s[12:15], s53 offen lds
    s_add_u32 m0, s49, 68608
    s_add_u32 s53, s52, 272384
    buffer_load_dwordx4 v185, s[12:15], s53 offen lds
    s_add_u32 m0, s49, 114688
    s_add_u32 s53, s52, 229376
    buffer_load_dwordx4 v185, s[16:19], s53 offen lds
    s_add_u32 m0, s49, 115712
    s_add_u32 s53, s52, 243712
    buffer_load_dwordx4 v185, s[16:19], s53 offen lds
    s_add_u32 m0, s49, 116736
    s_add_u32 s53, s52, 258048
    buffer_load_dwordx4 v185, s[16:19], s53 offen lds
    s_add_u32 m0, s49, 117760
    s_add_u32 s53, s52, 272384
    buffer_load_dwordx4 v185, s[16:19], s53 offen lds
    s_cmp_lg_u32 s3, 0
    s_cbranch_scc1 attn_wd27
    v_mov_b32 v251, 0
    s_mov_b32 s57, 0
attn_wt26:
    buffer_load_dword v250, v251, s[80:83], s87 offen sc0 sc1
    s_waitcnt vmcnt(0)
    v_readfirstlane_b32 s58, v250
    s_nop 0
    s_cmp_ge_u32 s58, 32
    s_cbranch_scc1 attn_wd27
    s_sleep 1
    s_add_u32 s57, s57, 1
    s_cmp_lt_u32 s57, 0x40000
    s_cbranch_scc1 attn_wt26
attn_wd27:
    s_barrier
    s_add_u32 m0, s49, 0
    s_add_u32 s45, s49, 0
    buffer_load_dwordx4 v184, s[8:11], s45 offen offset:0 lds
    buffer_load_dwordx4 v184, s[8:11], s45 offen offset:1024 lds
    buffer_load_dwordx4 v184, s[8:11], s45 offen offset:2048 lds
    buffer_load_dwordx4 v184, s[8:11], s45 offen offset:3072 lds
    s_add_u32 m0, s49, 16384
    s_add_u32 s45, s49, 16384
    buffer_load_dwordx4 v184, s[8:11], s45 offen offset:0 lds
    buffer_load_dwordx4 v184, s[8:11], s45 offen offset:1024 lds
    buffer_load_dwordx4 v184, s[8:11], s45 offen offset:2048 lds
    buffer_load_dwordx4 v184, s[8:11], s45 offen offset:3072 lds
    s_waitcnt vmcnt(4)
    s_barrier
    ds_read_b128 v[128:131], v176 offset:0
    ds_read_b128 v[132:135], v176 offset:4096
    ds_read_b64_tr_b16 v[136:137], v180 offset:0
    ds_read_b64_tr_b16 v[138:139], v180 offset:1024
    ds_read_b64_tr_b16 v[140:141], v181 offset:0
    ds_read_b64_tr_b16 v[142:143], v181 offset:1024
    ds_read_b64_tr_b16 v[144:145], v182 offset:0
    ds_read_b64_tr_b16 v[146:147], v182 offset:1024
    ds_read_b64_tr_b16 v[148:149], v183 offset:0
    ds_read_b64_tr_b16 v[150:151], v183 offset:1024
    s_waitcnt lgkmcnt(6)
    v_mfma_f32_32x32x16_bf16 v[0:15], v[136:139], v[128:131], 0
    ds_read_b128 v[152:155], v177 offset:0
    v_mfma_f32_32x32x16_bf16 v[16:31], v[136:139], v[132:135], 0
    ds_read_b128 v[156:159], v177 offset:4096
    s_add_u32 m0, s49, 32768
    s_add_u32 s45, s49, 32768
    buffer_load_dwordx4 v184, s[8:11], s45 offen offset:0 lds
    s_waitcnt lgkmcnt(6)
    v_mfma_f32_32x32x16_bf16 v[32:47], v[140:143], v[128:131], 0
    ds_read_b64_tr_b16 v[160:161], v180 offset:4096
    ds_read_b64_tr_b16 v[162:163], v180 offset:5120
    v_mfma_f32_32x32x16_bf16 v[48:63], v[140:143], v[132:135], 0
    ds_read_b64_tr_b16 v[164:165], v181 offset:4096
    ds_read_b64_tr_b16 v[166:167], v181 offset:5120
    buffer_load_dwordx4 v184, s[8:11], s45 offen offset:1024 lds
    s_waitcnt lgkmcnt(8)
    v_mfma_f32_32x32x16_bf16 v[64:79], v[144:147], v[128:131], 0
    ds_read_b64_tr_b16 v[168:169], v182 offset:4096
    ds_read_b64_tr_b16 v[170:171], v182 offset:5120
    v_mfma_f32_32x32x16_bf16 v[80:95], v[144:147], v[132:135], 0
    ds_read_b64_tr_b16 v[172:173], v183 offset:4096
    ds_read_b64_tr_b16 v[174:175], v183 offset:5120
    buffer_load_dwordx4 v184, s[8:11], s45 offen offset:2048 lds
    s_waitcnt lgkmcnt(10)
    v_mfma_f32_32x32x16_bf16 v[96:111], v[148:151], v[128:131], 0
    v_mfma_f32_32x32x16_bf16 v[112:127], v[148:151], v[132:135], 0
    buffer_load_dwordx4 v184, s[8:11], s45 offen offset:3072 lds
    s_waitcnt lgkmcnt(6)
    v_mfma_f32_32x32x16_bf16 v[0:15], v[160:163], v[152:155], v[0:15]
    ds_read_b128 v[128:131], v178 offset:0
    v_mfma_f32_32x32x16_bf16 v[16:31], v[160:163], v[156:159], v[16:31]
    ds_read_b128 v[132:135], v178 offset:4096
    s_add_u32 m0, s49, 81920
    s_add_u32 s53, s52, 458752
    buffer_load_dwordx4 v185, s[12:15], s53 offen lds
    s_waitcnt lgkmcnt(6)
    v_mfma_f32_32x32x16_bf16 v[32:47], v[164:167], v[152:155], v[32:47]
    ds_read_b64_tr_b16 v[136:137], v180 offset:8192
    ds_read_b64_tr_b16 v[138:139], v180 offset:9216
    v_mfma_f32_32x32x16_bf16 v[48:63], v[164:167], v[156:159], v[48:63]
    ds_read_b64_tr_b16 v[140:141], v181 offset:8192
    ds_read_b64_tr_b16 v[142:143], v181 offset:9216
    s_add_u32 m0, s49, 82944
    s_add_u32 s53, s52, 473088
    buffer_load_dwordx4 v185, s[12:15], s53 offen lds
    s_waitcnt lgkmcnt(8)
    v_mfma_f32_32x32x16_bf16 v[64:79], v[168:171], v[152:155], v[64:79]
    ds_read_b64_tr_b16 v[144:145], v182 offset:8192
    ds_read_b64_tr_b16 v[146:147], v182 offset:9216
    v_mfma_f32_32x32x16_bf16 v[80:95], v[168:171], v[156:159], v[80:95]
    ds_read_b64_tr_b16 v[148:149], v183 offset:8192
    ds_read_b64_tr_b16 v[150:151], v183 offset:9216
    s_add_u32 m0, s49, 83968
    s_add_u32 s53, s52, 487424
    buffer_load_dwordx4 v185, s[12:15], s53 offen lds
    s_waitcnt lgkmcnt(10)
    v_mfma_f32_32x32x16_bf16 v[96:111], v[172:175], v[152:155], v[96:111]
    v_mfma_f32_32x32x16_bf16 v[112:127], v[172:175], v[156:159], v[112:127]
    s_add_u32 m0, s49, 84992
    s_add_u32 s53, s52, 501760
    buffer_load_dwordx4 v185, s[12:15], s53 offen lds
    s_waitcnt lgkmcnt(6)
    v_mfma_f32_32x32x16_bf16 v[0:15], v[136:139], v[128:131], v[0:15]
    ds_read_b128 v[152:155], v179 offset:0
    v_mfma_f32_32x32x16_bf16 v[16:31], v[136:139], v[132:135], v[16:31]
    ds_read_b128 v[156:159], v179 offset:4096
    s_add_u32 m0, s49, 131072
    s_add_u32 s53, s52, 458752
    buffer_load_dwordx4 v185, s[16:19], s53 offen lds
    s_waitcnt lgkmcnt(6)
    v_mfma_f32_32x32x16_bf16 v[32:47], v[140:143], v[128:131], v[32:47]
    ds_read_b64_tr_b16 v[160:161], v180 offset:12288
    ds_read_b64_tr_b16 v[162:163], v180 offset:13312
    v_mfma_f32_32x32x16_bf16 v[48:63], v[140:143], v[132:135], v[48:63]
    ds_read_b64_tr_b16 v[164:165], v181 offset:12288
    ds_read_b64_tr_b16 v[166:167], v181 offset:13312
    s_add_u32 m0, s49, 132096
    s_add_u32 s53, s52, 473088
    buffer_load_dwordx4 v185, s[16:19], s53 offen lds
    s_waitcnt lgkmcnt(8)
    v_mfma_f32_32x32x16_bf16 v[64:79], v[144:147], v[128:131], v[64:79]
    ds_read_b64_tr_b16 v[168:169], v182 offset:12288
    ds_read_b64_tr_b16 v[170:171], v182 offset:13312
    v_mfma_f32_32x32x16_bf16 v[80:95], v[144:147], v[132:135], v[80:95]
    ds_read_b64_tr_b16 v[172:173], v183 offset:12288
    ds_read_b64_tr_b16 v[174:175], v183 offset:13312
    s_add_u32 m0, s49, 133120
    s_add_u32 s53, s52, 487424
    buffer_load_dwordx4 v185, s[16:19], s53 offen lds
    s_waitcnt lgkmcnt(10)
    v_mfma_f32_32x32x16_bf16 v[96:111], v[148:151], v[128:131], v[96:111]
    v_mfma_f32_32x32x16_bf16 v[112:127], v[148:151], v[132:135], v[112:127]
    s_add_u32 m0, s49, 134144
    s_add_u32 s53, s52, 501760
    buffer_load_dwordx4 v185, s[16:19], s53 offen lds
    s_waitcnt lgkmcnt(6)
    v_mfma_f32_32x32x16_bf16 v[0:15], v[160:163], v[152:155], v[0:15]
    v_mfma_f32_32x32x16_bf16 v[16:31], v[160:163], v[156:159], v[16:31]
    s_waitcnt lgkmcnt(4)
    v_mfma_f32_32x32x16_bf16 v[32:47], v[164:167], v[152:155], v[32:47]
    v_mfma_f32_32x32x16_bf16 v[48:63], v[164:167], v[156:159], v[48:63]
    s_waitcnt lgkmcnt(2)
    v_mfma_f32_32x32x16_bf16 v[64:79], v[168:171], v[152:155], v[64:79]
    v_mfma_f32_32x32x16_bf16 v[80:95], v[168:171], v[156:159], v[80:95]
    s_waitcnt lgkmcnt(0)
    v_mfma_f32_32x32x16_bf16 v[96:111], v[172:175], v[152:155], v[96:111]
    v_mfma_f32_32x32x16_bf16 v[112:127], v[172:175], v[156:159], v[112:127]
    s_waitcnt vmcnt(12)
    s_barrier
    ds_read_b128 v[128:131], v176 offset:16384
    ds_read_b128 v[132:135], v176 offset:20480
    ds_read_b64_tr_b16 v[136:137], v180 offset:16384
    ds_read_b64_tr_b16 v[138:139], v180 offset:17408
    ds_read_b64_tr_b16 v[140:141], v181 offset:16384
    ds_read_b64_tr_b16 v[142:143], v181 offset:17408
    ds_read_b64_tr_b16 v[144:145], v182 offset:16384
    ds_read_b64_tr_b16 v[146:147], v182 offset:17408
    ds_read_b64_tr_b16 v[148:149], v183 offset:16384
    ds_read_b64_tr_b16 v[150:151], v183 offset:17408
    s_waitcnt lgkmcnt(6)
    v_mfma_f32_32x32x16_bf16 v[0:15], v[136:139], v[128:131], v[0:15]
    ds_read_b128 v[152:155], v177 offset:16384
    v_mfma_f32_32x32x16_bf16 v[16:31], v[136:139], v[132:135], v[16:31]
    ds_read_b128 v[156:159], v177 offset:20480
    s_add_u32 m0, s49, 0
    s_add_u32 s45, s49, 49152
    buffer_load_dwordx4 v184, s[8:11], s45 offen offset:0 lds
    s_waitcnt lgkmcnt(6)
    v_mfma_f32_32x32x16_bf16 v[32:47], v[140:143], v[128:131], v[32:47]
    ds_read_b64_tr_b16 v[160:161], v180 offset:20480
    ds_read_b64_tr_b16 v[162:163], v180 offset:21504
    v_mfma_f32_32x32x16_bf16 v[48:63], v[140:143], v[132:135], v[48:63]
    ds_read_b64_tr_b16 v[164:165], v181 offset:20480
    ds_read_b64_tr_b16 v[166:167], v181 offset:21504
    buffer_load_dwordx4 v184, s[8:11], s45 offen offset:1024 lds
    s_waitcnt lgkmcnt(8)
    v_mfma_f32_32x32x16_bf16 v[64:79], v[144:147], v[128:131], v[64:79]
    ds_read_b64_tr_b16 v[168:169], v182 offset:20480
    ds_read_b64_tr_b16 v[170:171], v182 offset:21504
    v_mfma_f32_32x32x16_bf16 v[80:95], v[144:147], v[132:135], v[80:95]
    ds_read_b64_tr_b16 v[172:173], v183 offset:20480
    ds_read_b64_tr_b16 v[174:175], v183 offset:21504
    buffer_load_dwordx4 v184, s[8:11], s45 offen offset:2048 lds
    s_waitcnt lgkmcnt(10)
    v_mfma_f32_32x32x16_bf16 v[96:111], v[148:151], v[128:131], v[96:111]
    v_mfma_f32_32x32x16_bf16 v[112:127], v[148:151], v[132:135], v[112:127]
    buffer_load_dwordx4 v184, s[8:11], s45 offen offset:3072 lds
    s_waitcnt lgkmcnt(6)
    v_mfma_f32_32x32x16_bf16 v[0:15], v[160:163], v[152:155], v[0:15]
    ds_read_b128 v[128:131], v178 offset:16384
    v_mfma_f32_32x32x16_bf16 v[16:31], v[160:163], v[156:159], v[16:31]
    ds_read_b128 v[132:135], v178 offset:20480
    s_add_u32 m0, s49, 49152
    s_add_u32 s53, s52, 688128
    buffer_load_dwordx4 v185, s[12:15], s53 offen lds
    s_waitcnt lgkmcnt(6)
    v_mfma_f32_32x32x16_bf16 v[32:47], v[164:167], v[152:155], v[32:47]
    ds_read_b64_tr_b16 v[136:137], v180 offset:24576
    ds_read_b64_tr_b16 v[138:139], v180 offset:25600
    v_mfma_f32_32x32x16_bf16 v[48:63], v[164:167], v[156:159], v[48:63]
    ds_read_b64_tr_b16 v[140:141], v181 offset:24576
    ds_read_b64_tr_b16 v[142:143], v181 offset:25600
    s_add_u32 m0, s49, 50176
    s_add_u32 s53, s52, 702464
    buffer_load_dwordx4 v185, s[12:15], s53 offen lds
    s_waitcnt lgkmcnt(8)
    v_mfma_f32_32x32x16_bf16 v[64:79], v[168:171], v[152:155], v[64:79]
    ds_read_b64_tr_b16 v[144:145], v182 offset:24576
    ds_read_b64_tr_b16 v[146:147], v182 offset:25600
    v_mfma_f32_32x32x16_bf16 v[80:95], v[168:171], v[156:159], v[80:95]
    ds_read_b64_tr_b16 v[148:149], v183 offset:24576
    ds_read_b64_tr_b16 v[150:151], v183 offset:25600
    s_add_u32 m0, s49, 51200
    s_add_u32 s53, s52, 716800
    buffer_load_dwordx4 v185, s[12:15], s53 offen lds
    s_waitcnt lgkmcnt(10)
    v_mfma_f32_32x32x16_bf16 v[96:111], v[172:175], v[152:155], v[96:111]
    v_mfma_f32_32x32x16_bf16 v[112:127], v[172:175], v[156:159], v[112:127]
    s_add_u32 m0, s49, 52224
    s_add_u32 s53, s52, 731136
    buffer_load_dwordx4 v185, s[12:15], s53 offen lds
    s_waitcnt lgkmcnt(6)
    v_mfma_f32_32x32x16_bf16 v[0:15], v[136:139], v[128:131], v[0:15]
    ds_read_b128 v[152:155], v179 offset:16384
    v_mfma_f32_32x32x16_bf16 v[16:31], v[136:139], v[132:135], v[16:31]
    ds_read_b128 v[156:159], v179 offset:20480
    s_add_u32 m0, s49, 98304
    s_add_u32 s53, s52, 688128
    buffer_load_dwordx4 v185, s[16:19], s53 offen lds
    s_waitcnt lgkmcnt(6)
    v_mfma_f32_32x32x16_bf16 v[32:47], v[140:143], v[128:131], v[32:47]
    ds_read_b64_tr_b16 v[160:161], v180 offset:28672
    ds_read_b64_tr_b16 v[162:163], v180 offset:29696
    v_mfma_f32_32x32x16_bf16 v[48:63], v[140:143], v[132:135], v[48:63]
    ds_read_b64_tr_b16 v[164:165], v181 offset:28672
    ds_read_b64_tr_b16 v[166:167], v181 offset:29696
    s_add_u32 m0, s49, 99328
    s_add_u32 s53, s52, 702464
    buffer_load_dwordx4 v185, s[16:19], s53 offen lds
    s_waitcnt lgkmcnt(8)
    v_mfma_f32_32x32x16_bf16 v[64:79], v[144:147], v[128:131], v[64:79]
    ds_read_b64_tr_b16 v[168:169], v182 offset:28672
    ds_read_b64_tr_b16 v[170:171], v182 offset:29696
    v_mfma_f32_32x32x16_bf16 v[80:95], v[144:147], v[132:135], v[80:95]
    ds_read_b64_tr_b16 v[172:173], v183 offset:28672
    ds_read_b64_tr_b16 v[174:175], v183 offset:29696
    s_add_u32 m0, s49, 100352
    s_add_u32 s53, s52, 716800
    buffer_load_dwordx4 v185, s[16:19], s53 offen lds
    s_waitcnt lgkmcnt(10)
    v_mfma_f32_32x32x16_bf16 v[96:111], v[148:151], v[128:131], v[96:111]
    v_mfma_f32_32x32x16_bf16 v[112:127], v[148:151], v[132:135], v[112:127]
    s_add_u32 m0, s49, 101376
    s_add_u32 s53, s52, 731136
    buffer_load_dwordx4 v185, s[16:19], s53 offen lds
    s_waitcnt lgkmcnt(6)
    v_mfma_f32_32x32x16_bf16 v[0:15], v[160:163], v[152:155], v[0:15]
    v_mfma_f32_32x32x16_bf16 v[16:31], v[160:163], v[156:159], v[16:31]
    s_waitcnt lgkmcnt(4)
    v_mfma_f32_32x32x16_bf16 v[32:47], v[164:167], v[152:155], v[32:47]
    v_mfma_f32_32x32x16_bf16 v[48:63], v[164:167], v[156:159], v[48:63]
    s_waitcnt lgkmcnt(2)
    v_mfma_f32_32x32x16_bf16 v[64:79], v[168:171], v[152:155], v[64:79]
    v_mfma_f32_32x32x16_bf16 v[80:95], v[168:171], v[156:159], v[80:95]
    s_waitcnt lgkmcnt(0)
    v_mfma_f32_32x32x16_bf16 v[96:111], v[172:175], v[152:155], v[96:111]
    v_mfma_f32_32x32x16_bf16 v[112:127], v[172:175], v[156:159], v[112:127]
    s_waitcnt vmcnt(12)
    s_barrier
    ds_read_b128 v[128:131], v176 offset:32768
    ds_read_b128 v[132:135], v176 offset:36864
    ds_read_b64_tr_b16 v[136:137], v180 offset:32768
    ds_read_b64_tr_b16 v[138:139], v180 offset:33792
    ds_read_b64_tr_b16 v[140:141], v181 offset:32768
    ds_read_b64_tr_b16 v[142:143], v181 offset:33792
    ds_read_b64_tr_b16 v[144:145], v182 offset:32768
    ds_read_b64_tr_b16 v[146:147], v182 offset:33792
    ds_read_b64_tr_b16 v[148:149], v183 offset:32768
    ds_read_b64_tr_b16 v[150:151], v183 offset:33792
    s_waitcnt lgkmcnt(6)
    v_mfma_f32_32x32x16_bf16 v[0:15], v[136:139], v[128:131], v[0:15]
    ds_read_b128 v[152:155], v177 offset:32768
    v_mfma_f32_32x32x16_bf16 v[16:31], v[136:139], v[132:135], v[16:31]
    ds_read_b128 v[156:159], v177 offset:36864
    s_add_u32 m0, s49, 16384
    s_add_u32 s45, s49, 65536
    buffer_load_dwordx4 v184, s[8:11], s45 offen offset:0 lds
    s_waitcnt lgkmcnt(6)
    v_mfma_f32_32x32x16_bf16 v[32:47], v[140:143], v[128:131], v[32:47]
    ds_read_b64_tr_b16 v[160:161], v180 offset:36864
    ds_read_b64_tr_b16 v[162:163], v180 offset:37888
    v_mfma_f32_32x32x16_bf16 v[48:63], v[140:143], v[132:135], v[48:63]
    ds_read_b64_tr_b16 v[164:165], v181 offset:36864
    ds_read_b64_tr_b16 v[166:167], v181 offset:37888
    buffer_load_dwordx4 v184, s[8:11], s45 offen offset:1024 lds
    s_waitcnt lgkmcnt(8)
    v_mfma_f32_32x32x16_bf16 v[64:79], v[144:147], v[128:131], v[64:79]
    ds_read_b64_tr_b16 v[168:169], v182 offset:36864
    ds_read_b64_tr_b16 v[170:171], v182 offset:37888
    v_mfma_f32_32x32x16_bf16 v[80:95], v[144:147], v[132:135], v[80:95]
    ds_read_b64_tr_b16 v[172:173], v183 offset:36864
    ds_read_b64_tr_b16 v[174:175], v183 offset:37888
    buffer_load_dwordx4 v184, s[8:11], s45 offen offset:2048 lds
    s_waitcnt lgkmcnt(10)
    v_mfma_f32_32x32x16_bf16 v[96:111], v[148:151], v[128:131], v[96:111]
    v_mfma_f32_32x32x16_bf16 v[112:127], v[148:151], v[132:135], v[112:127]
    buffer_load_dwordx4 v184, s[8:11], s45 offen offset:3072 lds
    s_waitcnt lgkmcnt(6)
    v_mfma_f32_32x32x16_bf16 v[0:15], v[160:163], v[152:155], v[0:15]
    ds_read_b128 v[128:131], v178 offset:32768
    v_mfma_f32_32x32x16_bf16 v[16:31], v[160:163], v[156:159], v[16:31]
    ds_read_b128 v[132:135], v178 offset:36864
    s_add_u32 m0, s49, 65536
    s_add_u32 s53, s52, 917504
    buffer_load_dwordx4 v185, s[12:15], s53 offen lds
    s_waitcnt lgkmcnt(6)
    v_mfma_f32_32x32x16_bf16 v[32:47], v[164:167], v[152:155], v[32:47]
    ds_read_b64_tr_b16 v[136:137], v180 offset:40960
    ds_read_b64_tr_b16 v[138:139], v180 offset:41984
    v_mfma_f32_32x32x16_bf16 v[48:63], v[164:167], v[156:159], v[48:63]
    ds_read_b64_tr_b16 v[140:141], v181 offset:40960
    ds_read_b64_tr_b16 v[142:143], v181 offset:41984
    s_add_u32 m0, s49, 66560
    s_add_u32 s53, s52, 931840
    buffer_load_dwordx4 v185, s[12:15], s53 offen lds
    s_waitcnt lgkmcnt(8)
    v_mfma_f32_32x32x16_bf16 v[64:79], v[168:171], v[152:155], v[64:79]
    ds_read_b64_tr_b16 v[144:145], v182 offset:40960
    ds_read_b64_tr_b16 v[146:147], v182 offset:41984
    v_mfma_f32_32x32x16_bf16 v[80:95], v[168:171], v[156:159], v[80:95]
    ds_read_b64_tr_b16 v[148:149], v183 offset:40960
    ds_read_b64_tr_b16 v[150:151], v183 offset:41984
    s_add_u32 m0, s49, 67584
    s_add_u32 s53, s52, 946176
    buffer_load_dwordx4 v185, s[12:15], s53 offen lds
    s_waitcnt lgkmcnt(10)
    v_mfma_f32_32x32x16_bf16 v[96:111], v[172:175], v[152:155], v[96:111]
    v_mfma_f32_32x32x16_bf16 v[112:127], v[172:175], v[156:159], v[112:127]
    s_add_u32 m0, s49, 68608
    s_add_u32 s53, s52, 960512
    buffer_load_dwordx4 v185, s[12:15], s53 offen lds
    s_waitcnt lgkmcnt(6)
    v_mfma_f32_32x32x16_bf16 v[0:15], v[136:139], v[128:131], v[0:15]
    ds_read_b128 v[152:155], v179 offset:32768
    v_mfma_f32_32x32x16_bf16 v[16:31], v[136:139], v[132:135], v[16:31]
    ds_read_b128 v[156:159], v179 offset:36864
    s_add_u32 m0, s49, 114688
    s_add_u32 s53, s52, 917504
    buffer_load_dwordx4 v185, s[16:19], s53 offen lds
    s_waitcnt lgkmcnt(6)
    v_mfma_f32_32x32x16_bf16 v[32:47], v[140:143], v[128:131], v[32:47]
    ds_read_b64_tr_b16 v[160:161], v180 offset:45056
    ds_read_b64_tr_b16 v[162:163], v180 offset:46080
    v_mfma_f32_32x32x16_bf16 v[48:63], v[140:143], v[132:135], v[48:63]
    ds_read_b64_tr_b16 v[164:165], v181 offset:45056
    ds_read_b64_tr_b16 v[166:167], v181 offset:46080
    s_add_u32 m0, s49, 115712
    s_add_u32 s53, s52, 931840
    buffer_load_dwordx4 v185, s[16:19], s53 offen lds
    s_waitcnt lgkmcnt(8)
    v_mfma_f32_32x32x16_bf16 v[64:79], v[144:147], v[128:131], v[64:79]
    ds_read_b64_tr_b16 v[168:169], v182 offset:45056
    ds_read_b64_tr_b16 v[170:171], v182 offset:46080
    v_mfma_f32_32x32x16_bf16 v[80:95], v[144:147], v[132:135], v[80:95]
    ds_read_b64_tr_b16 v[172:173], v183 offset:45056
    ds_read_b64_tr_b16 v[174:175], v183 offset:46080
    s_add_u32 m0, s49, 116736
    s_add_u32 s53, s52, 946176
    buffer_load_dwordx4 v185, s[16:19], s53 offen lds
    s_waitcnt lgkmcnt(10)
    v_mfma_f32_32x32x16_bf16 v[96:111], v[148:151], v[128:131], v[96:111]
    v_mfma_f32_32x32x16_bf16 v[112:127], v[148:151], v[132:135], v[112:127]
    s_add_u32 m0, s49, 117760
    s_add_u32 s53, s52, 960512
    buffer_load_dwordx4 v185, s[16:19], s53 offen lds
    s_waitcnt lgkmcnt(6)
    v_mfma_f32_32x32x16_bf16 v[0:15], v[160:163], v[152:155], v[0:15]
    v_mfma_f32_32x32x16_bf16 v[16:31], v[160:163], v[156:159], v[16:31]
    s_waitcnt lgkmcnt(4)
    v_mfma_f32_32x32x16_bf16 v[32:47], v[164:167], v[152:155], v[32:47]
    v_mfma_f32_32x32x16_bf16 v[48:63], v[164:167], v[156:159], v[48:63]
    s_waitcnt lgkmcnt(2)
    v_mfma_f32_32x32x16_bf16 v[64:79], v[168:171], v[152:155], v[64:79]
    v_mfma_f32_32x32x16_bf16 v[80:95], v[168:171], v[156:159], v[80:95]
    s_waitcnt lgkmcnt(0)
    v_mfma_f32_32x32x16_bf16 v[96:111], v[172:175], v[152:155], v[96:111]
    v_mfma_f32_32x32x16_bf16 v[112:127], v[172:175], v[156:159], v[112:127]
    s_waitcnt vmcnt(12)
    s_barrier
    ds_read_b128 v[128:131], v176 offset:0
    ds_read_b128 v[132:135], v176 offset:4096
    ds_read_b64_tr_b16 v[136:137], v180 offset:0
    ds_read_b64_tr_b16 v[138:139], v180 offset:1024
    ds_read_b64_tr_b16 v[140:141], v181 offset:0
    ds_read_b64_tr_b16 v[142:143], v181 offset:1024
    ds_read_b64_tr_b16 v[144:145], v182 offset:0
    ds_read_b64_tr_b16 v[146:147], v182 offset:1024
    ds_read_b64_tr_b16 v[148:149], v183 offset:0
    ds_read_b64_tr_b16 v[150:151], v183 offset:1024
    s_waitcnt lgkmcnt(6)
    v_mfma_f32_32x32x16_bf16 v[0:15], v[136:139], v[128:131], v[0:15]
    ds_read_b128 v[152:155], v177 offset:0
    v_mfma_f32_32x32x16_bf16 v[16:31], v[136:139], v[132:135], v[16:31]
    ds_read_b128 v[156:159], v177 offset:4096
    s_add_u32 m0, s49, 32768
    s_add_u32 s45, s49, 81920
    buffer_load_dwordx4 v184, s[8:11], s45 offen offset:0 lds
    s_waitcnt lgkmcnt(6)
    v_mfma_f32_32x32x16_bf16 v[32:47], v[140:143], v[128:131], v[32:47]
    ds_read_b64_tr_b16 v[160:161], v180 offset:4096
    ds_read_b64_tr_b16 v[162:163], v180 offset:5120
    v_mfma_f32_32x32x16_bf16 v[48:63], v[140:143], v[132:135], v[48:63]
    ds_read_b64_tr_b16 v[164:165], v181 offset:4096
    ds_read_b64_tr_b16 v[166:167], v181 offset:5120
    buffer_load_dwordx4 v184, s[8:11], s45 offen offset:1024 lds
    s_waitcnt lgkmcnt(8)
    v_mfma_f32_32x32x16_bf16 v[64:79], v[144:147], v[128:131], v[64:79]
    ds_read_b64_tr_b16 v[168:169], v182 offset:4096
    ds_read_b64_tr_b16 v[170:171], v182 offset:5120
    v_mfma_f32_32x32x16_bf16 v[80:95], v[144:147], v[132:135], v[80:95]
    ds_read_b64_tr_b16 v[172:173], v183 offset:4096
    ds_read_b64_tr_b16 v[174:175], v183 offset:5120
    buffer_load_dwordx4 v184, s[8:11], s45 offen offset:2048 lds
    s_waitcnt lgkmcnt(10)
    v_mfma_f32_32x32x16_bf16 v[96:111], v[148:151], v[128:131], v[96:111]
    v_mfma_f32_32x32x16_bf16 v[112:127], v[148:151], v[132:135], v[112:127]
    buffer_load_dwordx4 v184, s[8:11], s45 offen offset:3072 lds
    s_waitcnt lgkmcnt(6)
    v_mfma_f32_32x32x16_bf16 v[0:15], v[160:163], v[152:155], v[0:15]
    ds_read_b128 v[128:131], v178 offset:0
    v_mfma_f32_32x32x16_bf16 v[16:31], v[160:163], v[156:159], v[16:31]
    ds_read_b128 v[132:135], v178 offset:4096
    s_add_u32 m0, s49, 81920
    s_add_u32 s53, s52, 1146880
    buffer_load_dwordx4 v185, s[12:15], s53 offen lds
    s_waitcnt lgkmcnt(6)
    v_mfma_f32_32x32x16_bf16 v[32:47], v[164:167], v[152:155], v[32:47]
    ds_read_b64_tr_b16 v[136:137], v180 offset:8192
    ds_read_b64_tr_b16 v[138:139], v180 offset:9216
    v_mfma_f32_32x32x16_bf16 v[48:63], v[164:167], v[156:159], v[48:63]
    ds_read_b64_tr_b16 v[140:141], v181 offset:8192
    ds_read_b64_tr_b16 v[142:143], v181 offset:9216
    s_add_u32 m0, s49, 82944
    s_add_u32 s53, s52, 1161216
    buffer_load_dwordx4 v185, s[12:15], s53 offen lds
    s_waitcnt lgkmcnt(8)
    v_mfma_f32_32x32x16_bf16 v[64:79], v[168:171], v[152:155], v[64:79]
    ds_read_b64_tr_b16 v[144:145], v182 offset:8192
    ds_read_b64_tr_b16 v[146:147], v182 offset:9216
    v_mfma_f32_32x32x16_bf16 v[80:95], v[168:171], v[156:159], v[80:95]
    ds_read_b64_tr_b16 v[148:149], v183 offset:8192
    ds_read_b64_tr_b16 v[150:151], v183 offset:9216
    s_add_u32 m0, s49, 83968
    s_add_u32 s53, s52, 1175552
    buffer_load_dwordx4 v185, s[12:15], s53 offen lds
    s_waitcnt lgkmcnt(10)
    v_mfma_f32_32x32x16_bf16 v[96:111], v[172:175], v[152:155], v[96:111]
    v_mfma_f32_32x32x16_bf16 v[112:127], v[172:175], v[156:159], v[112:127]
    s_add_u32 m0, s49, 84992
    s_add_u32 s53, s52, 1189888
    buffer_load_dwordx4 v185, s[12:15], s53 offen lds
    s_waitcnt lgkmcnt(6)
    v_mfma_f32_32x32x16_bf16 v[0:15], v[136:139], v[128:131], v[0:15]
    ds_read_b128 v[152:155], v179 offset:0
    v_mfma_f32_32x32x16_bf16 v[16:31], v[136:139], v[132:135], v[16:31]
    ds_read_b128 v[156:159], v179 offset:4096
    s_add_u32 m0, s49, 131072
    s_add_u32 s53, s52, 1146880
    buffer_load_dwordx4 v185, s[16:19], s53 offen lds
    s_waitcnt lgkmcnt(6)
    v_mfma_f32_32x32x16_bf16 v[32:47], v[140:143], v[128:131], v[32:47]
    ds_read_b64_tr_b16 v[160:161], v180 offset:12288
    ds_read_b64_tr_b16 v[162:163], v180 offset:13312
    v_mfma_f32_32x32x16_bf16 v[48:63], v[140:143], v[132:135], v[48:63]
    ds_read_b64_tr_b16 v[164:165], v181 offset:12288
    ds_read_b64_tr_b16 v[166:167], v181 offset:13312
    s_add_u32 m0, s49, 132096
    s_add_u32 s53, s52, 1161216
    buffer_load_dwordx4 v185, s[16:19], s53 offen lds
    s_waitcnt lgkmcnt(8)
    v_mfma_f32_32x32x16_bf16 v[64:79], v[144:147], v[128:131], v[64:79]
    ds_read_b64_tr_b16 v[168:169], v182 offset:12288
    ds_read_b64_tr_b16 v[170:171], v182 offset:13312
    v_mfma_f32_32x32x16_bf16 v[80:95], v[144:147], v[132:135], v[80:95]
    ds_read_b64_tr_b16 v[172:173], v183 offset:12288
    ds_read_b64_tr_b16 v[174:175], v183 offset:13312
    s_add_u32 m0, s49, 133120
    s_add_u32 s53, s52, 1175552
    buffer_load_dwordx4 v185, s[16:19], s53 offen lds
    s_waitcnt lgkmcnt(10)
    v_mfma_f32_32x32x16_bf16 v[96:111], v[148:151], v[128:131], v[96:111]
    v_mfma_f32_32x32x16_bf16 v[112:127], v[148:151], v[132:135], v[112:127]
    s_add_u32 m0, s49, 134144
    s_add_u32 s53, s52, 1189888
    buffer_load_dwordx4 v185, s[16:19], s53 offen lds
    s_waitcnt lgkmcnt(6)
    v_mfma_f32_32x32x16_bf16 v[0:15], v[160:163], v[152:155], v[0:15]
    v_mfma_f32_32x32x16_bf16 v[16:31], v[160:163], v[156:159], v[16:31]
    s_waitcnt lgkmcnt(4)
    v_mfma_f32_32x32x16_bf16 v[32:47], v[164:167], v[152:155], v[32:47]
    v_mfma_f32_32x32x16_bf16 v[48:63], v[164:167], v[156:159], v[48:63]
    s_waitcnt lgkmcnt(2)
    v_mfma_f32_32x32x16_bf16 v[64:79], v[168:171], v[152:155], v[64:79]
    v_mfma_f32_32x32x16_bf16 v[80:95], v[168:171], v[156:159], v[80:95]
    s_waitcnt lgkmcnt(0)
    v_mfma_f32_32x32x16_bf16 v[96:111], v[172:175], v[152:155], v[96:111]
    v_mfma_f32_32x32x16_bf16 v[112:127], v[172:175], v[156:159], v[112:127]
    s_waitcnt vmcnt(12)
    s_barrier
    ds_read_b128 v[128:131], v176 offset:16384
    ds_read_b128 v[132:135], v176 offset:20480
    ds_read_b64_tr_b16 v[136:137], v180 offset:16384
    ds_read_b64_tr_b16 v[138:139], v180 offset:17408
    ds_read_b64_tr_b16 v[140:141], v181 offset:16384
    ds_read_b64_tr_b16 v[142:143], v181 offset:17408
    ds_read_b64_tr_b16 v[144:145], v182 offset:16384
    ds_read_b64_tr_b16 v[146:147], v182 offset:17408
    ds_read_b64_tr_b16 v[148:149], v183 offset:16384
    ds_read_b64_tr_b16 v[150:151], v183 offset:17408
    s_waitcnt lgkmcnt(6)
    v_mfma_f32_32x32x16_bf16 v[0:15], v[136:139], v[128:131], v[0:15]
    ds_read_b128 v[152:155], v177 offset:16384
    v_mfma_f32_32x32x16_bf16 v[16:31], v[136:139], v[132:135], v[16:31]
    ds_read_b128 v[156:159], v177 offset:20480
    s_add_u32 m0, s49, 0
    s_add_u32 s45, s49, 98304
    buffer_load_dwordx4 v184, s[8:11], s45 offen offset:0 lds
    s_waitcnt lgkmcnt(6)
    v_mfma_f32_32x32x16_bf16 v[32:47], v[140:143], v[128:131], v[32:47]
    ds_read_b64_tr_b16 v[160:161], v180 offset:20480
    ds_read_b64_tr_b16 v[162:163], v180 offset:21504
    v_mfma_f32_32x32x16_bf16 v[48:63], v[140:143], v[132:135], v[48:63]
    ds_read_b64_tr_b16 v[164:165], v181 offset:20480
    ds_read_b64_tr_b16 v[166:167], v181 offset:21504
    buffer_load_dwordx4 v184, s[8:11], s45 offen offset:1024 lds
    s_waitcnt lgkmcnt(8)
    v_mfma_f32_32x32x16_bf16 v[64:79], v[144:147], v[128:131], v[64:79]
    ds_read_b64_tr_b16 v[168:169], v182 offset:20480
    ds_read_b64_tr_b16 v[170:171], v182 offset:21504
    v_mfma_f32_32x32x16_bf16 v[80:95], v[144:147], v[132:135], v[80:95]
    ds_read_b64_tr_b16 v[172:173], v183 offset:20480
    ds_read_b64_tr_b16 v[174:175], v183 offset:21504
    buffer_load_dwordx4 v184, s[8:11], s45 offen offset:2048 lds
    s_waitcnt lgkmcnt(10)
    v_mfma_f32_32x32x16_bf16 v[96:111], v[148:151], v[128:131], v[96:111]
    v_mfma_f32_32x32x16_bf16 v[112:127], v[148:151], v[132:135], v[112:127]
    buffer_load_dwordx4 v184, s[8:11], s45 offen offset:3072 lds
    s_waitcnt lgkmcnt(6)
    v_mfma_f32_32x32x16_bf16 v[0:15], v[160:163], v[152:155], v[0:15]
    ds_read_b128 v[128:131], v178 offset:16384
    v_mfma_f32_32x32x16_bf16 v[16:31], v[160:163], v[156:159], v[16:31]
    ds_read_b128 v[132:135], v178 offset:20480
    s_add_u32 m0, s49, 49152
    s_add_u32 s53, s52, 1376256
    buffer_load_dwordx4 v185, s[12:15], s53 offen lds
    s_waitcnt lgkmcnt(6)
    v_mfma_f32_32x32x16_bf16 v[32:47], v[164:167], v[152:155], v[32:47]
    ds_read_b64_tr_b16 v[136:137], v180 offset:24576
    ds_read_b64_tr_b16 v[138:139], v180 offset:25600
    v_mfma_f32_32x32x16_bf16 v[48:63], v[164:167], v[156:159], v[48:63]
    ds_read_b64_tr_b16 v[140:141], v181 offset:24576
    ds_read_b64_tr_b16 v[142:143], v181 offset:25600
    s_add_u32 m0, s49, 50176
    s_add_u32 s53, s52, 1390592
    buffer_load_dwordx4 v185, s[12:15], s53 offen lds
    s_waitcnt lgkmcnt(8)
    v_mfma_f32_32x32x16_bf16 v[64:79], v[168:171], v[152:155], v[64:79]
    ds_read_b64_tr_b16 v[144:145], v182 offset:24576
    ds_read_b64_tr_b16 v[146:147], v182 offset:25600
    v_mfma_f32_32x32x16_bf16 v[80:95], v[168:171], v[156:159], v[80:95]
    ds_read_b64_tr_b16 v[148:149], v183 offset:24576
    ds_read_b64_tr_b16 v[150:151], v183 offset:25600
    s_add_u32 m0, s49, 51200
    s_add_u32 s53, s52, 1404928
    buffer_load_dwordx4 v185, s[12:15], s53 offen lds
    s_waitcnt lgkmcnt(10)
    v_mfma_f32_32x32x16_bf16 v[96:111], v[172:175], v[152:155], v[96:111]
    v_mfma_f32_32x32x16_bf16 v[112:127], v[172:175], v[156:159], v[112:127]
    s_add_u32 m0, s49, 52224
    s_add_u32 s53, s52, 1419264
    buffer_load_dwordx4 v185, s[12:15], s53 offen lds
    s_waitcnt lgkmcnt(6)
    v_mfma_f32_32x32x16_bf16 v[0:15], v[136:139], v[128:131], v[0:15]
    ds_read_b128 v[152:155], v179 offset:16384
    v_mfma_f32_32x32x16_bf16 v[16:31], v[136:139], v[132:135], v[16:31]
    ds_read_b128 v[156:159], v179 offset:20480
    s_add_u32 m0, s49, 98304
    s_add_u32 s53, s52, 1376256
    buffer_load_dwordx4 v185, s[16:19], s53 offen lds
    s_waitcnt lgkmcnt(6)
    v_mfma_f32_32x32x16_bf16 v[32:47], v[140:143], v[128:131], v[32:47]
    ds_read_b64_tr_b16 v[160:161], v180 offset:28672
    ds_read_b64_tr_b16 v[162:163], v180 offset:29696
    v_mfma_f32_32x32x16_bf16 v[48:63], v[140:143], v[132:135], v[48:63]
    ds_read_b64_tr_b16 v[164:165], v181 offset:28672
    ds_read_b64_tr_b16 v[166:167], v181 offset:29696
    s_add_u32 m0, s49, 99328
    s_add_u32 s53, s52, 1390592
    buffer_load_dwordx4 v185, s[16:19], s53 offen lds
    s_waitcnt lgkmcnt(8)
    v_mfma_f32_32x32x16_bf16 v[64:79], v[144:147], v[128:131], v[64:79]
    ds_read_b64_tr_b16 v[168:169], v182 offset:28672
    ds_read_b64_tr_b16 v[170:171], v182 offset:29696
    v_mfma_f32_32x32x16_bf16 v[80:95], v[144:147], v[132:135], v[80:95]
    ds_read_b64_tr_b16 v[172:173], v183 offset:28672
    ds_read_b64_tr_b16 v[174:175], v183 offset:29696
    s_add_u32 m0, s49, 100352
    s_add_u32 s53, s52, 1404928
    buffer_load_dwordx4 v185, s[16:19], s53 offen lds
    s_waitcnt lgkmcnt(10)
    v_mfma_f32_32x32x16_bf16 v[96:111], v[148:151], v[128:131], v[96:111]
    v_mfma_f32_32x32x16_bf16 v[112:127], v[148:151], v[132:135], v[112:127]
    s_add_u32 m0, s49, 101376
    s_add_u32 s53, s52, 1419264
    buffer_load_dwordx4 v185, s[16:19], s53 offen lds
    s_waitcnt lgkmcnt(6)
    v_mfma_f32_32x32x16_bf16 v[0:15], v[160:163], v[152:155], v[0:15]
    v_mfma_f32_32x32x16_bf16 v[16:31], v[160:163], v[156:159], v[16:31]
    s_waitcnt lgkmcnt(4)
    v_mfma_f32_32x32x16_bf16 v[32:47], v[164:167], v[152:155], v[32:47]
    v_mfma_f32_32x32x16_bf16 v[48:63], v[164:167], v[156:159], v[48:63]
    s_waitcnt lgkmcnt(2)
    v_mfma_f32_32x32x16_bf16 v[64:79], v[168:171], v[152:155], v[64:79]
    v_mfma_f32_32x32x16_bf16 v[80:95], v[168:171], v[156:159], v[80:95]
    s_waitcnt lgkmcnt(0)
    v_mfma_f32_32x32x16_bf16 v[96:111], v[172:175], v[152:155], v[96:111]
    v_mfma_f32_32x32x16_bf16 v[112:127], v[172:175], v[156:159], v[112:127]
    s_waitcnt vmcnt(12)
    s_barrier
    ds_read_b128 v[128:131], v176 offset:32768
    ds_read_b128 v[132:135], v176 offset:36864
    ds_read_b64_tr_b16 v[136:137], v180 offset:32768
    ds_read_b64_tr_b16 v[138:139], v180 offset:33792
    ds_read_b64_tr_b16 v[140:141], v181 offset:32768
    ds_read_b64_tr_b16 v[142:143], v181 offset:33792
    ds_read_b64_tr_b16 v[144:145], v182 offset:32768
    ds_read_b64_tr_b16 v[146:147], v182 offset:33792
    ds_read_b64_tr_b16 v[148:149], v183 offset:32768
    ds_read_b64_tr_b16 v[150:151], v183 offset:33792
    s_waitcnt lgkmcnt(6)
    v_mfma_f32_32x32x16_bf16 v[0:15], v[136:139], v[128:131], v[0:15]
    ds_read_b128 v[152:155], v177 offset:32768
    v_mfma_f32_32x32x16_bf16 v[16:31], v[136:139], v[132:135], v[16:31]
    ds_read_b128 v[156:159], v177 offset:36864
    s_add_u32 m0, s49, 16384
    s_add_u32 s45, s49, 114688
    buffer_load_dwordx4 v184, s[8:11], s45 offen offset:0 lds
    s_waitcnt lgkmcnt(6)
    v_mfma_f32_32x32x16_bf16 v[32:47], v[140:143], v[128:131], v[32:47]
    ds_read_b64_tr_b16 v[160:161], v180 offset:36864
    ds_read_b64_tr_b16 v[162:163], v180 offset:37888
    v_mfma_f32_32x32x16_bf16 v[48:63], v[140:143], v[132:135], v[48:63]
    ds_read_b64_tr_b16 v[164:165], v181 offset:36864
    ds_read_b64_tr_b16 v[166:167], v181 offset:37888
    buffer_load_dwordx4 v184, s[8:11], s45 offen offset:1024 lds
    s_waitcnt lgkmcnt(8)
    v_mfma_f32_32x32x16_bf16 v[64:79], v[144:147], v[128:131], v[64:79]
    ds_read_b64_tr_b16 v[168:169], v182 offset:36864
    ds_read_b64_tr_b16 v[170:171], v182 offset:37888
    v_mfma_f32_32x32x16_bf16 v[80:95], v[144:147], v[132:135], v[80:95]
    ds_read_b64_tr_b16 v[172:173], v183 offset:36864
    ds_read_b64_tr_b16 v[174:175], v183 offset:37888
    buffer_load_dwordx4 v184, s[8:11], s45 offen offset:2048 lds
    s_waitcnt lgkmcnt(10)
    v_mfma_f32_32x32x16_bf16 v[96:111], v[148:151], v[128:131], v[96:111]
    v_mfma_f32_32x32x16_bf16 v[112:127], v[148:151], v[132:135], v[112:127]
    buffer_load_dwordx4 v184, s[8:11], s45 offen offset:3072 lds
    s_waitcnt lgkmcnt(6)
    v_mfma_f32_32x32x16_bf16 v[0:15], v[160:163], v[152:155], v[0:15]
    ds_read_b128 v[128:131], v178 offset:32768
    v_mfma_f32_32x32x16_bf16 v[16:31], v[160:163], v[156:159], v[16:31]
    ds_read_b128 v[132:135], v178 offset:36864
    s_add_u32 m0, s49, 65536
    s_add_u32 s53, s52, 1605632
    buffer_load_dwordx4 v185, s[12:15], s53 offen lds
    s_waitcnt lgkmcnt(6)
    v_mfma_f32_32x32x16_bf16 v[32:47], v[164:167], v[152:155], v[32:47]
    ds_read_b64_tr_b16 v[136:137], v180 offset:40960
    ds_read_b64_tr_b16 v[138:139], v180 offset:41984
    v_mfma_f32_32x32x16_bf16 v[48:63], v[164:167], v[156:159], v[48:63]
    ds_read_b64_tr_b16 v[140:141], v181 offset:40960
    ds_read_b64_tr_b16 v[142:143], v181 offset:41984
    s_add_u32 m0, s49, 66560
    s_add_u32 s53, s52, 1619968
    buffer_load_dwordx4 v185, s[12:15], s53 offen lds
    s_waitcnt lgkmcnt(8)
    v_mfma_f32_32x32x16_bf16 v[64:79], v[168:171], v[152:155], v[64:79]
    ds_read_b64_tr_b16 v[144:145], v182 offset:40960
    ds_read_b64_tr_b16 v[146:147], v182 offset:41984
    v_mfma_f32_32x32x16_bf16 v[80:95], v[168:171], v[156:159], v[80:95]
    ds_read_b64_tr_b16 v[148:149], v183 offset:40960
    ds_read_b64_tr_b16 v[150:151], v183 offset:41984
    s_add_u32 m0, s49, 67584
    s_add_u32 s53, s52, 1634304
    buffer_load_dwordx4 v185, s[12:15], s53 offen lds
    s_waitcnt lgkmcnt(10)
    v_mfma_f32_32x32x16_bf16 v[96:111], v[172:175], v[152:155], v[96:111]
    v_mfma_f32_32x32x16_bf16 v[112:127], v[172:175], v[156:159], v[112:127]
    s_add_u32 m0, s49, 68608
    s_add_u32 s53, s52, 1648640
    buffer_load_dwordx4 v185, s[12:15], s53 offen lds
    s_waitcnt lgkmcnt(6)
    v_mfma_f32_32x32x16_bf16 v[0:15], v[136:139], v[128:131], v[0:15]
    ds_read_b128 v[152:155], v179 offset:32768
    v_mfma_f32_32x32x16_bf16 v[16:31], v[136:139], v[132:135], v[16:31]
    ds_read_b128 v[156:159], v179 offset:36864
    s_add_u32 m0, s49, 114688
    s_add_u32 s53, s52, 1605632
    buffer_load_dwordx4 v185, s[16:19], s53 offen lds
    s_waitcnt lgkmcnt(6)
    v_mfma_f32_32x32x16_bf16 v[32:47], v[140:143], v[128:131], v[32:47]
    ds_read_b64_tr_b16 v[160:161], v180 offset:45056
    ds_read_b64_tr_b16 v[162:163], v180 offset:46080
    v_mfma_f32_32x32x16_bf16 v[48:63], v[140:143], v[132:135], v[48:63]
    ds_read_b64_tr_b16 v[164:165], v181 offset:45056
    ds_read_b64_tr_b16 v[166:167], v181 offset:46080
    s_add_u32 m0, s49, 115712
    s_add_u32 s53, s52, 1619968
    buffer_load_dwordx4 v185, s[16:19], s53 offen lds
    s_waitcnt lgkmcnt(8)
    v_mfma_f32_32x32x16_bf16 v[64:79], v[144:147], v[128:131], v[64:79]
    ds_read_b64_tr_b16 v[168:169], v182 offset:45056
    ds_read_b64_tr_b16 v[170:171], v182 offset:46080
    v_mfma_f32_32x32x16_bf16 v[80:95], v[144:147], v[132:135], v[80:95]
    ds_read_b64_tr_b16 v[172:173], v183 offset:45056
    ds_read_b64_tr_b16 v[174:175], v183 offset:46080
    s_add_u32 m0, s49, 116736
    s_add_u32 s53, s52, 1634304
    buffer_load_dwordx4 v185, s[16:19], s53 offen lds
    s_waitcnt lgkmcnt(10)
    v_mfma_f32_32x32x16_bf16 v[96:111], v[148:151], v[128:131], v[96:111]
    v_mfma_f32_32x32x16_bf16 v[112:127], v[148:151], v[132:135], v[112:127]
    s_add_u32 m0, s49, 117760
    s_add_u32 s53, s52, 1648640
    buffer_load_dwordx4 v185, s[16:19], s53 offen lds
    s_waitcnt lgkmcnt(6)
    v_mfma_f32_32x32x16_bf16 v[0:15], v[160:163], v[152:155], v[0:15]
    v_mfma_f32_32x32x16_bf16 v[16:31], v[160:163], v[156:159], v[16:31]
    s_waitcnt lgkmcnt(4)
    v_mfma_f32_32x32x16_bf16 v[32:47], v[164:167], v[152:155], v[32:47]
    v_mfma_f32_32x32x16_bf16 v[48:63], v[164:167], v[156:159], v[48:63]
    s_waitcnt lgkmcnt(2)
    v_mfma_f32_32x32x16_bf16 v[64:79], v[168:171], v[152:155], v[64:79]
    v_mfma_f32_32x32x16_bf16 v[80:95], v[168:171], v[156:159], v[80:95]
    s_waitcnt lgkmcnt(0)
    v_mfma_f32_32x32x16_bf16 v[96:111], v[172:175], v[152:155], v[96:111]
    v_mfma_f32_32x32x16_bf16 v[112:127], v[172:175], v[156:159], v[112:127]
    s_waitcnt vmcnt(12)
    s_barrier
    ds_read_b128 v[128:131], v176 offset:0
    ds_read_b128 v[132:135], v176 offset:4096
    ds_read_b64_tr_b16 v[136:137], v180 offset:0
    ds_read_b64_tr_b16 v[138:139], v180 offset:1024
    ds_read_b64_tr_b16 v[140:141], v181 offset:0
    ds_read_b64_tr_b16 v[142:143], v181 offset:1024
    ds_read_b64_tr_b16 v[144:145], v182 offset:0
    ds_read_b64_tr_b16 v[146:147], v182 offset:1024
    ds_read_b64_tr_b16 v[148:149], v183 offset:0
    ds_read_b64_tr_b16 v[150:151], v183 offset:1024
    s_waitcnt lgkmcnt(6)
    v_mfma_f32_32x32x16_bf16 v[0:15], v[136:139], v[128:131], v[0:15]
    ds_read_b128 v[152:155], v177 offset:0
    v_mfma_f32_32x32x16_bf16 v[16:31], v[136:139], v[132:135], v[16:31]
    ds_read_b128 v[156:159], v177 offset:4096
    s_waitcnt lgkmcnt(6)
    v_mfma_f32_32x32x16_bf16 v[32:47], v[140:143], v[128:131], v[32:47]
    ds_read_b64_tr_b16 v[160:161], v180 offset:4096
    ds_read_b64_tr_b16 v[162:163], v180 offset:5120
    v_mfma_f32_32x32x16_bf16 v[48:63], v[140:143], v[132:135], v[48:63]
    ds_read_b64_tr_b16 v[164:165], v181 offset:4096
    ds_read_b64_tr_b16 v[166:167], v181 offset:5120
    s_waitcnt lgkmcnt(8)
    v_mfma_f32_32x32x16_bf16 v[64:79], v[144:147], v[128:131], v[64:79]
    ds_read_b64_tr_b16 v[168:169], v182 offset:4096
    ds_read_b64_tr_b16 v[170:171], v182 offset:5120
    v_mfma_f32_32x32x16_bf16 v[80:95], v[144:147], v[132:135], v[80:95]
    ds_read_b64_tr_b16 v[172:173], v183 offset:4096
    ds_read_b64_tr_b16 v[174:175], v183 offset:5120
    s_waitcnt lgkmcnt(10)
    v_mfma_f32_32x32x16_bf16 v[96:111], v[148:151], v[128:131], v[96:111]
    v_mfma_f32_32x32x16_bf16 v[112:127], v[148:151], v[132:135], v[112:127]
    s_waitcnt lgkmcnt(6)
    v_mfma_f32_32x32x16_bf16 v[0:15], v[160:163], v[152:155], v[0:15]
    ds_read_b128 v[128:131], v178 offset:0
    v_mfma_f32_32x32x16_bf16 v[16:31], v[160:163], v[156:159], v[16:31]
    ds_read_b128 v[132:135], v178 offset:4096
    s_waitcnt lgkmcnt(6)
    v_mfma_f32_32x32x16_bf16 v[32:47], v[164:167], v[152:155], v[32:47]
    ds_read_b64_tr_b16 v[136:137], v180 offset:8192
    ds_read_b64_tr_b16 v[138:139], v180 offset:9216
    v_mfma_f32_32x32x16_bf16 v[48:63], v[164:167], v[156:159], v[48:63]
    ds_read_b64_tr_b16 v[140:141], v181 offset:8192
    ds_read_b64_tr_b16 v[142:143], v181 offset:9216
    s_waitcnt lgkmcnt(8)
    v_mfma_f32_32x32x16_bf16 v[64:79], v[168:171], v[152:155], v[64:79]
    ds_read_b64_tr_b16 v[144:145], v182 offset:8192
    ds_read_b64_tr_b16 v[146:147], v182 offset:9216
    v_mfma_f32_32x32x16_bf16 v[80:95], v[168:171], v[156:159], v[80:95]
    ds_read_b64_tr_b16 v[148:149], v183 offset:8192
    ds_read_b64_tr_b16 v[150:151], v183 offset:9216
    s_waitcnt lgkmcnt(10)
    v_mfma_f32_32x32x16_bf16 v[96:111], v[172:175], v[152:155], v[96:111]
    v_mfma_f32_32x32x16_bf16 v[112:127], v[172:175], v[156:159], v[112:127]
    s_waitcnt lgkmcnt(6)
    v_mfma_f32_32x32x16_bf16 v[0:15], v[136:139], v[128:131], v[0:15]
    ds_read_b128 v[152:155], v179 offset:0
    v_mfma_f32_32x32x16_bf16 v[16:31], v[136:139], v[132:135], v[16:31]
    ds_read_b128 v[156:159], v179 offset:4096
    s_waitcnt lgkmcnt(6)
    v_mfma_f32_32x32x16_bf16 v[32:47], v[140:143], v[128:131], v[32:47]
    ds_read_b64_tr_b16 v[160:161], v180 offset:12288
    ds_read_b64_tr_b16 v[162:163], v180 offset:13312
    v_mfma_f32_32x32x16_bf16 v[48:63], v[140:143], v[132:135], v[48:63]
    ds_read_b64_tr_b16 v[164:165], v181 offset:12288
    ds_read_b64_tr_b16 v[166:167], v181 offset:13312
    s_waitcnt lgkmcnt(8)
    v_mfma_f32_32x32x16_bf16 v[64:79], v[144:147], v[128:131], v[64:79]
    ds_read_b64_tr_b16 v[168:169], v182 offset:12288
    ds_read_b64_tr_b16 v[170:171], v182 offset:13312
    v_mfma_f32_32x32x16_bf16 v[80:95], v[144:147], v[132:135], v[80:95]
    ds_read_b64_tr_b16 v[172:173], v183 offset:12288
    ds_read_b64_tr_b16 v[174:175], v183 offset:13312
    s_waitcnt lgkmcnt(10)
    v_mfma_f32_32x32x16_bf16 v[96:111], v[148:151], v[128:131], v[96:111]
    v_mfma_f32_32x32x16_bf16 v[112:127], v[148:151], v[132:135], v[112:127]
    s_waitcnt lgkmcnt(6)
    v_mfma_f32_32x32x16_bf16 v[0:15], v[160:163], v[152:155], v[0:15]
    v_mfma_f32_32x32x16_bf16 v[16:31], v[160:163], v[156:159], v[16:31]
    s_waitcnt lgkmcnt(4)
    v_mfma_f32_32x32x16_bf16 v[32:47], v[164:167], v[152:155], v[32:47]
    v_mfma_f32_32x32x16_bf16 v[48:63], v[164:167], v[156:159], v[48:63]
    s_waitcnt lgkmcnt(2)
    v_mfma_f32_32x32x16_bf16 v[64:79], v[168:171], v[152:155], v[64:79]
    v_mfma_f32_32x32x16_bf16 v[80:95], v[168:171], v[156:159], v[80:95]
    s_waitcnt lgkmcnt(0)
    v_mfma_f32_32x32x16_bf16 v[96:111], v[172:175], v[152:155], v[96:111]
    v_mfma_f32_32x32x16_bf16 v[112:127], v[172:175], v[156:159], v[112:127]
    s_waitcnt vmcnt(0)
    s_barrier
    ds_read_b128 v[128:131], v176 offset:16384
    ds_read_b128 v[132:135], v176 offset:20480
    ds_read_b64_tr_b16 v[136:137], v180 offset:16384
    ds_read_b64_tr_b16 v[138:139], v180 offset:17408
    ds_read_b64_tr_b16 v[140:141], v181 offset:16384
    ds_read_b64_tr_b16 v[142:143], v181 offset:17408
    ds_read_b64_tr_b16 v[144:145], v182 offset:16384
    ds_read_b64_tr_b16 v[146:147], v182 offset:17408
    ds_read_b64_tr_b16 v[148:149], v183 offset:16384
    ds_read_b64_tr_b16 v[150:151], v183 offset:17408
    s_waitcnt lgkmcnt(6)
    v_mfma_f32_32x32x16_bf16 v[0:15], v[136:139], v[128:131], v[0:15]
    ds_read_b128 v[152:155], v177 offset:16384
    v_mfma_f32_32x32x16_bf16 v[16:31], v[136:139], v[132:135], v[16:31]
    ds_read_b128 v[156:159], v177 offset:20480
    s_waitcnt lgkmcnt(6)
    v_mfma_f32_32x32x16_bf16 v[32:47], v[140:143], v[128:131], v[32:47]
    ds_read_b64_tr_b16 v[160:161], v180 offset:20480
    ds_read_b64_tr_b16 v[162:163], v180 offset:21504
    v_mfma_f32_32x32x16_bf16 v[48:63], v[140:143], v[132:135], v[48:63]
    ds_read_b64_tr_b16 v[164:165], v181 offset:20480
    ds_read_b64_tr_b16 v[166:167], v181 offset:21504
    s_waitcnt lgkmcnt(8)
    v_mfma_f32_32x32x16_bf16 v[64:79], v[144:147], v[128:131], v[64:79]
    ds_read_b64_tr_b16 v[168:169], v182 offset:20480
    ds_read_b64_tr_b16 v[170:171], v182 offset:21504
    v_mfma_f32_32x32x16_bf16 v[80:95], v[144:147], v[132:135], v[80:95]
    ds_read_b64_tr_b16 v[172:173], v183 offset:20480
    ds_read_b64_tr_b16 v[174:175], v183 offset:21504
    s_waitcnt lgkmcnt(10)
    v_mfma_f32_32x32x16_bf16 v[96:111], v[148:151], v[128:131], v[96:111]
    v_mfma_f32_32x32x16_bf16 v[112:127], v[148:151], v[132:135], v[112:127]
    s_waitcnt lgkmcnt(6)
    v_mfma_f32_32x32x16_bf16 v[0:15], v[160:163], v[152:155], v[0:15]
    ds_read_b128 v[128:131], v178 offset:16384
    v_mfma_f32_32x32x16_bf16 v[16:31], v[160:163], v[156:159], v[16:31]
    ds_read_b128 v[132:135], v178 offset:20480
    s_waitcnt lgkmcnt(6)
    v_mfma_f32_32x32x16_bf16 v[32:47], v[164:167], v[152:155], v[32:47]
    ds_read_b64_tr_b16 v[136:137], v180 offset:24576
    ds_read_b64_tr_b16 v[138:139], v180 offset:25600
    v_mfma_f32_32x32x16_bf16 v[48:63], v[164:167], v[156:159], v[48:63]
    ds_read_b64_tr_b16 v[140:141], v181 offset:24576
    ds_read_b64_tr_b16 v[142:143], v181 offset:25600
    s_waitcnt lgkmcnt(8)
    v_mfma_f32_32x32x16_bf16 v[64:79], v[168:171], v[152:155], v[64:79]
    ds_read_b64_tr_b16 v[144:145], v182 offset:24576
    ds_read_b64_tr_b16 v[146:147], v182 offset:25600
    v_mfma_f32_32x32x16_bf16 v[80:95], v[168:171], v[156:159], v[80:95]
    ds_read_b64_tr_b16 v[148:149], v183 offset:24576
    ds_read_b64_tr_b16 v[150:151], v183 offset:25600
    s_waitcnt lgkmcnt(10)
    v_mfma_f32_32x32x16_bf16 v[96:111], v[172:175], v[152:155], v[96:111]
    v_mfma_f32_32x32x16_bf16 v[112:127], v[172:175], v[156:159], v[112:127]
    s_waitcnt lgkmcnt(6)
    v_mfma_f32_32x32x16_bf16 v[0:15], v[136:139], v[128:131], v[0:15]
    ds_read_b128 v[152:155], v179 offset:16384
    v_mfma_f32_32x32x16_bf16 v[16:31], v[136:139], v[132:135], v[16:31]
    ds_read_b128 v[156:159], v179 offset:20480
    s_waitcnt lgkmcnt(6)
    v_mfma_f32_32x32x16_bf16 v[32:47], v[140:143], v[128:131], v[32:47]
    ds_read_b64_tr_b16 v[160:161], v180 offset:28672
    ds_read_b64_tr_b16 v[162:163], v180 offset:29696
    v_mfma_f32_32x32x16_bf16 v[48:63], v[140:143], v[132:135], v[48:63]
    ds_read_b64_tr_b16 v[164:165], v181 offset:28672
    ds_read_b64_tr_b16 v[166:167], v181 offset:29696
    s_waitcnt lgkmcnt(8)
    v_mfma_f32_32x32x16_bf16 v[64:79], v[144:147], v[128:131], v[64:79]
    ds_read_b64_tr_b16 v[168:169], v182 offset:28672
    ds_read_b64_tr_b16 v[170:171], v182 offset:29696
    v_mfma_f32_32x32x16_bf16 v[80:95], v[144:147], v[132:135], v[80:95]
    ds_read_b64_tr_b16 v[172:173], v183 offset:28672
    ds_read_b64_tr_b16 v[174:175], v183 offset:29696
    s_waitcnt lgkmcnt(10)
    v_mfma_f32_32x32x16_bf16 v[96:111], v[148:151], v[128:131], v[96:111]
    v_mfma_f32_32x32x16_bf16 v[112:127], v[148:151], v[132:135], v[112:127]
    s_waitcnt lgkmcnt(6)
    v_mfma_f32_32x32x16_bf16 v[0:15], v[160:163], v[152:155], v[0:15]
    v_mfma_f32_32x32x16_bf16 v[16:31], v[160:163], v[156:159], v[16:31]
    s_waitcnt lgkmcnt(4)
    v_mfma_f32_32x32x16_bf16 v[32:47], v[164:167], v[152:155], v[32:47]
    v_mfma_f32_32x32x16_bf16 v[48:63], v[164:167], v[156:159], v[48:63]
    s_waitcnt lgkmcnt(2)
    v_mfma_f32_32x32x16_bf16 v[64:79], v[168:171], v[152:155], v[64:79]
    v_mfma_f32_32x32x16_bf16 v[80:95], v[168:171], v[156:159], v[80:95]
    s_waitcnt lgkmcnt(0)
    v_mfma_f32_32x32x16_bf16 v[96:111], v[172:175], v[152:155], v[96:111]
    v_mfma_f32_32x32x16_bf16 v[112:127], v[172:175], v[156:159], v[112:127]
    v_and_b32 v191, 15, v255
    v_xor_b32 v191, v191, v187
    s_lshl_b32 s6, s51, 3
    v_xor_b32 v191, s6, v191
    s_lshl_b32 s6, s50, 14
    v_xor_b32 v192, 0, v191
    v_lshlrev_b32 v192, 4, v192
    v_lshl_add_u32 v192, v186, 8, v192
    v_add_u32 v194, s6, v192
    v_xor_b32 v192, 2, v191
    v_lshlrev_b32 v192, 4, v192
    v_lshl_add_u32 v192, v186, 8, v192
    v_add_u32 v195, s6, v192
    v_xor_b32 v192, 4, v191
    v_lshlrev_b32 v192, 4, v192
    v_lshl_add_u32 v192, v186, 8, v192
    v_add_u32 v196, s6, v192
    v_xor_b32 v192, 6, v191
    v_lshlrev_b32 v192, 4, v192
    v_lshl_add_u32 v192, v186, 8, v192
    v_add_u32 v197, s6, v192
    s_mul_i32 s55, s50, 229376
    s_lshl_b32 s6, s51, 12
    s_add_u32 s55, s55, s6
    s_mov_b32 s40, 0xbdd2d3e8
    s_mov_b32 s41, 0xbdd2d3e8
    v_mov_b32 v206, 0xc0135761
    v_mov_b32 v207, 0xc0135761
    v_pk_mul_f32 v[198:199], v[0:1], v[0:1]
    v_pk_mul_f32 v[200:201], v[2:3], v[2:3]
    v_pk_mul_f32 v[202:203], v[4:5], v[4:5]
    v_pk_mul_f32 v[204:205], v[6:7], v[6:7]
    v_pk_fma_f32 v[198:199], v[198:199], s[40:41], v[206:207]
    v_pk_fma_f32 v[200:201], v[200:201], s[40:41], v[206:207]
    v_pk_fma_f32 v[202:203], v[202:203], s[40:41], v[206:207]
    v_pk_fma_f32 v[204:205], v[204:205], s[40:41], v[206:207]
    v_pk_mul_f32 v[198:199], v[198:199], v[0:1]
    v_pk_mul_f32 v[200:201], v[200:201], v[2:3]
    v_pk_mul_f32 v[202:203], v[202:203], v[4:5]
    v_pk_mul_f32 v[204:205], v[204:205], v[6:7]
    v_exp_f32 v198, v198
    v_exp_f32 v200, v200
    v_exp_f32 v202, v202
    v_exp_f32 v204, v204
    v_exp_f32 v199, v199
    v_exp_f32 v201, v201
    v_exp_f32 v203, v203
    v_exp_f32 v205, v205
    v_pk_mul_f32 v[0:1], v[0:1], v[64:65]
    v_pk_mul_f32 v[2:3], v[2:3], v[66:67]
    v_pk_mul_f32 v[4:5], v[4:5], v[68:69]
    v_pk_mul_f32 v[6:7], v[6:7], v[70:71]
    v_pk_add_f32 v[198:199], v[198:199], 1.0 op_sel_hi:[1,0]
    v_pk_add_f32 v[200:201], v[200:201], 1.0 op_sel_hi:[1,0]
    v_pk_add_f32 v[202:203], v[202:203], 1.0 op_sel_hi:[1,0]
    v_pk_add_f32 v[204:205], v[204:205], 1.0 op_sel_hi:[1,0]
    v_rcp_f32 v198, v198
    v_rcp_f32 v200, v200
    v_rcp_f32 v202, v202
    v_rcp_f32 v204, v204
    v_rcp_f32 v199, v199
    v_rcp_f32 v201, v201
    v_rcp_f32 v203, v203
    v_rcp_f32 v205, v205
    v_pk_mul_f32 v[0:1], v[0:1], v[198:199]
    v_pk_mul_f32 v[2:3], v[2:3], v[200:201]
    v_pk_mul_f32 v[4:5], v[4:5], v[202:203]
    v_pk_mul_f32 v[6:7], v[6:7], v[204:205]
    v_cvt_pk_bf16_f32 v128, v0, v1
    v_cvt_pk_bf16_f32 v129, v2, v3
    v_cvt_pk_bf16_f32 v130, v4, v5
    v_cvt_pk_bf16_f32 v131, v6, v7
    s_nop 0
    v_permlane32_swap_b32 v128, v130
    v_permlane32_swap_b32 v129, v131
    s_add_u32 s7, s55, 0
    buffer_store_dwordx4 v[128:131], v184, s[24:27], s7 offen sc0 sc1
    v_pk_mul_f32 v[198:199], v[8:9], v[8:9]
    v_pk_mul_f32 v[200:201], v[10:11], v[10:11]
    v_pk_mul_f32 v[202:203], v[12:13], v[12:13]
    v_pk_mul_f32 v[204:205], v[14:15], v[14:15]
    v_pk_fma_f32 v[198:199], v[198:199], s[40:41], v[206:207]
    v_pk_fma_f32 v[200:201], v[200:201], s[40:41], v[206:207]
    v_pk_fma_f32 v[202:203], v[202:203], s[40:41], v[206:207]
    v_pk_fma_f32 v[204:205], v[204:205], s[40:41], v[206:207]
    v_pk_mul_f32 v[198:199], v[198:199], v[8:9]
    v_pk_mul_f32 v[200:201], v[200:201], v[10:11]
    v_pk_mul_f32 v[202:203], v[202:203], v[12:13]
    v_pk_mul_f32 v[204:205], v[204:205], v[14:15]
    v_exp_f32 v198, v198
    v_exp_f32 v200, v200
    v_exp_f32 v202, v202
    v_exp_f32 v204, v204
    v_exp_f32 v199, v199
    v_exp_f32 v201, v201
    v_exp_f32 v203, v203
    v_exp_f32 v205, v205
    v_pk_mul_f32 v[8:9], v[8:9], v[72:73]
    v_pk_mul_f32 v[10:11], v[10:11], v[74:75]
    v_pk_mul_f32 v[12:13], v[12:13], v[76:77]
    v_pk_mul_f32 v[14:15], v[14:15], v[78:79]
    v_pk_add_f32 v[198:199], v[198:199], 1.0 op_sel_hi:[1,0]
    v_pk_add_f32 v[200:201], v[200:201], 1.0 op_sel_hi:[1,0]
    v_pk_add_f32 v[202:203], v[202:203], 1.0 op_sel_hi:[1,0]
    v_pk_add_f32 v[204:205], v[204:205], 1.0 op_sel_hi:[1,0]
    v_rcp_f32 v198, v198
    v_rcp_f32 v200, v200
    v_rcp_f32 v202, v202
    v_rcp_f32 v204, v204
    v_rcp_f32 v199, v199
    v_rcp_f32 v201, v201
    v_rcp_f32 v203, v203
    v_rcp_f32 v205, v205
    v_pk_mul_f32 v[8:9], v[8:9], v[198:199]
    v_pk_mul_f32 v[10:11], v[10:11], v[200:201]
    v_pk_mul_f32 v[12:13], v[12:13], v[202:203]
    v_pk_mul_f32 v[14:15], v[14:15], v[204:205]
    v_cvt_pk_bf16_f32 v132, v8, v9
    v_cvt_pk_bf16_f32 v133, v10, v11
    v_cvt_pk_bf16_f32 v134, v12, v13
    v_cvt_pk_bf16_f32 v135, v14, v15
    s_nop 0
    v_permlane32_swap_b32 v132, v134
    v_permlane32_swap_b32 v133, v135
    s_add_u32 s7, s55, 1024
    buffer_store_dwordx4 v[132:135], v184, s[24:27], s7 offen sc0 sc1
    v_pk_mul_f32 v[198:199], v[16:17], v[16:17]
    v_pk_mul_f32 v[200:201], v[18:19], v[18:19]
    v_pk_mul_f32 v[202:203], v[20:21], v[20:21]
    v_pk_mul_f32 v[204:205], v[22:23], v[22:23]
    v_pk_fma_f32 v[198:199], v[198:199], s[40:41], v[206:207]
    v_pk_fma_f32 v[200:201], v[200:201], s[40:41], v[206:207]
    v_pk_fma_f32 v[202:203], v[202:203], s[40:41], v[206:207]
    v_pk_fma_f32 v[204:205], v[204:205], s[40:41], v[206:207]
    v_pk_mul_f32 v[198:199], v[198:199], v[16:17]
    v_pk_mul_f32 v[200:201], v[200:201], v[18:19]
    v_pk_mul_f32 v[202:203], v[202:203], v[20:21]
    v_pk_mul_f32 v[204:205], v[204:205], v[22:23]
    v_exp_f32 v198, v198
    v_exp_f32 v200, v200
    v_exp_f32 v202, v202
    v_exp_f32 v204, v204
    v_exp_f32 v199, v199
    v_exp_f32 v201, v201
    v_exp_f32 v203, v203
    v_exp_f32 v205, v205
    v_pk_mul_f32 v[16:17], v[16:17], v[80:81]
    v_pk_mul_f32 v[18:19], v[18:19], v[82:83]
    v_pk_mul_f32 v[20:21], v[20:21], v[84:85]
    v_pk_mul_f32 v[22:23], v[22:23], v[86:87]
    v_pk_add_f32 v[198:199], v[198:199], 1.0 op_sel_hi:[1,0]
    v_pk_add_f32 v[200:201], v[200:201], 1.0 op_sel_hi:[1,0]
    v_pk_add_f32 v[202:203], v[202:203], 1.0 op_sel_hi:[1,0]
    v_pk_add_f32 v[204:205], v[204:205], 1.0 op_sel_hi:[1,0]
    v_rcp_f32 v198, v198
    v_rcp_f32 v200, v200
    v_rcp_f32 v202, v202
    v_rcp_f32 v204, v204
    v_rcp_f32 v199, v199
    v_rcp_f32 v201, v201
    v_rcp_f32 v203, v203
    v_rcp_f32 v205, v205
    v_pk_mul_f32 v[16:17], v[16:17], v[198:199]
    v_pk_mul_f32 v[18:19], v[18:19], v[200:201]
    v_pk_mul_f32 v[20:21], v[20:21], v[202:203]
    v_pk_mul_f32 v[22:23], v[22:23], v[204:205]
    v_cvt_pk_bf16_f32 v136, v16, v17
    v_cvt_pk_bf16_f32 v137, v18, v19
    v_cvt_pk_bf16_f32 v138, v20, v21
    v_cvt_pk_bf16_f32 v139, v22, v23
    s_nop 0
    v_permlane32_swap_b32 v136, v138
    v_permlane32_swap_b32 v137, v139
    s_add_u32 s7, s55, 8192
    buffer_store_dwordx4 v[136:139], v184, s[24:27], s7 offen sc0 sc1
    v_pk_mul_f32 v[198:199], v[24:25], v[24:25]
    v_pk_mul_f32 v[200:201], v[26:27], v[26:27]
    v_pk_mul_f32 v[202:203], v[28:29], v[28:29]
    v_pk_mul_f32 v[204:205], v[30:31], v[30:31]
    v_pk_fma_f32 v[198:199], v[198:199], s[40:41], v[206:207]
    v_pk_fma_f32 v[200:201], v[200:201], s[40:41], v[206:207]
    v_pk_fma_f32 v[202:203], v[202:203], s[40:41], v[206:207]
    v_pk_fma_f32 v[204:205], v[204:205], s[40:41], v[206:207]
    v_pk_mul_f32 v[198:199], v[198:199], v[24:25]
    v_pk_mul_f32 v[200:201], v[200:201], v[26:27]
    v_pk_mul_f32 v[202:203], v[202:203], v[28:29]
    v_pk_mul_f32 v[204:205], v[204:205], v[30:31]
    v_exp_f32 v198, v198
    v_exp_f32 v200, v200
    v_exp_f32 v202, v202
    v_exp_f32 v204, v204
    v_exp_f32 v199, v199
    v_exp_f32 v201, v201
    v_exp_f32 v203, v203
    v_exp_f32 v205, v205
    v_pk_mul_f32 v[24:25], v[24:25], v[88:89]
    v_pk_mul_f32 v[26:27], v[26:27], v[90:91]
    v_pk_mul_f32 v[28:29], v[28:29], v[92:93]
    v_pk_mul_f32 v[30:31], v[30:31], v[94:95]
    v_pk_add_f32 v[198:199], v[198:199], 1.0 op_sel_hi:[1,0]
    v_pk_add_f32 v[200:201], v[200:201], 1.0 op_sel_hi:[1,0]
    v_pk_add_f32 v[202:203], v[202:203], 1.0 op_sel_hi:[1,0]
    v_pk_add_f32 v[204:205], v[204:205], 1.0 op_sel_hi:[1,0]
    v_rcp_f32 v198, v198
    v_rcp_f32 v200, v200
    v_rcp_f32 v202, v202
    v_rcp_f32 v204, v204
    v_rcp_f32 v199, v199
    v_rcp_f32 v201, v201
    v_rcp_f32 v203, v203
    v_rcp_f32 v205, v205
    v_pk_mul_f32 v[24:25], v[24:25], v[198:199]
    v_pk_mul_f32 v[26:27], v[26:27], v[200:201]
    v_pk_mul_f32 v[28:29], v[28:29], v[202:203]
    v_pk_mul_f32 v[30:31], v[30:31], v[204:205]
    v_cvt_pk_bf16_f32 v140, v24, v25
    v_cvt_pk_bf16_f32 v141, v26, v27
    v_cvt_pk_bf16_f32 v142, v28, v29
    v_cvt_pk_bf16_f32 v143, v30, v31
    s_nop 0
    v_permlane32_swap_b32 v140, v142
    v_permlane32_swap_b32 v141, v143
    s_add_u32 s7, s55, 9216
    buffer_store_dwordx4 v[140:143], v184, s[24:27], s7 offen sc0 sc1
    v_pk_mul_f32 v[198:199], v[32:33], v[32:33]
    v_pk_mul_f32 v[200:201], v[34:35], v[34:35]
    v_pk_mul_f32 v[202:203], v[36:37], v[36:37]
    v_pk_mul_f32 v[204:205], v[38:39], v[38:39]
    v_pk_fma_f32 v[198:199], v[198:199], s[40:41], v[206:207]
    v_pk_fma_f32 v[200:201], v[200:201], s[40:41], v[206:207]
    v_pk_fma_f32 v[202:203], v[202:203], s[40:41], v[206:207]
    v_pk_fma_f32 v[204:205], v[204:205], s[40:41], v[206:207]
    v_pk_mul_f32 v[198:199], v[198:199], v[32:33]
    v_pk_mul_f32 v[200:201], v[200:201], v[34:35]
    v_pk_mul_f32 v[202:203], v[202:203], v[36:37]
    v_pk_mul_f32 v[204:205], v[204:205], v[38:39]
    v_exp_f32 v198, v198
    v_exp_f32 v200, v200
    v_exp_f32 v202, v202
    v_exp_f32 v204, v204
    v_exp_f32 v199, v199
    v_exp_f32 v201, v201
    v_exp_f32 v203, v203
    v_exp_f32 v205, v205
    v_pk_mul_f32 v[32:33], v[32:33], v[96:97]
    v_pk_mul_f32 v[34:35], v[34:35], v[98:99]
    v_pk_mul_f32 v[36:37], v[36:37], v[100:101]
    v_pk_mul_f32 v[38:39], v[38:39], v[102:103]
    v_pk_add_f32 v[198:199], v[198:199], 1.0 op_sel_hi:[1,0]
    v_pk_add_f32 v[200:201], v[200:201], 1.0 op_sel_hi:[1,0]
    v_pk_add_f32 v[202:203], v[202:203], 1.0 op_sel_hi:[1,0]
    v_pk_add_f32 v[204:205], v[204:205], 1.0 op_sel_hi:[1,0]
    v_rcp_f32 v198, v198
    v_rcp_f32 v200, v200
    v_rcp_f32 v202, v202
    v_rcp_f32 v204, v204
    v_rcp_f32 v199, v199
    v_rcp_f32 v201, v201
    v_rcp_f32 v203, v203
    v_rcp_f32 v205, v205
    v_pk_mul_f32 v[32:33], v[32:33], v[198:199]
    v_pk_mul_f32 v[34:35], v[34:35], v[200:201]
    v_pk_mul_f32 v[36:37], v[36:37], v[202:203]
    v_pk_mul_f32 v[38:39], v[38:39], v[204:205]
    v_cvt_pk_bf16_f32 v144, v32, v33
    v_cvt_pk_bf16_f32 v145, v34, v35
    v_cvt_pk_bf16_f32 v146, v36, v37
    v_cvt_pk_bf16_f32 v147, v38, v39
    s_nop 0
    v_permlane32_swap_b32 v144, v146
    v_permlane32_swap_b32 v145, v147
    s_add_u32 s7, s55, 2048
    buffer_store_dwordx4 v[144:147], v184, s[24:27], s7 offen sc0 sc1
    v_pk_mul_f32 v[198:199], v[40:41], v[40:41]
    v_pk_mul_f32 v[200:201], v[42:43], v[42:43]
    v_pk_mul_f32 v[202:203], v[44:45], v[44:45]
    v_pk_mul_f32 v[204:205], v[46:47], v[46:47]
    v_pk_fma_f32 v[198:199], v[198:199], s[40:41], v[206:207]
    v_pk_fma_f32 v[200:201], v[200:201], s[40:41], v[206:207]
    v_pk_fma_f32 v[202:203], v[202:203], s[40:41], v[206:207]
    v_pk_fma_f32 v[204:205], v[204:205], s[40:41], v[206:207]
    v_pk_mul_f32 v[198:199], v[198:199], v[40:41]
    v_pk_mul_f32 v[200:201], v[200:201], v[42:43]
    v_pk_mul_f32 v[202:203], v[202:203], v[44:45]
    v_pk_mul_f32 v[204:205], v[204:205], v[46:47]
    v_exp_f32 v198, v198
    v_exp_f32 v200, v200
    v_exp_f32 v202, v202
    v_exp_f32 v204, v204
    v_exp_f32 v199, v199
    v_exp_f32 v201, v201
    v_exp_f32 v203, v203
    v_exp_f32 v205, v205
    v_pk_mul_f32 v[40:41], v[40:41], v[104:105]
    v_pk_mul_f32 v[42:43], v[42:43], v[106:107]
    v_pk_mul_f32 v[44:45], v[44:45], v[108:109]
    v_pk_mul_f32 v[46:47], v[46:47], v[110:111]
    v_pk_add_f32 v[198:199], v[198:199], 1.0 op_sel_hi:[1,0]
    v_pk_add_f32 v[200:201], v[200:201], 1.0 op_sel_hi:[1,0]
    v_pk_add_f32 v[202:203], v[202:203], 1.0 op_sel_hi:[1,0]
    v_pk_add_f32 v[204:205], v[204:205], 1.0 op_sel_hi:[1,0]
    v_rcp_f32 v198, v198
    v_rcp_f32 v200, v200
    v_rcp_f32 v202, v202
    v_rcp_f32 v204, v204
    v_rcp_f32 v199, v199
    v_rcp_f32 v201, v201
    v_rcp_f32 v203, v203
    v_rcp_f32 v205, v205
    v_pk_mul_f32 v[40:41], v[40:41], v[198:199]
    v_pk_mul_f32 v[42:43], v[42:43], v[200:201]
    v_pk_mul_f32 v[44:45], v[44:45], v[202:203]
    v_pk_mul_f32 v[46:47], v[46:47], v[204:205]
    v_cvt_pk_bf16_f32 v148, v40, v41
    v_cvt_pk_bf16_f32 v149, v42, v43
    v_cvt_pk_bf16_f32 v150, v44, v45
    v_cvt_pk_bf16_f32 v151, v46, v47
    s_nop 0
    v_permlane32_swap_b32 v148, v150
    v_permlane32_swap_b32 v149, v151
    s_add_u32 s7, s55, 3072
    buffer_store_dwordx4 v[148:151], v184, s[24:27], s7 offen sc0 sc1
    v_pk_mul_f32 v[198:199], v[48:49], v[48:49]
    v_pk_mul_f32 v[200:201], v[50:51], v[50:51]
    v_pk_mul_f32 v[202:203], v[52:53], v[52:53]
    v_pk_mul_f32 v[204:205], v[54:55], v[54:55]
    v_pk_fma_f32 v[198:199], v[198:199], s[40:41], v[206:207]
    v_pk_fma_f32 v[200:201], v[200:201], s[40:41], v[206:207]
    v_pk_fma_f32 v[202:203], v[202:203], s[40:41], v[206:207]
    v_pk_fma_f32 v[204:205], v[204:205], s[40:41], v[206:207]
    v_pk_mul_f32 v[198:199], v[198:199], v[48:49]
    v_pk_mul_f32 v[200:201], v[200:201], v[50:51]
    v_pk_mul_f32 v[202:203], v[202:203], v[52:53]
    v_pk_mul_f32 v[204:205], v[204:205], v[54:55]
    v_exp_f32 v198, v198
    v_exp_f32 v200, v200
    v_exp_f32 v202, v202
    v_exp_f32 v204, v204
    v_exp_f32 v199, v199
    v_exp_f32 v201, v201
    v_exp_f32 v203, v203
    v_exp_f32 v205, v205
    v_pk_mul_f32 v[48:49], v[48:49], v[112:113]
    v_pk_mul_f32 v[50:51], v[50:51], v[114:115]
    v_pk_mul_f32 v[52:53], v[52:53], v[116:117]
    v_pk_mul_f32 v[54:55], v[54:55], v[118:119]
    v_pk_add_f32 v[198:199], v[198:199], 1.0 op_sel_hi:[1,0]
    v_pk_add_f32 v[200:201], v[200:201], 1.0 op_sel_hi:[1,0]
    v_pk_add_f32 v[202:203], v[202:203], 1.0 op_sel_hi:[1,0]
    v_pk_add_f32 v[204:205], v[204:205], 1.0 op_sel_hi:[1,0]
    v_rcp_f32 v198, v198
    v_rcp_f32 v200, v200
    v_rcp_f32 v202, v202
    v_rcp_f32 v204, v204
    v_rcp_f32 v199, v199
    v_rcp_f32 v201, v201
    v_rcp_f32 v203, v203
    v_rcp_f32 v205, v205
    v_pk_mul_f32 v[48:49], v[48:49], v[198:199]
    v_pk_mul_f32 v[50:51], v[50:51], v[200:201]
    v_pk_mul_f32 v[52:53], v[52:53], v[202:203]
    v_pk_mul_f32 v[54:55], v[54:55], v[204:205]
    v_cvt_pk_bf16_f32 v152, v48, v49
    v_cvt_pk_bf16_f32 v153, v50, v51
    v_cvt_pk_bf16_f32 v154, v52, v53
    v_cvt_pk_bf16_f32 v155, v54, v55
    s_nop 0
    v_permlane32_swap_b32 v152, v154
    v_permlane32_swap_b32 v153, v155
    s_add_u32 s7, s55, 10240
    buffer_store_dwordx4 v[152:155], v184, s[24:27], s7 offen sc0 sc1
    v_pk_mul_f32 v[198:199], v[56:57], v[56:57]
    v_pk_mul_f32 v[200:201], v[58:59], v[58:59]
    v_pk_mul_f32 v[202:203], v[60:61], v[60:61]
    v_pk_mul_f32 v[204:205], v[62:63], v[62:63]
    v_pk_fma_f32 v[198:199], v[198:199], s[40:41], v[206:207]
    v_pk_fma_f32 v[200:201], v[200:201], s[40:41], v[206:207]
    v_pk_fma_f32 v[202:203], v[202:203], s[40:41], v[206:207]
    v_pk_fma_f32 v[204:205], v[204:205], s[40:41], v[206:207]
    v_pk_mul_f32 v[198:199], v[198:199], v[56:57]
    v_pk_mul_f32 v[200:201], v[200:201], v[58:59]
    v_pk_mul_f32 v[202:203], v[202:203], v[60:61]
    v_pk_mul_f32 v[204:205], v[204:205], v[62:63]
    v_exp_f32 v198, v198
    v_exp_f32 v200, v200
    v_exp_f32 v202, v202
    v_exp_f32 v204, v204
    v_exp_f32 v199, v199
    v_exp_f32 v201, v201
    v_exp_f32 v203, v203
    v_exp_f32 v205, v205
    v_pk_mul_f32 v[56:57], v[56:57], v[120:121]
    v_pk_mul_f32 v[58:59], v[58:59], v[122:123]
    v_pk_mul_f32 v[60:61], v[60:61], v[124:125]
    v_pk_mul_f32 v[62:63], v[62:63], v[126:127]
    v_pk_add_f32 v[198:199], v[198:199], 1.0 op_sel_hi:[1,0]
    v_pk_add_f32 v[200:201], v[200:201], 1.0 op_sel_hi:[1,0]
    v_pk_add_f32 v[202:203], v[202:203], 1.0 op_sel_hi:[1,0]
    v_pk_add_f32 v[204:205], v[204:205], 1.0 op_sel_hi:[1,0]
    v_rcp_f32 v198, v198
    v_rcp_f32 v200, v200
    v_rcp_f32 v202, v202
    v_rcp_f32 v204, v204
    v_rcp_f32 v199, v199
    v_rcp_f32 v201, v201
    v_rcp_f32 v203, v203
    v_rcp_f32 v205, v205
    v_pk_mul_f32 v[56:57], v[56:57], v[198:199]
    v_pk_mul_f32 v[58:59], v[58:59], v[200:201]
    v_pk_mul_f32 v[60:61], v[60:61], v[202:203]
    v_pk_mul_f32 v[62:63], v[62:63], v[204:205]
    v_cvt_pk_bf16_f32 v156, v56, v57
    v_cvt_pk_bf16_f32 v157, v58, v59
    v_cvt_pk_bf16_f32 v158, v60, v61
    v_cvt_pk_bf16_f32 v159, v62, v63
    s_nop 0
    v_permlane32_swap_b32 v156, v158
    v_permlane32_swap_b32 v157, v159
    s_add_u32 s7, s55, 11264
    buffer_store_dwordx4 v[156:159], v184, s[24:27], s7 offen sc0 sc1
    s_branch attn_jffn24
attn_noffn23:
    s_waitcnt vmcnt(0) lgkmcnt(0)
    s_barrier
    s_cmp_lg_u32 s3, 0
    s_cbranch_scc1 attn_sig28
    v_mov_b32 v250, 1
    v_mov_b32 v251, 0
    v_cmp_eq_u32 vcc, 0, v255
    s_nop 0
    s_and_saveexec_b64 s[58:59], vcc
    buffer_atomic_add v250, v251, s[80:83], s86 offen sc1
    s_mov_b64 exec, s[58:59]
attn_sig28:
    s_mov_b32 s87, 8064
attn_jffn24:
    s_load_dwordx2 s[28:29], s[0:1], 64
    s_load_dwordx2 s[32:33], s[0:1], 88
    s_lshr_b32 s6, s84, 3
    s_lshl_b32 s4, s85, 2
    s_add_u32 s4, s4, s6
    s_and_b32 s5, s84, 7
    s_lshr_b32 s86, s4, 1
    s_lshl_b32 s86, s86, 7
    s_add_u32 s86, s86, 4096
    s_waitcnt lgkmcnt(0)
    v_and_b32 v102, 31, v255
    v_lshrrev_b32 v103, 5, v255
    v_bfe_u32 v104, v255, 2, 2
    v_bfe_u32 v105, v255, 4, 1
    v_and_b32 v106, 3, v255
    s_mul_i32 s6, s4, 229376
    s_add_u32 s6, s6, 0x1800000
    s_add_u32 s8, s34, s6
    s_addc_u32 s9, s35, 0
    s_mov_b32 s10, 0x38000
    s_mov_b32 s11, 0x00020000
    s_lshl_b32 s6, s5, 7
    s_sub_u32 s7, 1835008, s6
    s_add_u32 s12, s28, s6
    s_addc_u32 s13, s29, 0
    s_mov_b32 s14, s7
    s_mov_b32 s15, 0x00020000
    s_mov_b32 s16, s34
    s_mov_b32 s17, s35
    s_mov_b32 s18, 0x3000
    s_mov_b32 s19, 0x00020000
    s_lshl_b32 s36, s4, 16
    s_add_u32 s36, s36, s6
    s_sub_u32 s7, 0x10000, s6
    s_add_u32 s24, s32, s36
    s_addc_u32 s25, s33, 0
    s_mov_b32 s26, s7
    s_mov_b32 s27, 0x00020000
    s_add_u32 s36, s36, 0x1400000
    s_add_u32 s20, s34, s36
    s_addc_u32 s21, s35, 0
    s_mov_b32 s22, s7
    s_mov_b32 s23, 0x00020000
    v_lshlrev_b32 v100, 4, v255
    v_lshrrev_b32 v107, 3, v255
    v_bfe_u32 v108, v255, 4, 1
    v_lshlrev_b32 v108, 2, v108
    v_and_b32 v101, 7, v255
    v_xor_b32 v101, v101, v108
    v_lshlrev_b32 v101, 4, v101
    v_lshl_add_u32 v101, v107, 10, v101
    s_lshl_b32 s52, s3, 15
    s_lshl_b32 s49, s3, 12
    v_and_b32 v107, 15, v255
    v_xor_b32 v107, v107, v103
    v_lshlrev_b32 v107, 4, v107
    v_lshl_add_u32 v107, v102, 8, v107
    s_lshl_b32 s6, s3, 6
    v_xor_b32 v96, s6, v107
    v_xor_b32 v97, 32, v96
    s_lshl_b32 s6, s3, 11
    v_add_u32 v96, s6, v100
    v_add_u32 v97, 1024, v96
    v_lshl_add_u32 v107, v103, 3, v104
    s_lshl_b32 s6, s3, 5
    v_add_u32 v107, s6, v107
    v_lshlrev_b32 v107, 7, v107
    v_add_u32 v107, 81920, v107
    v_and_b32 v108, 1, v106
    v_lshl_add_u32 v107, v108, 3, v107
    v_lshrrev_b32 v108, 1, v106
    v_lshl_add_u32 v108, v105, 1, v108
    v_lshrrev_b32 v109, 1, v104
    v_lshl_add_u32 v108, v109, 2, v108
    v_lshl_add_u32 v98, v108, 4, v107
    v_xor_b32 v108, 4, v108
    v_lshl_add_u32 v99, v108, 4, v107
    v_add_u32 v130, 0x10000, v96
    v_add_u32 v131, 0x10000, v97
    v_add_u32 v132, 0x10000, v98
    v_add_u32 v133, 0x10000, v99
    s_waitcnt vmcnt(0) lgkmcnt(0)
    s_barrier
    s_cmp_lg_u32 s3, 0
    s_cbranch_scc1 attn_sig29
    v_mov_b32 v250, 1
    v_mov_b32 v251, 0
    v_cmp_eq_u32 vcc, 0, v255
    s_nop 0
    s_and_saveexec_b64 s[58:59], vcc
    buffer_atomic_add v250, v251, s[80:83], s87 offen sc1
    s_mov_b64 exec, s[58:59]
attn_sig29:
    s_add_u32 m0, s49, 81920
    s_add_u32 s53, s52, 0
    buffer_load_dwordx4 v101, s[12:15], s53 offen lds
    s_add_u32 m0, s49, 82944
    s_add_u32 s53, s52, 8192
    buffer_load_dwordx4 v101, s[12:15], s53 offen lds
    s_add_u32 m0, s49, 83968
    s_add_u32 s53, s52, 16384
    buffer_load_dwordx4 v101, s[12:15], s53 offen lds
    s_add_u32 m0, s49, 84992
    s_add_u32 s53, s52, 24576
    buffer_load_dwordx4 v101, s[12:15], s53 offen lds
    s_add_u32 m0, s49, 98304
    s_add_u32 s53, s52, 131072
    buffer_load_dwordx4 v101, s[12:15], s53 offen lds
    s_add_u32 m0, s49, 99328
    s_add_u32 s53, s52, 139264
    buffer_load_dwordx4 v101, s[12:15], s53 offen lds
    s_add_u32 m0, s49, 100352
    s_add_u32 s53, s52, 147456
    buffer_load_dwordx4 v101, s[12:15], s53 offen lds
    s_add_u32 m0, s49, 101376
    s_add_u32 s53, s52, 155648
    buffer_load_dwordx4 v101, s[12:15], s53 offen lds
    s_add_u32 m0, s49, 114688
    s_add_u32 s53, s52, 262144
    buffer_load_dwordx4 v101, s[12:15], s53 offen lds
    s_add_u32 m0, s49, 115712
    s_add_u32 s53, s52, 270336
    buffer_load_dwordx4 v101, s[12:15], s53 offen lds
    s_add_u32 m0, s49, 116736
    s_add_u32 s53, s52, 278528
    buffer_load_dwordx4 v101, s[12:15], s53 offen lds
    s_add_u32 m0, s49, 117760
    s_add_u32 s53, s52, 286720
    buffer_load_dwordx4 v101, s[12:15], s53 offen lds
    s_add_u32 m0, s49, 131072
    s_add_u32 s53, s52, 393216
    buffer_load_dwordx4 v101, s[12:15], s53 offen lds
    s_add_u32 m0, s49, 132096
    s_add_u32 s53, s52, 401408
    buffer_load_dwordx4 v101, s[12:15], s53 offen lds
    s_add_u32 m0, s49, 133120
    s_add_u32 s53, s52, 409600
    buffer_load_dwordx4 v101, s[12:15], s53 offen lds
    s_add_u32 m0, s49, 134144
    s_add_u32 s53, s52, 417792
    buffer_load_dwordx4 v101, s[12:15], s53 offen lds
    s_cmp_lg_u32 s3, 0
    s_cbranch_scc1 attn_wd31
    v_mov_b32 v251, 0
    s_mov_b32 s57, 0
attn_wt30:
    buffer_load_dword v250, v251, s[80:83], s86 offen sc0 sc1
    s_waitcnt vmcnt(0)
    v_readfirstlane_b32 s58, v250
    s_nop 0
    s_cmp_ge_u32 s58, 46
    s_cbranch_scc1 attn_wd31
    s_sleep 1
    s_add_u32 s57, s57, 1
    s_cmp_lt_u32 s57, 0x40000
    s_cbranch_scc1 attn_wt30
attn_wd31:
    s_barrier
    s_add_u32 m0, s49, 0
    s_add_u32 s45, s49, 0
    buffer_load_dwordx4 v100, s[8:11], s45 offen offset:0 lds
    buffer_load_dwordx4 v100, s[8:11], s45 offen offset:1024 lds
    buffer_load_dwordx4 v100, s[8:11], s45 offen offset:2048 lds
    buffer_load_dwordx4 v100, s[8:11], s45 offen offset:3072 lds
    s_add_u32 m0, s49, 16384
    s_add_u32 s45, s49, 16384
    buffer_load_dwordx4 v100, s[8:11], s45 offen offset:0 lds
    buffer_load_dwordx4 v100, s[8:11], s45 offen offset:1024 lds
    buffer_load_dwordx4 v100, s[8:11], s45 offen offset:2048 lds
    buffer_load_dwordx4 v100, s[8:11], s45 offen offset:3072 lds
    s_add_u32 m0, s49, 32768
    s_add_u32 s45, s49, 32768
    buffer_load_dwordx4 v100, s[8:11], s45 offen offset:0 lds
    buffer_load_dwordx4 v100, s[8:11], s45 offen offset:1024 lds
    buffer_load_dwordx4 v100, s[8:11], s45 offen offset:2048 lds
    buffer_load_dwordx4 v100, s[8:11], s45 offen offset:3072 lds
    s_add_u32 m0, s49, 49152
    s_add_u32 s45, s49, 49152
    buffer_load_dwordx4 v100, s[8:11], s45 offen offset:0 lds
    buffer_load_dwordx4 v100, s[8:11], s45 offen offset:1024 lds
    buffer_load_dwordx4 v100, s[8:11], s45 offen offset:2048 lds
    buffer_load_dwordx4 v100, s[8:11], s45 offen offset:3072 lds
    s_waitcnt vmcnt(8)
    s_barrier
    ds_read_b128 v[64:67], v96 offset:0
    ds_read_b128 v[68:71], v96 offset:8192
    ds_read_b64_tr_b16 v[72:73], v98 offset:0
    ds_read_b64_tr_b16 v[74:75], v98 offset:512
    ds_read_b64_tr_b16 v[76:77], v99 offset:0
    ds_read_b64_tr_b16 v[78:79], v99 offset:512
    s_waitcnt lgkmcnt(2)
    v_mfma_f32_32x32x16_bf16 v[0:15], v[72:75], v[64:67], 0
    ds_read_b128 v[80:83], v97 offset:0
    s_add_u32 m0, s49, 65536
    s_add_u32 s45, s49, 65536
    buffer_load_dwordx4 v100, s[8:11], s45 offen offset:0 lds
    v_mfma_f32_32x32x16_bf16 v[16:31], v[72:75], v[68:71], 0
    ds_read_b128 v[84:87], v97 offset:8192
    buffer_load_dwordx4 v100, s[8:11], s45 offen offset:1024 lds
    s_waitcnt lgkmcnt(2)
    v_mfma_f32_32x32x16_bf16 v[32:47], v[76:79], v[64:67], 0
    ds_read_b64_tr_b16 v[88:89], v98 offset:2048
    ds_read_b64_tr_b16 v[90:91], v98 offset:2560
    buffer_load_dwordx4 v100, s[8:11], s45 offen offset:2048 lds
    v_mfma_f32_32x32x16_bf16 v[48:63], v[76:79], v[68:71], 0
    ds_read_b64_tr_b16 v[92:93], v99 offset:2048
    ds_read_b64_tr_b16 v[94:95], v99 offset:2560
    buffer_load_dwordx4 v100, s[8:11], s45 offen offset:3072 lds
    s_waitcnt lgkmcnt(2)
    v_mfma_f32_32x32x16_bf16 v[0:15], v[88:91], v[80:83], v[0:15]
    ds_read_b128 v[64:67], v96 offset:16384
    s_add_u32 m0, s49, 147456
    s_add_u32 s53, s52, 524288
    buffer_load_dwordx4 v101, s[12:15], s53 offen lds
    v_mfma_f32_32x32x16_bf16 v[16:31], v[88:91], v[84:87], v[16:31]
    ds_read_b128 v[68:71], v96 offset:24576
    s_add_u32 m0, s49, 148480
    s_add_u32 s53, s52, 532480
    buffer_load_dwordx4 v101, s[12:15], s53 offen lds
    s_waitcnt lgkmcnt(2)
    v_mfma_f32_32x32x16_bf16 v[32:47], v[92:95], v[80:83], v[32:47]
    ds_read_b64_tr_b16 v[72:73], v98 offset:16384
    ds_read_b64_tr_b16 v[74:75], v98 offset:16896
    s_add_u32 m0, s49, 149504
    s_add_u32 s53, s52, 540672
    buffer_load_dwordx4 v101, s[12:15], s53 offen lds
    v_mfma_f32_32x32x16_bf16 v[48:63], v[92:95], v[84:87], v[48:63]
    ds_read_b64_tr_b16 v[76:77], v99 offset:16384
    ds_read_b64_tr_b16 v[78:79], v99 offset:16896
    s_add_u32 m0, s49, 150528
    s_add_u32 s53, s52, 548864
    buffer_load_dwordx4 v101, s[12:15], s53 offen lds
    s_waitcnt vmcnt(12)
    s_barrier
    s_waitcnt lgkmcnt(2)
    v_mfma_f32_32x32x16_bf16 v[0:15], v[72:75], v[64:67], v[0:15]
    ds_read_b128 v[80:83], v97 offset:16384
    s_add_u32 m0, s49, 0
    s_add_u32 s45, s49, 81920
    buffer_load_dwordx4 v100, s[8:11], s45 offen offset:0 lds
    v_mfma_f32_32x32x16_bf16 v[16:31], v[72:75], v[68:71], v[16:31]
    ds_read_b128 v[84:87], v97 offset:24576
    buffer_load_dwordx4 v100, s[8:11], s45 offen offset:1024 lds
    s_waitcnt lgkmcnt(2)
    v_mfma_f32_32x32x16_bf16 v[32:47], v[76:79], v[64:67], v[32:47]
    ds_read_b64_tr_b16 v[88:89], v98 offset:18432
    ds_read_b64_tr_b16 v[90:91], v98 offset:18944
    buffer_load_dwordx4 v100, s[8:11], s45 offen offset:2048 lds
    v_mfma_f32_32x32x16_bf16 v[48:63], v[76:79], v[68:71], v[48:63]
    ds_read_b64_tr_b16 v[92:93], v99 offset:18432
    ds_read_b64_tr_b16 v[94:95], v99 offset:18944
    buffer_load_dwordx4 v100, s[8:11], s45 offen offset:3072 lds
    s_waitcnt lgkmcnt(2)
    v_mfma_f32_32x32x16_bf16 v[0:15], v[88:91], v[80:83], v[0:15]
    ds_read_b128 v[64:67], v96 offset:32768
    s_add_u32 m0, s49, 81920
    s_add_u32 s53, s52, 655360
    buffer_load_dwordx4 v101, s[12:15], s53 offen lds
    v_mfma_f32_32x32x16_bf16 v[16:31], v[88:91], v[84:87], v[16:31]
    ds_read_b128 v[68:71], v96 offset:40960
    s_add_u32 m0, s49, 82944
    s_add_u32 s53, s52, 663552
    buffer_load_dwordx4 v101, s[12:15], s53 offen lds
    s_waitcnt lgkmcnt(2)
    v_mfma_f32_32x32x16_bf16 v[32:47], v[92:95], v[80:83], v[32:47]
    ds_read_b64_tr_b16 v[72:73], v98 offset:32768
    ds_read_b64_tr_b16 v[74:75], v98 offset:33280
    s_add_u32 m0, s49, 83968
    s_add_u32 s53, s52, 671744
    buffer_load_dwordx4 v101, s[12:15], s53 offen lds
    v_mfma_f32_32x32x16_bf16 v[48:63], v[92:95], v[84:87], v[48:63]
    ds_read_b64_tr_b16 v[76:77], v99 offset:32768
    ds_read_b64_tr_b16 v[78:79], v99 offset:33280
    s_add_u32 m0, s49, 84992
    s_add_u32 s53, s52, 679936
    buffer_load_dwordx4 v101, s[12:15], s53 offen lds
    s_waitcnt vmcnt(16)
    s_barrier
    s_waitcnt lgkmcnt(2)
    v_mfma_f32_32x32x16_bf16 v[0:15], v[72:75], v[64:67], v[0:15]
    ds_read_b128 v[80:83], v97 offset:32768
    s_add_u32 m0, s49, 16384
    s_add_u32 s45, s49, 98304
    buffer_load_dwordx4 v100, s[8:11], s45 offen offset:0 lds
    v_mfma_f32_32x32x16_bf16 v[16:31], v[72:75], v[68:71], v[16:31]
    ds_read_b128 v[84:87], v97 offset:40960
    buffer_load_dwordx4 v100, s[8:11], s45 offen offset:1024 lds
    s_waitcnt lgkmcnt(2)
    v_mfma_f32_32x32x16_bf16 v[32:47], v[76:79], v[64:67], v[32:47]
    ds_read_b64_tr_b16 v[88:89], v98 offset:34816
    ds_read_b64_tr_b16 v[90:91], v98 offset:35328
    buffer_load_dwordx4 v100, s[8:11], s45 offen offset:2048 lds
    v_mfma_f32_32x32x16_bf16 v[48:63], v[76:79], v[68:71], v[48:63]
    ds_read_b64_tr_b16 v[92:93], v99 offset:34816
    ds_read_b64_tr_b16 v[94:95], v99 offset:35328
    buffer_load_dwordx4 v100, s[8:11], s45 offen offset:3072 lds
    s_waitcnt lgkmcnt(2)
    v_mfma_f32_32x32x16_bf16 v[0:15], v[88:91], v[80:83], v[0:15]
    ds_read_b128 v[64:67], v96 offset:49152
    s_add_u32 m0, s49, 98304
    s_add_u32 s53, s52, 786432
    buffer_load_dwordx4 v101, s[12:15], s53 offen lds
    v_mfma_f32_32x32x16_bf16 v[16:31], v[88:91], v[84:87], v[16:31]
    ds_read_b128 v[68:71], v96 offset:57344
    s_add_u32 m0, s49, 99328
    s_add_u32 s53, s52, 794624
    buffer_load_dwordx4 v101, s[12:15], s53 offen lds
    s_waitcnt lgkmcnt(2)
    v_mfma_f32_32x32x16_bf16 v[32:47], v[92:95], v[80:83], v[32:47]
    ds_read_b64_tr_b16 v[72:73], v98 offset:49152
    ds_read_b64_tr_b16 v[74:75], v98 offset:49664
    s_add_u32 m0, s49, 100352
    s_add_u32 s53, s52, 802816
    buffer_load_dwordx4 v101, s[12:15], s53 offen lds
    v_mfma_f32_32x32x16_bf16 v[48:63], v[92:95], v[84:87], v[48:63]
    ds_read_b64_tr_b16 v[76:77], v99 offset:49152
    ds_read_b64_tr_b16 v[78:79], v99 offset:49664
    s_add_u32 m0, s49, 101376
    s_add_u32 s53, s52, 811008
    buffer_load_dwordx4 v101, s[12:15], s53 offen lds
    s_waitcnt vmcnt(16)
    s_barrier
    s_waitcnt lgkmcnt(2)
    v_mfma_f32_32x32x16_bf16 v[0:15], v[72:75], v[64:67], v[0:15]
    ds_read_b128 v[80:83], v97 offset:49152
    s_add_u32 m0, s49, 32768
    s_add_u32 s45, s49, 114688
    buffer_load_dwordx4 v100, s[8:11], s45 offen offset:0 lds
    v_mfma_f32_32x32x16_bf16 v[16:31], v[72:75], v[68:71], v[16:31]
    ds_read_b128 v[84:87], v97 offset:57344
    buffer_load_dwordx4 v100, s[8:11], s45 offen offset:1024 lds
    s_waitcnt lgkmcnt(2)
    v_mfma_f32_32x32x16_bf16 v[32:47], v[76:79], v[64:67], v[32:47]
    ds_read_b64_tr_b16 v[88:89], v98 offset:51200
    ds_read_b64_tr_b16 v[90:91], v98 offset:51712
    buffer_load_dwordx4 v100, s[8:11], s45 offen offset:2048 lds
    v_mfma_f32_32x32x16_bf16 v[48:63], v[76:79], v[68:71], v[48:63]
    ds_read_b64_tr_b16 v[92:93], v99 offset:51200
    ds_read_b64_tr_b16 v[94:95], v99 offset:51712
    buffer_load_dwordx4 v100, s[8:11], s45 offen offset:3072 lds
    s_waitcnt lgkmcnt(2)
    v_mfma_f32_32x32x16_bf16 v[0:15], v[88:91], v[80:83], v[0:15]
    ds_read_b128 v[64:67], v130 offset:0
    s_add_u32 m0, s49, 114688
    s_add_u32 s53, s52, 917504
    buffer_load_dwordx4 v101, s[12:15], s53 offen lds
    v_mfma_f32_32x32x16_bf16 v[16:31], v[88:91], v[84:87], v[16:31]
    ds_read_b128 v[68:71], v130 offset:8192
    s_add_u32 m0, s49, 115712
    s_add_u32 s53, s52, 925696
    buffer_load_dwordx4 v101, s[12:15], s53 offen lds
    s_waitcnt lgkmcnt(2)
    v_mfma_f32_32x32x16_bf16 v[32:47], v[92:95], v[80:83], v[32:47]
    ds_read_b64_tr_b16 v[72:73], v132 offset:0
    ds_read_b64_tr_b16 v[74:75], v132 offset:512
    s_add_u32 m0, s49, 116736
    s_add_u32 s53, s52, 933888
    buffer_load_dwordx4 v101, s[12:15], s53 offen lds
    v_mfma_f32_32x32x16_bf16 v[48:63], v[92:95], v[84:87], v[48:63]
    ds_read_b64_tr_b16 v[76:77], v133 offset:0
    ds_read_b64_tr_b16 v[78:79], v133 offset:512
    s_add_u32 m0, s49, 117760
    s_add_u32 s53, s52, 942080
    buffer_load_dwordx4 v101, s[12:15], s53 offen lds
    s_waitcnt vmcnt(16)
    s_barrier
    s_waitcnt lgkmcnt(2)
    v_mfma_f32_32x32x16_bf16 v[0:15], v[72:75], v[64:67], v[0:15]
    ds_read_b128 v[80:83], v131 offset:0
    s_add_u32 m0, s49, 49152
    s_add_u32 s45, s49, 131072
    buffer_load_dwordx4 v100, s[8:11], s45 offen offset:0 lds
    v_mfma_f32_32x32x16_bf16 v[16:31], v[72:75], v[68:71], v[16:31]
    ds_read_b128 v[84:87], v131 offset:8192
    buffer_load_dwordx4 v100, s[8:11], s45 offen offset:1024 lds
    s_waitcnt lgkmcnt(2)
    v_mfma_f32_32x32x16_bf16 v[32:47], v[76:79], v[64:67], v[32:47]
    ds_read_b64_tr_b16 v[88:89], v132 offset:2048
    ds_read_b64_tr_b16 v[90:91], v132 offset:2560
    buffer_load_dwordx4 v100, s[8:11], s45 offen offset:2048 lds
    v_mfma_f32_32x32x16_bf16 v[48:63], v[76:79], v[68:71], v[48:63]
    ds_read_b64_tr_b16 v[92:93], v133 offset:2048
    ds_read_b64_tr_b16 v[94:95], v133 offset:2560
    buffer_load_dwordx4 v100, s[8:11], s45 offen offset:3072 lds
    s_waitcnt lgkmcnt(2)
    v_mfma_f32_32x32x16_bf16 v[0:15], v[88:91], v[80:83], v[0:15]
    ds_read_b128 v[64:67], v96 offset:0
    s_add_u32 m0, s49, 131072
    s_add_u32 s53, s52, 1048576
    buffer_load_dwordx4 v101, s[12:15], s53 offen lds
    v_mfma_f32_32x32x16_bf16 v[16:31], v[88:91], v[84:87], v[16:31]
    ds_read_b128 v[68:71], v96 offset:8192
    s_add_u32 m0, s49, 132096
    s_add_u32 s53, s52, 1056768
    buffer_load_dwordx4 v101, s[12:15], s53 offen lds
    s_waitcnt lgkmcnt(2)
    v_mfma_f32_32x32x16_bf16 v[32:47], v[92:95], v[80:83], v[32:47]
    ds_read_b64_tr_b16 v[72:73], v98 offset:0
    ds_read_b64_tr_b16 v[74:75], v98 offset:512
    s_add_u32 m0, s49, 133120
    s_add_u32 s53, s52, 1064960
    buffer_load_dwordx4 v101, s[12:15], s53 offen lds
    v_mfma_f32_32x32x16_bf16 v[48:63], v[92:95], v[84:87], v[48:63]
    ds_read_b64_tr_b16 v[76:77], v99 offset:0
    ds_read_b64_tr_b16 v[78:79], v99 offset:512
    s_add_u32 m0, s49, 134144
    s_add_u32 s53, s52, 1073152
    buffer_load_dwordx4 v101, s[12:15], s53 offen lds
    s_waitcnt vmcnt(16)
    s_barrier
    s_waitcnt lgkmcnt(2)
    v_mfma_f32_32x32x16_bf16 v[0:15], v[72:75], v[64:67], v[0:15]
    ds_read_b128 v[80:83], v97 offset:0
    s_add_u32 m0, s49, 65536
    s_add_u32 s45, s49, 147456
    buffer_load_dwordx4 v100, s[8:11], s45 offen offset:0 lds
    v_mfma_f32_32x32x16_bf16 v[16:31], v[72:75], v[68:71], v[16:31]
    ds_read_b128 v[84:87], v97 offset:8192
    buffer_load_dwordx4 v100, s[8:11], s45 offen offset:1024 lds
    s_waitcnt lgkmcnt(2)
    v_mfma_f32_32x32x16_bf16 v[32:47], v[76:79], v[64:67], v[32:47]
    ds_read_b64_tr_b16 v[88:89], v98 offset:2048
    ds_read_b64_tr_b16 v[90:91], v98 offset:2560
    buffer_load_dwordx4 v100, s[8:11], s45 offen offset:2048 lds
    v_mfma_f32_32x32x16_bf16 v[48:63], v[76:79], v[68:71], v[48:63]
    ds_read_b64_tr_b16 v[92:93], v99 offset:2048
    ds_read_b64_tr_b16 v[94:95], v99 offset:2560
    buffer_load_dwordx4 v100, s[8:11], s45 offen offset:3072 lds
    s_waitcnt lgkmcnt(2)
    v_mfma_f32_32x32x16_bf16 v[0:15], v[88:91], v[80:83], v[0:15]
    ds_read_b128 v[64:67], v96 offset:16384
    s_add_u32 m0, s49, 147456
    s_add_u32 s53, s52, 1179648
    buffer_load_dwordx4 v101, s[12:15], s53 offen lds
    v_mfma_f32_32x32x16_bf16 v[16:31], v[88:91], v[84:87], v[16:31]
    ds_read_b128 v[68:71], v96 offset:24576
    s_add_u32 m0, s49, 148480
    s_add_u32 s53, s52, 1187840
    buffer_load_dwordx4 v101, s[12:15], s53 offen lds
    s_waitcnt lgkmcnt(2)
    v_mfma_f32_32x32x16_bf16 v[32:47], v[92:95], v[80:83], v[32:47]
    ds_read_b64_tr_b16 v[72:73], v98 offset:16384
    ds_read_b64_tr_b16 v[74:75], v98 offset:16896
    s_add_u32 m0, s49, 149504
    s_add_u32 s53, s52, 1196032
    buffer_load_dwordx4 v101, s[12:15], s53 offen lds
    v_mfma_f32_32x32x16_bf16 v[48:63], v[92:95], v[84:87], v[48:63]
    ds_read_b64_tr_b16 v[76:77], v99 offset:16384
    ds_read_b64_tr_b16 v[78:79], v99 offset:16896
    s_add_u32 m0, s49, 150528
    s_add_u32 s53, s52, 1204224
    buffer_load_dwordx4 v101, s[12:15], s53 offen lds
    s_waitcnt vmcnt(16)
    s_barrier
    s_waitcnt lgkmcnt(2)
    v_mfma_f32_32x32x16_bf16 v[0:15], v[72:75], v[64:67], v[0:15]
    ds_read_b128 v[80:83], v97 offset:16384
    s_add_u32 m0, s49, 0
    s_add_u32 s45, s49, 163840
    buffer_load_dwordx4 v100, s[8:11], s45 offen offset:0 lds
    v_mfma_f32_32x32x16_bf16 v[16:31], v[72:75], v[68:71], v[16:31]
    ds_read_b128 v[84:87], v97 offset:24576
    buffer_load_dwordx4 v100, s[8:11], s45 offen offset:1024 lds
    s_waitcnt lgkmcnt(2)
    v_mfma_f32_32x32x16_bf16 v[32:47], v[76:79], v[64:67], v[32:47]
    ds_read_b64_tr_b16 v[88:89], v98 offset:18432
    ds_read_b64_tr_b16 v[90:91], v98 offset:18944
    buffer_load_dwordx4 v100, s[8:11], s45 offen offset:2048 lds
    v_mfma_f32_32x32x16_bf16 v[48:63], v[76:79], v[68:71], v[48:63]
    ds_read_b64_tr_b16 v[92:93], v99 offset:18432
    ds_read_b64_tr_b16 v[94:95], v99 offset:18944
    buffer_load_dwordx4 v100, s[8:11], s45 offen offset:3072 lds
    s_waitcnt lgkmcnt(2)
    v_mfma_f32_32x32x16_bf16 v[0:15], v[88:91], v[80:83], v[0:15]
    ds_read_b128 v[64:67], v96 offset:32768
    s_add_u32 m0, s49, 81920
    s_add_u32 s53, s52, 1310720
    buffer_load_dwordx4 v101, s[12:15], s53 offen lds
    v_mfma_f32_32x32x16_bf16 v[16:31], v[88:91], v[84:87], v[16:31]
    ds_read_b128 v[68:71], v96 offset:40960
    s_add_u32 m0, s49, 82944
    s_add_u32 s53, s52, 1318912
    buffer_load_dwordx4 v101, s[12:15], s53 offen lds
    s_waitcnt lgkmcnt(2)
    v_mfma_f32_32x32x16_bf16 v[32:47], v[92:95], v[80:83], v[32:47]
    ds_read_b64_tr_b16 v[72:73], v98 offset:32768
    ds_read_b64_tr_b16 v[74:75], v98 offset:33280
    s_add_u32 m0, s49, 83968
    s_add_u32 s53, s52, 1327104
    buffer_load_dwordx4 v101, s[12:15], s53 offen lds
    v_mfma_f32_32x32x16_bf16 v[48:63], v[92:95], v[84:87], v[48:63]
    ds_read_b64_tr_b16 v[76:77], v99 offset:32768
    ds_read_b64_tr_b16 v[78:79], v99 offset:33280
    s_add_u32 m0, s49, 84992
    s_add_u32 s53, s52, 1335296
    buffer_load_dwordx4 v101, s[12:15], s53 offen lds
    s_waitcnt vmcnt(16)
    s_barrier
    s_waitcnt lgkmcnt(2)
    v_mfma_f32_32x32x16_bf16 v[0:15], v[72:75], v[64:67], v[0:15]
    ds_read_b128 v[80:83], v97 offset:32768
    s_add_u32 m0, s49, 16384
    s_add_u32 s45, s49, 180224
    buffer_load_dwordx4 v100, s[8:11], s45 offen offset:0 lds
    v_mfma_f32_32x32x16_bf16 v[16:31], v[72:75], v[68:71], v[16:31]
    ds_read_b128 v[84:87], v97 offset:40960
    buffer_load_dwordx4 v100, s[8:11], s45 offen offset:1024 lds
    s_waitcnt lgkmcnt(2)
    v_mfma_f32_32x32x16_bf16 v[32:47], v[76:79], v[64:67], v[32:47]
    ds_read_b64_tr_b16 v[88:89], v98 offset:34816
    ds_read_b64_tr_b16 v[90:91], v98 offset:35328
    buffer_load_dwordx4 v100, s[8:11], s45 offen offset:2048 lds
    v_mfma_f32_32x32x16_bf16 v[48:63], v[76:79], v[68:71], v[48:63]
    ds_read_b64_tr_b16 v[92:93], v99 offset:34816
    ds_read_b64_tr_b16 v[94:95], v99 offset:35328
    buffer_load_dwordx4 v100, s[8:11], s45 offen offset:3072 lds
    s_waitcnt lgkmcnt(2)
    v_mfma_f32_32x32x16_bf16 v[0:15], v[88:91], v[80:83], v[0:15]
    ds_read_b128 v[64:67], v96 offset:49152
    s_add_u32 m0, s49, 98304
    s_add_u32 s53, s52, 1441792
    buffer_load_dwordx4 v101, s[12:15], s53 offen lds
    v_mfma_f32_32x32x16_bf16 v[16:31], v[88:91], v[84:87], v[16:31]
    ds_read_b128 v[68:71], v96 offset:57344
    s_add_u32 m0, s49, 99328
    s_add_u32 s53, s52, 1449984
    buffer_load_dwordx4 v101, s[12:15], s53 offen lds
    s_waitcnt lgkmcnt(2)
    v_mfma_f32_32x32x16_bf16 v[32:47], v[92:95], v[80:83], v[32:47]
    ds_read_b64_tr_b16 v[72:73], v98 offset:49152
    ds_read_b64_tr_b16 v[74:75], v98 offset:49664
    s_add_u32 m0, s49, 100352
    s_add_u32 s53, s52, 1458176
    buffer_load_dwordx4 v101, s[12:15], s53 offen lds
    v_mfma_f32_32x32x16_bf16 v[48:63], v[92:95], v[84:87], v[48:63]
    ds_read_b64_tr_b16 v[76:77], v99 offset:49152
    ds_read_b64_tr_b16 v[78:79], v99 offset:49664
    s_add_u32 m0, s49, 101376
    s_add_u32 s53, s52, 1466368
    buffer_load_dwordx4 v101, s[12:15], s53 offen lds
    s_waitcnt vmcnt(16)
    s_barrier
    s_waitcnt lgkmcnt(2)
    v_mfma_f32_32x32x16_bf16 v[0:15], v[72:75], v[64:67], v[0:15]
    ds_read_b128 v[80:83], v97 offset:49152
    s_add_u32 m0, s49, 32768
    s_add_u32 s45, s49, 196608
    buffer_load_dwordx4 v100, s[8:11], s45 offen offset:0 lds
    v_mfma_f32_32x32x16_bf16 v[16:31], v[72:75], v[68:71], v[16:31]
    ds_read_b128 v[84:87], v97 offset:57344
    buffer_load_dwordx4 v100, s[8:11], s45 offen offset:1024 lds
    s_waitcnt lgkmcnt(2)
    v_mfma_f32_32x32x16_bf16 v[32:47], v[76:79], v[64:67], v[32:47]
    ds_read_b64_tr_b16 v[88:89], v98 offset:51200
    ds_read_b64_tr_b16 v[90:91], v98 offset:51712
    buffer_load_dwordx4 v100, s[8:11], s45 offen offset:2048 lds
    v_mfma_f32_32x32x16_bf16 v[48:63], v[76:79], v[68:71], v[48:63]
    ds_read_b64_tr_b16 v[92:93], v99 offset:51200
    ds_read_b64_tr_b16 v[94:95], v99 offset:51712
    buffer_load_dwordx4 v100, s[8:11], s45 offen offset:3072 lds
    s_waitcnt lgkmcnt(2)
    v_mfma_f32_32x32x16_bf16 v[0:15], v[88:91], v[80:83], v[0:15]
    ds_read_b128 v[64:67], v130 offset:0
    s_add_u32 m0, s49, 114688
    s_add_u32 s53, s52, 1572864
    buffer_load_dwordx4 v101, s[12:15], s53 offen lds
    v_mfma_f32_32x32x16_bf16 v[16:31], v[88:91], v[84:87], v[16:31]
    ds_read_b128 v[68:71], v130 offset:8192
    s_add_u32 m0, s49, 115712
    s_add_u32 s53, s52, 1581056
    buffer_load_dwordx4 v101, s[12:15], s53 offen lds
    s_waitcnt lgkmcnt(2)
    v_mfma_f32_32x32x16_bf16 v[32:47], v[92:95], v[80:83], v[32:47]
    ds_read_b64_tr_b16 v[72:73], v132 offset:0
    ds_read_b64_tr_b16 v[74:75], v132 offset:512
    s_add_u32 m0, s49, 116736
    s_add_u32 s53, s52, 1589248
    buffer_load_dwordx4 v101, s[12:15], s53 offen lds
    v_mfma_f32_32x32x16_bf16 v[48:63], v[92:95], v[84:87], v[48:63]
    ds_read_b64_tr_b16 v[76:77], v133 offset:0
    ds_read_b64_tr_b16 v[78:79], v133 offset:512
    s_add_u32 m0, s49, 117760
    s_add_u32 s53, s52, 1597440
    buffer_load_dwordx4 v101, s[12:15], s53 offen lds
    s_waitcnt vmcnt(16)
    s_barrier
    s_waitcnt lgkmcnt(2)
    v_mfma_f32_32x32x16_bf16 v[0:15], v[72:75], v[64:67], v[0:15]
    ds_read_b128 v[80:83], v131 offset:0
    s_add_u32 m0, s49, 49152
    s_add_u32 s45, s49, 212992
    buffer_load_dwordx4 v100, s[8:11], s45 offen offset:0 lds
    v_mfma_f32_32x32x16_bf16 v[16:31], v[72:75], v[68:71], v[16:31]
    ds_read_b128 v[84:87], v131 offset:8192
    buffer_load_dwordx4 v100, s[8:11], s45 offen offset:1024 lds
    s_waitcnt lgkmcnt(2)
    v_mfma_f32_32x32x16_bf16 v[32:47], v[76:79], v[64:67], v[32:47]
    ds_read_b64_tr_b16 v[88:89], v132 offset:2048
    ds_read_b64_tr_b16 v[90:91], v132 offset:2560
    buffer_load_dwordx4 v100, s[8:11], s45 offen offset:2048 lds
    v_mfma_f32_32x32x16_bf16 v[48:63], v[76:79], v[68:71], v[48:63]
    ds_read_b64_tr_b16 v[92:93], v133 offset:2048
    ds_read_b64_tr_b16 v[94:95], v133 offset:2560
    buffer_load_dwordx4 v100, s[8:11], s45 offen offset:3072 lds
    s_waitcnt lgkmcnt(2)
    v_mfma_f32_32x32x16_bf16 v[0:15], v[88:91], v[80:83], v[0:15]
    ds_read_b128 v[64:67], v96 offset:0
    s_add_u32 m0, s49, 131072
    s_add_u32 s53, s52, 1703936
    buffer_load_dwordx4 v101, s[12:15], s53 offen lds
    v_mfma_f32_32x32x16_bf16 v[16:31], v[88:91], v[84:87], v[16:31]
    ds_read_b128 v[68:71], v96 offset:8192
    s_add_u32 m0, s49, 132096
    s_add_u32 s53, s52, 1712128
    buffer_load_dwordx4 v101, s[12:15], s53 offen lds
    s_waitcnt lgkmcnt(2)
    v_mfma_f32_32x32x16_bf16 v[32:47], v[92:95], v[80:83], v[32:47]
    ds_read_b64_tr_b16 v[72:73], v98 offset:0
    ds_read_b64_tr_b16 v[74:75], v98 offset:512
    s_add_u32 m0, s49, 133120
    s_add_u32 s53, s52, 1720320
    buffer_load_dwordx4 v101, s[12:15], s53 offen lds
    v_mfma_f32_32x32x16_bf16 v[48:63], v[92:95], v[84:87], v[48:63]
    ds_read_b64_tr_b16 v[76:77], v99 offset:0
    ds_read_b64_tr_b16 v[78:79], v99 offset:512
    s_add_u32 m0, s49, 134144
    s_add_u32 s53, s52, 1728512
    buffer_load_dwordx4 v101, s[12:15], s53 offen lds
    s_waitcnt vmcnt(16)
    s_barrier
    s_waitcnt lgkmcnt(2)
    v_mfma_f32_32x32x16_bf16 v[0:15], v[72:75], v[64:67], v[0:15]
    ds_read_b128 v[80:83], v97 offset:0
    v_mfma_f32_32x32x16_bf16 v[16:31], v[72:75], v[68:71], v[16:31]
    ds_read_b128 v[84:87], v97 offset:8192
    s_waitcnt lgkmcnt(2)
    v_mfma_f32_32x32x16_bf16 v[32:47], v[76:79], v[64:67], v[32:47]
    ds_read_b64_tr_b16 v[88:89], v98 offset:2048
    ds_read_b64_tr_b16 v[90:91], v98 offset:2560
    v_mfma_f32_32x32x16_bf16 v[48:63], v[76:79], v[68:71], v[48:63]
    ds_read_b64_tr_b16 v[92:93], v99 offset:2048
    ds_read_b64_tr_b16 v[94:95], v99 offset:2560
    s_waitcnt lgkmcnt(2)
    v_mfma_f32_32x32x16_bf16 v[0:15], v[88:91], v[80:83], v[0:15]
    ds_read_b128 v[64:67], v96 offset:16384
    v_mfma_f32_32x32x16_bf16 v[16:31], v[88:91], v[84:87], v[16:31]
    ds_read_b128 v[68:71], v96 offset:24576
    s_waitcnt lgkmcnt(2)
    v_mfma_f32_32x32x16_bf16 v[32:47], v[92:95], v[80:83], v[32:47]
    ds_read_b64_tr_b16 v[72:73], v98 offset:16384
    ds_read_b64_tr_b16 v[74:75], v98 offset:16896
    v_mfma_f32_32x32x16_bf16 v[48:63], v[92:95], v[84:87], v[48:63]
    ds_read_b64_tr_b16 v[76:77], v99 offset:16384
    ds_read_b64_tr_b16 v[78:79], v99 offset:16896
    s_waitcnt vmcnt(8)
    s_barrier
    s_waitcnt lgkmcnt(2)
    v_mfma_f32_32x32x16_bf16 v[0:15], v[72:75], v[64:67], v[0:15]
    ds_read_b128 v[80:83], v97 offset:16384
    v_mfma_f32_32x32x16_bf16 v[16:31], v[72:75], v[68:71], v[16:31]
    ds_read_b128 v[84:87], v97 offset:24576
    s_waitcnt lgkmcnt(2)
    v_mfma_f32_32x32x16_bf16 v[32:47], v[76:79], v[64:67], v[32:47]
    ds_read_b64_tr_b16 v[88:89], v98 offset:18432
    ds_read_b64_tr_b16 v[90:91], v98 offset:18944
    v_mfma_f32_32x32x16_bf16 v[48:63], v[76:79], v[68:71], v[48:63]
    ds_read_b64_tr_b16 v[92:93], v99 offset:18432
    ds_read_b64_tr_b16 v[94:95], v99 offset:18944
    s_waitcnt lgkmcnt(2)
    v_mfma_f32_32x32x16_bf16 v[0:15], v[88:91], v[80:83], v[0:15]
    ds_read_b128 v[64:67], v96 offset:32768
    v_mfma_f32_32x32x16_bf16 v[16:31], v[88:91], v[84:87], v[16:31]
    ds_read_b128 v[68:71], v96 offset:40960
    s_waitcnt lgkmcnt(2)
    v_mfma_f32_32x32x16_bf16 v[32:47], v[92:95], v[80:83], v[32:47]
    ds_read_b64_tr_b16 v[72:73], v98 offset:32768
    ds_read_b64_tr_b16 v[74:75], v98 offset:33280
    v_mfma_f32_32x32x16_bf16 v[48:63], v[92:95], v[84:87], v[48:63]
    ds_read_b64_tr_b16 v[76:77], v99 offset:32768
    ds_read_b64_tr_b16 v[78:79], v99 offset:33280
    s_waitcnt vmcnt(0)
    s_barrier
    s_waitcnt lgkmcnt(2)
    v_mfma_f32_32x32x16_bf16 v[0:15], v[72:75], v[64:67], v[0:15]
    ds_read_b128 v[80:83], v97 offset:32768
    v_mfma_f32_32x32x16_bf16 v[16:31], v[72:75], v[68:71], v[16:31]
    ds_read_b128 v[84:87], v97 offset:40960
    s_waitcnt lgkmcnt(2)
    v_mfma_f32_32x32x16_bf16 v[32:47], v[76:79], v[64:67], v[32:47]
    ds_read_b64_tr_b16 v[88:89], v98 offset:34816
    ds_read_b64_tr_b16 v[90:91], v98 offset:35328
    v_mfma_f32_32x32x16_bf16 v[48:63], v[76:79], v[68:71], v[48:63]
    ds_read_b64_tr_b16 v[92:93], v99 offset:34816
    ds_read_b64_tr_b16 v[94:95], v99 offset:35328
    s_waitcnt lgkmcnt(2)
    v_mfma_f32_32x32x16_bf16 v[0:15], v[88:91], v[80:83], v[0:15]
    ds_read_b128 v[64:67], v96 offset:49152
    v_mfma_f32_32x32x16_bf16 v[16:31], v[88:91], v[84:87], v[16:31]
    ds_read_b128 v[68:71], v96 offset:57344
    s_waitcnt lgkmcnt(2)
    v_mfma_f32_32x32x16_bf16 v[32:47], v[92:95], v[80:83], v[32:47]
    ds_read_b64_tr_b16 v[72:73], v98 offset:49152
    ds_read_b64_tr_b16 v[74:75], v98 offset:49664
    v_mfma_f32_32x32x16_bf16 v[48:63], v[92:95], v[84:87], v[48:63]
    ds_read_b64_tr_b16 v[76:77], v99 offset:49152
    ds_read_b64_tr_b16 v[78:79], v99 offset:49664
    s_waitcnt vmcnt(0)
    s_barrier
    s_waitcnt lgkmcnt(2)
    v_mfma_f32_32x32x16_bf16 v[0:15], v[72:75], v[64:67], v[0:15]
    ds_read_b128 v[80:83], v97 offset:49152
    v_mfma_f32_32x32x16_bf16 v[16:31], v[72:75], v[68:71], v[16:31]
    ds_read_b128 v[84:87], v97 offset:57344
    s_waitcnt lgkmcnt(2)
    v_mfma_f32_32x32x16_bf16 v[32:47], v[76:79], v[64:67], v[32:47]
    ds_read_b64_tr_b16 v[88:89], v98 offset:51200
    ds_read_b64_tr_b16 v[90:91], v98 offset:51712
    v_mfma_f32_32x32x16_bf16 v[48:63], v[76:79], v[68:71], v[48:63]
    ds_read_b64_tr_b16 v[92:93], v99 offset:51200
    ds_read_b64_tr_b16 v[94:95], v99 offset:51712
    s_waitcnt lgkmcnt(2)
    v_mfma_f32_32x32x16_bf16 v[0:15], v[88:91], v[80:83], v[0:15]
    v_mfma_f32_32x32x16_bf16 v[16:31], v[88:91], v[84:87], v[16:31]
    s_waitcnt lgkmcnt(0)
    v_mfma_f32_32x32x16_bf16 v[32:47], v[92:95], v[80:83], v[32:47]
    v_mfma_f32_32x32x16_bf16 v[48:63], v[92:95], v[84:87], v[48:63]
    s_lshr_b32 s6, s3, 1
    s_and_b32 s7, s3, 1
    v_lshlrev_b32 v107, 10, v102
    v_lshl_add_u32 v107, v103, 3, v107
    s_lshl_b32 s38, s7, 15
    s_lshl_b32 s39, s6, 6
    s_add_u32 s38, s38, s39
    buffer_load_dwordx2 v[88:89], v107, s[20:23], s38 offen offset:0
    buffer_load_dwordx2 v[90:91], v107, s[20:23], s38 offen offset:16
    buffer_load_dwordx2 v[92:93], v107, s[20:23], s38 offen offset:32
    buffer_load_dwordx2 v[94:95], v107, s[20:23], s38 offen offset:48
    v_lshlrev_b32 v108, 4, v103
    s_lshl_b32 s39, s5, 8
    s_lshl_b32 s40, s6, 7
    s_add_u32 s39, s39, s40
    s_add_u32 s39, s39, 10240
    buffer_load_dwordx4 v[112:115], v108, s[16:19], s39 offen offset:0
    buffer_load_dwordx4 v[116:119], v108, s[16:19], s39 offen offset:32
    buffer_load_dwordx4 v[120:123], v108, s[16:19], s39 offen offset:64
    buffer_load_dwordx4 v[124:127], v108, s[16:19], s39 offen offset:96
    s_barrier
    s_lshl_b32 s7, s3, 14
    v_add_u32 v110, s7, v100
    ds_write_b128 v110, v[0:3] offset:0
    ds_write_b128 v110, v[4:7] offset:1024
    ds_write_b128 v110, v[8:11] offset:2048
    ds_write_b128 v110, v[12:15] offset:3072
    ds_write_b128 v110, v[16:19] offset:4096
    ds_write_b128 v110, v[20:23] offset:5120
    ds_write_b128 v110, v[24:27] offset:6144
    ds_write_b128 v110, v[28:31] offset:7168
    ds_write_b128 v110, v[32:35] offset:8192
    ds_write_b128 v110, v[36:39] offset:9216
    ds_write_b128 v110, v[40:43] offset:10240
    ds_write_b128 v110, v[44:47] offset:11264
    ds_write_b128 v110, v[48:51] offset:12288
    ds_write_b128 v110, v[52:55] offset:13312
    ds_write_b128 v110, v[56:59] offset:14336
    ds_write_b128 v110, v[60:63] offset:15360
    s_waitcnt lgkmcnt(0)
    s_barrier
    s_lshl_b32 s7, s3, 12
    v_add_u32 v110, s7, v100
    ds_read_b128 v[0:3], v110 offset:0
    ds_read_b128 v[4:7], v110 offset:1024
    ds_read_b128 v[8:11], v110 offset:2048
    ds_read_b128 v[12:15], v110 offset:3072
    ds_read_b128 v[16:19], v110 offset:16384
    ds_read_b128 v[20:23], v110 offset:17408
    ds_read_b128 v[24:27], v110 offset:18432
    ds_read_b128 v[28:31], v110 offset:19456
    ds_read_b128 v[32:35], v110 offset:32768
    ds_read_b128 v[36:39], v110 offset:33792
    ds_read_b128 v[40:43], v110 offset:34816
    ds_read_b128 v[44:47], v110 offset:35840
    ds_read_b128 v[48:51], v110 offset:49152
    ds_read_b128 v[52:55], v110 offset:50176
    ds_read_b128 v[56:59], v110 offset:51200
    ds_read_b128 v[60:63], v110 offset:52224
    s_waitcnt lgkmcnt(11)
    v_add_f32 v0, v0, v16
    s_waitcnt lgkmcnt(3)
    v_add_f32 v32, v32, v48
    v_add_f32 v0, v0, v32
    v_add_f32 v1, v1, v17
    v_add_f32 v33, v33, v49
    v_add_f32 v1, v1, v33
    v_add_f32 v2, v2, v18
    v_add_f32 v34, v34, v50
    v_add_f32 v2, v2, v34
    v_add_f32 v3, v3, v19
    v_add_f32 v35, v35, v51
    v_add_f32 v3, v3, v35
    v_add_f32 v4, v4, v20
    s_waitcnt lgkmcnt(2)
    v_add_f32 v36, v36, v52
    v_add_f32 v4, v4, v36
    v_add_f32 v5, v5, v21
    v_add_f32 v37, v37, v53
    v_add_f32 v5, v5, v37
    v_add_f32 v6, v6, v22
    v_add_f32 v38, v38, v54
    v_add_f32 v6, v6, v38
    v_add_f32 v7, v7, v23
    v_add_f32 v39, v39, v55
    v_add_f32 v7, v7, v39
    v_add_f32 v8, v8, v24
    s_waitcnt lgkmcnt(1)
    v_add_f32 v40, v40, v56
    v_add_f32 v8, v8, v40
    v_add_f32 v9, v9, v25
    v_add_f32 v41, v41, v57
    v_add_f32 v9, v9, v41
    v_add_f32 v10, v10, v26
    v_add_f32 v42, v42, v58
    v_add_f32 v10, v10, v42
    v_add_f32 v11, v11, v27
    v_add_f32 v43, v43, v59
    v_add_f32 v11, v11, v43
    v_add_f32 v12, v12, v28
    s_waitcnt lgkmcnt(0)
    v_add_f32 v44, v44, v60
    v_add_f32 v12, v12, v44
    v_add_f32 v13, v13, v29
    v_add_f32 v45, v45, v61
    v_add_f32 v13, v13, v45
    v_add_f32 v14, v14, v30
    v_add_f32 v46, v46, v62
    v_add_f32 v14, v14, v46
    v_add_f32 v15, v15, v31
    v_add_f32 v47, v47, v63
    v_add_f32 v15, v15, v47
    s_waitcnt vmcnt(7)
    v_lshlrev_b32 v110, 16, v88
    v_and_b32 v109, 0xffff0000, v88
    s_waitcnt vmcnt(3)
    v_fma_f32 v0, v0, v112, v110
    v_fma_f32 v1, v1, v113, v109
    v_cvt_pk_bf16_f32 v16, v0, v1
    v_lshlrev_b32 v110, 16, v89
    v_and_b32 v109, 0xffff0000, v89
    v_fma_f32 v2, v2, v114, v110
    v_fma_f32 v3, v3, v115, v109
    v_cvt_pk_bf16_f32 v17, v2, v3
    v_lshlrev_b32 v110, 16, v90
    v_and_b32 v109, 0xffff0000, v90
    s_waitcnt vmcnt(2)
    v_fma_f32 v4, v4, v116, v110
    v_fma_f32 v5, v5, v117, v109
    v_cvt_pk_bf16_f32 v18, v4, v5
    v_lshlrev_b32 v110, 16, v91
    v_and_b32 v109, 0xffff0000, v91
    v_fma_f32 v6, v6, v118, v110
    v_fma_f32 v7, v7, v119, v109
    v_cvt_pk_bf16_f32 v19, v6, v7
    v_lshlrev_b32 v110, 16, v92
    v_and_b32 v109, 0xffff0000, v92
    s_waitcnt vmcnt(1)
    v_fma_f32 v8, v8, v120, v110
    v_fma_f32 v9, v9, v121, v109
    v_cvt_pk_bf16_f32 v20, v8, v9
    v_lshlrev_b32 v110, 16, v93
    v_and_b32 v109, 0xffff0000, v93
    v_fma_f32 v10, v10, v122, v110
    v_fma_f32 v11, v11, v123, v109
    v_cvt_pk_bf16_f32 v21, v10, v11
    v_lshlrev_b32 v110, 16, v94
    v_and_b32 v109, 0xffff0000, v94
    s_waitcnt vmcnt(0)
    v_fma_f32 v12, v12, v124, v110
    v_fma_f32 v13, v13, v125, v109
    v_cvt_pk_bf16_f32 v22, v12, v13
    v_lshlrev_b32 v110, 16, v95
    v_and_b32 v109, 0xffff0000, v95
    v_fma_f32 v14, v14, v126, v110
    v_fma_f32 v15, v15, v127, v109
    v_cvt_pk_bf16_f32 v23, v14, v15
    v_bfe_u32 v108, v255, 1, 3
    v_xor_b32 v108, v108, v103
    s_lshl_b32 s7, s6, 2
    v_xor_b32 v108, s7, v108
    v_xor_b32 v109, 2, v108
    v_lshlrev_b32 v108, 4, v108
    v_lshlrev_b32 v109, 4, v109
    v_lshl_add_u32 v108, v102, 7, v108
    v_lshl_add_u32 v109, v102, 7, v109
    s_and_b32 s7, s3, 1
    s_lshl_b32 s7, s7, 12
    s_add_u32 s7, s7, 0x10000
    v_add_u32 v108, s7, v108
    v_add_u32 v109, s7, v109
    v_permlane32_swap_b32 v16, v18
    v_permlane32_swap_b32 v17, v19
    ds_write_b128 v108, v[16:19]
    v_permlane32_swap_b32 v20, v22
    v_permlane32_swap_b32 v21, v23
    ds_write_b128 v109, v[20:23]
    s_waitcnt lgkmcnt(0)
    s_barrier
    v_lshrrev_b32 v107, 3, v255
    v_and_b32 v108, 7, v255
    s_lshl_b32 s7, s3, 11
    s_add_u32 s7, s7, 0x10000
    v_add_u32 v109, 0, v107
    v_lshrrev_b32 v109, 1, v109
    v_and_b32 v109, 7, v109
    v_xor_b32 v109, v109, v108
    v_lshlrev_b32 v109, 4, v109
    v_lshl_add_u32 v109, v107, 7, v109
    v_add_u32 v109, s7, v109
    ds_read_b128 v[32:35], v109 offset:0
    v_add_u32 v109, 8, v107
    v_lshrrev_b32 v109, 1, v109
    v_and_b32 v109, 7, v109
    v_xor_b32 v109, v109, v108
    v_lshlrev_b32 v109, 4, v109
    v_lshl_add_u32 v109, v107, 7, v109
    v_add_u32 v109, s7, v109
    ds_read_b128 v[36:39], v109 offset:1024
    v_lshlrev_b32 v108, 4, v108
    v_lshl_add_u32 v108, v107, 10, v108
    s_lshl_b32 s7, s3, 14
    s_add_u32 s38, s7, 8192
    s_waitcnt lgkmcnt(1)
    buffer_store_dwordx4 v[32:35], v108, s[24:27], s7 offen
    s_waitcnt lgkmcnt(0)
    buffer_store_dwordx4 v[36:39], v108, s[24:27], s38 offen
attn_end:
    s_endpgm
attn_rare1:
    s_nop 15
    v_max3_f32 v184, v64, v65, v66
    v_max3_f32 v184, v184, v67, v80
    v_max3_f32 v184, v184, v81, v82
    v_max_f32 v184, v184, v83
    v_mov_b32 v185, v184
    s_nop 1
    v_permlane16_swap_b32 v184, v185
    v_max_f32 v184, v184, v185
    v_mov_b32 v185, v184
    s_nop 1
    v_permlane32_swap_b32 v184, v185
    v_max_f32 v184, v184, v185
    v_add_f32 v185, 0x42c80000, v184
    v_cmp_gt_f32 vcc, v184, v226
    s_nop 1
    v_cndmask_b32 v185, 0, v185, vcc
    v_sub_f32 v64, v64, v185
    v_sub_f32 v80, v80, v185
    v_sub_f32 v65, v65, v185
    v_sub_f32 v81, v81, v185
    v_sub_f32 v66, v66, v185
    v_sub_f32 v82, v82, v185
    v_sub_f32 v67, v67, v185
    v_sub_f32 v83, v83, v185
    v_sub_f32 v96, v96, v185
    v_sub_f32 v97, v97, v185
    v_sub_f32 v98, v98, v185
    v_sub_f32 v99, v99, v185
    v_sub_f32 v112, v112, v185
    v_sub_f32 v113, v113, v185
    v_sub_f32 v114, v114, v185
    v_sub_f32 v115, v115, v185
    v_sub_f32 v160, v160, v185
    v_sub_f32 v161, v161, v185
    v_sub_f32 v162, v162, v185
    v_sub_f32 v163, v163, v185
    v_sub_f32 v185, 0, v185
    v_exp_f32 v185, v185
    s_nop 0
    v_mul_f32 v214, v214, v185
    v_accvgpr_read_b32 v186, a0
    v_mul_f32 v186, v186, v185
    v_accvgpr_write_b32 a0, v186
    v_accvgpr_read_b32 v187, a1
    v_mul_f32 v187, v187, v185
    v_accvgpr_write_b32 a1, v187
    v_accvgpr_read_b32 v188, a2
    v_mul_f32 v188, v188, v185
    v_accvgpr_write_b32 a2, v188
    v_accvgpr_read_b32 v189, a3
    v_mul_f32 v189, v189, v185
    v_accvgpr_write_b32 a3, v189
    v_accvgpr_read_b32 v186, a16
    v_mul_f32 v186, v186, v185
    v_accvgpr_write_b32 a16, v186
    v_accvgpr_read_b32 v187, a17
    v_mul_f32 v187, v187, v185
    v_accvgpr_write_b32 a17, v187
    v_accvgpr_read_b32 v188, a18
    v_mul_f32 v188, v188, v185
    v_accvgpr_write_b32 a18, v188
    v_accvgpr_read_b32 v189, a19
    v_mul_f32 v189, v189, v185
    v_accvgpr_write_b32 a19, v189
    v_accvgpr_read_b32 v186, a32
    v_mul_f32 v186, v186, v185
    v_accvgpr_write_b32 a32, v186
    v_accvgpr_read_b32 v187, a33
    v_mul_f32 v187, v187, v185
    v_accvgpr_write_b32 a33, v187
    v_accvgpr_read_b32 v188, a34
    v_mul_f32 v188, v188, v185
    v_accvgpr_write_b32 a34, v188
    v_accvgpr_read_b32 v189, a35
    v_mul_f32 v189, v189, v185
    v_accvgpr_write_b32 a35, v189
    v_accvgpr_read_b32 v186, a48
    v_mul_f32 v186, v186, v185
    v_accvgpr_write_b32 a48, v186
    v_accvgpr_read_b32 v187, a49
    v_mul_f32 v187, v187, v185
    v_accvgpr_write_b32 a49, v187
    v_accvgpr_read_b32 v188, a50
    v_mul_f32 v188, v188, v185
    v_accvgpr_write_b32 a50, v188
    v_accvgpr_read_b32 v189, a51
    v_mul_f32 v189, v189, v185
    v_accvgpr_write_b32 a51, v189
    v_accvgpr_read_b32 v186, a64
    v_mul_f32 v186, v186, v185
    v_accvgpr_write_b32 a64, v186
    v_accvgpr_read_b32 v187, a65
    v_mul_f32 v187, v187, v185
    v_accvgpr_write_b32 a65, v187
    v_accvgpr_read_b32 v188, a66
    v_mul_f32 v188, v188, v185
    v_accvgpr_write_b32 a66, v188
    v_accvgpr_read_b32 v189, a67
    v_mul_f32 v189, v189, v185
    v_accvgpr_write_b32 a67, v189
    v_accvgpr_read_b32 v186, a80
    v_mul_f32 v186, v186, v185
    v_accvgpr_write_b32 a80, v186
    v_accvgpr_read_b32 v187, a81
    v_mul_f32 v187, v187, v185
    v_accvgpr_write_b32 a81, v187
    v_accvgpr_read_b32 v188, a82
    v_mul_f32 v188, v188, v185
    v_accvgpr_write_b32 a82, v188
    v_accvgpr_read_b32 v189, a83
    v_mul_f32 v189, v189, v185
    v_accvgpr_write_b32 a83, v189
    v_accvgpr_read_b32 v186, a96
    v_mul_f32 v186, v186, v185
    v_accvgpr_write_b32 a96, v186
    v_accvgpr_read_b32 v187, a97
    v_mul_f32 v187, v187, v185
    v_accvgpr_write_b32 a97, v187
    v_accvgpr_read_b32 v188, a98
    v_mul_f32 v188, v188, v185
    v_accvgpr_write_b32 a98, v188
    v_accvgpr_read_b32 v189, a99
    v_mul_f32 v189, v189, v185
    v_accvgpr_write_b32 a99, v189
    v_accvgpr_read_b32 v186, a112
    v_mul_f32 v186, v186, v185
    v_accvgpr_write_b32 a112, v186
    v_accvgpr_read_b32 v187, a113
    v_mul_f32 v187, v187, v185
    v_accvgpr_write_b32 a113, v187
    v_accvgpr_read_b32 v188, a114
    v_mul_f32 v188, v188, v185
    v_accvgpr_write_b32 a114, v188
    v_accvgpr_read_b32 v189, a115
    v_mul_f32 v189, v189, v185
    v_accvgpr_write_b32 a115, v189
    v_max3_f32 v184, v68, v69, v70
    v_max3_f32 v184, v184, v71, v84
    v_max3_f32 v184, v184, v85, v86
    v_max_f32 v184, v184, v87
    v_mov_b32 v185, v184
    s_nop 1
    v_permlane16_swap_b32 v184, v185
    v_max_f32 v184, v184, v185
    v_mov_b32 v185, v184
    s_nop 1
    v_permlane32_swap_b32 v184, v185
    v_max_f32 v184, v184, v185
    v_add_f32 v185, 0x42c80000, v184
    v_cmp_gt_f32 vcc, v184, v226
    s_nop 1
    v_cndmask_b32 v185, 0, v185, vcc
    v_sub_f32 v68, v68, v185
    v_sub_f32 v84, v84, v185
    v_sub_f32 v69, v69, v185
    v_sub_f32 v85, v85, v185
    v_sub_f32 v70, v70, v185
    v_sub_f32 v86, v86, v185
    v_sub_f32 v71, v71, v185
    v_sub_f32 v87, v87, v185
    v_sub_f32 v100, v100, v185
    v_sub_f32 v101, v101, v185
    v_sub_f32 v102, v102, v185
    v_sub_f32 v103, v103, v185
    v_sub_f32 v116, v116, v185
    v_sub_f32 v117, v117, v185
    v_sub_f32 v118, v118, v185
    v_sub_f32 v119, v119, v185
    v_sub_f32 v164, v164, v185
    v_sub_f32 v165, v165, v185
    v_sub_f32 v166, v166, v185
    v_sub_f32 v167, v167, v185
    v_sub_f32 v185, 0, v185
    v_exp_f32 v185, v185
    s_nop 0
    v_mul_f32 v215, v215, v185
    v_accvgpr_read_b32 v186, a4
    v_mul_f32 v186, v186, v185
    v_accvgpr_write_b32 a4, v186
    v_accvgpr_read_b32 v187, a5
    v_mul_f32 v187, v187, v185
    v_accvgpr_write_b32 a5, v187
    v_accvgpr_read_b32 v188, a6
    v_mul_f32 v188, v188, v185
    v_accvgpr_write_b32 a6, v188
    v_accvgpr_read_b32 v189, a7
    v_mul_f32 v189, v189, v185
    v_accvgpr_write_b32 a7, v189
    v_accvgpr_read_b32 v186, a20
    v_mul_f32 v186, v186, v185
    v_accvgpr_write_b32 a20, v186
    v_accvgpr_read_b32 v187, a21
    v_mul_f32 v187, v187, v185
    v_accvgpr_write_b32 a21, v187
    v_accvgpr_read_b32 v188, a22
    v_mul_f32 v188, v188, v185
    v_accvgpr_write_b32 a22, v188
    v_accvgpr_read_b32 v189, a23
    v_mul_f32 v189, v189, v185
    v_accvgpr_write_b32 a23, v189
    v_accvgpr_read_b32 v186, a36
    v_mul_f32 v186, v186, v185
    v_accvgpr_write_b32 a36, v186
    v_accvgpr_read_b32 v187, a37
    v_mul_f32 v187, v187, v185
    v_accvgpr_write_b32 a37, v187
    v_accvgpr_read_b32 v188, a38
    v_mul_f32 v188, v188, v185
    v_accvgpr_write_b32 a38, v188
    v_accvgpr_read_b32 v189, a39
    v_mul_f32 v189, v189, v185
    v_accvgpr_write_b32 a39, v189
    v_accvgpr_read_b32 v186, a52
    v_mul_f32 v186, v186, v185
    v_accvgpr_write_b32 a52, v186
    v_accvgpr_read_b32 v187, a53
    v_mul_f32 v187, v187, v185
    v_accvgpr_write_b32 a53, v187
    v_accvgpr_read_b32 v188, a54
    v_mul_f32 v188, v188, v185
    v_accvgpr_write_b32 a54, v188
    v_accvgpr_read_b32 v189, a55
    v_mul_f32 v189, v189, v185
    v_accvgpr_write_b32 a55, v189
    v_accvgpr_read_b32 v186, a68
    v_mul_f32 v186, v186, v185
    v_accvgpr_write_b32 a68, v186
    v_accvgpr_read_b32 v187, a69
    v_mul_f32 v187, v187, v185
    v_accvgpr_write_b32 a69, v187
    v_accvgpr_read_b32 v188, a70
    v_mul_f32 v188, v188, v185
    v_accvgpr_write_b32 a70, v188
    v_accvgpr_read_b32 v189, a71
    v_mul_f32 v189, v189, v185
    v_accvgpr_write_b32 a71, v189
    v_accvgpr_read_b32 v186, a84
    v_mul_f32 v186, v186, v185
    v_accvgpr_write_b32 a84, v186
    v_accvgpr_read_b32 v187, a85
    v_mul_f32 v187, v187, v185
    v_accvgpr_write_b32 a85, v187
    v_accvgpr_read_b32 v188, a86
    v_mul_f32 v188, v188, v185
    v_accvgpr_write_b32 a86, v188
    v_accvgpr_read_b32 v189, a87
    v_mul_f32 v189, v189, v185
    v_accvgpr_write_b32 a87, v189
    v_accvgpr_read_b32 v186, a100
    v_mul_f32 v186, v186, v185
    v_accvgpr_write_b32 a100, v186
    v_accvgpr_read_b32 v187, a101
    v_mul_f32 v187, v187, v185
    v_accvgpr_write_b32 a101, v187
    v_accvgpr_read_b32 v188, a102
    v_mul_f32 v188, v188, v185
    v_accvgpr_write_b32 a102, v188
    v_accvgpr_read_b32 v189, a103
    v_mul_f32 v189, v189, v185
    v_accvgpr_write_b32 a103, v189
    v_accvgpr_read_b32 v186, a116
    v_mul_f32 v186, v186, v185
    v_accvgpr_write_b32 a116, v186
    v_accvgpr_read_b32 v187, a117
    v_mul_f32 v187, v187, v185
    v_accvgpr_write_b32 a117, v187
    v_accvgpr_read_b32 v188, a118
    v_mul_f32 v188, v188, v185
    v_accvgpr_write_b32 a118, v188
    v_accvgpr_read_b32 v189, a119
    v_mul_f32 v189, v189, v185
    v_accvgpr_write_b32 a119, v189
    v_max3_f32 v184, v72, v73, v74
    v_max3_f32 v184, v184, v75, v88
    v_max3_f32 v184, v184, v89, v90
    v_max_f32 v184, v184, v91
    v_mov_b32 v185, v184
    s_nop 1
    v_permlane16_swap_b32 v184, v185
    v_max_f32 v184, v184, v185
    v_mov_b32 v185, v184
    s_nop 1
    v_permlane32_swap_b32 v184, v185
    v_max_f32 v184, v184, v185
    v_add_f32 v185, 0x42c80000, v184
    v_cmp_gt_f32 vcc, v184, v226
    s_nop 1
    v_cndmask_b32 v185, 0, v185, vcc
    v_sub_f32 v72, v72, v185
    v_sub_f32 v88, v88, v185
    v_sub_f32 v73, v73, v185
    v_sub_f32 v89, v89, v185
    v_sub_f32 v74, v74, v185
    v_sub_f32 v90, v90, v185
    v_sub_f32 v75, v75, v185
    v_sub_f32 v91, v91, v185
    v_sub_f32 v104, v104, v185
    v_sub_f32 v105, v105, v185
    v_sub_f32 v106, v106, v185
    v_sub_f32 v107, v107, v185
    v_sub_f32 v120, v120, v185
    v_sub_f32 v121, v121, v185
    v_sub_f32 v122, v122, v185
    v_sub_f32 v123, v123, v185
    v_sub_f32 v168, v168, v185
    v_sub_f32 v169, v169, v185
    v_sub_f32 v170, v170, v185
    v_sub_f32 v171, v171, v185
    v_sub_f32 v185, 0, v185
    v_exp_f32 v185, v185
    s_nop 0
    v_mul_f32 v216, v216, v185
    v_accvgpr_read_b32 v186, a8
    v_mul_f32 v186, v186, v185
    v_accvgpr_write_b32 a8, v186
    v_accvgpr_read_b32 v187, a9
    v_mul_f32 v187, v187, v185
    v_accvgpr_write_b32 a9, v187
    v_accvgpr_read_b32 v188, a10
    v_mul_f32 v188, v188, v185
    v_accvgpr_write_b32 a10, v188
    v_accvgpr_read_b32 v189, a11
    v_mul_f32 v189, v189, v185
    v_accvgpr_write_b32 a11, v189
    v_accvgpr_read_b32 v186, a24
    v_mul_f32 v186, v186, v185
    v_accvgpr_write_b32 a24, v186
    v_accvgpr_read_b32 v187, a25
    v_mul_f32 v187, v187, v185
    v_accvgpr_write_b32 a25, v187
    v_accvgpr_read_b32 v188, a26
    v_mul_f32 v188, v188, v185
    v_accvgpr_write_b32 a26, v188
    v_accvgpr_read_b32 v189, a27
    v_mul_f32 v189, v189, v185
    v_accvgpr_write_b32 a27, v189
    v_accvgpr_read_b32 v186, a40
    v_mul_f32 v186, v186, v185
    v_accvgpr_write_b32 a40, v186
    v_accvgpr_read_b32 v187, a41
    v_mul_f32 v187, v187, v185
    v_accvgpr_write_b32 a41, v187
    v_accvgpr_read_b32 v188, a42
    v_mul_f32 v188, v188, v185
    v_accvgpr_write_b32 a42, v188
    v_accvgpr_read_b32 v189, a43
    v_mul_f32 v189, v189, v185
    v_accvgpr_write_b32 a43, v189
    v_accvgpr_read_b32 v186, a56
    v_mul_f32 v186, v186, v185
    v_accvgpr_write_b32 a56, v186
    v_accvgpr_read_b32 v187, a57
    v_mul_f32 v187, v187, v185
    v_accvgpr_write_b32 a57, v187
    v_accvgpr_read_b32 v188, a58
    v_mul_f32 v188, v188, v185
    v_accvgpr_write_b32 a58, v188
    v_accvgpr_read_b32 v189, a59
    v_mul_f32 v189, v189, v185
    v_accvgpr_write_b32 a59, v189
    v_accvgpr_read_b32 v186, a72
    v_mul_f32 v186, v186, v185
    v_accvgpr_write_b32 a72, v186
    v_accvgpr_read_b32 v187, a73
    v_mul_f32 v187, v187, v185
    v_accvgpr_write_b32 a73, v187
    v_accvgpr_read_b32 v188, a74
    v_mul_f32 v188, v188, v185
    v_accvgpr_write_b32 a74, v188
    v_accvgpr_read_b32 v189, a75
    v_mul_f32 v189, v189, v185
    v_accvgpr_write_b32 a75, v189
    v_accvgpr_read_b32 v186, a88
    v_mul_f32 v186, v186, v185
    v_accvgpr_write_b32 a88, v186
    v_accvgpr_read_b32 v187, a89
    v_mul_f32 v187, v187, v185
    v_accvgpr_write_b32 a89, v187
    v_accvgpr_read_b32 v188, a90
    v_mul_f32 v188, v188, v185
    v_accvgpr_write_b32 a90, v188
    v_accvgpr_read_b32 v189, a91
    v_mul_f32 v189, v189, v185
    v_accvgpr_write_b32 a91, v189
    v_accvgpr_read_b32 v186, a104
    v_mul_f32 v186, v186, v185
    v_accvgpr_write_b32 a104, v186
    v_accvgpr_read_b32 v187, a105
    v_mul_f32 v187, v187, v185
    v_accvgpr_write_b32 a105, v187
    v_accvgpr_read_b32 v188, a106
    v_mul_f32 v188, v188, v185
    v_accvgpr_write_b32 a106, v188
    v_accvgpr_read_b32 v189, a107
    v_mul_f32 v189, v189, v185
    v_accvgpr_write_b32 a107, v189
    v_accvgpr_read_b32 v186, a120
    v_mul_f32 v186, v186, v185
    v_accvgpr_write_b32 a120, v186
    v_accvgpr_read_b32 v187, a121
    v_mul_f32 v187, v187, v185
    v_accvgpr_write_b32 a121, v187
    v_accvgpr_read_b32 v188, a122
    v_mul_f32 v188, v188, v185
    v_accvgpr_write_b32 a122, v188
    v_accvgpr_read_b32 v189, a123
    v_mul_f32 v189, v189, v185
    v_accvgpr_write_b32 a123, v189
    v_max3_f32 v184, v76, v77, v78
    v_max3_f32 v184, v184, v79, v92
    v_max3_f32 v184, v184, v93, v94
    v_max_f32 v184, v184, v95
    v_mov_b32 v185, v184
    s_nop 1
    v_permlane16_swap_b32 v184, v185
    v_max_f32 v184, v184, v185
    v_mov_b32 v185, v184
    s_nop 1
    v_permlane32_swap_b32 v184, v185
    v_max_f32 v184, v184, v185
    v_add_f32 v185, 0x42c80000, v184
    v_cmp_gt_f32 vcc, v184, v226
    s_nop 1
    v_cndmask_b32 v185, 0, v185, vcc
    v_sub_f32 v76, v76, v185
    v_sub_f32 v92, v92, v185
    v_sub_f32 v77, v77, v185
    v_sub_f32 v93, v93, v185
    v_sub_f32 v78, v78, v185
    v_sub_f32 v94, v94, v185
    v_sub_f32 v79, v79, v185
    v_sub_f32 v95, v95, v185
    v_sub_f32 v108, v108, v185
    v_sub_f32 v109, v109, v185
    v_sub_f32 v110, v110, v185
    v_sub_f32 v111, v111, v185
    v_sub_f32 v124, v124, v185
    v_sub_f32 v125, v125, v185
    v_sub_f32 v126, v126, v185
    v_sub_f32 v127, v127, v185
    v_sub_f32 v172, v172, v185
    v_sub_f32 v173, v173, v185
    v_sub_f32 v174, v174, v185
    v_sub_f32 v175, v175, v185
    v_sub_f32 v185, 0, v185
    v_exp_f32 v185, v185
    s_nop 0
    v_mul_f32 v217, v217, v185
    v_accvgpr_read_b32 v186, a12
    v_mul_f32 v186, v186, v185
    v_accvgpr_write_b32 a12, v186
    v_accvgpr_read_b32 v187, a13
    v_mul_f32 v187, v187, v185
    v_accvgpr_write_b32 a13, v187
    v_accvgpr_read_b32 v188, a14
    v_mul_f32 v188, v188, v185
    v_accvgpr_write_b32 a14, v188
    v_accvgpr_read_b32 v189, a15
    v_mul_f32 v189, v189, v185
    v_accvgpr_write_b32 a15, v189
    v_accvgpr_read_b32 v186, a28
    v_mul_f32 v186, v186, v185
    v_accvgpr_write_b32 a28, v186
    v_accvgpr_read_b32 v187, a29
    v_mul_f32 v187, v187, v185
    v_accvgpr_write_b32 a29, v187
    v_accvgpr_read_b32 v188, a30
    v_mul_f32 v188, v188, v185
    v_accvgpr_write_b32 a30, v188
    v_accvgpr_read_b32 v189, a31
    v_mul_f32 v189, v189, v185
    v_accvgpr_write_b32 a31, v189
    v_accvgpr_read_b32 v186, a44
    v_mul_f32 v186, v186, v185
    v_accvgpr_write_b32 a44, v186
    v_accvgpr_read_b32 v187, a45
    v_mul_f32 v187, v187, v185
    v_accvgpr_write_b32 a45, v187
    v_accvgpr_read_b32 v188, a46
    v_mul_f32 v188, v188, v185
    v_accvgpr_write_b32 a46, v188
    v_accvgpr_read_b32 v189, a47
    v_mul_f32 v189, v189, v185
    v_accvgpr_write_b32 a47, v189
    v_accvgpr_read_b32 v186, a60
    v_mul_f32 v186, v186, v185
    v_accvgpr_write_b32 a60, v186
    v_accvgpr_read_b32 v187, a61
    v_mul_f32 v187, v187, v185
    v_accvgpr_write_b32 a61, v187
    v_accvgpr_read_b32 v188, a62
    v_mul_f32 v188, v188, v185
    v_accvgpr_write_b32 a62, v188
    v_accvgpr_read_b32 v189, a63
    v_mul_f32 v189, v189, v185
    v_accvgpr_write_b32 a63, v189
    v_accvgpr_read_b32 v186, a76
    v_mul_f32 v186, v186, v185
    v_accvgpr_write_b32 a76, v186
    v_accvgpr_read_b32 v187, a77
    v_mul_f32 v187, v187, v185
    v_accvgpr_write_b32 a77, v187
    v_accvgpr_read_b32 v188, a78
    v_mul_f32 v188, v188, v185
    v_accvgpr_write_b32 a78, v188
    v_accvgpr_read_b32 v189, a79
    v_mul_f32 v189, v189, v185
    v_accvgpr_write_b32 a79, v189
    v_accvgpr_read_b32 v186, a92
    v_mul_f32 v186, v186, v185
    v_accvgpr_write_b32 a92, v186
    v_accvgpr_read_b32 v187, a93
    v_mul_f32 v187, v187, v185
    v_accvgpr_write_b32 a93, v187
    v_accvgpr_read_b32 v188, a94
    v_mul_f32 v188, v188, v185
    v_accvgpr_write_b32 a94, v188
    v_accvgpr_read_b32 v189, a95
    v_mul_f32 v189, v189, v185
    v_accvgpr_write_b32 a95, v189
    v_accvgpr_read_b32 v186, a108
    v_mul_f32 v186, v186, v185
    v_accvgpr_write_b32 a108, v186
    v_accvgpr_read_b32 v187, a109
    v_mul_f32 v187, v187, v185
    v_accvgpr_write_b32 a109, v187
    v_accvgpr_read_b32 v188, a110
    v_mul_f32 v188, v188, v185
    v_accvgpr_write_b32 a110, v188
    v_accvgpr_read_b32 v189, a111
    v_mul_f32 v189, v189, v185
    v_accvgpr_write_b32 a111, v189
    v_accvgpr_read_b32 v186, a124
    v_mul_f32 v186, v186, v185
    v_accvgpr_write_b32 a124, v186
    v_accvgpr_read_b32 v187, a125
    v_mul_f32 v187, v187, v185
    v_accvgpr_write_b32 a125, v187
    v_accvgpr_read_b32 v188, a126
    v_mul_f32 v188, v188, v185
    v_accvgpr_write_b32 a126, v188
    v_accvgpr_read_b32 v189, a127
    v_mul_f32 v189, v189, v185
    v_accvgpr_write_b32 a127, v189
    v_exp_f32 v176, v64
    v_exp_f32 v177, v65
    s_nop 0
    v_add_f32 v218, v176, v177
    v_cvt_pk_bf16_f32 v128, v176, v177
    v_exp_f32 v178, v68
    v_exp_f32 v179, v69
    s_nop 0
    v_add_f32 v219, v178, v179
    v_cvt_pk_bf16_f32 v132, v178, v179
    v_exp_f32 v180, v72
    v_exp_f32 v181, v73
    s_nop 0
    v_add_f32 v220, v180, v181
    v_cvt_pk_bf16_f32 v136, v180, v181
    v_exp_f32 v182, v76
    v_exp_f32 v183, v77
    s_nop 0
    v_add_f32 v221, v182, v183
    v_cvt_pk_bf16_f32 v140, v182, v183
    v_exp_f32 v176, v66
    s_nop 0
    v_add_f32 v218, v218, v176
    v_exp_f32 v177, v67
    s_nop 0
    v_add_f32 v218, v218, v177
    v_cvt_pk_bf16_f32 v129, v176, v177
    v_exp_f32 v178, v70
    s_nop 0
    v_add_f32 v219, v219, v178
    v_exp_f32 v179, v71
    s_nop 0
    v_add_f32 v219, v219, v179
    v_cvt_pk_bf16_f32 v133, v178, v179
    v_exp_f32 v180, v74
    s_nop 0
    v_add_f32 v220, v220, v180
    v_exp_f32 v181, v75
    s_nop 0
    v_add_f32 v220, v220, v181
    v_cvt_pk_bf16_f32 v137, v180, v181
    v_exp_f32 v182, v78
    s_nop 0
    v_add_f32 v221, v221, v182
    v_exp_f32 v183, v79
    s_nop 0
    v_add_f32 v221, v221, v183
    v_cvt_pk_bf16_f32 v141, v182, v183
    v_exp_f32 v176, v80
    s_nop 0
    v_add_f32 v218, v218, v176
    v_exp_f32 v177, v81
    s_nop 0
    v_add_f32 v218, v218, v177
    v_cvt_pk_bf16_f32 v130, v176, v177
    v_exp_f32 v178, v84
    s_nop 0
    v_add_f32 v219, v219, v178
    v_exp_f32 v179, v85
    s_nop 0
    v_add_f32 v219, v219, v179
    v_cvt_pk_bf16_f32 v134, v178, v179
    v_exp_f32 v180, v88
    s_nop 0
    v_add_f32 v220, v220, v180
    v_exp_f32 v181, v89
    s_nop 0
    v_add_f32 v220, v220, v181
    v_cvt_pk_bf16_f32 v138, v180, v181
    v_exp_f32 v182, v92
    s_nop 0
    v_add_f32 v221, v221, v182
    v_exp_f32 v183, v93
    s_nop 0
    v_add_f32 v221, v221, v183
    v_cvt_pk_bf16_f32 v142, v182, v183
    v_exp_f32 v176, v82
    s_nop 0
    v_add_f32 v218, v218, v176
    v_exp_f32 v177, v83
    s_nop 0
    v_add_f32 v218, v218, v177
    v_cvt_pk_bf16_f32 v131, v176, v177
    v_exp_f32 v178, v86
    s_nop 0
    v_add_f32 v219, v219, v178
    v_exp_f32 v179, v87
    s_nop 0
    v_add_f32 v219, v219, v179
    v_cvt_pk_bf16_f32 v135, v178, v179
    v_exp_f32 v180, v90
    s_nop 0
    v_add_f32 v220, v220, v180
    v_exp_f32 v181, v91
    s_nop 0
    v_add_f32 v220, v220, v181
    v_cvt_pk_bf16_f32 v139, v180, v181
    v_exp_f32 v182, v94
    s_nop 0
    v_add_f32 v221, v221, v182
    v_exp_f32 v183, v95
    s_nop 0
    v_add_f32 v221, v221, v183
    v_cvt_pk_bf16_f32 v143, v182, v183
    s_nop 3
    s_branch attn_back2
attn_rare3:
    s_nop 15
    v_max3_f32 v184, v96, v97, v98
    v_max3_f32 v184, v184, v99, v112
    v_max3_f32 v184, v184, v113, v114
    v_max_f32 v184, v184, v115
    v_mov_b32 v185, v184
    s_nop 1
    v_permlane16_swap_b32 v184, v185
    v_max_f32 v184, v184, v185
    v_mov_b32 v185, v184
    s_nop 1
    v_permlane32_swap_b32 v184, v185
    v_max_f32 v184, v184, v185
    v_add_f32 v185, 0x42c80000, v184
    v_cmp_gt_f32 vcc, v184, v226
    s_nop 1
    v_cndmask_b32 v185, 0, v185, vcc
    v_sub_f32 v96, v96, v185
    v_sub_f32 v112, v112, v185
    v_sub_f32 v97, v97, v185
    v_sub_f32 v113, v113, v185
    v_sub_f32 v98, v98, v185
    v_sub_f32 v114, v114, v185
    v_sub_f32 v99, v99, v185
    v_sub_f32 v115, v115, v185
    v_sub_f32 v64, v64, v185
    v_sub_f32 v65, v65, v185
    v_sub_f32 v66, v66, v185
    v_sub_f32 v67, v67, v185
    v_sub_f32 v80, v80, v185
    v_sub_f32 v81, v81, v185
    v_sub_f32 v82, v82, v185
    v_sub_f32 v83, v83, v185
    v_sub_f32 v160, v160, v185
    v_sub_f32 v161, v161, v185
    v_sub_f32 v162, v162, v185
    v_sub_f32 v163, v163, v185
    v_sub_f32 v185, 0, v185
    v_exp_f32 v185, v185
    s_nop 0
    v_mul_f32 v214, v214, v185
    v_accvgpr_read_b32 v186, a0
    v_mul_f32 v186, v186, v185
    v_accvgpr_write_b32 a0, v186
    v_accvgpr_read_b32 v187, a1
    v_mul_f32 v187, v187, v185
    v_accvgpr_write_b32 a1, v187
    v_accvgpr_read_b32 v188, a2
    v_mul_f32 v188, v188, v185
    v_accvgpr_write_b32 a2, v188
    v_accvgpr_read_b32 v189, a3
    v_mul_f32 v189, v189, v185
    v_accvgpr_write_b32 a3, v189
    v_accvgpr_read_b32 v186, a16
    v_mul_f32 v186, v186, v185
    v_accvgpr_write_b32 a16, v186
    v_accvgpr_read_b32 v187, a17
    v_mul_f32 v187, v187, v185
    v_accvgpr_write_b32 a17, v187
    v_accvgpr_read_b32 v188, a18
    v_mul_f32 v188, v188, v185
    v_accvgpr_write_b32 a18, v188
    v_accvgpr_read_b32 v189, a19
    v_mul_f32 v189, v189, v185
    v_accvgpr_write_b32 a19, v189
    v_accvgpr_read_b32 v186, a32
    v_mul_f32 v186, v186, v185
    v_accvgpr_write_b32 a32, v186
    v_accvgpr_read_b32 v187, a33
    v_mul_f32 v187, v187, v185
    v_accvgpr_write_b32 a33, v187
    v_accvgpr_read_b32 v188, a34
    v_mul_f32 v188, v188, v185
    v_accvgpr_write_b32 a34, v188
    v_accvgpr_read_b32 v189, a35
    v_mul_f32 v189, v189, v185
    v_accvgpr_write_b32 a35, v189
    v_accvgpr_read_b32 v186, a48
    v_mul_f32 v186, v186, v185
    v_accvgpr_write_b32 a48, v186
    v_accvgpr_read_b32 v187, a49
    v_mul_f32 v187, v187, v185
    v_accvgpr_write_b32 a49, v187
    v_accvgpr_read_b32 v188, a50
    v_mul_f32 v188, v188, v185
    v_accvgpr_write_b32 a50, v188
    v_accvgpr_read_b32 v189, a51
    v_mul_f32 v189, v189, v185
    v_accvgpr_write_b32 a51, v189
    v_accvgpr_read_b32 v186, a64
    v_mul_f32 v186, v186, v185
    v_accvgpr_write_b32 a64, v186
    v_accvgpr_read_b32 v187, a65
    v_mul_f32 v187, v187, v185
    v_accvgpr_write_b32 a65, v187
    v_accvgpr_read_b32 v188, a66
    v_mul_f32 v188, v188, v185
    v_accvgpr_write_b32 a66, v188
    v_accvgpr_read_b32 v189, a67
    v_mul_f32 v189, v189, v185
    v_accvgpr_write_b32 a67, v189
    v_accvgpr_read_b32 v186, a80
    v_mul_f32 v186, v186, v185
    v_accvgpr_write_b32 a80, v186
    v_accvgpr_read_b32 v187, a81
    v_mul_f32 v187, v187, v185
    v_accvgpr_write_b32 a81, v187
    v_accvgpr_read_b32 v188, a82
    v_mul_f32 v188, v188, v185
    v_accvgpr_write_b32 a82, v188
    v_accvgpr_read_b32 v189, a83
    v_mul_f32 v189, v189, v185
    v_accvgpr_write_b32 a83, v189
    v_accvgpr_read_b32 v186, a96
    v_mul_f32 v186, v186, v185
    v_accvgpr_write_b32 a96, v186
    v_accvgpr_read_b32 v187, a97
    v_mul_f32 v187, v187, v185
    v_accvgpr_write_b32 a97, v187
    v_accvgpr_read_b32 v188, a98
    v_mul_f32 v188, v188, v185
    v_accvgpr_write_b32 a98, v188
    v_accvgpr_read_b32 v189, a99
    v_mul_f32 v189, v189, v185
    v_accvgpr_write_b32 a99, v189
    v_accvgpr_read_b32 v186, a112
    v_mul_f32 v186, v186, v185
    v_accvgpr_write_b32 a112, v186
    v_accvgpr_read_b32 v187, a113
    v_mul_f32 v187, v187, v185
    v_accvgpr_write_b32 a113, v187
    v_accvgpr_read_b32 v188, a114
    v_mul_f32 v188, v188, v185
    v_accvgpr_write_b32 a114, v188
    v_accvgpr_read_b32 v189, a115
    v_mul_f32 v189, v189, v185
    v_accvgpr_write_b32 a115, v189
    v_max3_f32 v184, v100, v101, v102
    v_max3_f32 v184, v184, v103, v116
    v_max3_f32 v184, v184, v117, v118
    v_max_f32 v184, v184, v119
    v_mov_b32 v185, v184
    s_nop 1
    v_permlane16_swap_b32 v184, v185
    v_max_f32 v184, v184, v185
    v_mov_b32 v185, v184
    s_nop 1
    v_permlane32_swap_b32 v184, v185
    v_max_f32 v184, v184, v185
    v_add_f32 v185, 0x42c80000, v184
    v_cmp_gt_f32 vcc, v184, v226
    s_nop 1
    v_cndmask_b32 v185, 0, v185, vcc
    v_sub_f32 v100, v100, v185
    v_sub_f32 v116, v116, v185
    v_sub_f32 v101, v101, v185
    v_sub_f32 v117, v117, v185
    v_sub_f32 v102, v102, v185
    v_sub_f32 v118, v118, v185
    v_sub_f32 v103, v103, v185
    v_sub_f32 v119, v119, v185
    v_sub_f32 v68, v68, v185
    v_sub_f32 v69, v69, v185
    v_sub_f32 v70, v70, v185
    v_sub_f32 v71, v71, v185
    v_sub_f32 v84, v84, v185
    v_sub_f32 v85, v85, v185
    v_sub_f32 v86, v86, v185
    v_sub_f32 v87, v87, v185
    v_sub_f32 v164, v164, v185
    v_sub_f32 v165, v165, v185
    v_sub_f32 v166, v166, v185
    v_sub_f32 v167, v167, v185
    v_sub_f32 v185, 0, v185
    v_exp_f32 v185, v185
    s_nop 0
    v_mul_f32 v215, v215, v185
    v_accvgpr_read_b32 v186, a4
    v_mul_f32 v186, v186, v185
    v_accvgpr_write_b32 a4, v186
    v_accvgpr_read_b32 v187, a5
    v_mul_f32 v187, v187, v185
    v_accvgpr_write_b32 a5, v187
    v_accvgpr_read_b32 v188, a6
    v_mul_f32 v188, v188, v185
    v_accvgpr_write_b32 a6, v188
    v_accvgpr_read_b32 v189, a7
    v_mul_f32 v189, v189, v185
    v_accvgpr_write_b32 a7, v189
    v_accvgpr_read_b32 v186, a20
    v_mul_f32 v186, v186, v185
    v_accvgpr_write_b32 a20, v186
    v_accvgpr_read_b32 v187, a21
    v_mul_f32 v187, v187, v185
    v_accvgpr_write_b32 a21, v187
    v_accvgpr_read_b32 v188, a22
    v_mul_f32 v188, v188, v185
    v_accvgpr_write_b32 a22, v188
    v_accvgpr_read_b32 v189, a23
    v_mul_f32 v189, v189, v185
    v_accvgpr_write_b32 a23, v189
    v_accvgpr_read_b32 v186, a36
    v_mul_f32 v186, v186, v185
    v_accvgpr_write_b32 a36, v186
    v_accvgpr_read_b32 v187, a37
    v_mul_f32 v187, v187, v185
    v_accvgpr_write_b32 a37, v187
    v_accvgpr_read_b32 v188, a38
    v_mul_f32 v188, v188, v185
    v_accvgpr_write_b32 a38, v188
    v_accvgpr_read_b32 v189, a39
    v_mul_f32 v189, v189, v185
    v_accvgpr_write_b32 a39, v189
    v_accvgpr_read_b32 v186, a52
    v_mul_f32 v186, v186, v185
    v_accvgpr_write_b32 a52, v186
    v_accvgpr_read_b32 v187, a53
    v_mul_f32 v187, v187, v185
    v_accvgpr_write_b32 a53, v187
    v_accvgpr_read_b32 v188, a54
    v_mul_f32 v188, v188, v185
    v_accvgpr_write_b32 a54, v188
    v_accvgpr_read_b32 v189, a55
    v_mul_f32 v189, v189, v185
    v_accvgpr_write_b32 a55, v189
    v_accvgpr_read_b32 v186, a68
    v_mul_f32 v186, v186, v185
    v_accvgpr_write_b32 a68, v186
    v_accvgpr_read_b32 v187, a69
    v_mul_f32 v187, v187, v185
    v_accvgpr_write_b32 a69, v187
    v_accvgpr_read_b32 v188, a70
    v_mul_f32 v188, v188, v185
    v_accvgpr_write_b32 a70, v188
    v_accvgpr_read_b32 v189, a71
    v_mul_f32 v189, v189, v185
    v_accvgpr_write_b32 a71, v189
    v_accvgpr_read_b32 v186, a84
    v_mul_f32 v186, v186, v185
    v_accvgpr_write_b32 a84, v186
    v_accvgpr_read_b32 v187, a85
    v_mul_f32 v187, v187, v185
    v_accvgpr_write_b32 a85, v187
    v_accvgpr_read_b32 v188, a86
    v_mul_f32 v188, v188, v185
    v_accvgpr_write_b32 a86, v188
    v_accvgpr_read_b32 v189, a87
    v_mul_f32 v189, v189, v185
    v_accvgpr_write_b32 a87, v189
    v_accvgpr_read_b32 v186, a100
    v_mul_f32 v186, v186, v185
    v_accvgpr_write_b32 a100, v186
    v_accvgpr_read_b32 v187, a101
    v_mul_f32 v187, v187, v185
    v_accvgpr_write_b32 a101, v187
    v_accvgpr_read_b32 v188, a102
    v_mul_f32 v188, v188, v185
    v_accvgpr_write_b32 a102, v188
    v_accvgpr_read_b32 v189, a103
    v_mul_f32 v189, v189, v185
    v_accvgpr_write_b32 a103, v189
    v_accvgpr_read_b32 v186, a116
    v_mul_f32 v186, v186, v185
    v_accvgpr_write_b32 a116, v186
    v_accvgpr_read_b32 v187, a117
    v_mul_f32 v187, v187, v185
    v_accvgpr_write_b32 a117, v187
    v_accvgpr_read_b32 v188, a118
    v_mul_f32 v188, v188, v185
    v_accvgpr_write_b32 a118, v188
    v_accvgpr_read_b32 v189, a119
    v_mul_f32 v189, v189, v185
    v_accvgpr_write_b32 a119, v189
    v_max3_f32 v184, v104, v105, v106
    v_max3_f32 v184, v184, v107, v120
    v_max3_f32 v184, v184, v121, v122
    v_max_f32 v184, v184, v123
    v_mov_b32 v185, v184
    s_nop 1
    v_permlane16_swap_b32 v184, v185
    v_max_f32 v184, v184, v185
    v_mov_b32 v185, v184
    s_nop 1
    v_permlane32_swap_b32 v184, v185
    v_max_f32 v184, v184, v185
    v_add_f32 v185, 0x42c80000, v184
    v_cmp_gt_f32 vcc, v184, v226
    s_nop 1
    v_cndmask_b32 v185, 0, v185, vcc
    v_sub_f32 v104, v104, v185
    v_sub_f32 v120, v120, v185
    v_sub_f32 v105, v105, v185
    v_sub_f32 v121, v121, v185
    v_sub_f32 v106, v106, v185
    v_sub_f32 v122, v122, v185
    v_sub_f32 v107, v107, v185
    v_sub_f32 v123, v123, v185
    v_sub_f32 v72, v72, v185
    v_sub_f32 v73, v73, v185
    v_sub_f32 v74, v74, v185
    v_sub_f32 v75, v75, v185
    v_sub_f32 v88, v88, v185
    v_sub_f32 v89, v89, v185
    v_sub_f32 v90, v90, v185
    v_sub_f32 v91, v91, v185
    v_sub_f32 v168, v168, v185
    v_sub_f32 v169, v169, v185
    v_sub_f32 v170, v170, v185
    v_sub_f32 v171, v171, v185
    v_sub_f32 v185, 0, v185
    v_exp_f32 v185, v185
    s_nop 0
    v_mul_f32 v216, v216, v185
    v_accvgpr_read_b32 v186, a8
    v_mul_f32 v186, v186, v185
    v_accvgpr_write_b32 a8, v186
    v_accvgpr_read_b32 v187, a9
    v_mul_f32 v187, v187, v185
    v_accvgpr_write_b32 a9, v187
    v_accvgpr_read_b32 v188, a10
    v_mul_f32 v188, v188, v185
    v_accvgpr_write_b32 a10, v188
    v_accvgpr_read_b32 v189, a11
    v_mul_f32 v189, v189, v185
    v_accvgpr_write_b32 a11, v189
    v_accvgpr_read_b32 v186, a24
    v_mul_f32 v186, v186, v185
    v_accvgpr_write_b32 a24, v186
    v_accvgpr_read_b32 v187, a25
    v_mul_f32 v187, v187, v185
    v_accvgpr_write_b32 a25, v187
    v_accvgpr_read_b32 v188, a26
    v_mul_f32 v188, v188, v185
    v_accvgpr_write_b32 a26, v188
    v_accvgpr_read_b32 v189, a27
    v_mul_f32 v189, v189, v185
    v_accvgpr_write_b32 a27, v189
    v_accvgpr_read_b32 v186, a40
    v_mul_f32 v186, v186, v185
    v_accvgpr_write_b32 a40, v186
    v_accvgpr_read_b32 v187, a41
    v_mul_f32 v187, v187, v185
    v_accvgpr_write_b32 a41, v187
    v_accvgpr_read_b32 v188, a42
    v_mul_f32 v188, v188, v185
    v_accvgpr_write_b32 a42, v188
    v_accvgpr_read_b32 v189, a43
    v_mul_f32 v189, v189, v185
    v_accvgpr_write_b32 a43, v189
    v_accvgpr_read_b32 v186, a56
    v_mul_f32 v186, v186, v185
    v_accvgpr_write_b32 a56, v186
    v_accvgpr_read_b32 v187, a57
    v_mul_f32 v187, v187, v185
    v_accvgpr_write_b32 a57, v187
    v_accvgpr_read_b32 v188, a58
    v_mul_f32 v188, v188, v185
    v_accvgpr_write_b32 a58, v188
    v_accvgpr_read_b32 v189, a59
    v_mul_f32 v189, v189, v185
    v_accvgpr_write_b32 a59, v189
    v_accvgpr_read_b32 v186, a72
    v_mul_f32 v186, v186, v185
    v_accvgpr_write_b32 a72, v186
    v_accvgpr_read_b32 v187, a73
    v_mul_f32 v187, v187, v185
    v_accvgpr_write_b32 a73, v187
    v_accvgpr_read_b32 v188, a74
    v_mul_f32 v188, v188, v185
    v_accvgpr_write_b32 a74, v188
    v_accvgpr_read_b32 v189, a75
    v_mul_f32 v189, v189, v185
    v_accvgpr_write_b32 a75, v189
    v_accvgpr_read_b32 v186, a88
    v_mul_f32 v186, v186, v185
    v_accvgpr_write_b32 a88, v186
    v_accvgpr_read_b32 v187, a89
    v_mul_f32 v187, v187, v185
    v_accvgpr_write_b32 a89, v187
    v_accvgpr_read_b32 v188, a90
    v_mul_f32 v188, v188, v185
    v_accvgpr_write_b32 a90, v188
    v_accvgpr_read_b32 v189, a91
    v_mul_f32 v189, v189, v185
    v_accvgpr_write_b32 a91, v189
    v_accvgpr_read_b32 v186, a104
    v_mul_f32 v186, v186, v185
    v_accvgpr_write_b32 a104, v186
    v_accvgpr_read_b32 v187, a105
    v_mul_f32 v187, v187, v185
    v_accvgpr_write_b32 a105, v187
    v_accvgpr_read_b32 v188, a106
    v_mul_f32 v188, v188, v185
    v_accvgpr_write_b32 a106, v188
    v_accvgpr_read_b32 v189, a107
    v_mul_f32 v189, v189, v185
    v_accvgpr_write_b32 a107, v189
    v_accvgpr_read_b32 v186, a120
    v_mul_f32 v186, v186, v185
    v_accvgpr_write_b32 a120, v186
    v_accvgpr_read_b32 v187, a121
    v_mul_f32 v187, v187, v185
    v_accvgpr_write_b32 a121, v187
    v_accvgpr_read_b32 v188, a122
    v_mul_f32 v188, v188, v185
    v_accvgpr_write_b32 a122, v188
    v_accvgpr_read_b32 v189, a123
    v_mul_f32 v189, v189, v185
    v_accvgpr_write_b32 a123, v189
    v_max3_f32 v184, v108, v109, v110
    v_max3_f32 v184, v184, v111, v124
    v_max3_f32 v184, v184, v125, v126
    v_max_f32 v184, v184, v127
    v_mov_b32 v185, v184
    s_nop 1
    v_permlane16_swap_b32 v184, v185
    v_max_f32 v184, v184, v185
    v_mov_b32 v185, v184
    s_nop 1
    v_permlane32_swap_b32 v184, v185
    v_max_f32 v184, v184, v185
    v_add_f32 v185, 0x42c80000, v184
    v_cmp_gt_f32 vcc, v184, v226
    s_nop 1
    v_cndmask_b32 v185, 0, v185, vcc
    v_sub_f32 v108, v108, v185
    v_sub_f32 v124, v124, v185
    v_sub_f32 v109, v109, v185
    v_sub_f32 v125, v125, v185
    v_sub_f32 v110, v110, v185
    v_sub_f32 v126, v126, v185
    v_sub_f32 v111, v111, v185
    v_sub_f32 v127, v127, v185
    v_sub_f32 v76, v76, v185
    v_sub_f32 v77, v77, v185
    v_sub_f32 v78, v78, v185
    v_sub_f32 v79, v79, v185
    v_sub_f32 v92, v92, v185
    v_sub_f32 v93, v93, v185
    v_sub_f32 v94, v94, v185
    v_sub_f32 v95, v95, v185
    v_sub_f32 v172, v172, v185
    v_sub_f32 v173, v173, v185
    v_sub_f32 v174, v174, v185
    v_sub_f32 v175, v175, v185
    v_sub_f32 v185, 0, v185
    v_exp_f32 v185, v185
    s_nop 0
    v_mul_f32 v217, v217, v185
    v_accvgpr_read_b32 v186, a12
    v_mul_f32 v186, v186, v185
    v_accvgpr_write_b32 a12, v186
    v_accvgpr_read_b32 v187, a13
    v_mul_f32 v187, v187, v185
    v_accvgpr_write_b32 a13, v187
    v_accvgpr_read_b32 v188, a14
    v_mul_f32 v188, v188, v185
    v_accvgpr_write_b32 a14, v188
    v_accvgpr_read_b32 v189, a15
    v_mul_f32 v189, v189, v185
    v_accvgpr_write_b32 a15, v189
    v_accvgpr_read_b32 v186, a28
    v_mul_f32 v186, v186, v185
    v_accvgpr_write_b32 a28, v186
    v_accvgpr_read_b32 v187, a29
    v_mul_f32 v187, v187, v185
    v_accvgpr_write_b32 a29, v187
    v_accvgpr_read_b32 v188, a30
    v_mul_f32 v188, v188, v185
    v_accvgpr_write_b32 a30, v188
    v_accvgpr_read_b32 v189, a31
    v_mul_f32 v189, v189, v185
    v_accvgpr_write_b32 a31, v189
    v_accvgpr_read_b32 v186, a44
    v_mul_f32 v186, v186, v185
    v_accvgpr_write_b32 a44, v186
    v_accvgpr_read_b32 v187, a45
    v_mul_f32 v187, v187, v185
    v_accvgpr_write_b32 a45, v187
    v_accvgpr_read_b32 v188, a46
    v_mul_f32 v188, v188, v185
    v_accvgpr_write_b32 a46, v188
    v_accvgpr_read_b32 v189, a47
    v_mul_f32 v189, v189, v185
    v_accvgpr_write_b32 a47, v189
    v_accvgpr_read_b32 v186, a60
    v_mul_f32 v186, v186, v185
    v_accvgpr_write_b32 a60, v186
    v_accvgpr_read_b32 v187, a61
    v_mul_f32 v187, v187, v185
    v_accvgpr_write_b32 a61, v187
    v_accvgpr_read_b32 v188, a62
    v_mul_f32 v188, v188, v185
    v_accvgpr_write_b32 a62, v188
    v_accvgpr_read_b32 v189, a63
    v_mul_f32 v189, v189, v185
    v_accvgpr_write_b32 a63, v189
    v_accvgpr_read_b32 v186, a76
    v_mul_f32 v186, v186, v185
    v_accvgpr_write_b32 a76, v186
    v_accvgpr_read_b32 v187, a77
    v_mul_f32 v187, v187, v185
    v_accvgpr_write_b32 a77, v187
    v_accvgpr_read_b32 v188, a78
    v_mul_f32 v188, v188, v185
    v_accvgpr_write_b32 a78, v188
    v_accvgpr_read_b32 v189, a79
    v_mul_f32 v189, v189, v185
    v_accvgpr_write_b32 a79, v189
    v_accvgpr_read_b32 v186, a92
    v_mul_f32 v186, v186, v185
    v_accvgpr_write_b32 a92, v186
    v_accvgpr_read_b32 v187, a93
    v_mul_f32 v187, v187, v185
    v_accvgpr_write_b32 a93, v187
    v_accvgpr_read_b32 v188, a94
    v_mul_f32 v188, v188, v185
    v_accvgpr_write_b32 a94, v188
    v_accvgpr_read_b32 v189, a95
    v_mul_f32 v189, v189, v185
    v_accvgpr_write_b32 a95, v189
    v_accvgpr_read_b32 v186, a108
    v_mul_f32 v186, v186, v185
    v_accvgpr_write_b32 a108, v186
    v_accvgpr_read_b32 v187, a109
    v_mul_f32 v187, v187, v185
    v_accvgpr_write_b32 a109, v187
    v_accvgpr_read_b32 v188, a110
    v_mul_f32 v188, v188, v185
    v_accvgpr_write_b32 a110, v188
    v_accvgpr_read_b32 v189, a111
    v_mul_f32 v189, v189, v185
    v_accvgpr_write_b32 a111, v189
    v_accvgpr_read_b32 v186, a124
    v_mul_f32 v186, v186, v185
    v_accvgpr_write_b32 a124, v186
    v_accvgpr_read_b32 v187, a125
    v_mul_f32 v187, v187, v185
    v_accvgpr_write_b32 a125, v187
    v_accvgpr_read_b32 v188, a126
    v_mul_f32 v188, v188, v185
    v_accvgpr_write_b32 a126, v188
    v_accvgpr_read_b32 v189, a127
    v_mul_f32 v189, v189, v185
    v_accvgpr_write_b32 a127, v189
    v_exp_f32 v176, v96
    v_exp_f32 v177, v97
    s_nop 0
    v_add_f32 v218, v176, v177
    v_cvt_pk_bf16_f32 v144, v176, v177
    v_exp_f32 v178, v100
    v_exp_f32 v179, v101
    s_nop 0
    v_add_f32 v219, v178, v179
    v_cvt_pk_bf16_f32 v148, v178, v179
    v_exp_f32 v180, v104
    v_exp_f32 v181, v105
    s_nop 0
    v_add_f32 v220, v180, v181
    v_cvt_pk_bf16_f32 v152, v180, v181
    v_exp_f32 v182, v108
    v_exp_f32 v183, v109
    s_nop 0
    v_add_f32 v221, v182, v183
    v_cvt_pk_bf16_f32 v156, v182, v183
    v_exp_f32 v176, v98
    s_nop 0
    v_add_f32 v218, v218, v176
    v_exp_f32 v177, v99
    s_nop 0
    v_add_f32 v218, v218, v177
    v_cvt_pk_bf16_f32 v145, v176, v177
    v_exp_f32 v178, v102
    s_nop 0
    v_add_f32 v219, v219, v178
    v_exp_f32 v179, v103
    s_nop 0
    v_add_f32 v219, v219, v179
    v_cvt_pk_bf16_f32 v149, v178, v179
    v_exp_f32 v180, v106
    s_nop 0
    v_add_f32 v220, v220, v180
    v_exp_f32 v181, v107
    s_nop 0
    v_add_f32 v220, v220, v181
    v_cvt_pk_bf16_f32 v153, v180, v181
    v_exp_f32 v182, v110
    s_nop 0
    v_add_f32 v221, v221, v182
    v_exp_f32 v183, v111
    s_nop 0
    v_add_f32 v221, v221, v183
    v_cvt_pk_bf16_f32 v157, v182, v183
    v_exp_f32 v176, v112
    s_nop 0
    v_add_f32 v218, v218, v176
    v_exp_f32 v177, v113
    s_nop 0
    v_add_f32 v218, v218, v177
    v_cvt_pk_bf16_f32 v146, v176, v177
    v_exp_f32 v178, v116
    s_nop 0
    v_add_f32 v219, v219, v178
    v_exp_f32 v179, v117
    s_nop 0
    v_add_f32 v219, v219, v179
    v_cvt_pk_bf16_f32 v150, v178, v179
    v_exp_f32 v180, v120
    s_nop 0
    v_add_f32 v220, v220, v180
    v_exp_f32 v181, v121
    s_nop 0
    v_add_f32 v220, v220, v181
    v_cvt_pk_bf16_f32 v154, v180, v181
    v_exp_f32 v182, v124
    s_nop 0
    v_add_f32 v221, v221, v182
    v_exp_f32 v183, v125
    s_nop 0
    v_add_f32 v221, v221, v183
    v_cvt_pk_bf16_f32 v158, v182, v183
    v_exp_f32 v176, v114
    s_nop 0
    v_add_f32 v218, v218, v176
    v_exp_f32 v177, v115
    s_nop 0
    v_add_f32 v218, v218, v177
    v_cvt_pk_bf16_f32 v147, v176, v177
    v_exp_f32 v178, v118
    s_nop 0
    v_add_f32 v219, v219, v178
    v_exp_f32 v179, v119
    s_nop 0
    v_add_f32 v219, v219, v179
    v_cvt_pk_bf16_f32 v151, v178, v179
    v_exp_f32 v180, v122
    s_nop 0
    v_add_f32 v220, v220, v180
    v_exp_f32 v181, v123
    s_nop 0
    v_add_f32 v220, v220, v181
    v_cvt_pk_bf16_f32 v155, v180, v181
    v_exp_f32 v182, v126
    s_nop 0
    v_add_f32 v221, v221, v182
    v_exp_f32 v183, v127
    s_nop 0
    v_add_f32 v221, v221, v183
    v_cvt_pk_bf16_f32 v159, v182, v183
    s_nop 3
    s_branch attn_back4
attn_rare5:
    s_nop 15
    v_max3_f32 v184, v64, v65, v66
    v_max3_f32 v184, v184, v67, v80
    v_max3_f32 v184, v184, v81, v82
    v_max_f32 v184, v184, v83
    v_mov_b32 v185, v184
    s_nop 1
    v_permlane16_swap_b32 v184, v185
    v_max_f32 v184, v184, v185
    v_mov_b32 v185, v184
    s_nop 1
    v_permlane32_swap_b32 v184, v185
    v_max_f32 v184, v184, v185
    v_add_f32 v185, 0x42c80000, v184
    v_cmp_gt_f32 vcc, v184, v226
    s_nop 1
    v_cndmask_b32 v185, 0, v185, vcc
    v_sub_f32 v64, v64, v185
    v_sub_f32 v80, v80, v185
    v_sub_f32 v65, v65, v185
    v_sub_f32 v81, v81, v185
    v_sub_f32 v66, v66, v185
    v_sub_f32 v82, v82, v185
    v_sub_f32 v67, v67, v185
    v_sub_f32 v83, v83, v185
    v_sub_f32 v96, v96, v185
    v_sub_f32 v97, v97, v185
    v_sub_f32 v98, v98, v185
    v_sub_f32 v99, v99, v185
    v_sub_f32 v112, v112, v185
    v_sub_f32 v113, v113, v185
    v_sub_f32 v114, v114, v185
    v_sub_f32 v115, v115, v185
    v_sub_f32 v160, v160, v185
    v_sub_f32 v161, v161, v185
    v_sub_f32 v162, v162, v185
    v_sub_f32 v163, v163, v185
    v_sub_f32 v185, 0, v185
    v_exp_f32 v185, v185
    s_nop 0
    v_mul_f32 v214, v214, v185
    v_accvgpr_read_b32 v186, a0
    v_mul_f32 v186, v186, v185
    v_accvgpr_write_b32 a0, v186
    v_accvgpr_read_b32 v187, a1
    v_mul_f32 v187, v187, v185
    v_accvgpr_write_b32 a1, v187
    v_accvgpr_read_b32 v188, a2
    v_mul_f32 v188, v188, v185
    v_accvgpr_write_b32 a2, v188
    v_accvgpr_read_b32 v189, a3
    v_mul_f32 v189, v189, v185
    v_accvgpr_write_b32 a3, v189
    v_accvgpr_read_b32 v186, a16
    v_mul_f32 v186, v186, v185
    v_accvgpr_write_b32 a16, v186
    v_accvgpr_read_b32 v187, a17
    v_mul_f32 v187, v187, v185
    v_accvgpr_write_b32 a17, v187
    v_accvgpr_read_b32 v188, a18
    v_mul_f32 v188, v188, v185
    v_accvgpr_write_b32 a18, v188
    v_accvgpr_read_b32 v189, a19
    v_mul_f32 v189, v189, v185
    v_accvgpr_write_b32 a19, v189
    v_accvgpr_read_b32 v186, a32
    v_mul_f32 v186, v186, v185
    v_accvgpr_write_b32 a32, v186
    v_accvgpr_read_b32 v187, a33
    v_mul_f32 v187, v187, v185
    v_accvgpr_write_b32 a33, v187
    v_accvgpr_read_b32 v188, a34
    v_mul_f32 v188, v188, v185
    v_accvgpr_write_b32 a34, v188
    v_accvgpr_read_b32 v189, a35
    v_mul_f32 v189, v189, v185
    v_accvgpr_write_b32 a35, v189
    v_accvgpr_read_b32 v186, a48
    v_mul_f32 v186, v186, v185
    v_accvgpr_write_b32 a48, v186
    v_accvgpr_read_b32 v187, a49
    v_mul_f32 v187, v187, v185
    v_accvgpr_write_b32 a49, v187
    v_accvgpr_read_b32 v188, a50
    v_mul_f32 v188, v188, v185
    v_accvgpr_write_b32 a50, v188
    v_accvgpr_read_b32 v189, a51
    v_mul_f32 v189, v189, v185
    v_accvgpr_write_b32 a51, v189
    v_accvgpr_read_b32 v186, a64
    v_mul_f32 v186, v186, v185
    v_accvgpr_write_b32 a64, v186
    v_accvgpr_read_b32 v187, a65
    v_mul_f32 v187, v187, v185
    v_accvgpr_write_b32 a65, v187
    v_accvgpr_read_b32 v188, a66
    v_mul_f32 v188, v188, v185
    v_accvgpr_write_b32 a66, v188
    v_accvgpr_read_b32 v189, a67
    v_mul_f32 v189, v189, v185
    v_accvgpr_write_b32 a67, v189
    v_accvgpr_read_b32 v186, a80
    v_mul_f32 v186, v186, v185
    v_accvgpr_write_b32 a80, v186
    v_accvgpr_read_b32 v187, a81
    v_mul_f32 v187, v187, v185
    v_accvgpr_write_b32 a81, v187
    v_accvgpr_read_b32 v188, a82
    v_mul_f32 v188, v188, v185
    v_accvgpr_write_b32 a82, v188
    v_accvgpr_read_b32 v189, a83
    v_mul_f32 v189, v189, v185
    v_accvgpr_write_b32 a83, v189
    v_accvgpr_read_b32 v186, a96
    v_mul_f32 v186, v186, v185
    v_accvgpr_write_b32 a96, v186
    v_accvgpr_read_b32 v187, a97
    v_mul_f32 v187, v187, v185
    v_accvgpr_write_b32 a97, v187
    v_accvgpr_read_b32 v188, a98
    v_mul_f32 v188, v188, v185
    v_accvgpr_write_b32 a98, v188
    v_accvgpr_read_b32 v189, a99
    v_mul_f32 v189, v189, v185
    v_accvgpr_write_b32 a99, v189
    v_accvgpr_read_b32 v186, a112
    v_mul_f32 v186, v186, v185
    v_accvgpr_write_b32 a112, v186
    v_accvgpr_read_b32 v187, a113
    v_mul_f32 v187, v187, v185
    v_accvgpr_write_b32 a113, v187
    v_accvgpr_read_b32 v188, a114
    v_mul_f32 v188, v188, v185
    v_accvgpr_write_b32 a114, v188
    v_accvgpr_read_b32 v189, a115
    v_mul_f32 v189, v189, v185
    v_accvgpr_write_b32 a115, v189
    v_max3_f32 v184, v68, v69, v70
    v_max3_f32 v184, v184, v71, v84
    v_max3_f32 v184, v184, v85, v86
    v_max_f32 v184, v184, v87
    v_mov_b32 v185, v184
    s_nop 1
    v_permlane16_swap_b32 v184, v185
    v_max_f32 v184, v184, v185
    v_mov_b32 v185, v184
    s_nop 1
    v_permlane32_swap_b32 v184, v185
    v_max_f32 v184, v184, v185
    v_add_f32 v185, 0x42c80000, v184
    v_cmp_gt_f32 vcc, v184, v226
    s_nop 1
    v_cndmask_b32 v185, 0, v185, vcc
    v_sub_f32 v68, v68, v185
    v_sub_f32 v84, v84, v185
    v_sub_f32 v69, v69, v185
    v_sub_f32 v85, v85, v185
    v_sub_f32 v70, v70, v185
    v_sub_f32 v86, v86, v185
    v_sub_f32 v71, v71, v185
    v_sub_f32 v87, v87, v185
    v_sub_f32 v100, v100, v185
    v_sub_f32 v101, v101, v185
    v_sub_f32 v102, v102, v185
    v_sub_f32 v103, v103, v185
    v_sub_f32 v116, v116, v185
    v_sub_f32 v117, v117, v185
    v_sub_f32 v118, v118, v185
    v_sub_f32 v119, v119, v185
    v_sub_f32 v164, v164, v185
    v_sub_f32 v165, v165, v185
    v_sub_f32 v166, v166, v185
    v_sub_f32 v167, v167, v185
    v_sub_f32 v185, 0, v185
    v_exp_f32 v185, v185
    s_nop 0
    v_mul_f32 v215, v215, v185
    v_accvgpr_read_b32 v186, a4
    v_mul_f32 v186, v186, v185
    v_accvgpr_write_b32 a4, v186
    v_accvgpr_read_b32 v187, a5
    v_mul_f32 v187, v187, v185
    v_accvgpr_write_b32 a5, v187
    v_accvgpr_read_b32 v188, a6
    v_mul_f32 v188, v188, v185
    v_accvgpr_write_b32 a6, v188
    v_accvgpr_read_b32 v189, a7
    v_mul_f32 v189, v189, v185
    v_accvgpr_write_b32 a7, v189
    v_accvgpr_read_b32 v186, a20
    v_mul_f32 v186, v186, v185
    v_accvgpr_write_b32 a20, v186
    v_accvgpr_read_b32 v187, a21
    v_mul_f32 v187, v187, v185
    v_accvgpr_write_b32 a21, v187
    v_accvgpr_read_b32 v188, a22
    v_mul_f32 v188, v188, v185
    v_accvgpr_write_b32 a22, v188
    v_accvgpr_read_b32 v189, a23
    v_mul_f32 v189, v189, v185
    v_accvgpr_write_b32 a23, v189
    v_accvgpr_read_b32 v186, a36
    v_mul_f32 v186, v186, v185
    v_accvgpr_write_b32 a36, v186
    v_accvgpr_read_b32 v187, a37
    v_mul_f32 v187, v187, v185
    v_accvgpr_write_b32 a37, v187
    v_accvgpr_read_b32 v188, a38
    v_mul_f32 v188, v188, v185
    v_accvgpr_write_b32 a38, v188
    v_accvgpr_read_b32 v189, a39
    v_mul_f32 v189, v189, v185
    v_accvgpr_write_b32 a39, v189
    v_accvgpr_read_b32 v186, a52
    v_mul_f32 v186, v186, v185
    v_accvgpr_write_b32 a52, v186
    v_accvgpr_read_b32 v187, a53
    v_mul_f32 v187, v187, v185
    v_accvgpr_write_b32 a53, v187
    v_accvgpr_read_b32 v188, a54
    v_mul_f32 v188, v188, v185
    v_accvgpr_write_b32 a54, v188
    v_accvgpr_read_b32 v189, a55
    v_mul_f32 v189, v189, v185
    v_accvgpr_write_b32 a55, v189
    v_accvgpr_read_b32 v186, a68
    v_mul_f32 v186, v186, v185
    v_accvgpr_write_b32 a68, v186
    v_accvgpr_read_b32 v187, a69
    v_mul_f32 v187, v187, v185
    v_accvgpr_write_b32 a69, v187
    v_accvgpr_read_b32 v188, a70
    v_mul_f32 v188, v188, v185
    v_accvgpr_write_b32 a70, v188
    v_accvgpr_read_b32 v189, a71
    v_mul_f32 v189, v189, v185
    v_accvgpr_write_b32 a71, v189
    v_accvgpr_read_b32 v186, a84
    v_mul_f32 v186, v186, v185
    v_accvgpr_write_b32 a84, v186
    v_accvgpr_read_b32 v187, a85
    v_mul_f32 v187, v187, v185
    v_accvgpr_write_b32 a85, v187
    v_accvgpr_read_b32 v188, a86
    v_mul_f32 v188, v188, v185
    v_accvgpr_write_b32 a86, v188
    v_accvgpr_read_b32 v189, a87
    v_mul_f32 v189, v189, v185
    v_accvgpr_write_b32 a87, v189
    v_accvgpr_read_b32 v186, a100
    v_mul_f32 v186, v186, v185
    v_accvgpr_write_b32 a100, v186
    v_accvgpr_read_b32 v187, a101
    v_mul_f32 v187, v187, v185
    v_accvgpr_write_b32 a101, v187
    v_accvgpr_read_b32 v188, a102
    v_mul_f32 v188, v188, v185
    v_accvgpr_write_b32 a102, v188
    v_accvgpr_read_b32 v189, a103
    v_mul_f32 v189, v189, v185
    v_accvgpr_write_b32 a103, v189
    v_accvgpr_read_b32 v186, a116
    v_mul_f32 v186, v186, v185
    v_accvgpr_write_b32 a116, v186
    v_accvgpr_read_b32 v187, a117
    v_mul_f32 v187, v187, v185
    v_accvgpr_write_b32 a117, v187
    v_accvgpr_read_b32 v188, a118
    v_mul_f32 v188, v188, v185
    v_accvgpr_write_b32 a118, v188
    v_accvgpr_read_b32 v189, a119
    v_mul_f32 v189, v189, v185
    v_accvgpr_write_b32 a119, v189
    v_max3_f32 v184, v72, v73, v74
    v_max3_f32 v184, v184, v75, v88
    v_max3_f32 v184, v184, v89, v90
    v_max_f32 v184, v184, v91
    v_mov_b32 v185, v184
    s_nop 1
    v_permlane16_swap_b32 v184, v185
    v_max_f32 v184, v184, v185
    v_mov_b32 v185, v184
    s_nop 1
    v_permlane32_swap_b32 v184, v185
    v_max_f32 v184, v184, v185
    v_add_f32 v185, 0x42c80000, v184
    v_cmp_gt_f32 vcc, v184, v226
    s_nop 1
    v_cndmask_b32 v185, 0, v185, vcc
    v_sub_f32 v72, v72, v185
    v_sub_f32 v88, v88, v185
    v_sub_f32 v73, v73, v185
    v_sub_f32 v89, v89, v185
    v_sub_f32 v74, v74, v185
    v_sub_f32 v90, v90, v185
    v_sub_f32 v75, v75, v185
    v_sub_f32 v91, v91, v185
    v_sub_f32 v104, v104, v185
    v_sub_f32 v105, v105, v185
    v_sub_f32 v106, v106, v185
    v_sub_f32 v107, v107, v185
    v_sub_f32 v120, v120, v185
    v_sub_f32 v121, v121, v185
    v_sub_f32 v122, v122, v185
    v_sub_f32 v123, v123, v185
    v_sub_f32 v168, v168, v185
    v_sub_f32 v169, v169, v185
    v_sub_f32 v170, v170, v185
    v_sub_f32 v171, v171, v185
    v_sub_f32 v185, 0, v185
    v_exp_f32 v185, v185
    s_nop 0
    v_mul_f32 v216, v216, v185
    v_accvgpr_read_b32 v186, a8
    v_mul_f32 v186, v186, v185
    v_accvgpr_write_b32 a8, v186
    v_accvgpr_read_b32 v187, a9
    v_mul_f32 v187, v187, v185
    v_accvgpr_write_b32 a9, v187
    v_accvgpr_read_b32 v188, a10
    v_mul_f32 v188, v188, v185
    v_accvgpr_write_b32 a10, v188
    v_accvgpr_read_b32 v189, a11
    v_mul_f32 v189, v189, v185
    v_accvgpr_write_b32 a11, v189
    v_accvgpr_read_b32 v186, a24
    v_mul_f32 v186, v186, v185
    v_accvgpr_write_b32 a24, v186
    v_accvgpr_read_b32 v187, a25
    v_mul_f32 v187, v187, v185
    v_accvgpr_write_b32 a25, v187
    v_accvgpr_read_b32 v188, a26
    v_mul_f32 v188, v188, v185
    v_accvgpr_write_b32 a26, v188
    v_accvgpr_read_b32 v189, a27
    v_mul_f32 v189, v189, v185
    v_accvgpr_write_b32 a27, v189
    v_accvgpr_read_b32 v186, a40
    v_mul_f32 v186, v186, v185
    v_accvgpr_write_b32 a40, v186
    v_accvgpr_read_b32 v187, a41
    v_mul_f32 v187, v187, v185
    v_accvgpr_write_b32 a41, v187
    v_accvgpr_read_b32 v188, a42
    v_mul_f32 v188, v188, v185
    v_accvgpr_write_b32 a42, v188
    v_accvgpr_read_b32 v189, a43
    v_mul_f32 v189, v189, v185
    v_accvgpr_write_b32 a43, v189
    v_accvgpr_read_b32 v186, a56
    v_mul_f32 v186, v186, v185
    v_accvgpr_write_b32 a56, v186
    v_accvgpr_read_b32 v187, a57
    v_mul_f32 v187, v187, v185
    v_accvgpr_write_b32 a57, v187
    v_accvgpr_read_b32 v188, a58
    v_mul_f32 v188, v188, v185
    v_accvgpr_write_b32 a58, v188
    v_accvgpr_read_b32 v189, a59
    v_mul_f32 v189, v189, v185
    v_accvgpr_write_b32 a59, v189
    v_accvgpr_read_b32 v186, a72
    v_mul_f32 v186, v186, v185
    v_accvgpr_write_b32 a72, v186
    v_accvgpr_read_b32 v187, a73
    v_mul_f32 v187, v187, v185
    v_accvgpr_write_b32 a73, v187
    v_accvgpr_read_b32 v188, a74
    v_mul_f32 v188, v188, v185
    v_accvgpr_write_b32 a74, v188
    v_accvgpr_read_b32 v189, a75
    v_mul_f32 v189, v189, v185
    v_accvgpr_write_b32 a75, v189
    v_accvgpr_read_b32 v186, a88
    v_mul_f32 v186, v186, v185
    v_accvgpr_write_b32 a88, v186
    v_accvgpr_read_b32 v187, a89
    v_mul_f32 v187, v187, v185
    v_accvgpr_write_b32 a89, v187
    v_accvgpr_read_b32 v188, a90
    v_mul_f32 v188, v188, v185
    v_accvgpr_write_b32 a90, v188
    v_accvgpr_read_b32 v189, a91
    v_mul_f32 v189, v189, v185
    v_accvgpr_write_b32 a91, v189
    v_accvgpr_read_b32 v186, a104
    v_mul_f32 v186, v186, v185
    v_accvgpr_write_b32 a104, v186
    v_accvgpr_read_b32 v187, a105
    v_mul_f32 v187, v187, v185
    v_accvgpr_write_b32 a105, v187
    v_accvgpr_read_b32 v188, a106
    v_mul_f32 v188, v188, v185
    v_accvgpr_write_b32 a106, v188
    v_accvgpr_read_b32 v189, a107
    v_mul_f32 v189, v189, v185
    v_accvgpr_write_b32 a107, v189
    v_accvgpr_read_b32 v186, a120
    v_mul_f32 v186, v186, v185
    v_accvgpr_write_b32 a120, v186
    v_accvgpr_read_b32 v187, a121
    v_mul_f32 v187, v187, v185
    v_accvgpr_write_b32 a121, v187
    v_accvgpr_read_b32 v188, a122
    v_mul_f32 v188, v188, v185
    v_accvgpr_write_b32 a122, v188
    v_accvgpr_read_b32 v189, a123
    v_mul_f32 v189, v189, v185
    v_accvgpr_write_b32 a123, v189
    v_max3_f32 v184, v76, v77, v78
    v_max3_f32 v184, v184, v79, v92
    v_max3_f32 v184, v184, v93, v94
    v_max_f32 v184, v184, v95
    v_mov_b32 v185, v184
    s_nop 1
    v_permlane16_swap_b32 v184, v185
    v_max_f32 v184, v184, v185
    v_mov_b32 v185, v184
    s_nop 1
    v_permlane32_swap_b32 v184, v185
    v_max_f32 v184, v184, v185
    v_add_f32 v185, 0x42c80000, v184
    v_cmp_gt_f32 vcc, v184, v226
    s_nop 1
    v_cndmask_b32 v185, 0, v185, vcc
    v_sub_f32 v76, v76, v185
    v_sub_f32 v92, v92, v185
    v_sub_f32 v77, v77, v185
    v_sub_f32 v93, v93, v185
    v_sub_f32 v78, v78, v185
    v_sub_f32 v94, v94, v185
    v_sub_f32 v79, v79, v185
    v_sub_f32 v95, v95, v185
    v_sub_f32 v108, v108, v185
    v_sub_f32 v109, v109, v185
    v_sub_f32 v110, v110, v185
    v_sub_f32 v111, v111, v185
    v_sub_f32 v124, v124, v185
    v_sub_f32 v125, v125, v185
    v_sub_f32 v126, v126, v185
    v_sub_f32 v127, v127, v185
    v_sub_f32 v172, v172, v185
    v_sub_f32 v173, v173, v185
    v_sub_f32 v174, v174, v185
    v_sub_f32 v175, v175, v185
    v_sub_f32 v185, 0, v185
    v_exp_f32 v185, v185
    s_nop 0
    v_mul_f32 v217, v217, v185
    v_accvgpr_read_b32 v186, a12
    v_mul_f32 v186, v186, v185
    v_accvgpr_write_b32 a12, v186
    v_accvgpr_read_b32 v187, a13
    v_mul_f32 v187, v187, v185
    v_accvgpr_write_b32 a13, v187
    v_accvgpr_read_b32 v188, a14
    v_mul_f32 v188, v188, v185
    v_accvgpr_write_b32 a14, v188
    v_accvgpr_read_b32 v189, a15
    v_mul_f32 v189, v189, v185
    v_accvgpr_write_b32 a15, v189
    v_accvgpr_read_b32 v186, a28
    v_mul_f32 v186, v186, v185
    v_accvgpr_write_b32 a28, v186
    v_accvgpr_read_b32 v187, a29
    v_mul_f32 v187, v187, v185
    v_accvgpr_write_b32 a29, v187
    v_accvgpr_read_b32 v188, a30
    v_mul_f32 v188, v188, v185
    v_accvgpr_write_b32 a30, v188
    v_accvgpr_read_b32 v189, a31
    v_mul_f32 v189, v189, v185
    v_accvgpr_write_b32 a31, v189
    v_accvgpr_read_b32 v186, a44
    v_mul_f32 v186, v186, v185
    v_accvgpr_write_b32 a44, v186
    v_accvgpr_read_b32 v187, a45
    v_mul_f32 v187, v187, v185
    v_accvgpr_write_b32 a45, v187
    v_accvgpr_read_b32 v188, a46
    v_mul_f32 v188, v188, v185
    v_accvgpr_write_b32 a46, v188
    v_accvgpr_read_b32 v189, a47
    v_mul_f32 v189, v189, v185
    v_accvgpr_write_b32 a47, v189
    v_accvgpr_read_b32 v186, a60
    v_mul_f32 v186, v186, v185
    v_accvgpr_write_b32 a60, v186
    v_accvgpr_read_b32 v187, a61
    v_mul_f32 v187, v187, v185
    v_accvgpr_write_b32 a61, v187
    v_accvgpr_read_b32 v188, a62
    v_mul_f32 v188, v188, v185
    v_accvgpr_write_b32 a62, v188
    v_accvgpr_read_b32 v189, a63
    v_mul_f32 v189, v189, v185
    v_accvgpr_write_b32 a63, v189
    v_accvgpr_read_b32 v186, a76
    v_mul_f32 v186, v186, v185
    v_accvgpr_write_b32 a76, v186
    v_accvgpr_read_b32 v187, a77
    v_mul_f32 v187, v187, v185
    v_accvgpr_write_b32 a77, v187
    v_accvgpr_read_b32 v188, a78
    v_mul_f32 v188, v188, v185
    v_accvgpr_write_b32 a78, v188
    v_accvgpr_read_b32 v189, a79
    v_mul_f32 v189, v189, v185
    v_accvgpr_write_b32 a79, v189
    v_accvgpr_read_b32 v186, a92
    v_mul_f32 v186, v186, v185
    v_accvgpr_write_b32 a92, v186
    v_accvgpr_read_b32 v187, a93
    v_mul_f32 v187, v187, v185
    v_accvgpr_write_b32 a93, v187
    v_accvgpr_read_b32 v188, a94
    v_mul_f32 v188, v188, v185
    v_accvgpr_write_b32 a94, v188
    v_accvgpr_read_b32 v189, a95
    v_mul_f32 v189, v189, v185
    v_accvgpr_write_b32 a95, v189
    v_accvgpr_read_b32 v186, a108
    v_mul_f32 v186, v186, v185
    v_accvgpr_write_b32 a108, v186
    v_accvgpr_read_b32 v187, a109
    v_mul_f32 v187, v187, v185
    v_accvgpr_write_b32 a109, v187
    v_accvgpr_read_b32 v188, a110
    v_mul_f32 v188, v188, v185
    v_accvgpr_write_b32 a110, v188
    v_accvgpr_read_b32 v189, a111
    v_mul_f32 v189, v189, v185
    v_accvgpr_write_b32 a111, v189
    v_accvgpr_read_b32 v186, a124
    v_mul_f32 v186, v186, v185
    v_accvgpr_write_b32 a124, v186
    v_accvgpr_read_b32 v187, a125
    v_mul_f32 v187, v187, v185
    v_accvgpr_write_b32 a125, v187
    v_accvgpr_read_b32 v188, a126
    v_mul_f32 v188, v188, v185
    v_accvgpr_write_b32 a126, v188
    v_accvgpr_read_b32 v189, a127
    v_mul_f32 v189, v189, v185
    v_accvgpr_write_b32 a127, v189
    v_exp_f32 v176, v64
    v_exp_f32 v177, v65
    s_nop 0
    v_add_f32 v218, v176, v177
    v_cvt_pk_bf16_f32 v128, v176, v177
    v_exp_f32 v178, v68
    v_exp_f32 v179, v69
    s_nop 0
    v_add_f32 v219, v178, v179
    v_cvt_pk_bf16_f32 v132, v178, v179
    v_exp_f32 v180, v72
    v_exp_f32 v181, v73
    s_nop 0
    v_add_f32 v220, v180, v181
    v_cvt_pk_bf16_f32 v136, v180, v181
    v_exp_f32 v182, v76
    v_exp_f32 v183, v77
    s_nop 0
    v_add_f32 v221, v182, v183
    v_cvt_pk_bf16_f32 v140, v182, v183
    v_exp_f32 v176, v66
    s_nop 0
    v_add_f32 v218, v218, v176
    v_exp_f32 v177, v67
    s_nop 0
    v_add_f32 v218, v218, v177
    v_cvt_pk_bf16_f32 v129, v176, v177
    v_exp_f32 v178, v70
    s_nop 0
    v_add_f32 v219, v219, v178
    v_exp_f32 v179, v71
    s_nop 0
    v_add_f32 v219, v219, v179
    v_cvt_pk_bf16_f32 v133, v178, v179
    v_exp_f32 v180, v74
    s_nop 0
    v_add_f32 v220, v220, v180
    v_exp_f32 v181, v75
    s_nop 0
    v_add_f32 v220, v220, v181
    v_cvt_pk_bf16_f32 v137, v180, v181
    v_exp_f32 v182, v78
    s_nop 0
    v_add_f32 v221, v221, v182
    v_exp_f32 v183, v79
    s_nop 0
    v_add_f32 v221, v221, v183
    v_cvt_pk_bf16_f32 v141, v182, v183
    v_exp_f32 v176, v80
    s_nop 0
    v_add_f32 v218, v218, v176
    v_exp_f32 v177, v81
    s_nop 0
    v_add_f32 v218, v218, v177
    v_cvt_pk_bf16_f32 v130, v176, v177
    v_exp_f32 v178, v84
    s_nop 0
    v_add_f32 v219, v219, v178
    v_exp_f32 v179, v85
    s_nop 0
    v_add_f32 v219, v219, v179
    v_cvt_pk_bf16_f32 v134, v178, v179
    v_exp_f32 v180, v88
    s_nop 0
    v_add_f32 v220, v220, v180
    v_exp_f32 v181, v89
    s_nop 0
    v_add_f32 v220, v220, v181
    v_cvt_pk_bf16_f32 v138, v180, v181
    v_exp_f32 v182, v92
    s_nop 0
    v_add_f32 v221, v221, v182
    v_exp_f32 v183, v93
    s_nop 0
    v_add_f32 v221, v221, v183
    v_cvt_pk_bf16_f32 v142, v182, v183
    v_exp_f32 v176, v82
    s_nop 0
    v_add_f32 v218, v218, v176
    v_exp_f32 v177, v83
    s_nop 0
    v_add_f32 v218, v218, v177
    v_cvt_pk_bf16_f32 v131, v176, v177
    v_exp_f32 v178, v86
    s_nop 0
    v_add_f32 v219, v219, v178
    v_exp_f32 v179, v87
    s_nop 0
    v_add_f32 v219, v219, v179
    v_cvt_pk_bf16_f32 v135, v178, v179
    v_exp_f32 v180, v90
    s_nop 0
    v_add_f32 v220, v220, v180
    v_exp_f32 v181, v91
    s_nop 0
    v_add_f32 v220, v220, v181
    v_cvt_pk_bf16_f32 v139, v180, v181
    v_exp_f32 v182, v94
    s_nop 0
    v_add_f32 v221, v221, v182
    v_exp_f32 v183, v95
    s_nop 0
    v_add_f32 v221, v221, v183
    v_cvt_pk_bf16_f32 v143, v182, v183
    s_nop 3
    s_branch attn_back6
attn_rare7:
    s_nop 15
    v_max3_f32 v184, v96, v97, v98
    v_max3_f32 v184, v184, v99, v112
    v_max3_f32 v184, v184, v113, v114
    v_max_f32 v184, v184, v115
    v_mov_b32 v185, v184
    s_nop 1
    v_permlane16_swap_b32 v184, v185
    v_max_f32 v184, v184, v185
    v_mov_b32 v185, v184
    s_nop 1
    v_permlane32_swap_b32 v184, v185
    v_max_f32 v184, v184, v185
    v_add_f32 v185, 0x42c80000, v184
    v_cmp_gt_f32 vcc, v184, v226
    s_nop 1
    v_cndmask_b32 v185, 0, v185, vcc
    v_sub_f32 v96, v96, v185
    v_sub_f32 v112, v112, v185
    v_sub_f32 v97, v97, v185
    v_sub_f32 v113, v113, v185
    v_sub_f32 v98, v98, v185
    v_sub_f32 v114, v114, v185
    v_sub_f32 v99, v99, v185
    v_sub_f32 v115, v115, v185
    v_sub_f32 v64, v64, v185
    v_sub_f32 v65, v65, v185
    v_sub_f32 v66, v66, v185
    v_sub_f32 v67, v67, v185
    v_sub_f32 v80, v80, v185
    v_sub_f32 v81, v81, v185
    v_sub_f32 v82, v82, v185
    v_sub_f32 v83, v83, v185
    v_sub_f32 v160, v160, v185
    v_sub_f32 v161, v161, v185
    v_sub_f32 v162, v162, v185
    v_sub_f32 v163, v163, v185
    v_sub_f32 v185, 0, v185
    v_exp_f32 v185, v185
    s_nop 0
    v_mul_f32 v214, v214, v185
    v_accvgpr_read_b32 v186, a0
    v_mul_f32 v186, v186, v185
    v_accvgpr_write_b32 a0, v186
    v_accvgpr_read_b32 v187, a1
    v_mul_f32 v187, v187, v185
    v_accvgpr_write_b32 a1, v187
    v_accvgpr_read_b32 v188, a2
    v_mul_f32 v188, v188, v185
    v_accvgpr_write_b32 a2, v188
    v_accvgpr_read_b32 v189, a3
    v_mul_f32 v189, v189, v185
    v_accvgpr_write_b32 a3, v189
    v_accvgpr_read_b32 v186, a16
    v_mul_f32 v186, v186, v185
    v_accvgpr_write_b32 a16, v186
    v_accvgpr_read_b32 v187, a17
    v_mul_f32 v187, v187, v185
    v_accvgpr_write_b32 a17, v187
    v_accvgpr_read_b32 v188, a18
    v_mul_f32 v188, v188, v185
    v_accvgpr_write_b32 a18, v188
    v_accvgpr_read_b32 v189, a19
    v_mul_f32 v189, v189, v185
    v_accvgpr_write_b32 a19, v189
    v_accvgpr_read_b32 v186, a32
    v_mul_f32 v186, v186, v185
    v_accvgpr_write_b32 a32, v186
    v_accvgpr_read_b32 v187, a33
    v_mul_f32 v187, v187, v185
    v_accvgpr_write_b32 a33, v187
    v_accvgpr_read_b32 v188, a34
    v_mul_f32 v188, v188, v185
    v_accvgpr_write_b32 a34, v188
    v_accvgpr_read_b32 v189, a35
    v_mul_f32 v189, v189, v185
    v_accvgpr_write_b32 a35, v189
    v_accvgpr_read_b32 v186, a48
    v_mul_f32 v186, v186, v185
    v_accvgpr_write_b32 a48, v186
    v_accvgpr_read_b32 v187, a49
    v_mul_f32 v187, v187, v185
    v_accvgpr_write_b32 a49, v187
    v_accvgpr_read_b32 v188, a50
    v_mul_f32 v188, v188, v185
    v_accvgpr_write_b32 a50, v188
    v_accvgpr_read_b32 v189, a51
    v_mul_f32 v189, v189, v185
    v_accvgpr_write_b32 a51, v189
    v_accvgpr_read_b32 v186, a64
    v_mul_f32 v186, v186, v185
    v_accvgpr_write_b32 a64, v186
    v_accvgpr_read_b32 v187, a65
    v_mul_f32 v187, v187, v185
    v_accvgpr_write_b32 a65, v187
    v_accvgpr_read_b32 v188, a66
    v_mul_f32 v188, v188, v185
    v_accvgpr_write_b32 a66, v188
    v_accvgpr_read_b32 v189, a67
    v_mul_f32 v189, v189, v185
    v_accvgpr_write_b32 a67, v189
    v_accvgpr_read_b32 v186, a80
    v_mul_f32 v186, v186, v185
    v_accvgpr_write_b32 a80, v186
    v_accvgpr_read_b32 v187, a81
    v_mul_f32 v187, v187, v185
    v_accvgpr_write_b32 a81, v187
    v_accvgpr_read_b32 v188, a82
    v_mul_f32 v188, v188, v185
    v_accvgpr_write_b32 a82, v188
    v_accvgpr_read_b32 v189, a83
    v_mul_f32 v189, v189, v185
    v_accvgpr_write_b32 a83, v189
    v_accvgpr_read_b32 v186, a96
    v_mul_f32 v186, v186, v185
    v_accvgpr_write_b32 a96, v186
    v_accvgpr_read_b32 v187, a97
    v_mul_f32 v187, v187, v185
    v_accvgpr_write_b32 a97, v187
    v_accvgpr_read_b32 v188, a98
    v_mul_f32 v188, v188, v185
    v_accvgpr_write_b32 a98, v188
    v_accvgpr_read_b32 v189, a99
    v_mul_f32 v189, v189, v185
    v_accvgpr_write_b32 a99, v189
    v_accvgpr_read_b32 v186, a112
    v_mul_f32 v186, v186, v185
    v_accvgpr_write_b32 a112, v186
    v_accvgpr_read_b32 v187, a113
    v_mul_f32 v187, v187, v185
    v_accvgpr_write_b32 a113, v187
    v_accvgpr_read_b32 v188, a114
    v_mul_f32 v188, v188, v185
    v_accvgpr_write_b32 a114, v188
    v_accvgpr_read_b32 v189, a115
    v_mul_f32 v189, v189, v185
    v_accvgpr_write_b32 a115, v189
    v_max3_f32 v184, v100, v101, v102
    v_max3_f32 v184, v184, v103, v116
    v_max3_f32 v184, v184, v117, v118
    v_max_f32 v184, v184, v119
    v_mov_b32 v185, v184
    s_nop 1
    v_permlane16_swap_b32 v184, v185
    v_max_f32 v184, v184, v185
    v_mov_b32 v185, v184
    s_nop 1
    v_permlane32_swap_b32 v184, v185
    v_max_f32 v184, v184, v185
    v_add_f32 v185, 0x42c80000, v184
    v_cmp_gt_f32 vcc, v184, v226
    s_nop 1
    v_cndmask_b32 v185, 0, v185, vcc
    v_sub_f32 v100, v100, v185
    v_sub_f32 v116, v116, v185
    v_sub_f32 v101, v101, v185
    v_sub_f32 v117, v117, v185
    v_sub_f32 v102, v102, v185
    v_sub_f32 v118, v118, v185
    v_sub_f32 v103, v103, v185
    v_sub_f32 v119, v119, v185
    v_sub_f32 v68, v68, v185
    v_sub_f32 v69, v69, v185
    v_sub_f32 v70, v70, v185
    v_sub_f32 v71, v71, v185
    v_sub_f32 v84, v84, v185
    v_sub_f32 v85, v85, v185
    v_sub_f32 v86, v86, v185
    v_sub_f32 v87, v87, v185
    v_sub_f32 v164, v164, v185
    v_sub_f32 v165, v165, v185
    v_sub_f32 v166, v166, v185
    v_sub_f32 v167, v167, v185
    v_sub_f32 v185, 0, v185
    v_exp_f32 v185, v185
    s_nop 0
    v_mul_f32 v215, v215, v185
    v_accvgpr_read_b32 v186, a4
    v_mul_f32 v186, v186, v185
    v_accvgpr_write_b32 a4, v186
    v_accvgpr_read_b32 v187, a5
    v_mul_f32 v187, v187, v185
    v_accvgpr_write_b32 a5, v187
    v_accvgpr_read_b32 v188, a6
    v_mul_f32 v188, v188, v185
    v_accvgpr_write_b32 a6, v188
    v_accvgpr_read_b32 v189, a7
    v_mul_f32 v189, v189, v185
    v_accvgpr_write_b32 a7, v189
    v_accvgpr_read_b32 v186, a20
    v_mul_f32 v186, v186, v185
    v_accvgpr_write_b32 a20, v186
    v_accvgpr_read_b32 v187, a21
    v_mul_f32 v187, v187, v185
    v_accvgpr_write_b32 a21, v187
    v_accvgpr_read_b32 v188, a22
    v_mul_f32 v188, v188, v185
    v_accvgpr_write_b32 a22, v188
    v_accvgpr_read_b32 v189, a23
    v_mul_f32 v189, v189, v185
    v_accvgpr_write_b32 a23, v189
    v_accvgpr_read_b32 v186, a36
    v_mul_f32 v186, v186, v185
    v_accvgpr_write_b32 a36, v186
    v_accvgpr_read_b32 v187, a37
    v_mul_f32 v187, v187, v185
    v_accvgpr_write_b32 a37, v187
    v_accvgpr_read_b32 v188, a38
    v_mul_f32 v188, v188, v185
    v_accvgpr_write_b32 a38, v188
    v_accvgpr_read_b32 v189, a39
    v_mul_f32 v189, v189, v185
    v_accvgpr_write_b32 a39, v189
    v_accvgpr_read_b32 v186, a52
    v_mul_f32 v186, v186, v185
    v_accvgpr_write_b32 a52, v186
    v_accvgpr_read_b32 v187, a53
    v_mul_f32 v187, v187, v185
    v_accvgpr_write_b32 a53, v187
    v_accvgpr_read_b32 v188, a54
    v_mul_f32 v188, v188, v185
    v_accvgpr_write_b32 a54, v188
    v_accvgpr_read_b32 v189, a55
    v_mul_f32 v189, v189, v185
    v_accvgpr_write_b32 a55, v189
    v_accvgpr_read_b32 v186, a68
    v_mul_f32 v186, v186, v185
    v_accvgpr_write_b32 a68, v186
    v_accvgpr_read_b32 v187, a69
    v_mul_f32 v187, v187, v185
    v_accvgpr_write_b32 a69, v187
    v_accvgpr_read_b32 v188, a70
    v_mul_f32 v188, v188, v185
    v_accvgpr_write_b32 a70, v188
    v_accvgpr_read_b32 v189, a71
    v_mul_f32 v189, v189, v185
    v_accvgpr_write_b32 a71, v189
    v_accvgpr_read_b32 v186, a84
    v_mul_f32 v186, v186, v185
    v_accvgpr_write_b32 a84, v186
    v_accvgpr_read_b32 v187, a85
    v_mul_f32 v187, v187, v185
    v_accvgpr_write_b32 a85, v187
    v_accvgpr_read_b32 v188, a86
    v_mul_f32 v188, v188, v185
    v_accvgpr_write_b32 a86, v188
    v_accvgpr_read_b32 v189, a87
    v_mul_f32 v189, v189, v185
    v_accvgpr_write_b32 a87, v189
    v_accvgpr_read_b32 v186, a100
    v_mul_f32 v186, v186, v185
    v_accvgpr_write_b32 a100, v186
    v_accvgpr_read_b32 v187, a101
    v_mul_f32 v187, v187, v185
    v_accvgpr_write_b32 a101, v187
    v_accvgpr_read_b32 v188, a102
    v_mul_f32 v188, v188, v185
    v_accvgpr_write_b32 a102, v188
    v_accvgpr_read_b32 v189, a103
    v_mul_f32 v189, v189, v185
    v_accvgpr_write_b32 a103, v189
    v_accvgpr_read_b32 v186, a116
    v_mul_f32 v186, v186, v185
    v_accvgpr_write_b32 a116, v186
    v_accvgpr_read_b32 v187, a117
    v_mul_f32 v187, v187, v185
    v_accvgpr_write_b32 a117, v187
    v_accvgpr_read_b32 v188, a118
    v_mul_f32 v188, v188, v185
    v_accvgpr_write_b32 a118, v188
    v_accvgpr_read_b32 v189, a119
    v_mul_f32 v189, v189, v185
    v_accvgpr_write_b32 a119, v189
    v_max3_f32 v184, v104, v105, v106
    v_max3_f32 v184, v184, v107, v120
    v_max3_f32 v184, v184, v121, v122
    v_max_f32 v184, v184, v123
    v_mov_b32 v185, v184
    s_nop 1
    v_permlane16_swap_b32 v184, v185
    v_max_f32 v184, v184, v185
    v_mov_b32 v185, v184
    s_nop 1
    v_permlane32_swap_b32 v184, v185
    v_max_f32 v184, v184, v185
    v_add_f32 v185, 0x42c80000, v184
    v_cmp_gt_f32 vcc, v184, v226
    s_nop 1
    v_cndmask_b32 v185, 0, v185, vcc
    v_sub_f32 v104, v104, v185
    v_sub_f32 v120, v120, v185
    v_sub_f32 v105, v105, v185
    v_sub_f32 v121, v121, v185
    v_sub_f32 v106, v106, v185
    v_sub_f32 v122, v122, v185
    v_sub_f32 v107, v107, v185
    v_sub_f32 v123, v123, v185
    v_sub_f32 v72, v72, v185
    v_sub_f32 v73, v73, v185
    v_sub_f32 v74, v74, v185
    v_sub_f32 v75, v75, v185
    v_sub_f32 v88, v88, v185
    v_sub_f32 v89, v89, v185
    v_sub_f32 v90, v90, v185
    v_sub_f32 v91, v91, v185
    v_sub_f32 v168, v168, v185
    v_sub_f32 v169, v169, v185
    v_sub_f32 v170, v170, v185
    v_sub_f32 v171, v171, v185
    v_sub_f32 v185, 0, v185
    v_exp_f32 v185, v185
    s_nop 0
    v_mul_f32 v216, v216, v185
    v_accvgpr_read_b32 v186, a8
    v_mul_f32 v186, v186, v185
    v_accvgpr_write_b32 a8, v186
    v_accvgpr_read_b32 v187, a9
    v_mul_f32 v187, v187, v185
    v_accvgpr_write_b32 a9, v187
    v_accvgpr_read_b32 v188, a10
    v_mul_f32 v188, v188, v185
    v_accvgpr_write_b32 a10, v188
    v_accvgpr_read_b32 v189, a11
    v_mul_f32 v189, v189, v185
    v_accvgpr_write_b32 a11, v189
    v_accvgpr_read_b32 v186, a24
    v_mul_f32 v186, v186, v185
    v_accvgpr_write_b32 a24, v186
    v_accvgpr_read_b32 v187, a25
    v_mul_f32 v187, v187, v185
    v_accvgpr_write_b32 a25, v187
    v_accvgpr_read_b32 v188, a26
    v_mul_f32 v188, v188, v185
    v_accvgpr_write_b32 a26, v188
    v_accvgpr_read_b32 v189, a27
    v_mul_f32 v189, v189, v185
    v_accvgpr_write_b32 a27, v189
    v_accvgpr_read_b32 v186, a40
    v_mul_f32 v186, v186, v185
    v_accvgpr_write_b32 a40, v186
    v_accvgpr_read_b32 v187, a41
    v_mul_f32 v187, v187, v185
    v_accvgpr_write_b32 a41, v187
    v_accvgpr_read_b32 v188, a42
    v_mul_f32 v188, v188, v185
    v_accvgpr_write_b32 a42, v188
    v_accvgpr_read_b32 v189, a43
    v_mul_f32 v189, v189, v185
    v_accvgpr_write_b32 a43, v189
    v_accvgpr_read_b32 v186, a56
    v_mul_f32 v186, v186, v185
    v_accvgpr_write_b32 a56, v186
    v_accvgpr_read_b32 v187, a57
    v_mul_f32 v187, v187, v185
    v_accvgpr_write_b32 a57, v187
    v_accvgpr_read_b32 v188, a58
    v_mul_f32 v188, v188, v185
    v_accvgpr_write_b32 a58, v188
    v_accvgpr_read_b32 v189, a59
    v_mul_f32 v189, v189, v185
    v_accvgpr_write_b32 a59, v189
    v_accvgpr_read_b32 v186, a72
    v_mul_f32 v186, v186, v185
    v_accvgpr_write_b32 a72, v186
    v_accvgpr_read_b32 v187, a73
    v_mul_f32 v187, v187, v185
    v_accvgpr_write_b32 a73, v187
    v_accvgpr_read_b32 v188, a74
    v_mul_f32 v188, v188, v185
    v_accvgpr_write_b32 a74, v188
    v_accvgpr_read_b32 v189, a75
    v_mul_f32 v189, v189, v185
    v_accvgpr_write_b32 a75, v189
    v_accvgpr_read_b32 v186, a88
    v_mul_f32 v186, v186, v185
    v_accvgpr_write_b32 a88, v186
    v_accvgpr_read_b32 v187, a89
    v_mul_f32 v187, v187, v185
    v_accvgpr_write_b32 a89, v187
    v_accvgpr_read_b32 v188, a90
    v_mul_f32 v188, v188, v185
    v_accvgpr_write_b32 a90, v188
    v_accvgpr_read_b32 v189, a91
    v_mul_f32 v189, v189, v185
    v_accvgpr_write_b32 a91, v189
    v_accvgpr_read_b32 v186, a104
    v_mul_f32 v186, v186, v185
    v_accvgpr_write_b32 a104, v186
    v_accvgpr_read_b32 v187, a105
    v_mul_f32 v187, v187, v185
    v_accvgpr_write_b32 a105, v187
    v_accvgpr_read_b32 v188, a106
    v_mul_f32 v188, v188, v185
    v_accvgpr_write_b32 a106, v188
    v_accvgpr_read_b32 v189, a107
    v_mul_f32 v189, v189, v185
    v_accvgpr_write_b32 a107, v189
    v_accvgpr_read_b32 v186, a120
    v_mul_f32 v186, v186, v185
    v_accvgpr_write_b32 a120, v186
    v_accvgpr_read_b32 v187, a121
    v_mul_f32 v187, v187, v185
    v_accvgpr_write_b32 a121, v187
    v_accvgpr_read_b32 v188, a122
    v_mul_f32 v188, v188, v185
    v_accvgpr_write_b32 a122, v188
    v_accvgpr_read_b32 v189, a123
    v_mul_f32 v189, v189, v185
    v_accvgpr_write_b32 a123, v189
    v_max3_f32 v184, v108, v109, v110
    v_max3_f32 v184, v184, v111, v124
    v_max3_f32 v184, v184, v125, v126
    v_max_f32 v184, v184, v127
    v_mov_b32 v185, v184
    s_nop 1
    v_permlane16_swap_b32 v184, v185
    v_max_f32 v184, v184, v185
    v_mov_b32 v185, v184
    s_nop 1
    v_permlane32_swap_b32 v184, v185
    v_max_f32 v184, v184, v185
    v_add_f32 v185, 0x42c80000, v184
    v_cmp_gt_f32 vcc, v184, v226
    s_nop 1
    v_cndmask_b32 v185, 0, v185, vcc
    v_sub_f32 v108, v108, v185
    v_sub_f32 v124, v124, v185
    v_sub_f32 v109, v109, v185
    v_sub_f32 v125, v125, v185
    v_sub_f32 v110, v110, v185
    v_sub_f32 v126, v126, v185
    v_sub_f32 v111, v111, v185
    v_sub_f32 v127, v127, v185
    v_sub_f32 v76, v76, v185
    v_sub_f32 v77, v77, v185
    v_sub_f32 v78, v78, v185
    v_sub_f32 v79, v79, v185
    v_sub_f32 v92, v92, v185
    v_sub_f32 v93, v93, v185
    v_sub_f32 v94, v94, v185
    v_sub_f32 v95, v95, v185
    v_sub_f32 v172, v172, v185
    v_sub_f32 v173, v173, v185
    v_sub_f32 v174, v174, v185
    v_sub_f32 v175, v175, v185
    v_sub_f32 v185, 0, v185
    v_exp_f32 v185, v185
    s_nop 0
    v_mul_f32 v217, v217, v185
    v_accvgpr_read_b32 v186, a12
    v_mul_f32 v186, v186, v185
    v_accvgpr_write_b32 a12, v186
    v_accvgpr_read_b32 v187, a13
    v_mul_f32 v187, v187, v185
    v_accvgpr_write_b32 a13, v187
    v_accvgpr_read_b32 v188, a14
    v_mul_f32 v188, v188, v185
    v_accvgpr_write_b32 a14, v188
    v_accvgpr_read_b32 v189, a15
    v_mul_f32 v189, v189, v185
    v_accvgpr_write_b32 a15, v189
    v_accvgpr_read_b32 v186, a28
    v_mul_f32 v186, v186, v185
    v_accvgpr_write_b32 a28, v186
    v_accvgpr_read_b32 v187, a29
    v_mul_f32 v187, v187, v185
    v_accvgpr_write_b32 a29, v187
    v_accvgpr_read_b32 v188, a30
    v_mul_f32 v188, v188, v185
    v_accvgpr_write_b32 a30, v188
    v_accvgpr_read_b32 v189, a31
    v_mul_f32 v189, v189, v185
    v_accvgpr_write_b32 a31, v189
    v_accvgpr_read_b32 v186, a44
    v_mul_f32 v186, v186, v185
    v_accvgpr_write_b32 a44, v186
    v_accvgpr_read_b32 v187, a45
    v_mul_f32 v187, v187, v185
    v_accvgpr_write_b32 a45, v187
    v_accvgpr_read_b32 v188, a46
    v_mul_f32 v188, v188, v185
    v_accvgpr_write_b32 a46, v188
    v_accvgpr_read_b32 v189, a47
    v_mul_f32 v189, v189, v185
    v_accvgpr_write_b32 a47, v189
    v_accvgpr_read_b32 v186, a60
    v_mul_f32 v186, v186, v185
    v_accvgpr_write_b32 a60, v186
    v_accvgpr_read_b32 v187, a61
    v_mul_f32 v187, v187, v185
    v_accvgpr_write_b32 a61, v187
    v_accvgpr_read_b32 v188, a62
    v_mul_f32 v188, v188, v185
    v_accvgpr_write_b32 a62, v188
    v_accvgpr_read_b32 v189, a63
    v_mul_f32 v189, v189, v185
    v_accvgpr_write_b32 a63, v189
    v_accvgpr_read_b32 v186, a76
    v_mul_f32 v186, v186, v185
    v_accvgpr_write_b32 a76, v186
    v_accvgpr_read_b32 v187, a77
    v_mul_f32 v187, v187, v185
    v_accvgpr_write_b32 a77, v187
    v_accvgpr_read_b32 v188, a78
    v_mul_f32 v188, v188, v185
    v_accvgpr_write_b32 a78, v188
    v_accvgpr_read_b32 v189, a79
    v_mul_f32 v189, v189, v185
    v_accvgpr_write_b32 a79, v189
    v_accvgpr_read_b32 v186, a92
    v_mul_f32 v186, v186, v185
    v_accvgpr_write_b32 a92, v186
    v_accvgpr_read_b32 v187, a93
    v_mul_f32 v187, v187, v185
    v_accvgpr_write_b32 a93, v187
    v_accvgpr_read_b32 v188, a94
    v_mul_f32 v188, v188, v185
    v_accvgpr_write_b32 a94, v188
    v_accvgpr_read_b32 v189, a95
    v_mul_f32 v189, v189, v185
    v_accvgpr_write_b32 a95, v189
    v_accvgpr_read_b32 v186, a108
    v_mul_f32 v186, v186, v185
    v_accvgpr_write_b32 a108, v186
    v_accvgpr_read_b32 v187, a109
    v_mul_f32 v187, v187, v185
    v_accvgpr_write_b32 a109, v187
    v_accvgpr_read_b32 v188, a110
    v_mul_f32 v188, v188, v185
    v_accvgpr_write_b32 a110, v188
    v_accvgpr_read_b32 v189, a111
    v_mul_f32 v189, v189, v185
    v_accvgpr_write_b32 a111, v189
    v_accvgpr_read_b32 v186, a124
    v_mul_f32 v186, v186, v185
    v_accvgpr_write_b32 a124, v186
    v_accvgpr_read_b32 v187, a125
    v_mul_f32 v187, v187, v185
    v_accvgpr_write_b32 a125, v187
    v_accvgpr_read_b32 v188, a126
    v_mul_f32 v188, v188, v185
    v_accvgpr_write_b32 a126, v188
    v_accvgpr_read_b32 v189, a127
    v_mul_f32 v189, v189, v185
    v_accvgpr_write_b32 a127, v189
    v_exp_f32 v176, v96
    v_exp_f32 v177, v97
    s_nop 0
    v_add_f32 v218, v176, v177
    v_cvt_pk_bf16_f32 v144, v176, v177
    v_exp_f32 v178, v100
    v_exp_f32 v179, v101
    s_nop 0
    v_add_f32 v219, v178, v179
    v_cvt_pk_bf16_f32 v148, v178, v179
    v_exp_f32 v180, v104
    v_exp_f32 v181, v105
    s_nop 0
    v_add_f32 v220, v180, v181
    v_cvt_pk_bf16_f32 v152, v180, v181
    v_exp_f32 v182, v108
    v_exp_f32 v183, v109
    s_nop 0
    v_add_f32 v221, v182, v183
    v_cvt_pk_bf16_f32 v156, v182, v183
    v_exp_f32 v176, v98
    s_nop 0
    v_add_f32 v218, v218, v176
    v_exp_f32 v177, v99
    s_nop 0
    v_add_f32 v218, v218, v177
    v_cvt_pk_bf16_f32 v145, v176, v177
    v_exp_f32 v178, v102
    s_nop 0
    v_add_f32 v219, v219, v178
    v_exp_f32 v179, v103
    s_nop 0
    v_add_f32 v219, v219, v179
    v_cvt_pk_bf16_f32 v149, v178, v179
    v_exp_f32 v180, v106
    s_nop 0
    v_add_f32 v220, v220, v180
    v_exp_f32 v181, v107
    s_nop 0
    v_add_f32 v220, v220, v181
    v_cvt_pk_bf16_f32 v153, v180, v181
    v_exp_f32 v182, v110
    s_nop 0
    v_add_f32 v221, v221, v182
    v_exp_f32 v183, v111
    s_nop 0
    v_add_f32 v221, v221, v183
    v_cvt_pk_bf16_f32 v157, v182, v183
    v_exp_f32 v176, v112
    s_nop 0
    v_add_f32 v218, v218, v176
    v_exp_f32 v177, v113
    s_nop 0
    v_add_f32 v218, v218, v177
    v_cvt_pk_bf16_f32 v146, v176, v177
    v_exp_f32 v178, v116
    s_nop 0
    v_add_f32 v219, v219, v178
    v_exp_f32 v179, v117
    s_nop 0
    v_add_f32 v219, v219, v179
    v_cvt_pk_bf16_f32 v150, v178, v179
    v_exp_f32 v180, v120
    s_nop 0
    v_add_f32 v220, v220, v180
    v_exp_f32 v181, v121
    s_nop 0
    v_add_f32 v220, v220, v181
    v_cvt_pk_bf16_f32 v154, v180, v181
    v_exp_f32 v182, v124
    s_nop 0
    v_add_f32 v221, v221, v182
    v_exp_f32 v183, v125
    s_nop 0
    v_add_f32 v221, v221, v183
    v_cvt_pk_bf16_f32 v158, v182, v183
    v_exp_f32 v176, v114
    s_nop 0
    v_add_f32 v218, v218, v176
    v_exp_f32 v177, v115
    s_nop 0
    v_add_f32 v218, v218, v177
    v_cvt_pk_bf16_f32 v147, v176, v177
    v_exp_f32 v178, v118
    s_nop 0
    v_add_f32 v219, v219, v178
    v_exp_f32 v179, v119
    s_nop 0
    v_add_f32 v219, v219, v179
    v_cvt_pk_bf16_f32 v151, v178, v179
    v_exp_f32 v180, v122
    s_nop 0
    v_add_f32 v220, v220, v180
    v_exp_f32 v181, v123
    s_nop 0
    v_add_f32 v220, v220, v181
    v_cvt_pk_bf16_f32 v155, v180, v181
    v_exp_f32 v182, v126
    s_nop 0
    v_add_f32 v221, v221, v182
    v_exp_f32 v183, v127
    s_nop 0
    v_add_f32 v221, v221, v183
    v_cvt_pk_bf16_f32 v159, v182, v183
    s_nop 3
    s_branch attn_back8
attn_rare9:
    s_nop 15
    v_max3_f32 v184, v64, v65, v66
    v_max3_f32 v184, v184, v67, v80
    v_max3_f32 v184, v184, v81, v82
    v_max_f32 v184, v184, v83
    v_mov_b32 v185, v184
    s_nop 1
    v_permlane16_swap_b32 v184, v185
    v_max_f32 v184, v184, v185
    v_mov_b32 v185, v184
    s_nop 1
    v_permlane32_swap_b32 v184, v185
    v_max_f32 v184, v184, v185
    v_add_f32 v185, 0x42c80000, v184
    v_cmp_gt_f32 vcc, v184, v226
    s_nop 1
    v_cndmask_b32 v185, 0, v185, vcc
    v_sub_f32 v64, v64, v185
    v_sub_f32 v80, v80, v185
    v_sub_f32 v65, v65, v185
    v_sub_f32 v81, v81, v185
    v_sub_f32 v66, v66, v185
    v_sub_f32 v82, v82, v185
    v_sub_f32 v67, v67, v185
    v_sub_f32 v83, v83, v185
    v_sub_f32 v96, v96, v185
    v_sub_f32 v97, v97, v185
    v_sub_f32 v98, v98, v185
    v_sub_f32 v99, v99, v185
    v_sub_f32 v112, v112, v185
    v_sub_f32 v113, v113, v185
    v_sub_f32 v114, v114, v185
    v_sub_f32 v115, v115, v185
    v_sub_f32 v160, v160, v185
    v_sub_f32 v161, v161, v185
    v_sub_f32 v162, v162, v185
    v_sub_f32 v163, v163, v185
    v_sub_f32 v185, 0, v185
    v_exp_f32 v185, v185
    s_nop 0
    v_mul_f32 v214, v214, v185
    v_accvgpr_read_b32 v186, a0
    v_mul_f32 v186, v186, v185
    v_accvgpr_write_b32 a0, v186
    v_accvgpr_read_b32 v187, a1
    v_mul_f32 v187, v187, v185
    v_accvgpr_write_b32 a1, v187
    v_accvgpr_read_b32 v188, a2
    v_mul_f32 v188, v188, v185
    v_accvgpr_write_b32 a2, v188
    v_accvgpr_read_b32 v189, a3
    v_mul_f32 v189, v189, v185
    v_accvgpr_write_b32 a3, v189
    v_accvgpr_read_b32 v186, a16
    v_mul_f32 v186, v186, v185
    v_accvgpr_write_b32 a16, v186
    v_accvgpr_read_b32 v187, a17
    v_mul_f32 v187, v187, v185
    v_accvgpr_write_b32 a17, v187
    v_accvgpr_read_b32 v188, a18
    v_mul_f32 v188, v188, v185
    v_accvgpr_write_b32 a18, v188
    v_accvgpr_read_b32 v189, a19
    v_mul_f32 v189, v189, v185
    v_accvgpr_write_b32 a19, v189
    v_accvgpr_read_b32 v186, a32
    v_mul_f32 v186, v186, v185
    v_accvgpr_write_b32 a32, v186
    v_accvgpr_read_b32 v187, a33
    v_mul_f32 v187, v187, v185
    v_accvgpr_write_b32 a33, v187
    v_accvgpr_read_b32 v188, a34
    v_mul_f32 v188, v188, v185
    v_accvgpr_write_b32 a34, v188
    v_accvgpr_read_b32 v189, a35
    v_mul_f32 v189, v189, v185
    v_accvgpr_write_b32 a35, v189
    v_accvgpr_read_b32 v186, a48
    v_mul_f32 v186, v186, v185
    v_accvgpr_write_b32 a48, v186
    v_accvgpr_read_b32 v187, a49
    v_mul_f32 v187, v187, v185
    v_accvgpr_write_b32 a49, v187
    v_accvgpr_read_b32 v188, a50
    v_mul_f32 v188, v188, v185
    v_accvgpr_write_b32 a50, v188
    v_accvgpr_read_b32 v189, a51
    v_mul_f32 v189, v189, v185
    v_accvgpr_write_b32 a51, v189
    v_accvgpr_read_b32 v186, a64
    v_mul_f32 v186, v186, v185
    v_accvgpr_write_b32 a64, v186
    v_accvgpr_read_b32 v187, a65
    v_mul_f32 v187, v187, v185
    v_accvgpr_write_b32 a65, v187
    v_accvgpr_read_b32 v188, a66
    v_mul_f32 v188, v188, v185
    v_accvgpr_write_b32 a66, v188
    v_accvgpr_read_b32 v189, a67
    v_mul_f32 v189, v189, v185
    v_accvgpr_write_b32 a67, v189
    v_accvgpr_read_b32 v186, a80
    v_mul_f32 v186, v186, v185
    v_accvgpr_write_b32 a80, v186
    v_accvgpr_read_b32 v187, a81
    v_mul_f32 v187, v187, v185
    v_accvgpr_write_b32 a81, v187
    v_accvgpr_read_b32 v188, a82
    v_mul_f32 v188, v188, v185
    v_accvgpr_write_b32 a82, v188
    v_accvgpr_read_b32 v189, a83
    v_mul_f32 v189, v189, v185
    v_accvgpr_write_b32 a83, v189
    v_accvgpr_read_b32 v186, a96
    v_mul_f32 v186, v186, v185
    v_accvgpr_write_b32 a96, v186
    v_accvgpr_read_b32 v187, a97
    v_mul_f32 v187, v187, v185
    v_accvgpr_write_b32 a97, v187
    v_accvgpr_read_b32 v188, a98
    v_mul_f32 v188, v188, v185
    v_accvgpr_write_b32 a98, v188
    v_accvgpr_read_b32 v189, a99
    v_mul_f32 v189, v189, v185
    v_accvgpr_write_b32 a99, v189
    v_accvgpr_read_b32 v186, a112
    v_mul_f32 v186, v186, v185
    v_accvgpr_write_b32 a112, v186
    v_accvgpr_read_b32 v187, a113
    v_mul_f32 v187, v187, v185
    v_accvgpr_write_b32 a113, v187
    v_accvgpr_read_b32 v188, a114
    v_mul_f32 v188, v188, v185
    v_accvgpr_write_b32 a114, v188
    v_accvgpr_read_b32 v189, a115
    v_mul_f32 v189, v189, v185
    v_accvgpr_write_b32 a115, v189
    v_max3_f32 v184, v68, v69, v70
    v_max3_f32 v184, v184, v71, v84
    v_max3_f32 v184, v184, v85, v86
    v_max_f32 v184, v184, v87
    v_mov_b32 v185, v184
    s_nop 1
    v_permlane16_swap_b32 v184, v185
    v_max_f32 v184, v184, v185
    v_mov_b32 v185, v184
    s_nop 1
    v_permlane32_swap_b32 v184, v185
    v_max_f32 v184, v184, v185
    v_add_f32 v185, 0x42c80000, v184
    v_cmp_gt_f32 vcc, v184, v226
    s_nop 1
    v_cndmask_b32 v185, 0, v185, vcc
    v_sub_f32 v68, v68, v185
    v_sub_f32 v84, v84, v185
    v_sub_f32 v69, v69, v185
    v_sub_f32 v85, v85, v185
    v_sub_f32 v70, v70, v185
    v_sub_f32 v86, v86, v185
    v_sub_f32 v71, v71, v185
    v_sub_f32 v87, v87, v185
    v_sub_f32 v100, v100, v185
    v_sub_f32 v101, v101, v185
    v_sub_f32 v102, v102, v185
    v_sub_f32 v103, v103, v185
    v_sub_f32 v116, v116, v185
    v_sub_f32 v117, v117, v185
    v_sub_f32 v118, v118, v185
    v_sub_f32 v119, v119, v185
    v_sub_f32 v164, v164, v185
    v_sub_f32 v165, v165, v185
    v_sub_f32 v166, v166, v185
    v_sub_f32 v167, v167, v185
    v_sub_f32 v185, 0, v185
    v_exp_f32 v185, v185
    s_nop 0
    v_mul_f32 v215, v215, v185
    v_accvgpr_read_b32 v186, a4
    v_mul_f32 v186, v186, v185
    v_accvgpr_write_b32 a4, v186
    v_accvgpr_read_b32 v187, a5
    v_mul_f32 v187, v187, v185
    v_accvgpr_write_b32 a5, v187
    v_accvgpr_read_b32 v188, a6
    v_mul_f32 v188, v188, v185
    v_accvgpr_write_b32 a6, v188
    v_accvgpr_read_b32 v189, a7
    v_mul_f32 v189, v189, v185
    v_accvgpr_write_b32 a7, v189
    v_accvgpr_read_b32 v186, a20
    v_mul_f32 v186, v186, v185
    v_accvgpr_write_b32 a20, v186
    v_accvgpr_read_b32 v187, a21
    v_mul_f32 v187, v187, v185
    v_accvgpr_write_b32 a21, v187
    v_accvgpr_read_b32 v188, a22
    v_mul_f32 v188, v188, v185
    v_accvgpr_write_b32 a22, v188
    v_accvgpr_read_b32 v189, a23
    v_mul_f32 v189, v189, v185
    v_accvgpr_write_b32 a23, v189
    v_accvgpr_read_b32 v186, a36
    v_mul_f32 v186, v186, v185
    v_accvgpr_write_b32 a36, v186
    v_accvgpr_read_b32 v187, a37
    v_mul_f32 v187, v187, v185
    v_accvgpr_write_b32 a37, v187
    v_accvgpr_read_b32 v188, a38
    v_mul_f32 v188, v188, v185
    v_accvgpr_write_b32 a38, v188
    v_accvgpr_read_b32 v189, a39
    v_mul_f32 v189, v189, v185
    v_accvgpr_write_b32 a39, v189
    v_accvgpr_read_b32 v186, a52
    v_mul_f32 v186, v186, v185
    v_accvgpr_write_b32 a52, v186
    v_accvgpr_read_b32 v187, a53
    v_mul_f32 v187, v187, v185
    v_accvgpr_write_b32 a53, v187
    v_accvgpr_read_b32 v188, a54
    v_mul_f32 v188, v188, v185
    v_accvgpr_write_b32 a54, v188
    v_accvgpr_read_b32 v189, a55
    v_mul_f32 v189, v189, v185
    v_accvgpr_write_b32 a55, v189
    v_accvgpr_read_b32 v186, a68
    v_mul_f32 v186, v186, v185
    v_accvgpr_write_b32 a68, v186
    v_accvgpr_read_b32 v187, a69
    v_mul_f32 v187, v187, v185
    v_accvgpr_write_b32 a69, v187
    v_accvgpr_read_b32 v188, a70
    v_mul_f32 v188, v188, v185
    v_accvgpr_write_b32 a70, v188
    v_accvgpr_read_b32 v189, a71
    v_mul_f32 v189, v189, v185
    v_accvgpr_write_b32 a71, v189
    v_accvgpr_read_b32 v186, a84
    v_mul_f32 v186, v186, v185
    v_accvgpr_write_b32 a84, v186
    v_accvgpr_read_b32 v187, a85
    v_mul_f32 v187, v187, v185
    v_accvgpr_write_b32 a85, v187
    v_accvgpr_read_b32 v188, a86
    v_mul_f32 v188, v188, v185
    v_accvgpr_write_b32 a86, v188
    v_accvgpr_read_b32 v189, a87
    v_mul_f32 v189, v189, v185
    v_accvgpr_write_b32 a87, v189
    v_accvgpr_read_b32 v186, a100
    v_mul_f32 v186, v186, v185
    v_accvgpr_write_b32 a100, v186
    v_accvgpr_read_b32 v187, a101
    v_mul_f32 v187, v187, v185
    v_accvgpr_write_b32 a101, v187
    v_accvgpr_read_b32 v188, a102
    v_mul_f32 v188, v188, v185
    v_accvgpr_write_b32 a102, v188
    v_accvgpr_read_b32 v189, a103
    v_mul_f32 v189, v189, v185
    v_accvgpr_write_b32 a103, v189
    v_accvgpr_read_b32 v186, a116
    v_mul_f32 v186, v186, v185
    v_accvgpr_write_b32 a116, v186
    v_accvgpr_read_b32 v187, a117
    v_mul_f32 v187, v187, v185
    v_accvgpr_write_b32 a117, v187
    v_accvgpr_read_b32 v188, a118
    v_mul_f32 v188, v188, v185
    v_accvgpr_write_b32 a118, v188
    v_accvgpr_read_b32 v189, a119
    v_mul_f32 v189, v189, v185
    v_accvgpr_write_b32 a119, v189
    v_max3_f32 v184, v72, v73, v74
    v_max3_f32 v184, v184, v75, v88
    v_max3_f32 v184, v184, v89, v90
    v_max_f32 v184, v184, v91
    v_mov_b32 v185, v184
    s_nop 1
    v_permlane16_swap_b32 v184, v185
    v_max_f32 v184, v184, v185
    v_mov_b32 v185, v184
    s_nop 1
    v_permlane32_swap_b32 v184, v185
    v_max_f32 v184, v184, v185
    v_add_f32 v185, 0x42c80000, v184
    v_cmp_gt_f32 vcc, v184, v226
    s_nop 1
    v_cndmask_b32 v185, 0, v185, vcc
    v_sub_f32 v72, v72, v185
    v_sub_f32 v88, v88, v185
    v_sub_f32 v73, v73, v185
    v_sub_f32 v89, v89, v185
    v_sub_f32 v74, v74, v185
    v_sub_f32 v90, v90, v185
    v_sub_f32 v75, v75, v185
    v_sub_f32 v91, v91, v185
    v_sub_f32 v104, v104, v185
    v_sub_f32 v105, v105, v185
    v_sub_f32 v106, v106, v185
    v_sub_f32 v107, v107, v185
    v_sub_f32 v120, v120, v185
    v_sub_f32 v121, v121, v185
    v_sub_f32 v122, v122, v185
    v_sub_f32 v123, v123, v185
    v_sub_f32 v168, v168, v185
    v_sub_f32 v169, v169, v185
    v_sub_f32 v170, v170, v185
    v_sub_f32 v171, v171, v185
    v_sub_f32 v185, 0, v185
    v_exp_f32 v185, v185
    s_nop 0
    v_mul_f32 v216, v216, v185
    v_accvgpr_read_b32 v186, a8
    v_mul_f32 v186, v186, v185
    v_accvgpr_write_b32 a8, v186
    v_accvgpr_read_b32 v187, a9
    v_mul_f32 v187, v187, v185
    v_accvgpr_write_b32 a9, v187
    v_accvgpr_read_b32 v188, a10
    v_mul_f32 v188, v188, v185
    v_accvgpr_write_b32 a10, v188
    v_accvgpr_read_b32 v189, a11
    v_mul_f32 v189, v189, v185
    v_accvgpr_write_b32 a11, v189
    v_accvgpr_read_b32 v186, a24
    v_mul_f32 v186, v186, v185
    v_accvgpr_write_b32 a24, v186
    v_accvgpr_read_b32 v187, a25
    v_mul_f32 v187, v187, v185
    v_accvgpr_write_b32 a25, v187
    v_accvgpr_read_b32 v188, a26
    v_mul_f32 v188, v188, v185
    v_accvgpr_write_b32 a26, v188
    v_accvgpr_read_b32 v189, a27
    v_mul_f32 v189, v189, v185
    v_accvgpr_write_b32 a27, v189
    v_accvgpr_read_b32 v186, a40
    v_mul_f32 v186, v186, v185
    v_accvgpr_write_b32 a40, v186
    v_accvgpr_read_b32 v187, a41
    v_mul_f32 v187, v187, v185
    v_accvgpr_write_b32 a41, v187
    v_accvgpr_read_b32 v188, a42
    v_mul_f32 v188, v188, v185
    v_accvgpr_write_b32 a42, v188
    v_accvgpr_read_b32 v189, a43
    v_mul_f32 v189, v189, v185
    v_accvgpr_write_b32 a43, v189
    v_accvgpr_read_b32 v186, a56
    v_mul_f32 v186, v186, v185
    v_accvgpr_write_b32 a56, v186
    v_accvgpr_read_b32 v187, a57
    v_mul_f32 v187, v187, v185
    v_accvgpr_write_b32 a57, v187
    v_accvgpr_read_b32 v188, a58
    v_mul_f32 v188, v188, v185
    v_accvgpr_write_b32 a58, v188
    v_accvgpr_read_b32 v189, a59
    v_mul_f32 v189, v189, v185
    v_accvgpr_write_b32 a59, v189
    v_accvgpr_read_b32 v186, a72
    v_mul_f32 v186, v186, v185
    v_accvgpr_write_b32 a72, v186
    v_accvgpr_read_b32 v187, a73
    v_mul_f32 v187, v187, v185
    v_accvgpr_write_b32 a73, v187
    v_accvgpr_read_b32 v188, a74
    v_mul_f32 v188, v188, v185
    v_accvgpr_write_b32 a74, v188
    v_accvgpr_read_b32 v189, a75
    v_mul_f32 v189, v189, v185
    v_accvgpr_write_b32 a75, v189
    v_accvgpr_read_b32 v186, a88
    v_mul_f32 v186, v186, v185
    v_accvgpr_write_b32 a88, v186
    v_accvgpr_read_b32 v187, a89
    v_mul_f32 v187, v187, v185
    v_accvgpr_write_b32 a89, v187
    v_accvgpr_read_b32 v188, a90
    v_mul_f32 v188, v188, v185
    v_accvgpr_write_b32 a90, v188
    v_accvgpr_read_b32 v189, a91
    v_mul_f32 v189, v189, v185
    v_accvgpr_write_b32 a91, v189
    v_accvgpr_read_b32 v186, a104
    v_mul_f32 v186, v186, v185
    v_accvgpr_write_b32 a104, v186
    v_accvgpr_read_b32 v187, a105
    v_mul_f32 v187, v187, v185
    v_accvgpr_write_b32 a105, v187
    v_accvgpr_read_b32 v188, a106
    v_mul_f32 v188, v188, v185
    v_accvgpr_write_b32 a106, v188
    v_accvgpr_read_b32 v189, a107
    v_mul_f32 v189, v189, v185
    v_accvgpr_write_b32 a107, v189
    v_accvgpr_read_b32 v186, a120
    v_mul_f32 v186, v186, v185
    v_accvgpr_write_b32 a120, v186
    v_accvgpr_read_b32 v187, a121
    v_mul_f32 v187, v187, v185
    v_accvgpr_write_b32 a121, v187
    v_accvgpr_read_b32 v188, a122
    v_mul_f32 v188, v188, v185
    v_accvgpr_write_b32 a122, v188
    v_accvgpr_read_b32 v189, a123
    v_mul_f32 v189, v189, v185
    v_accvgpr_write_b32 a123, v189
    v_max3_f32 v184, v76, v77, v78
    v_max3_f32 v184, v184, v79, v92
    v_max3_f32 v184, v184, v93, v94
    v_max_f32 v184, v184, v95
    v_mov_b32 v185, v184
    s_nop 1
    v_permlane16_swap_b32 v184, v185
    v_max_f32 v184, v184, v185
    v_mov_b32 v185, v184
    s_nop 1
    v_permlane32_swap_b32 v184, v185
    v_max_f32 v184, v184, v185
    v_add_f32 v185, 0x42c80000, v184
    v_cmp_gt_f32 vcc, v184, v226
    s_nop 1
    v_cndmask_b32 v185, 0, v185, vcc
    v_sub_f32 v76, v76, v185
    v_sub_f32 v92, v92, v185
    v_sub_f32 v77, v77, v185
    v_sub_f32 v93, v93, v185
    v_sub_f32 v78, v78, v185
    v_sub_f32 v94, v94, v185
    v_sub_f32 v79, v79, v185
    v_sub_f32 v95, v95, v185
    v_sub_f32 v108, v108, v185
    v_sub_f32 v109, v109, v185
    v_sub_f32 v110, v110, v185
    v_sub_f32 v111, v111, v185
    v_sub_f32 v124, v124, v185
    v_sub_f32 v125, v125, v185
    v_sub_f32 v126, v126, v185
    v_sub_f32 v127, v127, v185
    v_sub_f32 v172, v172, v185
    v_sub_f32 v173, v173, v185
    v_sub_f32 v174, v174, v185
    v_sub_f32 v175, v175, v185
    v_sub_f32 v185, 0, v185
    v_exp_f32 v185, v185
    s_nop 0
    v_mul_f32 v217, v217, v185
    v_accvgpr_read_b32 v186, a12
    v_mul_f32 v186, v186, v185
    v_accvgpr_write_b32 a12, v186
    v_accvgpr_read_b32 v187, a13
    v_mul_f32 v187, v187, v185
    v_accvgpr_write_b32 a13, v187
    v_accvgpr_read_b32 v188, a14
    v_mul_f32 v188, v188, v185
    v_accvgpr_write_b32 a14, v188
    v_accvgpr_read_b32 v189, a15
    v_mul_f32 v189, v189, v185
    v_accvgpr_write_b32 a15, v189
    v_accvgpr_read_b32 v186, a28
    v_mul_f32 v186, v186, v185
    v_accvgpr_write_b32 a28, v186
    v_accvgpr_read_b32 v187, a29
    v_mul_f32 v187, v187, v185
    v_accvgpr_write_b32 a29, v187
    v_accvgpr_read_b32 v188, a30
    v_mul_f32 v188, v188, v185
    v_accvgpr_write_b32 a30, v188
    v_accvgpr_read_b32 v189, a31
    v_mul_f32 v189, v189, v185
    v_accvgpr_write_b32 a31, v189
    v_accvgpr_read_b32 v186, a44
    v_mul_f32 v186, v186, v185
    v_accvgpr_write_b32 a44, v186
    v_accvgpr_read_b32 v187, a45
    v_mul_f32 v187, v187, v185
    v_accvgpr_write_b32 a45, v187
    v_accvgpr_read_b32 v188, a46
    v_mul_f32 v188, v188, v185
    v_accvgpr_write_b32 a46, v188
    v_accvgpr_read_b32 v189, a47
    v_mul_f32 v189, v189, v185
    v_accvgpr_write_b32 a47, v189
    v_accvgpr_read_b32 v186, a60
    v_mul_f32 v186, v186, v185
    v_accvgpr_write_b32 a60, v186
    v_accvgpr_read_b32 v187, a61
    v_mul_f32 v187, v187, v185
    v_accvgpr_write_b32 a61, v187
    v_accvgpr_read_b32 v188, a62
    v_mul_f32 v188, v188, v185
    v_accvgpr_write_b32 a62, v188
    v_accvgpr_read_b32 v189, a63
    v_mul_f32 v189, v189, v185
    v_accvgpr_write_b32 a63, v189
    v_accvgpr_read_b32 v186, a76
    v_mul_f32 v186, v186, v185
    v_accvgpr_write_b32 a76, v186
    v_accvgpr_read_b32 v187, a77
    v_mul_f32 v187, v187, v185
    v_accvgpr_write_b32 a77, v187
    v_accvgpr_read_b32 v188, a78
    v_mul_f32 v188, v188, v185
    v_accvgpr_write_b32 a78, v188
    v_accvgpr_read_b32 v189, a79
    v_mul_f32 v189, v189, v185
    v_accvgpr_write_b32 a79, v189
    v_accvgpr_read_b32 v186, a92
    v_mul_f32 v186, v186, v185
    v_accvgpr_write_b32 a92, v186
    v_accvgpr_read_b32 v187, a93
    v_mul_f32 v187, v187, v185
    v_accvgpr_write_b32 a93, v187
    v_accvgpr_read_b32 v188, a94
    v_mul_f32 v188, v188, v185
    v_accvgpr_write_b32 a94, v188
    v_accvgpr_read_b32 v189, a95
    v_mul_f32 v189, v189, v185
    v_accvgpr_write_b32 a95, v189
    v_accvgpr_read_b32 v186, a108
    v_mul_f32 v186, v186, v185
    v_accvgpr_write_b32 a108, v186
    v_accvgpr_read_b32 v187, a109
    v_mul_f32 v187, v187, v185
    v_accvgpr_write_b32 a109, v187
    v_accvgpr_read_b32 v188, a110
    v_mul_f32 v188, v188, v185
    v_accvgpr_write_b32 a110, v188
    v_accvgpr_read_b32 v189, a111
    v_mul_f32 v189, v189, v185
    v_accvgpr_write_b32 a111, v189
    v_accvgpr_read_b32 v186, a124
    v_mul_f32 v186, v186, v185
    v_accvgpr_write_b32 a124, v186
    v_accvgpr_read_b32 v187, a125
    v_mul_f32 v187, v187, v185
    v_accvgpr_write_b32 a125, v187
    v_accvgpr_read_b32 v188, a126
    v_mul_f32 v188, v188, v185
    v_accvgpr_write_b32 a126, v188
    v_accvgpr_read_b32 v189, a127
    v_mul_f32 v189, v189, v185
    v_accvgpr_write_b32 a127, v189
    v_exp_f32 v176, v64
    v_exp_f32 v177, v65
    s_nop 0
    v_add_f32 v218, v176, v177
    v_cvt_pk_bf16_f32 v128, v176, v177
    v_exp_f32 v178, v68
    v_exp_f32 v179, v69
    s_nop 0
    v_add_f32 v219, v178, v179
    v_cvt_pk_bf16_f32 v132, v178, v179
    v_exp_f32 v180, v72
    v_exp_f32 v181, v73
    s_nop 0
    v_add_f32 v220, v180, v181
    v_cvt_pk_bf16_f32 v136, v180, v181
    v_exp_f32 v182, v76
    v_exp_f32 v183, v77
    s_nop 0
    v_add_f32 v221, v182, v183
    v_cvt_pk_bf16_f32 v140, v182, v183
    v_exp_f32 v176, v66
    s_nop 0
    v_add_f32 v218, v218, v176
    v_exp_f32 v177, v67
    s_nop 0
    v_add_f32 v218, v218, v177
    v_cvt_pk_bf16_f32 v129, v176, v177
    v_exp_f32 v178, v70
    s_nop 0
    v_add_f32 v219, v219, v178
    v_exp_f32 v179, v71
    s_nop 0
    v_add_f32 v219, v219, v179
    v_cvt_pk_bf16_f32 v133, v178, v179
    v_exp_f32 v180, v74
    s_nop 0
    v_add_f32 v220, v220, v180
    v_exp_f32 v181, v75
    s_nop 0
    v_add_f32 v220, v220, v181
    v_cvt_pk_bf16_f32 v137, v180, v181
    v_exp_f32 v182, v78
    s_nop 0
    v_add_f32 v221, v221, v182
    v_exp_f32 v183, v79
    s_nop 0
    v_add_f32 v221, v221, v183
    v_cvt_pk_bf16_f32 v141, v182, v183
    v_exp_f32 v176, v80
    s_nop 0
    v_add_f32 v218, v218, v176
    v_exp_f32 v177, v81
    s_nop 0
    v_add_f32 v218, v218, v177
    v_cvt_pk_bf16_f32 v130, v176, v177
    v_exp_f32 v178, v84
    s_nop 0
    v_add_f32 v219, v219, v178
    v_exp_f32 v179, v85
    s_nop 0
    v_add_f32 v219, v219, v179
    v_cvt_pk_bf16_f32 v134, v178, v179
    v_exp_f32 v180, v88
    s_nop 0
    v_add_f32 v220, v220, v180
    v_exp_f32 v181, v89
    s_nop 0
    v_add_f32 v220, v220, v181
    v_cvt_pk_bf16_f32 v138, v180, v181
    v_exp_f32 v182, v92
    s_nop 0
    v_add_f32 v221, v221, v182
    v_exp_f32 v183, v93
    s_nop 0
    v_add_f32 v221, v221, v183
    v_cvt_pk_bf16_f32 v142, v182, v183
    v_exp_f32 v176, v82
    s_nop 0
    v_add_f32 v218, v218, v176
    v_exp_f32 v177, v83
    s_nop 0
    v_add_f32 v218, v218, v177
    v_cvt_pk_bf16_f32 v131, v176, v177
    v_exp_f32 v178, v86
    s_nop 0
    v_add_f32 v219, v219, v178
    v_exp_f32 v179, v87
    s_nop 0
    v_add_f32 v219, v219, v179
    v_cvt_pk_bf16_f32 v135, v178, v179
    v_exp_f32 v180, v90
    s_nop 0
    v_add_f32 v220, v220, v180
    v_exp_f32 v181, v91
    s_nop 0
    v_add_f32 v220, v220, v181
    v_cvt_pk_bf16_f32 v139, v180, v181
    v_exp_f32 v182, v94
    s_nop 0
    v_add_f32 v221, v221, v182
    v_exp_f32 v183, v95
    s_nop 0
    v_add_f32 v221, v221, v183
    v_cvt_pk_bf16_f32 v143, v182, v183
    s_nop 3
    s_branch attn_back10
attn_rare11:
    s_nop 15
    v_max3_f32 v184, v96, v97, v98
    v_max3_f32 v184, v184, v99, v112
    v_max3_f32 v184, v184, v113, v114
    v_max_f32 v184, v184, v115
    v_mov_b32 v185, v184
    s_nop 1
    v_permlane16_swap_b32 v184, v185
    v_max_f32 v184, v184, v185
    v_mov_b32 v185, v184
    s_nop 1
    v_permlane32_swap_b32 v184, v185
    v_max_f32 v184, v184, v185
    v_add_f32 v185, 0x42c80000, v184
    v_cmp_gt_f32 vcc, v184, v226
    s_nop 1
    v_cndmask_b32 v185, 0, v185, vcc
    v_sub_f32 v96, v96, v185
    v_sub_f32 v112, v112, v185
    v_sub_f32 v97, v97, v185
    v_sub_f32 v113, v113, v185
    v_sub_f32 v98, v98, v185
    v_sub_f32 v114, v114, v185
    v_sub_f32 v99, v99, v185
    v_sub_f32 v115, v115, v185
    v_sub_f32 v64, v64, v185
    v_sub_f32 v65, v65, v185
    v_sub_f32 v66, v66, v185
    v_sub_f32 v67, v67, v185
    v_sub_f32 v80, v80, v185
    v_sub_f32 v81, v81, v185
    v_sub_f32 v82, v82, v185
    v_sub_f32 v83, v83, v185
    v_sub_f32 v160, v160, v185
    v_sub_f32 v161, v161, v185
    v_sub_f32 v162, v162, v185
    v_sub_f32 v163, v163, v185
    v_sub_f32 v185, 0, v185
    v_exp_f32 v185, v185
    s_nop 0
    v_mul_f32 v214, v214, v185
    v_accvgpr_read_b32 v186, a0
    v_mul_f32 v186, v186, v185
    v_accvgpr_write_b32 a0, v186
    v_accvgpr_read_b32 v187, a1
    v_mul_f32 v187, v187, v185
    v_accvgpr_write_b32 a1, v187
    v_accvgpr_read_b32 v188, a2
    v_mul_f32 v188, v188, v185
    v_accvgpr_write_b32 a2, v188
    v_accvgpr_read_b32 v189, a3
    v_mul_f32 v189, v189, v185
    v_accvgpr_write_b32 a3, v189
    v_accvgpr_read_b32 v186, a16
    v_mul_f32 v186, v186, v185
    v_accvgpr_write_b32 a16, v186
    v_accvgpr_read_b32 v187, a17
    v_mul_f32 v187, v187, v185
    v_accvgpr_write_b32 a17, v187
    v_accvgpr_read_b32 v188, a18
    v_mul_f32 v188, v188, v185
    v_accvgpr_write_b32 a18, v188
    v_accvgpr_read_b32 v189, a19
    v_mul_f32 v189, v189, v185
    v_accvgpr_write_b32 a19, v189
    v_accvgpr_read_b32 v186, a32
    v_mul_f32 v186, v186, v185
    v_accvgpr_write_b32 a32, v186
    v_accvgpr_read_b32 v187, a33
    v_mul_f32 v187, v187, v185
    v_accvgpr_write_b32 a33, v187
    v_accvgpr_read_b32 v188, a34
    v_mul_f32 v188, v188, v185
    v_accvgpr_write_b32 a34, v188
    v_accvgpr_read_b32 v189, a35
    v_mul_f32 v189, v189, v185
    v_accvgpr_write_b32 a35, v189
    v_accvgpr_read_b32 v186, a48
    v_mul_f32 v186, v186, v185
    v_accvgpr_write_b32 a48, v186
    v_accvgpr_read_b32 v187, a49
    v_mul_f32 v187, v187, v185
    v_accvgpr_write_b32 a49, v187
    v_accvgpr_read_b32 v188, a50
    v_mul_f32 v188, v188, v185
    v_accvgpr_write_b32 a50, v188
    v_accvgpr_read_b32 v189, a51
    v_mul_f32 v189, v189, v185
    v_accvgpr_write_b32 a51, v189
    v_accvgpr_read_b32 v186, a64
    v_mul_f32 v186, v186, v185
    v_accvgpr_write_b32 a64, v186
    v_accvgpr_read_b32 v187, a65
    v_mul_f32 v187, v187, v185
    v_accvgpr_write_b32 a65, v187
    v_accvgpr_read_b32 v188, a66
    v_mul_f32 v188, v188, v185
    v_accvgpr_write_b32 a66, v188
    v_accvgpr_read_b32 v189, a67
    v_mul_f32 v189, v189, v185
    v_accvgpr_write_b32 a67, v189
    v_accvgpr_read_b32 v186, a80
    v_mul_f32 v186, v186, v185
    v_accvgpr_write_b32 a80, v186
    v_accvgpr_read_b32 v187, a81
    v_mul_f32 v187, v187, v185
    v_accvgpr_write_b32 a81, v187
    v_accvgpr_read_b32 v188, a82
    v_mul_f32 v188, v188, v185
    v_accvgpr_write_b32 a82, v188
    v_accvgpr_read_b32 v189, a83
    v_mul_f32 v189, v189, v185
    v_accvgpr_write_b32 a83, v189
    v_accvgpr_read_b32 v186, a96
    v_mul_f32 v186, v186, v185
    v_accvgpr_write_b32 a96, v186
    v_accvgpr_read_b32 v187, a97
    v_mul_f32 v187, v187, v185
    v_accvgpr_write_b32 a97, v187
    v_accvgpr_read_b32 v188, a98
    v_mul_f32 v188, v188, v185
    v_accvgpr_write_b32 a98, v188
    v_accvgpr_read_b32 v189, a99
    v_mul_f32 v189, v189, v185
    v_accvgpr_write_b32 a99, v189
    v_accvgpr_read_b32 v186, a112
    v_mul_f32 v186, v186, v185
    v_accvgpr_write_b32 a112, v186
    v_accvgpr_read_b32 v187, a113
    v_mul_f32 v187, v187, v185
    v_accvgpr_write_b32 a113, v187
    v_accvgpr_read_b32 v188, a114
    v_mul_f32 v188, v188, v185
    v_accvgpr_write_b32 a114, v188
    v_accvgpr_read_b32 v189, a115
    v_mul_f32 v189, v189, v185
    v_accvgpr_write_b32 a115, v189
    v_max3_f32 v184, v100, v101, v102
    v_max3_f32 v184, v184, v103, v116
    v_max3_f32 v184, v184, v117, v118
    v_max_f32 v184, v184, v119
    v_mov_b32 v185, v184
    s_nop 1
    v_permlane16_swap_b32 v184, v185
    v_max_f32 v184, v184, v185
    v_mov_b32 v185, v184
    s_nop 1
    v_permlane32_swap_b32 v184, v185
    v_max_f32 v184, v184, v185
    v_add_f32 v185, 0x42c80000, v184
    v_cmp_gt_f32 vcc, v184, v226
    s_nop 1
    v_cndmask_b32 v185, 0, v185, vcc
    v_sub_f32 v100, v100, v185
    v_sub_f32 v116, v116, v185
    v_sub_f32 v101, v101, v185
    v_sub_f32 v117, v117, v185
    v_sub_f32 v102, v102, v185
    v_sub_f32 v118, v118, v185
    v_sub_f32 v103, v103, v185
    v_sub_f32 v119, v119, v185
    v_sub_f32 v68, v68, v185
    v_sub_f32 v69, v69, v185
    v_sub_f32 v70, v70, v185
    v_sub_f32 v71, v71, v185
    v_sub_f32 v84, v84, v185
    v_sub_f32 v85, v85, v185
    v_sub_f32 v86, v86, v185
    v_sub_f32 v87, v87, v185
    v_sub_f32 v164, v164, v185
    v_sub_f32 v165, v165, v185
    v_sub_f32 v166, v166, v185
    v_sub_f32 v167, v167, v185
    v_sub_f32 v185, 0, v185
    v_exp_f32 v185, v185
    s_nop 0
    v_mul_f32 v215, v215, v185
    v_accvgpr_read_b32 v186, a4
    v_mul_f32 v186, v186, v185
    v_accvgpr_write_b32 a4, v186
    v_accvgpr_read_b32 v187, a5
    v_mul_f32 v187, v187, v185
    v_accvgpr_write_b32 a5, v187
    v_accvgpr_read_b32 v188, a6
    v_mul_f32 v188, v188, v185
    v_accvgpr_write_b32 a6, v188
    v_accvgpr_read_b32 v189, a7
    v_mul_f32 v189, v189, v185
    v_accvgpr_write_b32 a7, v189
    v_accvgpr_read_b32 v186, a20
    v_mul_f32 v186, v186, v185
    v_accvgpr_write_b32 a20, v186
    v_accvgpr_read_b32 v187, a21
    v_mul_f32 v187, v187, v185
    v_accvgpr_write_b32 a21, v187
    v_accvgpr_read_b32 v188, a22
    v_mul_f32 v188, v188, v185
    v_accvgpr_write_b32 a22, v188
    v_accvgpr_read_b32 v189, a23
    v_mul_f32 v189, v189, v185
    v_accvgpr_write_b32 a23, v189
    v_accvgpr_read_b32 v186, a36
    v_mul_f32 v186, v186, v185
    v_accvgpr_write_b32 a36, v186
    v_accvgpr_read_b32 v187, a37
    v_mul_f32 v187, v187, v185
    v_accvgpr_write_b32 a37, v187
    v_accvgpr_read_b32 v188, a38
    v_mul_f32 v188, v188, v185
    v_accvgpr_write_b32 a38, v188
    v_accvgpr_read_b32 v189, a39
    v_mul_f32 v189, v189, v185
    v_accvgpr_write_b32 a39, v189
    v_accvgpr_read_b32 v186, a52
    v_mul_f32 v186, v186, v185
    v_accvgpr_write_b32 a52, v186
    v_accvgpr_read_b32 v187, a53
    v_mul_f32 v187, v187, v185
    v_accvgpr_write_b32 a53, v187
    v_accvgpr_read_b32 v188, a54
    v_mul_f32 v188, v188, v185
    v_accvgpr_write_b32 a54, v188
    v_accvgpr_read_b32 v189, a55
    v_mul_f32 v189, v189, v185
    v_accvgpr_write_b32 a55, v189
    v_accvgpr_read_b32 v186, a68
    v_mul_f32 v186, v186, v185
    v_accvgpr_write_b32 a68, v186
    v_accvgpr_read_b32 v187, a69
    v_mul_f32 v187, v187, v185
    v_accvgpr_write_b32 a69, v187
    v_accvgpr_read_b32 v188, a70
    v_mul_f32 v188, v188, v185
    v_accvgpr_write_b32 a70, v188
    v_accvgpr_read_b32 v189, a71
    v_mul_f32 v189, v189, v185
    v_accvgpr_write_b32 a71, v189
    v_accvgpr_read_b32 v186, a84
    v_mul_f32 v186, v186, v185
    v_accvgpr_write_b32 a84, v186
    v_accvgpr_read_b32 v187, a85
    v_mul_f32 v187, v187, v185
    v_accvgpr_write_b32 a85, v187
    v_accvgpr_read_b32 v188, a86
    v_mul_f32 v188, v188, v185
    v_accvgpr_write_b32 a86, v188
    v_accvgpr_read_b32 v189, a87
    v_mul_f32 v189, v189, v185
    v_accvgpr_write_b32 a87, v189
    v_accvgpr_read_b32 v186, a100
    v_mul_f32 v186, v186, v185
    v_accvgpr_write_b32 a100, v186
    v_accvgpr_read_b32 v187, a101
    v_mul_f32 v187, v187, v185
    v_accvgpr_write_b32 a101, v187
    v_accvgpr_read_b32 v188, a102
    v_mul_f32 v188, v188, v185
    v_accvgpr_write_b32 a102, v188
    v_accvgpr_read_b32 v189, a103
    v_mul_f32 v189, v189, v185
    v_accvgpr_write_b32 a103, v189
    v_accvgpr_read_b32 v186, a116
    v_mul_f32 v186, v186, v185
    v_accvgpr_write_b32 a116, v186
    v_accvgpr_read_b32 v187, a117
    v_mul_f32 v187, v187, v185
    v_accvgpr_write_b32 a117, v187
    v_accvgpr_read_b32 v188, a118
    v_mul_f32 v188, v188, v185
    v_accvgpr_write_b32 a118, v188
    v_accvgpr_read_b32 v189, a119
    v_mul_f32 v189, v189, v185
    v_accvgpr_write_b32 a119, v189
    v_max3_f32 v184, v104, v105, v106
    v_max3_f32 v184, v184, v107, v120
    v_max3_f32 v184, v184, v121, v122
    v_max_f32 v184, v184, v123
    v_mov_b32 v185, v184
    s_nop 1
    v_permlane16_swap_b32 v184, v185
    v_max_f32 v184, v184, v185
    v_mov_b32 v185, v184
    s_nop 1
    v_permlane32_swap_b32 v184, v185
    v_max_f32 v184, v184, v185
    v_add_f32 v185, 0x42c80000, v184
    v_cmp_gt_f32 vcc, v184, v226
    s_nop 1
    v_cndmask_b32 v185, 0, v185, vcc
    v_sub_f32 v104, v104, v185
    v_sub_f32 v120, v120, v185
    v_sub_f32 v105, v105, v185
    v_sub_f32 v121, v121, v185
    v_sub_f32 v106, v106, v185
    v_sub_f32 v122, v122, v185
    v_sub_f32 v107, v107, v185
    v_sub_f32 v123, v123, v185
    v_sub_f32 v72, v72, v185
    v_sub_f32 v73, v73, v185
    v_sub_f32 v74, v74, v185
    v_sub_f32 v75, v75, v185
    v_sub_f32 v88, v88, v185
    v_sub_f32 v89, v89, v185
    v_sub_f32 v90, v90, v185
    v_sub_f32 v91, v91, v185
    v_sub_f32 v168, v168, v185
    v_sub_f32 v169, v169, v185
    v_sub_f32 v170, v170, v185
    v_sub_f32 v171, v171, v185
    v_sub_f32 v185, 0, v185
    v_exp_f32 v185, v185
    s_nop 0
    v_mul_f32 v216, v216, v185
    v_accvgpr_read_b32 v186, a8
    v_mul_f32 v186, v186, v185
    v_accvgpr_write_b32 a8, v186
    v_accvgpr_read_b32 v187, a9
    v_mul_f32 v187, v187, v185
    v_accvgpr_write_b32 a9, v187
    v_accvgpr_read_b32 v188, a10
    v_mul_f32 v188, v188, v185
    v_accvgpr_write_b32 a10, v188
    v_accvgpr_read_b32 v189, a11
    v_mul_f32 v189, v189, v185
    v_accvgpr_write_b32 a11, v189
    v_accvgpr_read_b32 v186, a24
    v_mul_f32 v186, v186, v185
    v_accvgpr_write_b32 a24, v186
    v_accvgpr_read_b32 v187, a25
    v_mul_f32 v187, v187, v185
    v_accvgpr_write_b32 a25, v187
    v_accvgpr_read_b32 v188, a26
    v_mul_f32 v188, v188, v185
    v_accvgpr_write_b32 a26, v188
    v_accvgpr_read_b32 v189, a27
    v_mul_f32 v189, v189, v185
    v_accvgpr_write_b32 a27, v189
    v_accvgpr_read_b32 v186, a40
    v_mul_f32 v186, v186, v185
    v_accvgpr_write_b32 a40, v186
    v_accvgpr_read_b32 v187, a41
    v_mul_f32 v187, v187, v185
    v_accvgpr_write_b32 a41, v187
    v_accvgpr_read_b32 v188, a42
    v_mul_f32 v188, v188, v185
    v_accvgpr_write_b32 a42, v188
    v_accvgpr_read_b32 v189, a43
    v_mul_f32 v189, v189, v185
    v_accvgpr_write_b32 a43, v189
    v_accvgpr_read_b32 v186, a56
    v_mul_f32 v186, v186, v185
    v_accvgpr_write_b32 a56, v186
    v_accvgpr_read_b32 v187, a57
    v_mul_f32 v187, v187, v185
    v_accvgpr_write_b32 a57, v187
    v_accvgpr_read_b32 v188, a58
    v_mul_f32 v188, v188, v185
    v_accvgpr_write_b32 a58, v188
    v_accvgpr_read_b32 v189, a59
    v_mul_f32 v189, v189, v185
    v_accvgpr_write_b32 a59, v189
    v_accvgpr_read_b32 v186, a72
    v_mul_f32 v186, v186, v185
    v_accvgpr_write_b32 a72, v186
    v_accvgpr_read_b32 v187, a73
    v_mul_f32 v187, v187, v185
    v_accvgpr_write_b32 a73, v187
    v_accvgpr_read_b32 v188, a74
    v_mul_f32 v188, v188, v185
    v_accvgpr_write_b32 a74, v188
    v_accvgpr_read_b32 v189, a75
    v_mul_f32 v189, v189, v185
    v_accvgpr_write_b32 a75, v189
    v_accvgpr_read_b32 v186, a88
    v_mul_f32 v186, v186, v185
    v_accvgpr_write_b32 a88, v186
    v_accvgpr_read_b32 v187, a89
    v_mul_f32 v187, v187, v185
    v_accvgpr_write_b32 a89, v187
    v_accvgpr_read_b32 v188, a90
    v_mul_f32 v188, v188, v185
    v_accvgpr_write_b32 a90, v188
    v_accvgpr_read_b32 v189, a91
    v_mul_f32 v189, v189, v185
    v_accvgpr_write_b32 a91, v189
    v_accvgpr_read_b32 v186, a104
    v_mul_f32 v186, v186, v185
    v_accvgpr_write_b32 a104, v186
    v_accvgpr_read_b32 v187, a105
    v_mul_f32 v187, v187, v185
    v_accvgpr_write_b32 a105, v187
    v_accvgpr_read_b32 v188, a106
    v_mul_f32 v188, v188, v185
    v_accvgpr_write_b32 a106, v188
    v_accvgpr_read_b32 v189, a107
    v_mul_f32 v189, v189, v185
    v_accvgpr_write_b32 a107, v189
    v_accvgpr_read_b32 v186, a120
    v_mul_f32 v186, v186, v185
    v_accvgpr_write_b32 a120, v186
    v_accvgpr_read_b32 v187, a121
    v_mul_f32 v187, v187, v185
    v_accvgpr_write_b32 a121, v187
    v_accvgpr_read_b32 v188, a122
    v_mul_f32 v188, v188, v185
    v_accvgpr_write_b32 a122, v188
    v_accvgpr_read_b32 v189, a123
    v_mul_f32 v189, v189, v185
    v_accvgpr_write_b32 a123, v189
    v_max3_f32 v184, v108, v109, v110
    v_max3_f32 v184, v184, v111, v124
    v_max3_f32 v184, v184, v125, v126
    v_max_f32 v184, v184, v127
    v_mov_b32 v185, v184
    s_nop 1
    v_permlane16_swap_b32 v184, v185
    v_max_f32 v184, v184, v185
    v_mov_b32 v185, v184
    s_nop 1
    v_permlane32_swap_b32 v184, v185
    v_max_f32 v184, v184, v185
    v_add_f32 v185, 0x42c80000, v184
    v_cmp_gt_f32 vcc, v184, v226
    s_nop 1
    v_cndmask_b32 v185, 0, v185, vcc
    v_sub_f32 v108, v108, v185
    v_sub_f32 v124, v124, v185
    v_sub_f32 v109, v109, v185
    v_sub_f32 v125, v125, v185
    v_sub_f32 v110, v110, v185
    v_sub_f32 v126, v126, v185
    v_sub_f32 v111, v111, v185
    v_sub_f32 v127, v127, v185
    v_sub_f32 v76, v76, v185
    v_sub_f32 v77, v77, v185
    v_sub_f32 v78, v78, v185
    v_sub_f32 v79, v79, v185
    v_sub_f32 v92, v92, v185
    v_sub_f32 v93, v93, v185
    v_sub_f32 v94, v94, v185
    v_sub_f32 v95, v95, v185
    v_sub_f32 v172, v172, v185
    v_sub_f32 v173, v173, v185
    v_sub_f32 v174, v174, v185
    v_sub_f32 v175, v175, v185
    v_sub_f32 v185, 0, v185
    v_exp_f32 v185, v185
    s_nop 0
    v_mul_f32 v217, v217, v185
    v_accvgpr_read_b32 v186, a12
    v_mul_f32 v186, v186, v185
    v_accvgpr_write_b32 a12, v186
    v_accvgpr_read_b32 v187, a13
    v_mul_f32 v187, v187, v185
    v_accvgpr_write_b32 a13, v187
    v_accvgpr_read_b32 v188, a14
    v_mul_f32 v188, v188, v185
    v_accvgpr_write_b32 a14, v188
    v_accvgpr_read_b32 v189, a15
    v_mul_f32 v189, v189, v185
    v_accvgpr_write_b32 a15, v189
    v_accvgpr_read_b32 v186, a28
    v_mul_f32 v186, v186, v185
    v_accvgpr_write_b32 a28, v186
    v_accvgpr_read_b32 v187, a29
    v_mul_f32 v187, v187, v185
    v_accvgpr_write_b32 a29, v187
    v_accvgpr_read_b32 v188, a30
    v_mul_f32 v188, v188, v185
    v_accvgpr_write_b32 a30, v188
    v_accvgpr_read_b32 v189, a31
    v_mul_f32 v189, v189, v185
    v_accvgpr_write_b32 a31, v189
    v_accvgpr_read_b32 v186, a44
    v_mul_f32 v186, v186, v185
    v_accvgpr_write_b32 a44, v186
    v_accvgpr_read_b32 v187, a45
    v_mul_f32 v187, v187, v185
    v_accvgpr_write_b32 a45, v187
    v_accvgpr_read_b32 v188, a46
    v_mul_f32 v188, v188, v185
    v_accvgpr_write_b32 a46, v188
    v_accvgpr_read_b32 v189, a47
    v_mul_f32 v189, v189, v185
    v_accvgpr_write_b32 a47, v189
    v_accvgpr_read_b32 v186, a60
    v_mul_f32 v186, v186, v185
    v_accvgpr_write_b32 a60, v186
    v_accvgpr_read_b32 v187, a61
    v_mul_f32 v187, v187, v185
    v_accvgpr_write_b32 a61, v187
    v_accvgpr_read_b32 v188, a62
    v_mul_f32 v188, v188, v185
    v_accvgpr_write_b32 a62, v188
    v_accvgpr_read_b32 v189, a63
    v_mul_f32 v189, v189, v185
    v_accvgpr_write_b32 a63, v189
    v_accvgpr_read_b32 v186, a76
    v_mul_f32 v186, v186, v185
    v_accvgpr_write_b32 a76, v186
    v_accvgpr_read_b32 v187, a77
    v_mul_f32 v187, v187, v185
    v_accvgpr_write_b32 a77, v187
    v_accvgpr_read_b32 v188, a78
    v_mul_f32 v188, v188, v185
    v_accvgpr_write_b32 a78, v188
    v_accvgpr_read_b32 v189, a79
    v_mul_f32 v189, v189, v185
    v_accvgpr_write_b32 a79, v189
    v_accvgpr_read_b32 v186, a92
    v_mul_f32 v186, v186, v185
    v_accvgpr_write_b32 a92, v186
    v_accvgpr_read_b32 v187, a93
    v_mul_f32 v187, v187, v185
    v_accvgpr_write_b32 a93, v187
    v_accvgpr_read_b32 v188, a94
    v_mul_f32 v188, v188, v185
    v_accvgpr_write_b32 a94, v188
    v_accvgpr_read_b32 v189, a95
    v_mul_f32 v189, v189, v185
    v_accvgpr_write_b32 a95, v189
    v_accvgpr_read_b32 v186, a108
    v_mul_f32 v186, v186, v185
    v_accvgpr_write_b32 a108, v186
    v_accvgpr_read_b32 v187, a109
    v_mul_f32 v187, v187, v185
    v_accvgpr_write_b32 a109, v187
    v_accvgpr_read_b32 v188, a110
    v_mul_f32 v188, v188, v185
    v_accvgpr_write_b32 a110, v188
    v_accvgpr_read_b32 v189, a111
    v_mul_f32 v189, v189, v185
    v_accvgpr_write_b32 a111, v189
    v_accvgpr_read_b32 v186, a124
    v_mul_f32 v186, v186, v185
    v_accvgpr_write_b32 a124, v186
    v_accvgpr_read_b32 v187, a125
    v_mul_f32 v187, v187, v185
    v_accvgpr_write_b32 a125, v187
    v_accvgpr_read_b32 v188, a126
    v_mul_f32 v188, v188, v185
    v_accvgpr_write_b32 a126, v188
    v_accvgpr_read_b32 v189, a127
    v_mul_f32 v189, v189, v185
    v_accvgpr_write_b32 a127, v189
    v_exp_f32 v176, v96
    v_exp_f32 v177, v97
    s_nop 0
    v_add_f32 v218, v176, v177
    v_cvt_pk_bf16_f32 v144, v176, v177
    v_exp_f32 v178, v100
    v_exp_f32 v179, v101
    s_nop 0
    v_add_f32 v219, v178, v179
    v_cvt_pk_bf16_f32 v148, v178, v179
    v_exp_f32 v180, v104
    v_exp_f32 v181, v105
    s_nop 0
    v_add_f32 v220, v180, v181
    v_cvt_pk_bf16_f32 v152, v180, v181
    v_exp_f32 v182, v108
    v_exp_f32 v183, v109
    s_nop 0
    v_add_f32 v221, v182, v183
    v_cvt_pk_bf16_f32 v156, v182, v183
    v_exp_f32 v176, v98
    s_nop 0
    v_add_f32 v218, v218, v176
    v_exp_f32 v177, v99
    s_nop 0
    v_add_f32 v218, v218, v177
    v_cvt_pk_bf16_f32 v145, v176, v177
    v_exp_f32 v178, v102
    s_nop 0
    v_add_f32 v219, v219, v178
    v_exp_f32 v179, v103
    s_nop 0
    v_add_f32 v219, v219, v179
    v_cvt_pk_bf16_f32 v149, v178, v179
    v_exp_f32 v180, v106
    s_nop 0
    v_add_f32 v220, v220, v180
    v_exp_f32 v181, v107
    s_nop 0
    v_add_f32 v220, v220, v181
    v_cvt_pk_bf16_f32 v153, v180, v181
    v_exp_f32 v182, v110
    s_nop 0
    v_add_f32 v221, v221, v182
    v_exp_f32 v183, v111
    s_nop 0
    v_add_f32 v221, v221, v183
    v_cvt_pk_bf16_f32 v157, v182, v183
    v_exp_f32 v176, v112
    s_nop 0
    v_add_f32 v218, v218, v176
    v_exp_f32 v177, v113
    s_nop 0
    v_add_f32 v218, v218, v177
    v_cvt_pk_bf16_f32 v146, v176, v177
    v_exp_f32 v178, v116
    s_nop 0
    v_add_f32 v219, v219, v178
    v_exp_f32 v179, v117
    s_nop 0
    v_add_f32 v219, v219, v179
    v_cvt_pk_bf16_f32 v150, v178, v179
    v_exp_f32 v180, v120
    s_nop 0
    v_add_f32 v220, v220, v180
    v_exp_f32 v181, v121
    s_nop 0
    v_add_f32 v220, v220, v181
    v_cvt_pk_bf16_f32 v154, v180, v181
    v_exp_f32 v182, v124
    s_nop 0
    v_add_f32 v221, v221, v182
    v_exp_f32 v183, v125
    s_nop 0
    v_add_f32 v221, v221, v183
    v_cvt_pk_bf16_f32 v158, v182, v183
    v_exp_f32 v176, v114
    s_nop 0
    v_add_f32 v218, v218, v176
    v_exp_f32 v177, v115
    s_nop 0
    v_add_f32 v218, v218, v177
    v_cvt_pk_bf16_f32 v147, v176, v177
    v_exp_f32 v178, v118
    s_nop 0
    v_add_f32 v219, v219, v178
    v_exp_f32 v179, v119
    s_nop 0
    v_add_f32 v219, v219, v179
    v_cvt_pk_bf16_f32 v151, v178, v179
    v_exp_f32 v180, v122
    s_nop 0
    v_add_f32 v220, v220, v180
    v_exp_f32 v181, v123
    s_nop 0
    v_add_f32 v220, v220, v181
    v_cvt_pk_bf16_f32 v155, v180, v181
    v_exp_f32 v182, v126
    s_nop 0
    v_add_f32 v221, v221, v182
    v_exp_f32 v183, v127
    s_nop 0
    v_add_f32 v221, v221, v183
    v_cvt_pk_bf16_f32 v159, v182, v183
    s_nop 3
    s_branch attn_back12
attn_rare13:
    s_nop 15
    v_max3_f32 v184, v64, v65, v66
    v_max3_f32 v184, v184, v67, v80
    v_max3_f32 v184, v184, v81, v82
    v_max_f32 v184, v184, v83
    v_mov_b32 v185, v184
    s_nop 1
    v_permlane16_swap_b32 v184, v185
    v_max_f32 v184, v184, v185
    v_mov_b32 v185, v184
    s_nop 1
    v_permlane32_swap_b32 v184, v185
    v_max_f32 v184, v184, v185
    v_add_f32 v185, 0x42c80000, v184
    v_cmp_gt_f32 vcc, v184, v226
    s_nop 1
    v_cndmask_b32 v185, 0, v185, vcc
    v_sub_f32 v64, v64, v185
    v_sub_f32 v80, v80, v185
    v_sub_f32 v65, v65, v185
    v_sub_f32 v81, v81, v185
    v_sub_f32 v66, v66, v185
    v_sub_f32 v82, v82, v185
    v_sub_f32 v67, v67, v185
    v_sub_f32 v83, v83, v185
    v_sub_f32 v96, v96, v185
    v_sub_f32 v97, v97, v185
    v_sub_f32 v98, v98, v185
    v_sub_f32 v99, v99, v185
    v_sub_f32 v112, v112, v185
    v_sub_f32 v113, v113, v185
    v_sub_f32 v114, v114, v185
    v_sub_f32 v115, v115, v185
    v_sub_f32 v160, v160, v185
    v_sub_f32 v161, v161, v185
    v_sub_f32 v162, v162, v185
    v_sub_f32 v163, v163, v185
    v_sub_f32 v185, 0, v185
    v_exp_f32 v185, v185
    s_nop 0
    v_mul_f32 v214, v214, v185
    v_accvgpr_read_b32 v186, a0
    v_mul_f32 v186, v186, v185
    v_accvgpr_write_b32 a0, v186
    v_accvgpr_read_b32 v187, a1
    v_mul_f32 v187, v187, v185
    v_accvgpr_write_b32 a1, v187
    v_accvgpr_read_b32 v188, a2
    v_mul_f32 v188, v188, v185
    v_accvgpr_write_b32 a2, v188
    v_accvgpr_read_b32 v189, a3
    v_mul_f32 v189, v189, v185
    v_accvgpr_write_b32 a3, v189
    v_accvgpr_read_b32 v186, a16
    v_mul_f32 v186, v186, v185
    v_accvgpr_write_b32 a16, v186
    v_accvgpr_read_b32 v187, a17
    v_mul_f32 v187, v187, v185
    v_accvgpr_write_b32 a17, v187
    v_accvgpr_read_b32 v188, a18
    v_mul_f32 v188, v188, v185
    v_accvgpr_write_b32 a18, v188
    v_accvgpr_read_b32 v189, a19
    v_mul_f32 v189, v189, v185
    v_accvgpr_write_b32 a19, v189
    v_accvgpr_read_b32 v186, a32
    v_mul_f32 v186, v186, v185
    v_accvgpr_write_b32 a32, v186
    v_accvgpr_read_b32 v187, a33
    v_mul_f32 v187, v187, v185
    v_accvgpr_write_b32 a33, v187
    v_accvgpr_read_b32 v188, a34
    v_mul_f32 v188, v188, v185
    v_accvgpr_write_b32 a34, v188
    v_accvgpr_read_b32 v189, a35
    v_mul_f32 v189, v189, v185
    v_accvgpr_write_b32 a35, v189
    v_accvgpr_read_b32 v186, a48
    v_mul_f32 v186, v186, v185
    v_accvgpr_write_b32 a48, v186
    v_accvgpr_read_b32 v187, a49
    v_mul_f32 v187, v187, v185
    v_accvgpr_write_b32 a49, v187
    v_accvgpr_read_b32 v188, a50
    v_mul_f32 v188, v188, v185
    v_accvgpr_write_b32 a50, v188
    v_accvgpr_read_b32 v189, a51
    v_mul_f32 v189, v189, v185
    v_accvgpr_write_b32 a51, v189
    v_accvgpr_read_b32 v186, a64
    v_mul_f32 v186, v186, v185
    v_accvgpr_write_b32 a64, v186
    v_accvgpr_read_b32 v187, a65
    v_mul_f32 v187, v187, v185
    v_accvgpr_write_b32 a65, v187
    v_accvgpr_read_b32 v188, a66
    v_mul_f32 v188, v188, v185
    v_accvgpr_write_b32 a66, v188
    v_accvgpr_read_b32 v189, a67
    v_mul_f32 v189, v189, v185
    v_accvgpr_write_b32 a67, v189
    v_accvgpr_read_b32 v186, a80
    v_mul_f32 v186, v186, v185
    v_accvgpr_write_b32 a80, v186
    v_accvgpr_read_b32 v187, a81
    v_mul_f32 v187, v187, v185
    v_accvgpr_write_b32 a81, v187
    v_accvgpr_read_b32 v188, a82
    v_mul_f32 v188, v188, v185
    v_accvgpr_write_b32 a82, v188
    v_accvgpr_read_b32 v189, a83
    v_mul_f32 v189, v189, v185
    v_accvgpr_write_b32 a83, v189
    v_accvgpr_read_b32 v186, a96
    v_mul_f32 v186, v186, v185
    v_accvgpr_write_b32 a96, v186
    v_accvgpr_read_b32 v187, a97
    v_mul_f32 v187, v187, v185
    v_accvgpr_write_b32 a97, v187
    v_accvgpr_read_b32 v188, a98
    v_mul_f32 v188, v188, v185
    v_accvgpr_write_b32 a98, v188
    v_accvgpr_read_b32 v189, a99
    v_mul_f32 v189, v189, v185
    v_accvgpr_write_b32 a99, v189
    v_accvgpr_read_b32 v186, a112
    v_mul_f32 v186, v186, v185
    v_accvgpr_write_b32 a112, v186
    v_accvgpr_read_b32 v187, a113
    v_mul_f32 v187, v187, v185
    v_accvgpr_write_b32 a113, v187
    v_accvgpr_read_b32 v188, a114
    v_mul_f32 v188, v188, v185
    v_accvgpr_write_b32 a114, v188
    v_accvgpr_read_b32 v189, a115
    v_mul_f32 v189, v189, v185
    v_accvgpr_write_b32 a115, v189
    v_max3_f32 v184, v68, v69, v70
    v_max3_f32 v184, v184, v71, v84
    v_max3_f32 v184, v184, v85, v86
    v_max_f32 v184, v184, v87
    v_mov_b32 v185, v184
    s_nop 1
    v_permlane16_swap_b32 v184, v185
    v_max_f32 v184, v184, v185
    v_mov_b32 v185, v184
    s_nop 1
    v_permlane32_swap_b32 v184, v185
    v_max_f32 v184, v184, v185
    v_add_f32 v185, 0x42c80000, v184
    v_cmp_gt_f32 vcc, v184, v226
    s_nop 1
    v_cndmask_b32 v185, 0, v185, vcc
    v_sub_f32 v68, v68, v185
    v_sub_f32 v84, v84, v185
    v_sub_f32 v69, v69, v185
    v_sub_f32 v85, v85, v185
    v_sub_f32 v70, v70, v185
    v_sub_f32 v86, v86, v185
    v_sub_f32 v71, v71, v185
    v_sub_f32 v87, v87, v185
    v_sub_f32 v100, v100, v185
    v_sub_f32 v101, v101, v185
    v_sub_f32 v102, v102, v185
    v_sub_f32 v103, v103, v185
    v_sub_f32 v116, v116, v185
    v_sub_f32 v117, v117, v185
    v_sub_f32 v118, v118, v185
    v_sub_f32 v119, v119, v185
    v_sub_f32 v164, v164, v185
    v_sub_f32 v165, v165, v185
    v_sub_f32 v166, v166, v185
    v_sub_f32 v167, v167, v185
    v_sub_f32 v185, 0, v185
    v_exp_f32 v185, v185
    s_nop 0
    v_mul_f32 v215, v215, v185
    v_accvgpr_read_b32 v186, a4
    v_mul_f32 v186, v186, v185
    v_accvgpr_write_b32 a4, v186
    v_accvgpr_read_b32 v187, a5
    v_mul_f32 v187, v187, v185
    v_accvgpr_write_b32 a5, v187
    v_accvgpr_read_b32 v188, a6
    v_mul_f32 v188, v188, v185
    v_accvgpr_write_b32 a6, v188
    v_accvgpr_read_b32 v189, a7
    v_mul_f32 v189, v189, v185
    v_accvgpr_write_b32 a7, v189
    v_accvgpr_read_b32 v186, a20
    v_mul_f32 v186, v186, v185
    v_accvgpr_write_b32 a20, v186
    v_accvgpr_read_b32 v187, a21
    v_mul_f32 v187, v187, v185
    v_accvgpr_write_b32 a21, v187
    v_accvgpr_read_b32 v188, a22
    v_mul_f32 v188, v188, v185
    v_accvgpr_write_b32 a22, v188
    v_accvgpr_read_b32 v189, a23
    v_mul_f32 v189, v189, v185
    v_accvgpr_write_b32 a23, v189
    v_accvgpr_read_b32 v186, a36
    v_mul_f32 v186, v186, v185
    v_accvgpr_write_b32 a36, v186
    v_accvgpr_read_b32 v187, a37
    v_mul_f32 v187, v187, v185
    v_accvgpr_write_b32 a37, v187
    v_accvgpr_read_b32 v188, a38
    v_mul_f32 v188, v188, v185
    v_accvgpr_write_b32 a38, v188
    v_accvgpr_read_b32 v189, a39
    v_mul_f32 v189, v189, v185
    v_accvgpr_write_b32 a39, v189
    v_accvgpr_read_b32 v186, a52
    v_mul_f32 v186, v186, v185
    v_accvgpr_write_b32 a52, v186
    v_accvgpr_read_b32 v187, a53
    v_mul_f32 v187, v187, v185
    v_accvgpr_write_b32 a53, v187
    v_accvgpr_read_b32 v188, a54
    v_mul_f32 v188, v188, v185
    v_accvgpr_write_b32 a54, v188
    v_accvgpr_read_b32 v189, a55
    v_mul_f32 v189, v189, v185
    v_accvgpr_write_b32 a55, v189
    v_accvgpr_read_b32 v186, a68
    v_mul_f32 v186, v186, v185
    v_accvgpr_write_b32 a68, v186
    v_accvgpr_read_b32 v187, a69
    v_mul_f32 v187, v187, v185
    v_accvgpr_write_b32 a69, v187
    v_accvgpr_read_b32 v188, a70
    v_mul_f32 v188, v188, v185
    v_accvgpr_write_b32 a70, v188
    v_accvgpr_read_b32 v189, a71
    v_mul_f32 v189, v189, v185
    v_accvgpr_write_b32 a71, v189
    v_accvgpr_read_b32 v186, a84
    v_mul_f32 v186, v186, v185
    v_accvgpr_write_b32 a84, v186
    v_accvgpr_read_b32 v187, a85
    v_mul_f32 v187, v187, v185
    v_accvgpr_write_b32 a85, v187
    v_accvgpr_read_b32 v188, a86
    v_mul_f32 v188, v188, v185
    v_accvgpr_write_b32 a86, v188
    v_accvgpr_read_b32 v189, a87
    v_mul_f32 v189, v189, v185
    v_accvgpr_write_b32 a87, v189
    v_accvgpr_read_b32 v186, a100
    v_mul_f32 v186, v186, v185
    v_accvgpr_write_b32 a100, v186
    v_accvgpr_read_b32 v187, a101
    v_mul_f32 v187, v187, v185
    v_accvgpr_write_b32 a101, v187
    v_accvgpr_read_b32 v188, a102
    v_mul_f32 v188, v188, v185
    v_accvgpr_write_b32 a102, v188
    v_accvgpr_read_b32 v189, a103
    v_mul_f32 v189, v189, v185
    v_accvgpr_write_b32 a103, v189
    v_accvgpr_read_b32 v186, a116
    v_mul_f32 v186, v186, v185
    v_accvgpr_write_b32 a116, v186
    v_accvgpr_read_b32 v187, a117
    v_mul_f32 v187, v187, v185
    v_accvgpr_write_b32 a117, v187
    v_accvgpr_read_b32 v188, a118
    v_mul_f32 v188, v188, v185
    v_accvgpr_write_b32 a118, v188
    v_accvgpr_read_b32 v189, a119
    v_mul_f32 v189, v189, v185
    v_accvgpr_write_b32 a119, v189
    v_max3_f32 v184, v72, v73, v74
    v_max3_f32 v184, v184, v75, v88
    v_max3_f32 v184, v184, v89, v90
    v_max_f32 v184, v184, v91
    v_mov_b32 v185, v184
    s_nop 1
    v_permlane16_swap_b32 v184, v185
    v_max_f32 v184, v184, v185
    v_mov_b32 v185, v184
    s_nop 1
    v_permlane32_swap_b32 v184, v185
    v_max_f32 v184, v184, v185
    v_add_f32 v185, 0x42c80000, v184
    v_cmp_gt_f32 vcc, v184, v226
    s_nop 1
    v_cndmask_b32 v185, 0, v185, vcc
    v_sub_f32 v72, v72, v185
    v_sub_f32 v88, v88, v185
    v_sub_f32 v73, v73, v185
    v_sub_f32 v89, v89, v185
    v_sub_f32 v74, v74, v185
    v_sub_f32 v90, v90, v185
    v_sub_f32 v75, v75, v185
    v_sub_f32 v91, v91, v185
    v_sub_f32 v104, v104, v185
    v_sub_f32 v105, v105, v185
    v_sub_f32 v106, v106, v185
    v_sub_f32 v107, v107, v185
    v_sub_f32 v120, v120, v185
    v_sub_f32 v121, v121, v185
    v_sub_f32 v122, v122, v185
    v_sub_f32 v123, v123, v185
    v_sub_f32 v168, v168, v185
    v_sub_f32 v169, v169, v185
    v_sub_f32 v170, v170, v185
    v_sub_f32 v171, v171, v185
    v_sub_f32 v185, 0, v185
    v_exp_f32 v185, v185
    s_nop 0
    v_mul_f32 v216, v216, v185
    v_accvgpr_read_b32 v186, a8
    v_mul_f32 v186, v186, v185
    v_accvgpr_write_b32 a8, v186
    v_accvgpr_read_b32 v187, a9
    v_mul_f32 v187, v187, v185
    v_accvgpr_write_b32 a9, v187
    v_accvgpr_read_b32 v188, a10
    v_mul_f32 v188, v188, v185
    v_accvgpr_write_b32 a10, v188
    v_accvgpr_read_b32 v189, a11
    v_mul_f32 v189, v189, v185
    v_accvgpr_write_b32 a11, v189
    v_accvgpr_read_b32 v186, a24
    v_mul_f32 v186, v186, v185
    v_accvgpr_write_b32 a24, v186
    v_accvgpr_read_b32 v187, a25
    v_mul_f32 v187, v187, v185
    v_accvgpr_write_b32 a25, v187
    v_accvgpr_read_b32 v188, a26
    v_mul_f32 v188, v188, v185
    v_accvgpr_write_b32 a26, v188
    v_accvgpr_read_b32 v189, a27
    v_mul_f32 v189, v189, v185
    v_accvgpr_write_b32 a27, v189
    v_accvgpr_read_b32 v186, a40
    v_mul_f32 v186, v186, v185
    v_accvgpr_write_b32 a40, v186
    v_accvgpr_read_b32 v187, a41
    v_mul_f32 v187, v187, v185
    v_accvgpr_write_b32 a41, v187
    v_accvgpr_read_b32 v188, a42
    v_mul_f32 v188, v188, v185
    v_accvgpr_write_b32 a42, v188
    v_accvgpr_read_b32 v189, a43
    v_mul_f32 v189, v189, v185
    v_accvgpr_write_b32 a43, v189
    v_accvgpr_read_b32 v186, a56
    v_mul_f32 v186, v186, v185
    v_accvgpr_write_b32 a56, v186
    v_accvgpr_read_b32 v187, a57
    v_mul_f32 v187, v187, v185
    v_accvgpr_write_b32 a57, v187
    v_accvgpr_read_b32 v188, a58
    v_mul_f32 v188, v188, v185
    v_accvgpr_write_b32 a58, v188
    v_accvgpr_read_b32 v189, a59
    v_mul_f32 v189, v189, v185
    v_accvgpr_write_b32 a59, v189
    v_accvgpr_read_b32 v186, a72
    v_mul_f32 v186, v186, v185
    v_accvgpr_write_b32 a72, v186
    v_accvgpr_read_b32 v187, a73
    v_mul_f32 v187, v187, v185
    v_accvgpr_write_b32 a73, v187
    v_accvgpr_read_b32 v188, a74
    v_mul_f32 v188, v188, v185
    v_accvgpr_write_b32 a74, v188
    v_accvgpr_read_b32 v189, a75
    v_mul_f32 v189, v189, v185
    v_accvgpr_write_b32 a75, v189
    v_accvgpr_read_b32 v186, a88
    v_mul_f32 v186, v186, v185
    v_accvgpr_write_b32 a88, v186
    v_accvgpr_read_b32 v187, a89
    v_mul_f32 v187, v187, v185
    v_accvgpr_write_b32 a89, v187
    v_accvgpr_read_b32 v188, a90
    v_mul_f32 v188, v188, v185
    v_accvgpr_write_b32 a90, v188
    v_accvgpr_read_b32 v189, a91
    v_mul_f32 v189, v189, v185
    v_accvgpr_write_b32 a91, v189
    v_accvgpr_read_b32 v186, a104
    v_mul_f32 v186, v186, v185
    v_accvgpr_write_b32 a104, v186
    v_accvgpr_read_b32 v187, a105
    v_mul_f32 v187, v187, v185
    v_accvgpr_write_b32 a105, v187
    v_accvgpr_read_b32 v188, a106
    v_mul_f32 v188, v188, v185
    v_accvgpr_write_b32 a106, v188
    v_accvgpr_read_b32 v189, a107
    v_mul_f32 v189, v189, v185
    v_accvgpr_write_b32 a107, v189
    v_accvgpr_read_b32 v186, a120
    v_mul_f32 v186, v186, v185
    v_accvgpr_write_b32 a120, v186
    v_accvgpr_read_b32 v187, a121
    v_mul_f32 v187, v187, v185
    v_accvgpr_write_b32 a121, v187
    v_accvgpr_read_b32 v188, a122
    v_mul_f32 v188, v188, v185
    v_accvgpr_write_b32 a122, v188
    v_accvgpr_read_b32 v189, a123
    v_mul_f32 v189, v189, v185
    v_accvgpr_write_b32 a123, v189
    v_max3_f32 v184, v76, v77, v78
    v_max3_f32 v184, v184, v79, v92
    v_max3_f32 v184, v184, v93, v94
    v_max_f32 v184, v184, v95
    v_mov_b32 v185, v184
    s_nop 1
    v_permlane16_swap_b32 v184, v185
    v_max_f32 v184, v184, v185
    v_mov_b32 v185, v184
    s_nop 1
    v_permlane32_swap_b32 v184, v185
    v_max_f32 v184, v184, v185
    v_add_f32 v185, 0x42c80000, v184
    v_cmp_gt_f32 vcc, v184, v226
    s_nop 1
    v_cndmask_b32 v185, 0, v185, vcc
    v_sub_f32 v76, v76, v185
    v_sub_f32 v92, v92, v185
    v_sub_f32 v77, v77, v185
    v_sub_f32 v93, v93, v185
    v_sub_f32 v78, v78, v185
    v_sub_f32 v94, v94, v185
    v_sub_f32 v79, v79, v185
    v_sub_f32 v95, v95, v185
    v_sub_f32 v108, v108, v185
    v_sub_f32 v109, v109, v185
    v_sub_f32 v110, v110, v185
    v_sub_f32 v111, v111, v185
    v_sub_f32 v124, v124, v185
    v_sub_f32 v125, v125, v185
    v_sub_f32 v126, v126, v185
    v_sub_f32 v127, v127, v185
    v_sub_f32 v172, v172, v185
    v_sub_f32 v173, v173, v185
    v_sub_f32 v174, v174, v185
    v_sub_f32 v175, v175, v185
    v_sub_f32 v185, 0, v185
    v_exp_f32 v185, v185
    s_nop 0
    v_mul_f32 v217, v217, v185
    v_accvgpr_read_b32 v186, a12
    v_mul_f32 v186, v186, v185
    v_accvgpr_write_b32 a12, v186
    v_accvgpr_read_b32 v187, a13
    v_mul_f32 v187, v187, v185
    v_accvgpr_write_b32 a13, v187
    v_accvgpr_read_b32 v188, a14
    v_mul_f32 v188, v188, v185
    v_accvgpr_write_b32 a14, v188
    v_accvgpr_read_b32 v189, a15
    v_mul_f32 v189, v189, v185
    v_accvgpr_write_b32 a15, v189
    v_accvgpr_read_b32 v186, a28
    v_mul_f32 v186, v186, v185
    v_accvgpr_write_b32 a28, v186
    v_accvgpr_read_b32 v187, a29
    v_mul_f32 v187, v187, v185
    v_accvgpr_write_b32 a29, v187
    v_accvgpr_read_b32 v188, a30
    v_mul_f32 v188, v188, v185
    v_accvgpr_write_b32 a30, v188
    v_accvgpr_read_b32 v189, a31
    v_mul_f32 v189, v189, v185
    v_accvgpr_write_b32 a31, v189
    v_accvgpr_read_b32 v186, a44
    v_mul_f32 v186, v186, v185
    v_accvgpr_write_b32 a44, v186
    v_accvgpr_read_b32 v187, a45
    v_mul_f32 v187, v187, v185
    v_accvgpr_write_b32 a45, v187
    v_accvgpr_read_b32 v188, a46
    v_mul_f32 v188, v188, v185
    v_accvgpr_write_b32 a46, v188
    v_accvgpr_read_b32 v189, a47
    v_mul_f32 v189, v189, v185
    v_accvgpr_write_b32 a47, v189
    v_accvgpr_read_b32 v186, a60
    v_mul_f32 v186, v186, v185
    v_accvgpr_write_b32 a60, v186
    v_accvgpr_read_b32 v187, a61
    v_mul_f32 v187, v187, v185
    v_accvgpr_write_b32 a61, v187
    v_accvgpr_read_b32 v188, a62
    v_mul_f32 v188, v188, v185
    v_accvgpr_write_b32 a62, v188
    v_accvgpr_read_b32 v189, a63
    v_mul_f32 v189, v189, v185
    v_accvgpr_write_b32 a63, v189
    v_accvgpr_read_b32 v186, a76
    v_mul_f32 v186, v186, v185
    v_accvgpr_write_b32 a76, v186
    v_accvgpr_read_b32 v187, a77
    v_mul_f32 v187, v187, v185
    v_accvgpr_write_b32 a77, v187
    v_accvgpr_read_b32 v188, a78
    v_mul_f32 v188, v188, v185
    v_accvgpr_write_b32 a78, v188
    v_accvgpr_read_b32 v189, a79
    v_mul_f32 v189, v189, v185
    v_accvgpr_write_b32 a79, v189
    v_accvgpr_read_b32 v186, a92
    v_mul_f32 v186, v186, v185
    v_accvgpr_write_b32 a92, v186
    v_accvgpr_read_b32 v187, a93
    v_mul_f32 v187, v187, v185
    v_accvgpr_write_b32 a93, v187
    v_accvgpr_read_b32 v188, a94
    v_mul_f32 v188, v188, v185
    v_accvgpr_write_b32 a94, v188
    v_accvgpr_read_b32 v189, a95
    v_mul_f32 v189, v189, v185
    v_accvgpr_write_b32 a95, v189
    v_accvgpr_read_b32 v186, a108
    v_mul_f32 v186, v186, v185
    v_accvgpr_write_b32 a108, v186
    v_accvgpr_read_b32 v187, a109
    v_mul_f32 v187, v187, v185
    v_accvgpr_write_b32 a109, v187
    v_accvgpr_read_b32 v188, a110
    v_mul_f32 v188, v188, v185
    v_accvgpr_write_b32 a110, v188
    v_accvgpr_read_b32 v189, a111
    v_mul_f32 v189, v189, v185
    v_accvgpr_write_b32 a111, v189
    v_accvgpr_read_b32 v186, a124
    v_mul_f32 v186, v186, v185
    v_accvgpr_write_b32 a124, v186
    v_accvgpr_read_b32 v187, a125
    v_mul_f32 v187, v187, v185
    v_accvgpr_write_b32 a125, v187
    v_accvgpr_read_b32 v188, a126
    v_mul_f32 v188, v188, v185
    v_accvgpr_write_b32 a126, v188
    v_accvgpr_read_b32 v189, a127
    v_mul_f32 v189, v189, v185
    v_accvgpr_write_b32 a127, v189
    v_exp_f32 v176, v64
    v_exp_f32 v177, v65
    s_nop 0
    v_add_f32 v218, v176, v177
    v_cvt_pk_bf16_f32 v128, v176, v177
    v_exp_f32 v178, v68
    v_exp_f32 v179, v69
    s_nop 0
    v_add_f32 v219, v178, v179
    v_cvt_pk_bf16_f32 v132, v178, v179
    v_exp_f32 v180, v72
    v_exp_f32 v181, v73
    s_nop 0
    v_add_f32 v220, v180, v181
    v_cvt_pk_bf16_f32 v136, v180, v181
    v_exp_f32 v182, v76
    v_exp_f32 v183, v77
    s_nop 0
    v_add_f32 v221, v182, v183
    v_cvt_pk_bf16_f32 v140, v182, v183
    v_exp_f32 v176, v66
    s_nop 0
    v_add_f32 v218, v218, v176
    v_exp_f32 v177, v67
    s_nop 0
    v_add_f32 v218, v218, v177
    v_cvt_pk_bf16_f32 v129, v176, v177
    v_exp_f32 v178, v70
    s_nop 0
    v_add_f32 v219, v219, v178
    v_exp_f32 v179, v71
    s_nop 0
    v_add_f32 v219, v219, v179
    v_cvt_pk_bf16_f32 v133, v178, v179
    v_exp_f32 v180, v74
    s_nop 0
    v_add_f32 v220, v220, v180
    v_exp_f32 v181, v75
    s_nop 0
    v_add_f32 v220, v220, v181
    v_cvt_pk_bf16_f32 v137, v180, v181
    v_exp_f32 v182, v78
    s_nop 0
    v_add_f32 v221, v221, v182
    v_exp_f32 v183, v79
    s_nop 0
    v_add_f32 v221, v221, v183
    v_cvt_pk_bf16_f32 v141, v182, v183
    v_exp_f32 v176, v80
    s_nop 0
    v_add_f32 v218, v218, v176
    v_exp_f32 v177, v81
    s_nop 0
    v_add_f32 v218, v218, v177
    v_cvt_pk_bf16_f32 v130, v176, v177
    v_exp_f32 v178, v84
    s_nop 0
    v_add_f32 v219, v219, v178
    v_exp_f32 v179, v85
    s_nop 0
    v_add_f32 v219, v219, v179
    v_cvt_pk_bf16_f32 v134, v178, v179
    v_exp_f32 v180, v88
    s_nop 0
    v_add_f32 v220, v220, v180
    v_exp_f32 v181, v89
    s_nop 0
    v_add_f32 v220, v220, v181
    v_cvt_pk_bf16_f32 v138, v180, v181
    v_exp_f32 v182, v92
    s_nop 0
    v_add_f32 v221, v221, v182
    v_exp_f32 v183, v93
    s_nop 0
    v_add_f32 v221, v221, v183
    v_cvt_pk_bf16_f32 v142, v182, v183
    v_exp_f32 v176, v82
    s_nop 0
    v_add_f32 v218, v218, v176
    v_exp_f32 v177, v83
    s_nop 0
    v_add_f32 v218, v218, v177
    v_cvt_pk_bf16_f32 v131, v176, v177
    v_exp_f32 v178, v86
    s_nop 0
    v_add_f32 v219, v219, v178
    v_exp_f32 v179, v87
    s_nop 0
    v_add_f32 v219, v219, v179
    v_cvt_pk_bf16_f32 v135, v178, v179
    v_exp_f32 v180, v90
    s_nop 0
    v_add_f32 v220, v220, v180
    v_exp_f32 v181, v91
    s_nop 0
    v_add_f32 v220, v220, v181
    v_cvt_pk_bf16_f32 v139, v180, v181
    v_exp_f32 v182, v94
    s_nop 0
    v_add_f32 v221, v221, v182
    v_exp_f32 v183, v95
    s_nop 0
    v_add_f32 v221, v221, v183
    v_cvt_pk_bf16_f32 v143, v182, v183
    s_nop 3
    s_branch attn_back14
attn_rare15:
    s_nop 15
    v_max3_f32 v184, v96, v97, v98
    v_max3_f32 v184, v184, v99, v112
    v_max3_f32 v184, v184, v113, v114
    v_max_f32 v184, v184, v115
    v_mov_b32 v185, v184
    s_nop 1
    v_permlane16_swap_b32 v184, v185
    v_max_f32 v184, v184, v185
    v_mov_b32 v185, v184
    s_nop 1
    v_permlane32_swap_b32 v184, v185
    v_max_f32 v184, v184, v185
    v_add_f32 v185, 0x42c80000, v184
    v_cmp_gt_f32 vcc, v184, v226
    s_nop 1
    v_cndmask_b32 v185, 0, v185, vcc
    v_sub_f32 v96, v96, v185
    v_sub_f32 v112, v112, v185
    v_sub_f32 v97, v97, v185
    v_sub_f32 v113, v113, v185
    v_sub_f32 v98, v98, v185
    v_sub_f32 v114, v114, v185
    v_sub_f32 v99, v99, v185
    v_sub_f32 v115, v115, v185
    v_sub_f32 v64, v64, v185
    v_sub_f32 v65, v65, v185
    v_sub_f32 v66, v66, v185
    v_sub_f32 v67, v67, v185
    v_sub_f32 v80, v80, v185
    v_sub_f32 v81, v81, v185
    v_sub_f32 v82, v82, v185
    v_sub_f32 v83, v83, v185
    v_sub_f32 v160, v160, v185
    v_sub_f32 v161, v161, v185
    v_sub_f32 v162, v162, v185
    v_sub_f32 v163, v163, v185
    v_sub_f32 v185, 0, v185
    v_exp_f32 v185, v185
    s_nop 0
    v_mul_f32 v214, v214, v185
    v_accvgpr_read_b32 v186, a0
    v_mul_f32 v186, v186, v185
    v_accvgpr_write_b32 a0, v186
    v_accvgpr_read_b32 v187, a1
    v_mul_f32 v187, v187, v185
    v_accvgpr_write_b32 a1, v187
    v_accvgpr_read_b32 v188, a2
    v_mul_f32 v188, v188, v185
    v_accvgpr_write_b32 a2, v188
    v_accvgpr_read_b32 v189, a3
    v_mul_f32 v189, v189, v185
    v_accvgpr_write_b32 a3, v189
    v_accvgpr_read_b32 v186, a16
    v_mul_f32 v186, v186, v185
    v_accvgpr_write_b32 a16, v186
    v_accvgpr_read_b32 v187, a17
    v_mul_f32 v187, v187, v185
    v_accvgpr_write_b32 a17, v187
    v_accvgpr_read_b32 v188, a18
    v_mul_f32 v188, v188, v185
    v_accvgpr_write_b32 a18, v188
    v_accvgpr_read_b32 v189, a19
    v_mul_f32 v189, v189, v185
    v_accvgpr_write_b32 a19, v189
    v_accvgpr_read_b32 v186, a32
    v_mul_f32 v186, v186, v185
    v_accvgpr_write_b32 a32, v186
    v_accvgpr_read_b32 v187, a33
    v_mul_f32 v187, v187, v185
    v_accvgpr_write_b32 a33, v187
    v_accvgpr_read_b32 v188, a34
    v_mul_f32 v188, v188, v185
    v_accvgpr_write_b32 a34, v188
    v_accvgpr_read_b32 v189, a35
    v_mul_f32 v189, v189, v185
    v_accvgpr_write_b32 a35, v189
    v_accvgpr_read_b32 v186, a48
    v_mul_f32 v186, v186, v185
    v_accvgpr_write_b32 a48, v186
    v_accvgpr_read_b32 v187, a49
    v_mul_f32 v187, v187, v185
    v_accvgpr_write_b32 a49, v187
    v_accvgpr_read_b32 v188, a50
    v_mul_f32 v188, v188, v185
    v_accvgpr_write_b32 a50, v188
    v_accvgpr_read_b32 v189, a51
    v_mul_f32 v189, v189, v185
    v_accvgpr_write_b32 a51, v189
    v_accvgpr_read_b32 v186, a64
    v_mul_f32 v186, v186, v185
    v_accvgpr_write_b32 a64, v186
    v_accvgpr_read_b32 v187, a65
    v_mul_f32 v187, v187, v185
    v_accvgpr_write_b32 a65, v187
    v_accvgpr_read_b32 v188, a66
    v_mul_f32 v188, v188, v185
    v_accvgpr_write_b32 a66, v188
    v_accvgpr_read_b32 v189, a67
    v_mul_f32 v189, v189, v185
    v_accvgpr_write_b32 a67, v189
    v_accvgpr_read_b32 v186, a80
    v_mul_f32 v186, v186, v185
    v_accvgpr_write_b32 a80, v186
    v_accvgpr_read_b32 v187, a81
    v_mul_f32 v187, v187, v185
    v_accvgpr_write_b32 a81, v187
    v_accvgpr_read_b32 v188, a82
    v_mul_f32 v188, v188, v185
    v_accvgpr_write_b32 a82, v188
    v_accvgpr_read_b32 v189, a83
    v_mul_f32 v189, v189, v185
    v_accvgpr_write_b32 a83, v189
    v_accvgpr_read_b32 v186, a96
    v_mul_f32 v186, v186, v185
    v_accvgpr_write_b32 a96, v186
    v_accvgpr_read_b32 v187, a97
    v_mul_f32 v187, v187, v185
    v_accvgpr_write_b32 a97, v187
    v_accvgpr_read_b32 v188, a98
    v_mul_f32 v188, v188, v185
    v_accvgpr_write_b32 a98, v188
    v_accvgpr_read_b32 v189, a99
    v_mul_f32 v189, v189, v185
    v_accvgpr_write_b32 a99, v189
    v_accvgpr_read_b32 v186, a112
    v_mul_f32 v186, v186, v185
    v_accvgpr_write_b32 a112, v186
    v_accvgpr_read_b32 v187, a113
    v_mul_f32 v187, v187, v185
    v_accvgpr_write_b32 a113, v187
    v_accvgpr_read_b32 v188, a114
    v_mul_f32 v188, v188, v185
    v_accvgpr_write_b32 a114, v188
    v_accvgpr_read_b32 v189, a115
    v_mul_f32 v189, v189, v185
    v_accvgpr_write_b32 a115, v189
    v_max3_f32 v184, v100, v101, v102
    v_max3_f32 v184, v184, v103, v116
    v_max3_f32 v184, v184, v117, v118
    v_max_f32 v184, v184, v119
    v_mov_b32 v185, v184
    s_nop 1
    v_permlane16_swap_b32 v184, v185
    v_max_f32 v184, v184, v185
    v_mov_b32 v185, v184
    s_nop 1
    v_permlane32_swap_b32 v184, v185
    v_max_f32 v184, v184, v185
    v_add_f32 v185, 0x42c80000, v184
    v_cmp_gt_f32 vcc, v184, v226
    s_nop 1
    v_cndmask_b32 v185, 0, v185, vcc
    v_sub_f32 v100, v100, v185
    v_sub_f32 v116, v116, v185
    v_sub_f32 v101, v101, v185
    v_sub_f32 v117, v117, v185
    v_sub_f32 v102, v102, v185
    v_sub_f32 v118, v118, v185
    v_sub_f32 v103, v103, v185
    v_sub_f32 v119, v119, v185
    v_sub_f32 v68, v68, v185
    v_sub_f32 v69, v69, v185
    v_sub_f32 v70, v70, v185
    v_sub_f32 v71, v71, v185
    v_sub_f32 v84, v84, v185
    v_sub_f32 v85, v85, v185
    v_sub_f32 v86, v86, v185
    v_sub_f32 v87, v87, v185
    v_sub_f32 v164, v164, v185
    v_sub_f32 v165, v165, v185
    v_sub_f32 v166, v166, v185
    v_sub_f32 v167, v167, v185
    v_sub_f32 v185, 0, v185
    v_exp_f32 v185, v185
    s_nop 0
    v_mul_f32 v215, v215, v185
    v_accvgpr_read_b32 v186, a4
    v_mul_f32 v186, v186, v185
    v_accvgpr_write_b32 a4, v186
    v_accvgpr_read_b32 v187, a5
    v_mul_f32 v187, v187, v185
    v_accvgpr_write_b32 a5, v187
    v_accvgpr_read_b32 v188, a6
    v_mul_f32 v188, v188, v185
    v_accvgpr_write_b32 a6, v188
    v_accvgpr_read_b32 v189, a7
    v_mul_f32 v189, v189, v185
    v_accvgpr_write_b32 a7, v189
    v_accvgpr_read_b32 v186, a20
    v_mul_f32 v186, v186, v185
    v_accvgpr_write_b32 a20, v186
    v_accvgpr_read_b32 v187, a21
    v_mul_f32 v187, v187, v185
    v_accvgpr_write_b32 a21, v187
    v_accvgpr_read_b32 v188, a22
    v_mul_f32 v188, v188, v185
    v_accvgpr_write_b32 a22, v188
    v_accvgpr_read_b32 v189, a23
    v_mul_f32 v189, v189, v185
    v_accvgpr_write_b32 a23, v189
    v_accvgpr_read_b32 v186, a36
    v_mul_f32 v186, v186, v185
    v_accvgpr_write_b32 a36, v186
    v_accvgpr_read_b32 v187, a37
    v_mul_f32 v187, v187, v185
    v_accvgpr_write_b32 a37, v187
    v_accvgpr_read_b32 v188, a38
    v_mul_f32 v188, v188, v185
    v_accvgpr_write_b32 a38, v188
    v_accvgpr_read_b32 v189, a39
    v_mul_f32 v189, v189, v185
    v_accvgpr_write_b32 a39, v189
    v_accvgpr_read_b32 v186, a52
    v_mul_f32 v186, v186, v185
    v_accvgpr_write_b32 a52, v186
    v_accvgpr_read_b32 v187, a53
    v_mul_f32 v187, v187, v185
    v_accvgpr_write_b32 a53, v187
    v_accvgpr_read_b32 v188, a54
    v_mul_f32 v188, v188, v185
    v_accvgpr_write_b32 a54, v188
    v_accvgpr_read_b32 v189, a55
    v_mul_f32 v189, v189, v185
    v_accvgpr_write_b32 a55, v189
    v_accvgpr_read_b32 v186, a68
    v_mul_f32 v186, v186, v185
    v_accvgpr_write_b32 a68, v186
    v_accvgpr_read_b32 v187, a69
    v_mul_f32 v187, v187, v185
    v_accvgpr_write_b32 a69, v187
    v_accvgpr_read_b32 v188, a70
    v_mul_f32 v188, v188, v185
    v_accvgpr_write_b32 a70, v188
    v_accvgpr_read_b32 v189, a71
    v_mul_f32 v189, v189, v185
    v_accvgpr_write_b32 a71, v189
    v_accvgpr_read_b32 v186, a84
    v_mul_f32 v186, v186, v185
    v_accvgpr_write_b32 a84, v186
    v_accvgpr_read_b32 v187, a85
    v_mul_f32 v187, v187, v185
    v_accvgpr_write_b32 a85, v187
    v_accvgpr_read_b32 v188, a86
    v_mul_f32 v188, v188, v185
    v_accvgpr_write_b32 a86, v188
    v_accvgpr_read_b32 v189, a87
    v_mul_f32 v189, v189, v185
    v_accvgpr_write_b32 a87, v189
    v_accvgpr_read_b32 v186, a100
    v_mul_f32 v186, v186, v185
    v_accvgpr_write_b32 a100, v186
    v_accvgpr_read_b32 v187, a101
    v_mul_f32 v187, v187, v185
    v_accvgpr_write_b32 a101, v187
    v_accvgpr_read_b32 v188, a102
    v_mul_f32 v188, v188, v185
    v_accvgpr_write_b32 a102, v188
    v_accvgpr_read_b32 v189, a103
    v_mul_f32 v189, v189, v185
    v_accvgpr_write_b32 a103, v189
    v_accvgpr_read_b32 v186, a116
    v_mul_f32 v186, v186, v185
    v_accvgpr_write_b32 a116, v186
    v_accvgpr_read_b32 v187, a117
    v_mul_f32 v187, v187, v185
    v_accvgpr_write_b32 a117, v187
    v_accvgpr_read_b32 v188, a118
    v_mul_f32 v188, v188, v185
    v_accvgpr_write_b32 a118, v188
    v_accvgpr_read_b32 v189, a119
    v_mul_f32 v189, v189, v185
    v_accvgpr_write_b32 a119, v189
    v_max3_f32 v184, v104, v105, v106
    v_max3_f32 v184, v184, v107, v120
    v_max3_f32 v184, v184, v121, v122
    v_max_f32 v184, v184, v123
    v_mov_b32 v185, v184
    s_nop 1
    v_permlane16_swap_b32 v184, v185
    v_max_f32 v184, v184, v185
    v_mov_b32 v185, v184
    s_nop 1
    v_permlane32_swap_b32 v184, v185
    v_max_f32 v184, v184, v185
    v_add_f32 v185, 0x42c80000, v184
    v_cmp_gt_f32 vcc, v184, v226
    s_nop 1
    v_cndmask_b32 v185, 0, v185, vcc
    v_sub_f32 v104, v104, v185
    v_sub_f32 v120, v120, v185
    v_sub_f32 v105, v105, v185
    v_sub_f32 v121, v121, v185
    v_sub_f32 v106, v106, v185
    v_sub_f32 v122, v122, v185
    v_sub_f32 v107, v107, v185
    v_sub_f32 v123, v123, v185
    v_sub_f32 v72, v72, v185
    v_sub_f32 v73, v73, v185
    v_sub_f32 v74, v74, v185
    v_sub_f32 v75, v75, v185
    v_sub_f32 v88, v88, v185
    v_sub_f32 v89, v89, v185
    v_sub_f32 v90, v90, v185
    v_sub_f32 v91, v91, v185
    v_sub_f32 v168, v168, v185
    v_sub_f32 v169, v169, v185
    v_sub_f32 v170, v170, v185
    v_sub_f32 v171, v171, v185
    v_sub_f32 v185, 0, v185
    v_exp_f32 v185, v185
    s_nop 0
    v_mul_f32 v216, v216, v185
    v_accvgpr_read_b32 v186, a8
    v_mul_f32 v186, v186, v185
    v_accvgpr_write_b32 a8, v186
    v_accvgpr_read_b32 v187, a9
    v_mul_f32 v187, v187, v185
    v_accvgpr_write_b32 a9, v187
    v_accvgpr_read_b32 v188, a10
    v_mul_f32 v188, v188, v185
    v_accvgpr_write_b32 a10, v188
    v_accvgpr_read_b32 v189, a11
    v_mul_f32 v189, v189, v185
    v_accvgpr_write_b32 a11, v189
    v_accvgpr_read_b32 v186, a24
    v_mul_f32 v186, v186, v185
    v_accvgpr_write_b32 a24, v186
    v_accvgpr_read_b32 v187, a25
    v_mul_f32 v187, v187, v185
    v_accvgpr_write_b32 a25, v187
    v_accvgpr_read_b32 v188, a26
    v_mul_f32 v188, v188, v185
    v_accvgpr_write_b32 a26, v188
    v_accvgpr_read_b32 v189, a27
    v_mul_f32 v189, v189, v185
    v_accvgpr_write_b32 a27, v189
    v_accvgpr_read_b32 v186, a40
    v_mul_f32 v186, v186, v185
    v_accvgpr_write_b32 a40, v186
    v_accvgpr_read_b32 v187, a41
    v_mul_f32 v187, v187, v185
    v_accvgpr_write_b32 a41, v187
    v_accvgpr_read_b32 v188, a42
    v_mul_f32 v188, v188, v185
    v_accvgpr_write_b32 a42, v188
    v_accvgpr_read_b32 v189, a43
    v_mul_f32 v189, v189, v185
    v_accvgpr_write_b32 a43, v189
    v_accvgpr_read_b32 v186, a56
    v_mul_f32 v186, v186, v185
    v_accvgpr_write_b32 a56, v186
    v_accvgpr_read_b32 v187, a57
    v_mul_f32 v187, v187, v185
    v_accvgpr_write_b32 a57, v187
    v_accvgpr_read_b32 v188, a58
    v_mul_f32 v188, v188, v185
    v_accvgpr_write_b32 a58, v188
    v_accvgpr_read_b32 v189, a59
    v_mul_f32 v189, v189, v185
    v_accvgpr_write_b32 a59, v189
    v_accvgpr_read_b32 v186, a72
    v_mul_f32 v186, v186, v185
    v_accvgpr_write_b32 a72, v186
    v_accvgpr_read_b32 v187, a73
    v_mul_f32 v187, v187, v185
    v_accvgpr_write_b32 a73, v187
    v_accvgpr_read_b32 v188, a74
    v_mul_f32 v188, v188, v185
    v_accvgpr_write_b32 a74, v188
    v_accvgpr_read_b32 v189, a75
    v_mul_f32 v189, v189, v185
    v_accvgpr_write_b32 a75, v189
    v_accvgpr_read_b32 v186, a88
    v_mul_f32 v186, v186, v185
    v_accvgpr_write_b32 a88, v186
    v_accvgpr_read_b32 v187, a89
    v_mul_f32 v187, v187, v185
    v_accvgpr_write_b32 a89, v187
    v_accvgpr_read_b32 v188, a90
    v_mul_f32 v188, v188, v185
    v_accvgpr_write_b32 a90, v188
    v_accvgpr_read_b32 v189, a91
    v_mul_f32 v189, v189, v185
    v_accvgpr_write_b32 a91, v189
    v_accvgpr_read_b32 v186, a104
    v_mul_f32 v186, v186, v185
    v_accvgpr_write_b32 a104, v186
    v_accvgpr_read_b32 v187, a105
    v_mul_f32 v187, v187, v185
    v_accvgpr_write_b32 a105, v187
    v_accvgpr_read_b32 v188, a106
    v_mul_f32 v188, v188, v185
    v_accvgpr_write_b32 a106, v188
    v_accvgpr_read_b32 v189, a107
    v_mul_f32 v189, v189, v185
    v_accvgpr_write_b32 a107, v189
    v_accvgpr_read_b32 v186, a120
    v_mul_f32 v186, v186, v185
    v_accvgpr_write_b32 a120, v186
    v_accvgpr_read_b32 v187, a121
    v_mul_f32 v187, v187, v185
    v_accvgpr_write_b32 a121, v187
    v_accvgpr_read_b32 v188, a122
    v_mul_f32 v188, v188, v185
    v_accvgpr_write_b32 a122, v188
    v_accvgpr_read_b32 v189, a123
    v_mul_f32 v189, v189, v185
    v_accvgpr_write_b32 a123, v189
    v_max3_f32 v184, v108, v109, v110
    v_max3_f32 v184, v184, v111, v124
    v_max3_f32 v184, v184, v125, v126
    v_max_f32 v184, v184, v127
    v_mov_b32 v185, v184
    s_nop 1
    v_permlane16_swap_b32 v184, v185
    v_max_f32 v184, v184, v185
    v_mov_b32 v185, v184
    s_nop 1
    v_permlane32_swap_b32 v184, v185
    v_max_f32 v184, v184, v185
    v_add_f32 v185, 0x42c80000, v184
    v_cmp_gt_f32 vcc, v184, v226
    s_nop 1
    v_cndmask_b32 v185, 0, v185, vcc
    v_sub_f32 v108, v108, v185
    v_sub_f32 v124, v124, v185
    v_sub_f32 v109, v109, v185
    v_sub_f32 v125, v125, v185
    v_sub_f32 v110, v110, v185
    v_sub_f32 v126, v126, v185
    v_sub_f32 v111, v111, v185
    v_sub_f32 v127, v127, v185
    v_sub_f32 v76, v76, v185
    v_sub_f32 v77, v77, v185
    v_sub_f32 v78, v78, v185
    v_sub_f32 v79, v79, v185
    v_sub_f32 v92, v92, v185
    v_sub_f32 v93, v93, v185
    v_sub_f32 v94, v94, v185
    v_sub_f32 v95, v95, v185
    v_sub_f32 v172, v172, v185
    v_sub_f32 v173, v173, v185
    v_sub_f32 v174, v174, v185
    v_sub_f32 v175, v175, v185
    v_sub_f32 v185, 0, v185
    v_exp_f32 v185, v185
    s_nop 0
    v_mul_f32 v217, v217, v185
    v_accvgpr_read_b32 v186, a12
    v_mul_f32 v186, v186, v185
    v_accvgpr_write_b32 a12, v186
    v_accvgpr_read_b32 v187, a13
    v_mul_f32 v187, v187, v185
    v_accvgpr_write_b32 a13, v187
    v_accvgpr_read_b32 v188, a14
    v_mul_f32 v188, v188, v185
    v_accvgpr_write_b32 a14, v188
    v_accvgpr_read_b32 v189, a15
    v_mul_f32 v189, v189, v185
    v_accvgpr_write_b32 a15, v189
    v_accvgpr_read_b32 v186, a28
    v_mul_f32 v186, v186, v185
    v_accvgpr_write_b32 a28, v186
    v_accvgpr_read_b32 v187, a29
    v_mul_f32 v187, v187, v185
    v_accvgpr_write_b32 a29, v187
    v_accvgpr_read_b32 v188, a30
    v_mul_f32 v188, v188, v185
    v_accvgpr_write_b32 a30, v188
    v_accvgpr_read_b32 v189, a31
    v_mul_f32 v189, v189, v185
    v_accvgpr_write_b32 a31, v189
    v_accvgpr_read_b32 v186, a44
    v_mul_f32 v186, v186, v185
    v_accvgpr_write_b32 a44, v186
    v_accvgpr_read_b32 v187, a45
    v_mul_f32 v187, v187, v185
    v_accvgpr_write_b32 a45, v187
    v_accvgpr_read_b32 v188, a46
    v_mul_f32 v188, v188, v185
    v_accvgpr_write_b32 a46, v188
    v_accvgpr_read_b32 v189, a47
    v_mul_f32 v189, v189, v185
    v_accvgpr_write_b32 a47, v189
    v_accvgpr_read_b32 v186, a60
    v_mul_f32 v186, v186, v185
    v_accvgpr_write_b32 a60, v186
    v_accvgpr_read_b32 v187, a61
    v_mul_f32 v187, v187, v185
    v_accvgpr_write_b32 a61, v187
    v_accvgpr_read_b32 v188, a62
    v_mul_f32 v188, v188, v185
    v_accvgpr_write_b32 a62, v188
    v_accvgpr_read_b32 v189, a63
    v_mul_f32 v189, v189, v185
    v_accvgpr_write_b32 a63, v189
    v_accvgpr_read_b32 v186, a76
    v_mul_f32 v186, v186, v185
    v_accvgpr_write_b32 a76, v186
    v_accvgpr_read_b32 v187, a77
    v_mul_f32 v187, v187, v185
    v_accvgpr_write_b32 a77, v187
    v_accvgpr_read_b32 v188, a78
    v_mul_f32 v188, v188, v185
    v_accvgpr_write_b32 a78, v188
    v_accvgpr_read_b32 v189, a79
    v_mul_f32 v189, v189, v185
    v_accvgpr_write_b32 a79, v189
    v_accvgpr_read_b32 v186, a92
    v_mul_f32 v186, v186, v185
    v_accvgpr_write_b32 a92, v186
    v_accvgpr_read_b32 v187, a93
    v_mul_f32 v187, v187, v185
    v_accvgpr_write_b32 a93, v187
    v_accvgpr_read_b32 v188, a94
    v_mul_f32 v188, v188, v185
    v_accvgpr_write_b32 a94, v188
    v_accvgpr_read_b32 v189, a95
    v_mul_f32 v189, v189, v185
    v_accvgpr_write_b32 a95, v189
    v_accvgpr_read_b32 v186, a108
    v_mul_f32 v186, v186, v185
    v_accvgpr_write_b32 a108, v186
    v_accvgpr_read_b32 v187, a109
    v_mul_f32 v187, v187, v185
    v_accvgpr_write_b32 a109, v187
    v_accvgpr_read_b32 v188, a110
    v_mul_f32 v188, v188, v185
    v_accvgpr_write_b32 a110, v188
    v_accvgpr_read_b32 v189, a111
    v_mul_f32 v189, v189, v185
    v_accvgpr_write_b32 a111, v189
    v_accvgpr_read_b32 v186, a124
    v_mul_f32 v186, v186, v185
    v_accvgpr_write_b32 a124, v186
    v_accvgpr_read_b32 v187, a125
    v_mul_f32 v187, v187, v185
    v_accvgpr_write_b32 a125, v187
    v_accvgpr_read_b32 v188, a126
    v_mul_f32 v188, v188, v185
    v_accvgpr_write_b32 a126, v188
    v_accvgpr_read_b32 v189, a127
    v_mul_f32 v189, v189, v185
    v_accvgpr_write_b32 a127, v189
    v_exp_f32 v176, v96
    v_exp_f32 v177, v97
    s_nop 0
    v_add_f32 v218, v176, v177
    v_cvt_pk_bf16_f32 v144, v176, v177
    v_exp_f32 v178, v100
    v_exp_f32 v179, v101
    s_nop 0
    v_add_f32 v219, v178, v179
    v_cvt_pk_bf16_f32 v148, v178, v179
    v_exp_f32 v180, v104
    v_exp_f32 v181, v105
    s_nop 0
    v_add_f32 v220, v180, v181
    v_cvt_pk_bf16_f32 v152, v180, v181
    v_exp_f32 v182, v108
    v_exp_f32 v183, v109
    s_nop 0
    v_add_f32 v221, v182, v183
    v_cvt_pk_bf16_f32 v156, v182, v183
    v_exp_f32 v176, v98
    s_nop 0
    v_add_f32 v218, v218, v176
    v_exp_f32 v177, v99
    s_nop 0
    v_add_f32 v218, v218, v177
    v_cvt_pk_bf16_f32 v145, v176, v177
    v_exp_f32 v178, v102
    s_nop 0
    v_add_f32 v219, v219, v178
    v_exp_f32 v179, v103
    s_nop 0
    v_add_f32 v219, v219, v179
    v_cvt_pk_bf16_f32 v149, v178, v179
    v_exp_f32 v180, v106
    s_nop 0
    v_add_f32 v220, v220, v180
    v_exp_f32 v181, v107
    s_nop 0
    v_add_f32 v220, v220, v181
    v_cvt_pk_bf16_f32 v153, v180, v181
    v_exp_f32 v182, v110
    s_nop 0
    v_add_f32 v221, v221, v182
    v_exp_f32 v183, v111
    s_nop 0
    v_add_f32 v221, v221, v183
    v_cvt_pk_bf16_f32 v157, v182, v183
    v_exp_f32 v176, v112
    s_nop 0
    v_add_f32 v218, v218, v176
    v_exp_f32 v177, v113
    s_nop 0
    v_add_f32 v218, v218, v177
    v_cvt_pk_bf16_f32 v146, v176, v177
    v_exp_f32 v178, v116
    s_nop 0
    v_add_f32 v219, v219, v178
    v_exp_f32 v179, v117
    s_nop 0
    v_add_f32 v219, v219, v179
    v_cvt_pk_bf16_f32 v150, v178, v179
    v_exp_f32 v180, v120
    s_nop 0
    v_add_f32 v220, v220, v180
    v_exp_f32 v181, v121
    s_nop 0
    v_add_f32 v220, v220, v181
    v_cvt_pk_bf16_f32 v154, v180, v181
    v_exp_f32 v182, v124
    s_nop 0
    v_add_f32 v221, v221, v182
    v_exp_f32 v183, v125
    s_nop 0
    v_add_f32 v221, v221, v183
    v_cvt_pk_bf16_f32 v158, v182, v183
    v_exp_f32 v176, v114
    s_nop 0
    v_add_f32 v218, v218, v176
    v_exp_f32 v177, v115
    s_nop 0
    v_add_f32 v218, v218, v177
    v_cvt_pk_bf16_f32 v147, v176, v177
    v_exp_f32 v178, v118
    s_nop 0
    v_add_f32 v219, v219, v178
    v_exp_f32 v179, v119
    s_nop 0
    v_add_f32 v219, v219, v179
    v_cvt_pk_bf16_f32 v151, v178, v179
    v_exp_f32 v180, v122
    s_nop 0
    v_add_f32 v220, v220, v180
    v_exp_f32 v181, v123
    s_nop 0
    v_add_f32 v220, v220, v181
    v_cvt_pk_bf16_f32 v155, v180, v181
    v_exp_f32 v182, v126
    s_nop 0
    v_add_f32 v221, v221, v182
    v_exp_f32 v183, v127
    s_nop 0
    v_add_f32 v221, v221, v183
    v_cvt_pk_bf16_f32 v159, v182, v183
    s_nop 3
    s_branch attn_back16
.section .rodata,"a"
.p2align 6
.amdhsa_kernel k0_kernel
  .amdhsa_next_free_vgpr 56
  .amdhsa_next_free_sgpr 32
  .amdhsa_accum_offset 56
  .amdhsa_group_segment_fixed_size 0
  .amdhsa_kernarg_size 112
  .amdhsa_user_sgpr_count 2
  .amdhsa_user_sgpr_kernarg_segment_ptr 1
  .amdhsa_system_sgpr_workgroup_id_x 1
  .amdhsa_float_denorm_mode_32 3
.end_amdhsa_kernel
.p2align 6
.amdhsa_kernel attn_kernel
  .amdhsa_next_free_vgpr 512
  .amdhsa_next_free_sgpr 100
  .amdhsa_accum_offset 256
  .amdhsa_group_segment_fixed_size 0
  .amdhsa_kernarg_size 112
  .amdhsa_user_sgpr_count 2
  .amdhsa_user_sgpr_kernarg_segment_ptr 1
  .amdhsa_system_sgpr_workgroup_id_x 1
  .amdhsa_float_denorm_mode_32 3
.end_amdhsa_kernel
```
